```python
import torch

def _softmax(x, axis=-1):
    return torch.softmax(x, dim=axis)
def _gelu(x):
    return torch.nn.functional.gelu(x, approximate="tanh")
def _silu(x):
    return torch.nn.functional.silu(x)
def _sigmoid(x):
    return torch.sigmoid(x)
def _layernorm(x, axis=-1, eps=1e-5):
    m = x.mean(dim=axis, keepdim=True)
    v = x.var(dim=axis, keepdim=True, unbiased=False)
    return (x - m) / torch.sqrt(v + eps)
def _scatter_add(tgt, idx, src, axis=0):
    return tgt.clone().index_add_(axis, idx, src)
def _segment_sum(src, seg, n):
    out = torch.zeros((n,) + src.shape[1:], dtype=src.dtype)
    return out.index_add_(0, seg, src)
def _pad(x, pw):
    flat = tuple(v for pair in reversed(pw) for v in pair)
    return torch.nn.functional.pad(x, flat)

kernel_name = 'concat_heads__mha_block_cached__gqa_block_cached__near_ridge'

def setup_inputs():

    _w = (lambda a: (lambda t: t.to(torch.bfloat16) if t.is_floating_point() else t)(torch.as_tensor(a)))
    def _A_setup():
        B, Sq, D = 8, 240, 512
        H, Sk, Dh = 32, 1024, 128
        return {
            "x": _w((lambda *s: torch.randn(*s, dtype=torch.bfloat16) * 0.8)(B, Sq, D)),
            "k_cache": _w((lambda *s: torch.randn(*s, dtype=torch.bfloat16) * 0.8)(B, H, Sk, Dh)),
            "v_cache": _w((lambda *s: torch.randn(*s, dtype=torch.bfloat16) * 0.05)(B, H, Sk, Dh)),
            "wq": _w((lambda *s: torch.randn(*s, dtype=torch.bfloat16) * 0.8)(D, H * Dh) * (D ** -0.5)),
            "wo": _w((lambda *s: torch.randn(*s, dtype=torch.bfloat16) * 0.05)(H * Dh, D) * ((H * Dh) ** -0.5)),
        }
    _A_in = _A_setup()

    def _B_setup():
        B, Sq, D = 8, 240, 512
        Hq, Hkv, Sk, Dh = 32, 32, 1024, 128
        assert Hq % Hkv == 0, (Hq, Hkv)
        return {
            "x": _w((lambda *s: torch.randn(*s, dtype=torch.bfloat16) * 0.8)(B, Sq, D)),
            "k_cache": _w((lambda *s: torch.randn(*s, dtype=torch.bfloat16) * 0.8)(B, Hkv, Sk, Dh)),
            "v_cache": _w((lambda *s: torch.randn(*s, dtype=torch.bfloat16) * 0.05)(B, Hkv, Sk, Dh)),
            "wq": _w((lambda *s: torch.randn(*s, dtype=torch.bfloat16) * 0.8)(D, Hq * Dh) * (D ** -0.5)),
            "wo": _w((lambda *s: torch.randn(*s, dtype=torch.bfloat16) * 0.05)(Hq * Dh, D) * ((Hq * Dh) ** -0.5)),
        }
    _B_in = _B_setup()

    return {
        "A_x": _A_in["x"],
        "A_k_cache": _A_in["k_cache"],
        "A_v_cache": _A_in["v_cache"],
        "A_wq": _A_in["wq"],
        "A_wo": _A_in["wo"],
        "B_x": _B_in["x"],
        "B_k_cache": _B_in["k_cache"],
        "B_v_cache": _B_in["v_cache"],
        "B_wq": _B_in["wq"],
        "B_wo": _B_in["wo"],
    }

def reference(A_x, A_k_cache, A_v_cache, A_wq, A_wo, B_x, B_k_cache, B_v_cache, B_wq, B_wo):
    def _A_ref(x, k_cache, v_cache, wq, wo):
        B, Sq, D = x.shape
        H, Dh = 32, 128
        q = (lambda x, *d: x.permute(*d))((x @ wq).reshape(B, Sq, H, Dh), 0, 2, 1, 3)
        scores = torch.einsum("bhqd,bhkd->bhqk", q, k_cache) * (Dh ** -0.5)
        p = _softmax(scores, axis=-1)
        o = torch.einsum("bhqk,bhkd->bhqd", p, v_cache)
        return (lambda x, *d: x.permute(*d))(o, 0, 2, 1, 3).reshape(B, Sq, H * Dh) @ wo

    def _B_ref(x, k_cache, v_cache, wq, wo):
        B, Sq, D = x.shape
        Hq, Dh = 32, 128
        Hkv = k_cache.shape[1]
        rep = Hq // Hkv
        q = (lambda x, *d: x.permute(*d))((x @ wq).reshape(B, Sq, Hq, Dh), 0, 2, 1, 3)
        k = (lambda x, n, axis: torch.repeat_interleave(x, n, dim=axis))(k_cache, rep, axis=1)
        v = (lambda x, n, axis: torch.repeat_interleave(x, n, dim=axis))(v_cache, rep, axis=1)
        scores = torch.einsum("bhqd,bhkd->bhqk", q, k) * (Dh ** -0.5)
        p = _softmax(scores, axis=-1)
        o = torch.einsum("bhqk,bhkd->bhqd", p, v)
        return (lambda x, *d: x.permute(*d))(o, 0, 2, 1, 3).reshape(B, Sq, Hq * Dh) @ wo

    a = _A_ref(A_x, A_k_cache, A_v_cache, A_wq, A_wo)
    b = _B_ref(B_x, B_k_cache, B_v_cache, B_wq, B_wo)
    return torch.concatenate([a, b], axis=-1)
```

```asm
; @launch grid=(256,1,1) block=(256,1,1) lds=163840
.amdgcn_target "amdgcn-amd-amdhsa--gfx950"
.text
.globl concat_heads__mha_block_cached__gqa_block_cached__near_ridge_kernel
.p2align 8
.type concat_heads__mha_block_cached__gqa_block_cached__near_ridge_kernel,@function
concat_heads__mha_block_cached__gqa_block_cached__near_ridge_kernel:
    s_cmp_ge_u32 s2, 256
    s_cbranch_scc1 L_end
    v_lshrrev_b32 v1, 6, v0
    v_and_b32 v0, 63, v0
    v_readfirstlane_b32 s24, v1
    s_mov_b32 s38, 0
    s_mov_b32 s37, 0
L_start:
    s_bfe_u32 s40, s2, 0x10002
    s_mul_i32 s3, s40, 40
    s_add_u32 s44, s0, s3
    s_addc_u32 s45, s1, 0
    s_load_dwordx8 s[56:63], s[44:45], 0
    s_load_dwordx2 s[64:65], s[0:1], 96
    s_load_dwordx2 s[34:35], s[44:45], 32
    s_load_dwordx2 s[82:83], s[0:1], 80
    s_load_dwordx2 s[84:85], s[0:1], 88
    s_and_b32 s41, s2, 3
    s_lshl_b32 s41, s41, 2
    s_bfe_u32 s42, s2, 0x20003
    s_add_u32 s41, s41, s42
    s_lshr_b32 s42, s2, 5
    v_lshrrev_b32 v1, 3, v0
    v_lshrrev_b32 v2, 4, v0
    v_xor_b32 v2, v2, v0
    v_and_b32 v2, 7, v2
    v_lshlrev_b32 v2, 4, v2
    v_lshl_add_u32 v4, v1, 10, v2
    s_lshl_b32 s3, s24, 16
    v_add_u32 v17, s3, v4
    v_xor_b32 v6, 64, v17
    v_add_u32 v18, 7168, v6
    v_add_u32 v19, 14336, v17
    v_add_u32 v20, 21504, v6
    s_lshl_b32 s31, s24, 13
    v_lshrrev_b32 v4, 5, v0
    v_and_b32 v5, 31, v0
    s_and_b32 s3, s24, 1
    s_lshl_b32 s3, s3, 3
    v_lshl_or_b32 v6, v4, 1, s3
    v_xor_b32 v5, v5, v6
    v_lshlrev_b32 v5, 4, v5
    v_lshl_add_u32 v5, v4, 13, v5
    s_lshl_b32 s3, s24, 16
    v_add_u32 v21, s3, v5
    v_xor_b32 v6, 64, v21
    v_add_u32 v22, 15360, v6
    v_add_u32 v23, 30720, v21
    v_add_u32 v24, 46080, v6
    s_lshl_b32 s29, s24, 11
    s_lshl_b32 s30, s24, 12
    s_mov_b32 s27, 0
    s_lshl_b32 s28, s41, 9
    s_xor_b32 s3, s42, s41
    s_and_b32 s3, s3, 3
    s_lshl_b32 s54, s3, 7
    s_lshl_b32 s55, s3, 19
    s_mov_b32 s52, s54
    s_xor_b32 s53, s28, s55
    s_mul_i32 s3, s42, 245760
    s_waitcnt lgkmcnt(0)
    s_add_u32 s12, s56, s3
    s_addc_u32 s13, s57, 0
    s_mov_b32 s14, 245760
    s_mov_b32 s15, 0x20000
    s_mov_b32 s16, s62
    s_mov_b32 s17, s63
    s_mov_b32 s18, 0x400000
    s_mov_b32 s19, 0x20000
    s_add_u32 m0, s30, 147456
    s_nop 0
    buffer_load_dwordx4 v21, s[16:19], s53 offen offset:0  lds
    buffer_load_dwordx4 v22, s[16:19], s53 offen offset:1024  lds
    buffer_load_dwordx4 v23, s[16:19], s53 offen offset:2048  lds
    buffer_load_dwordx4 v24, s[16:19], s53 offen offset:3072  lds
    s_add_u32 s28, s28, 262144
    s_xor_b32 s53, s28, s55
    s_add_u32 m0, s31, 0
    s_nop 0
    buffer_load_dwordx4 v17, s[12:15], s52 offen offset:0  lds
    s_add_u32 s32, s52, 32768
    buffer_load_dwordx4 v18, s[12:15], s52 offen offset:1024  lds
    buffer_load_dwordx4 v19, s[12:15], s52 offen offset:2048  lds
    buffer_load_dwordx4 v20, s[12:15], s52 offen offset:3072  lds
    s_add_u32 m0, s31, 4096
    s_nop 0
    buffer_load_dwordx4 v17, s[12:15], s32 offen offset:0  lds
    s_add_u32 s27, s27, 128
    s_xor_b32 s52, s27, s54
    buffer_load_dwordx4 v18, s[12:15], s32 offen offset:1024  lds
    buffer_load_dwordx4 v19, s[12:15], s32 offen offset:2048  lds
    buffer_load_dwordx4 v20, s[12:15], s32 offen offset:3072  lds
    s_lshl_b32 s3, s42, 4
    s_add_u32 s3, s3, s41
    s_lshl_b32 s3, s3, 19
    s_add_u32 s4, s58, s3
    s_addc_u32 s5, s59, 0
    s_mov_b32 s6, 0x80000
    s_mov_b32 s7, 0x20000
    s_add_u32 s8, s60, s3
    s_addc_u32 s9, s61, 0
    s_mov_b32 s10, 0x80000
    s_mov_b32 s11, 0x20000
    s_mul_i32 s3, s40, 15728640
    s_add_u32 s20, s64, s3
    s_addc_u32 s21, s65, 0
    s_and_b32 s3, s37, 1
    s_cselect_b32 s22, 0, 15728640
    s_mov_b32 s23, 0x20000
    s_mov_b32 s92, s34
    s_mov_b32 s93, s35
    s_mov_b32 s94, 0x400000
    s_mov_b32 s95, 0x20000
    s_add_u32 s96, s64, 33554432
    s_addc_u32 s97, s65, 0
    s_mov_b32 s98, 0x1000000
    s_mov_b32 s99, 0x20000
    s_mul_i32 s3, s42, 15
    s_lshl_b32 s43, s24, 2
    s_add_u32 s3, s3, s43
    s_lshl_b32 s3, s3, 12
    s_mul_i32 s43, s41, 983040
    s_add_u32 s39, s3, s43
    s_mov_b32 s25, s29
    s_mov_b32 s26, s29
    s_lshr_b32 s3, s2, 3
    s_lshl_b32 s49, s2, 2
    s_xor_b32 s3, s3, s49
    s_and_b32 s3, s3, 31
    s_lshl_b32 s49, s3, 13
    s_xor_b32 s50, s25, s49
    s_xor_b32 s51, s26, s49
    s_mov_b32 s46, 0x3e0293ee
    s_mov_b32 s47, 0
    s_mov_b32 s33, 0
    s_mov_b32 s48, 0x4e800000
    s_mov_b32 s36, 0
    s_and_b32 s3, s2, 3
    s_lshr_b32 s43, s2, 3
    s_lshl_b32 s3, s3, 5
    s_add_u32 s3, s3, s43
    s_lshl_b32 s3, s3, 15
    s_lshl_b32 s43, s24, 13
    s_add_u32 s3, s3, s43
    v_lshl_add_u32 v30, v0, 7, s3
    v_lshrrev_b32 v1, 3, v0
    v_lshl_add_u32 v30, v1, 23, v30
    s_lshl_b32 s3, s40, 3
    s_add_u32 s100, s3, s42
    s_lshl_b32 s100, s100, 13
    s_add_u32 s100, s100, 2097152
    s_cmp_eq_u32 s24, 0
    s_cselect_b32 s100, s100, 1073741824
    s_and_b32 s43, s37, 4
    s_or_b32 s43, s43, s41
    s_cselect_b32 s90, 1073741824, s100
    s_or_b32 s37, s37, 4
    s_and_b32 s41, s2, 2
    s_lshl_b32 s41, s41, 1
    s_lshr_b32 s43, s2, 6
    s_add_u32 s41, s41, s43
    s_add_u32 s35, s3, s41
    s_lshl_b32 s35, s35, 13
    s_add_u32 s35, s35, 2097152
    s_cmp_eq_u32 s24, 0
    s_cselect_b32 s35, s35, 1073741824
    s_cselect_b32 s91, 16, 0
    s_bfe_u32 s43, s2, 0x20003
    s_lshl_b32 s43, s43, 1
    s_and_b32 s42, s2, 1
    s_add_u32 s43, s43, s42
    s_bfe_u32 s42, s2, 0x10005
    s_mul_i32 s41, s41, 15
    s_lshl_b32 s3, s42, 3
    s_add_u32 s41, s41, s3
    s_lshl_b32 s3, s24, 1
    s_add_u32 s41, s41, s3
    s_lshl_b32 s56, s41, 12
    s_lshl_b32 s57, s24, 15
    s_lshl_b32 s3, s43, 7
    s_add_u32 s57, s57, s3
    s_lshl_b32 s63, s41, 15
    s_add_u32 s63, s63, s3
    s_lshl_b32 s3, s40, 10
    s_add_u32 s63, s63, s3
    s_add_u32 s34, s63, 32768
    s_lshr_b32 s3, s2, 6
    s_mul_i32 s3, s3, 2
    s_add_u32 s3, s3, s43
    s_and_b32 s61, s3, 3
    s_lshl_b32 s3, s42, 2
    s_add_u32 s3, s3, s24
    s_cmp_eq_u32 s3, 7
    s_cselect_b32 s34, 0x40000000, s34
    s_mov_b32 s101, 4096
    s_cselect_b32 s101, 0x40000000, s101
    v_and_b32 v1, 15, v0
    v_lshrrev_b32 v2, 4, v0
    s_lshl_b32 s3, s24, 3
    s_and_b32 s3, s3, 15
    v_add_u32 v3, s3, v2
    v_xor_b32 v4, v1, v3
    v_lshlrev_b32 v4, 4, v4
    v_lshl_add_u32 v25, v2, 8, v4
    v_xor_b32 v26, 64, v25
    v_lshlrev_b32 v3, 1, v2
    v_xor_b32 v4, v1, v3
    v_lshlrev_b32 v4, 4, v4
    v_lshl_add_u32 v27, v2, 8, v4
    v_xor_b32 v28, 0x80, v27
    v_lshrrev_b32 v3, 1, v1
    v_xor_b32 v4, v3, v2
    v_lshlrev_b32 v4, 4, v4
    v_lshl_add_u32 v4, v1, 7, v4
    v_add_u32 v16, s31, v4
    v_bfe_u32 v3, v0, 2, 2
    v_and_b32 v4, 3, v0
    v_and_b32 v5, 1, v2
    v_lshl_or_b32 v5, v5, 2, v3
    v_lshl_add_u32 v6, v2, 3, v3
    v_lshlrev_b32 v6, 9, v6
    v_lshl_add_u32 v6, v5, 5, v6
    v_lshl_add_u32 v6, v4, 3, v6
    v_add_u32 v8, 147456, v6
    v_xor_b32 v9, 32, v8
    v_xor_b32 v10, 64, v8
    v_xor_b32 v11, 96, v8
    v_xor_b32 v12, 128, v8
    v_xor_b32 v13, 160, v8
    v_xor_b32 v14, 192, v8
    v_xor_b32 v15, 224, v8
    s_getpc_b64 s[80:81]
L_pc:
    s_sub_u32 s80, s80, L_pc-concat_heads__mha_block_cached__gqa_block_cached__near_ridge_kernel
    s_subb_u32 s81, s81, 0
    s_lshr_b32 s3, s2, 3
    s_lshl_b32 s3, s3, 2
    s_add_u32 s3, s3, s24
    s_mul_i32 s3, s3, 768
    v_min_u32 v29, 5, v0
    v_lshl_add_u32 v29, v29, 7, s3
    v_min_u32 v29, L_codeend-concat_heads__mha_block_cached__gqa_block_cached__near_ridge_kernel-4, v29
    global_load_dword v31, v29, s[80:81]
    v_lshrrev_b32 v5, 5, v0
    v_lshl_add_u32 v4, v0, 8, s90
    v_lshl_add_u32 v4, v5, 24, v4
    v_mov_b32 v5, 0
    buffer_store_dword v5, v4, s[96:99], 0 offen sc1
    v_mov_b32 v32, 0
    v_mov_b32 v33, 0
    v_mov_b32 v34, 0
    v_mov_b32 v35, 0
    v_mov_b32 v36, 0
    v_mov_b32 v37, 0
    v_mov_b32 v38, 0
    v_mov_b32 v39, 0
    v_mov_b32 v40, 0
    v_mov_b32 v41, 0
    v_mov_b32 v42, 0
    v_mov_b32 v43, 0
    v_mov_b32 v44, 0
    v_mov_b32 v45, 0
    v_mov_b32 v46, 0
    v_mov_b32 v47, 0
    v_mov_b32 v48, 0
    v_mov_b32 v49, 0
    v_mov_b32 v50, 0
    v_mov_b32 v51, 0
    v_mov_b32 v52, 0
    v_mov_b32 v53, 0
    v_mov_b32 v54, 0
    v_mov_b32 v55, 0
    v_mov_b32 v56, 0
    v_mov_b32 v57, 0
    v_mov_b32 v58, 0
    v_mov_b32 v59, 0
    v_mov_b32 v60, 0
    v_mov_b32 v61, 0
    v_mov_b32 v62, 0
    v_mov_b32 v63, 0
    v_mov_b32 v64, 0
    v_mov_b32 v65, 0
    v_mov_b32 v66, 0
    v_mov_b32 v67, 0
    v_mov_b32 v68, 0
    v_mov_b32 v69, 0
    v_mov_b32 v70, 0
    v_mov_b32 v71, 0
    v_mov_b32 v72, 0
    v_mov_b32 v73, 0
    v_mov_b32 v74, 0
    v_mov_b32 v75, 0
    v_mov_b32 v76, 0
    v_mov_b32 v77, 0
    v_mov_b32 v78, 0
    v_mov_b32 v79, 0
    v_mov_b32 v80, 0
    v_mov_b32 v81, 0
    v_mov_b32 v82, 0
    v_mov_b32 v83, 0
    v_mov_b32 v84, 0
    v_mov_b32 v85, 0
    v_mov_b32 v86, 0
    v_mov_b32 v87, 0
    v_mov_b32 v88, 0
    v_mov_b32 v89, 0
    v_mov_b32 v90, 0
    v_mov_b32 v91, 0
    v_mov_b32 v92, 0
    v_mov_b32 v93, 0
    v_mov_b32 v94, 0
    v_mov_b32 v95, 0
    v_mov_b32 v96, 0
    v_mov_b32 v97, 0
    v_mov_b32 v98, 0
    v_mov_b32 v99, 0
    v_mov_b32 v100, 0
    v_mov_b32 v101, 0
    v_mov_b32 v102, 0
    v_mov_b32 v103, 0
    v_mov_b32 v104, 0
    v_mov_b32 v105, 0
    v_mov_b32 v106, 0
    v_mov_b32 v107, 0
    v_mov_b32 v108, 0
    v_mov_b32 v109, 0
    v_mov_b32 v110, 0
    v_mov_b32 v111, 0
    v_mov_b32 v112, 0
    v_mov_b32 v113, 0
    v_mov_b32 v114, 0
    v_mov_b32 v115, 0
    v_mov_b32 v116, 0
    v_mov_b32 v117, 0
    v_mov_b32 v118, 0
    v_mov_b32 v119, 0
    v_mov_b32 v120, 0
    v_mov_b32 v121, 0
    v_mov_b32 v122, 0
    v_mov_b32 v123, 0
    v_mov_b32 v124, 0
    v_mov_b32 v125, 0
    v_mov_b32 v126, 0
    v_mov_b32 v127, 0
    v_mov_b32 v128, 0
    v_mov_b32 v129, 0
    v_mov_b32 v130, 0
    v_mov_b32 v131, 0
    v_mov_b32 v132, 0
    v_mov_b32 v133, 0
    v_mov_b32 v134, 0
    v_mov_b32 v135, 0
    v_mov_b32 v136, 0
    v_mov_b32 v137, 0
    v_mov_b32 v138, 0
    v_mov_b32 v139, 0
    v_mov_b32 v140, 0
    v_mov_b32 v141, 0
    v_mov_b32 v142, 0
    v_mov_b32 v143, 0
    v_mov_b32 v144, 0
    v_mov_b32 v145, 0
    v_mov_b32 v146, 0
    v_mov_b32 v147, 0
    v_mov_b32 v148, 0
    v_mov_b32 v149, 0
    v_mov_b32 v150, 0
    v_mov_b32 v151, 0
    v_mov_b32 v152, 0
    v_mov_b32 v153, 0
    v_mov_b32 v154, 0
    v_mov_b32 v155, 0
    v_mov_b32 v156, 0
    v_mov_b32 v157, 0
    v_mov_b32 v158, 0
    v_mov_b32 v159, 0
    v_mov_b32 v160, 0
    v_mov_b32 v161, 0
    v_mov_b32 v162, 0
    v_mov_b32 v163, 0
    v_mov_b32 v164, 0
    v_mov_b32 v165, 0
    v_mov_b32 v166, 0
    v_mov_b32 v167, 0
    v_mov_b32 v168, 0
    v_mov_b32 v169, 0
    v_mov_b32 v170, 0
    v_mov_b32 v171, 0
    v_mov_b32 v172, 0
    v_mov_b32 v173, 0
    v_mov_b32 v174, 0
    v_mov_b32 v175, 0
    v_mov_b32 v176, 0
    v_mov_b32 v177, 0
    v_mov_b32 v178, 0
    v_mov_b32 v179, 0
    v_mov_b32 v180, 0
    v_mov_b32 v181, 0
    v_mov_b32 v182, 0
    v_mov_b32 v183, 0
    v_mov_b32 v184, 0
    v_mov_b32 v185, 0
    v_mov_b32 v186, 0
    v_mov_b32 v187, 0
    v_mov_b32 v188, 0
    v_mov_b32 v189, 0
    v_mov_b32 v190, 0
    v_mov_b32 v191, 0
    v_mov_b32 v192, 0
    v_mov_b32 v193, 0
    v_mov_b32 v194, 0
    v_mov_b32 v195, 0
    v_mov_b32 v196, 0
    v_mov_b32 v197, 0
    v_mov_b32 v198, 0
    v_mov_b32 v199, 0
    v_mov_b32 v200, 0
    v_mov_b32 v201, 0
    v_mov_b32 v202, 0
    v_mov_b32 v203, 0
    v_mov_b32 v204, 0
    v_mov_b32 v205, 0
    v_mov_b32 v206, 0
    v_mov_b32 v207, 0
    v_mov_b32 v208, 0
    v_mov_b32 v209, 0
    v_mov_b32 v210, 0
    v_mov_b32 v211, 0
    v_mov_b32 v212, 0
    v_mov_b32 v213, 0
    v_mov_b32 v214, 0
    v_mov_b32 v215, 0
    v_mov_b32 v216, 0
    v_mov_b32 v217, 0
    v_mov_b32 v218, 0
    v_mov_b32 v219, 0
    v_mov_b32 v220, 0
    v_mov_b32 v221, 0
    v_mov_b32 v222, 0
    v_mov_b32 v223, 0
    v_mov_b32 v224, 0
    v_mov_b32 v225, 0
    v_mov_b32 v226, 0
    v_mov_b32 v227, 0
    v_mov_b32 v228, 0
    v_mov_b32 v229, 0
    v_mov_b32 v230, 0
    v_mov_b32 v231, 0
    v_mov_b32 v232, 0
    v_mov_b32 v233, 0
    v_mov_b32 v234, 0
    v_mov_b32 v235, 0
    v_mov_b32 v236, 0
    v_mov_b32 v237, 0
    v_mov_b32 v238, 0
    v_mov_b32 v239, 0
    v_mov_b32 v240, 0
    v_mov_b32 v241, 0
    v_mov_b32 v242, 0
    v_mov_b32 v243, 0
    v_mov_b32 v244, 0
    v_mov_b32 v245, 0
    v_mov_b32 v246, 0
    v_mov_b32 v247, 0
    v_mov_b32 v248, 0
    v_mov_b32 v249, 0
    v_mov_b32 v250, 0
    v_mov_b32 v251, 0
    v_mov_b32 v252, 0
    v_mov_b32 v253, 0
    v_mov_b32 v254, 0
    v_mov_b32 v255, 0
    v_xor_b32 v4, 64, v16
    v_accvgpr_write_b32 a224, 0
    v_accvgpr_write_b32 a225, 0
    v_accvgpr_write_b32 a226, 0
    v_accvgpr_write_b32 a227, 0
    v_accvgpr_write_b32 a228, 0
    v_accvgpr_write_b32 a229, 0
    v_accvgpr_write_b32 a230, 0
    v_accvgpr_write_b32 a231, 0
    v_accvgpr_write_b32 a232, 0
    v_accvgpr_write_b32 a233, 0
    v_accvgpr_write_b32 a234, 0
    v_accvgpr_write_b32 a235, 0
    v_accvgpr_write_b32 a236, 0
    v_accvgpr_write_b32 a237, 0
    v_accvgpr_write_b32 a238, 0
    v_accvgpr_write_b32 a239, 0
    v_accvgpr_write_b32 a240, 0
    v_accvgpr_write_b32 a241, 0
    v_accvgpr_write_b32 a242, 0
    v_accvgpr_write_b32 a243, 0
    v_accvgpr_write_b32 a244, 0
    v_accvgpr_write_b32 a245, 0
    v_accvgpr_write_b32 a246, 0
    v_accvgpr_write_b32 a247, 0
    v_accvgpr_write_b32 a248, 0
    v_accvgpr_write_b32 a249, 0
    v_accvgpr_write_b32 a250, 0
    v_accvgpr_write_b32 a251, 0
    v_accvgpr_write_b32 a252, 0
    v_accvgpr_write_b32 a253, 0
    v_accvgpr_write_b32 a254, 0
    v_accvgpr_write_b32 a255, 0
    s_add_u32 m0, s30, 81920
    s_nop 0
    buffer_load_dwordx4 v21, s[16:19], s53 offen offset:0  lds
    buffer_load_dwordx4 v22, s[16:19], s53 offen offset:1024  lds
    buffer_load_dwordx4 v23, s[16:19], s53 offen offset:2048  lds
    buffer_load_dwordx4 v24, s[16:19], s53 offen offset:3072  lds
    s_add_u32 s28, s28, 262144
    s_xor_b32 s53, s28, s55
    s_waitcnt vmcnt(6)
    s_barrier
    ds_read_b128 a[64:67], v16 offset:0
    ds_read_b128 a[68:71], v16 offset:2048
    ds_read_b128 a[72:75], v16 offset:4096
    ds_read_b128 a[76:79], v16 offset:6144
    ds_read_b64_tr_b16 a[128:129], v8 offset:0
    ds_read_b64_tr_b16 a[130:131], v8 offset:2048
    ds_read_b64_tr_b16 a[132:133], v9 offset:0
    ds_read_b64_tr_b16 a[134:135], v9 offset:2048
    ds_read_b64_tr_b16 a[136:137], v10 offset:0
    ds_read_b64_tr_b16 a[138:139], v10 offset:2048
    ds_read_b64_tr_b16 a[140:141], v11 offset:0
    ds_read_b64_tr_b16 a[142:143], v11 offset:2048
    ds_read_b64_tr_b16 a[144:145], v12 offset:0
    ds_read_b64_tr_b16 a[146:147], v12 offset:2048
    ds_read_b64_tr_b16 a[148:149], v13 offset:0
    ds_read_b64_tr_b16 a[150:151], v13 offset:2048
    ds_read_b64_tr_b16 a[152:153], v14 offset:0
    ds_read_b64_tr_b16 a[154:155], v14 offset:2048
    ds_read_b64_tr_b16 a[156:157], v15 offset:0
    ds_read_b64_tr_b16 a[158:159], v15 offset:2048
    ds_read_b128 a[80:83], v4 offset:0
    ds_read_b128 a[84:87], v4 offset:2048
    ds_read_b128 a[88:91], v4 offset:4096
    ds_read_b128 a[92:95], v4 offset:6144
    s_add_u32 m0, s30, 98304
    s_nop 0
    buffer_load_dwordx4 v21, s[16:19], s53 offen offset:0  lds
    buffer_load_dwordx4 v22, s[16:19], s53 offen offset:1024  lds
    buffer_load_dwordx4 v23, s[16:19], s53 offen offset:2048  lds
    buffer_load_dwordx4 v24, s[16:19], s53 offen offset:3072  lds
    s_add_u32 s28, s28, 262144
    s_xor_b32 s53, s28, s55
    s_waitcnt lgkmcnt(14)
    v_mfma_f32_16x16x32_bf16 a[224:227], a[128:131], a[64:67], a[224:227]
    ds_read_b64_tr_b16 a[160:161], v8 offset:256
    v_mfma_f32_16x16x32_bf16 a[228:231], a[128:131], a[68:71], a[228:231]
    ds_read_b64_tr_b16 a[162:163], v8 offset:2304
    v_mfma_f32_16x16x32_bf16 a[232:235], a[128:131], a[72:75], a[232:235]
    ds_read_b64_tr_b16 a[164:165], v9 offset:256
    v_mfma_f32_16x16x32_bf16 a[236:239], a[128:131], a[76:79], a[236:239]
    s_add_u32 m0, s31, 32768
    ds_read_b64_tr_b16 a[166:167], v9 offset:2304
    v_mfma_f32_16x16x32_bf16 a[240:243], a[132:135], a[64:67], a[240:243]
    buffer_load_dwordx4 v17, s[12:15], s52 offen offset:0  lds
    s_add_u32 s32, s52, 32768
    v_mfma_f32_16x16x32_bf16 a[244:247], a[132:135], a[68:71], a[244:247]
    buffer_load_dwordx4 v18, s[12:15], s52 offen offset:1024  lds
    v_mfma_f32_16x16x32_bf16 a[248:251], a[132:135], a[72:75], a[248:251]
    ds_read_b64_tr_b16 a[168:169], v10 offset:256
    v_mfma_f32_16x16x32_bf16 a[252:255], a[132:135], a[76:79], a[252:255]
    ds_read_b64_tr_b16 a[170:171], v10 offset:2304
    v_mfma_f32_16x16x32_bf16 v[128:131], a[136:139], a[64:67], v[128:131]
    ds_read_b64_tr_b16 a[172:173], v11 offset:256
    v_mfma_f32_16x16x32_bf16 v[132:135], a[136:139], a[68:71], v[132:135]
    ds_read_b64_tr_b16 a[174:175], v11 offset:2304
    v_mfma_f32_16x16x32_bf16 v[136:139], a[136:139], a[72:75], v[136:139]
    buffer_load_dwordx4 v19, s[12:15], s52 offen offset:2048  lds
    v_mfma_f32_16x16x32_bf16 v[140:143], a[136:139], a[76:79], v[140:143]
    s_waitcnt lgkmcnt(12)
    v_mfma_f32_16x16x32_bf16 v[144:147], a[140:143], a[64:67], v[144:147]
    ds_read_b64_tr_b16 a[176:177], v12 offset:256
    v_mfma_f32_16x16x32_bf16 v[148:151], a[140:143], a[68:71], v[148:151]
    ds_read_b64_tr_b16 a[178:179], v12 offset:2304
    v_mfma_f32_16x16x32_bf16 v[152:155], a[140:143], a[72:75], v[152:155]
    ds_read_b64_tr_b16 a[180:181], v13 offset:256
    v_mfma_f32_16x16x32_bf16 v[156:159], a[140:143], a[76:79], v[156:159]
    ds_read_b64_tr_b16 a[182:183], v13 offset:2304
    v_mfma_f32_16x16x32_bf16 v[32:35], a[144:147], a[64:67], v[32:35]
    buffer_load_dwordx4 v20, s[12:15], s52 offen offset:3072  lds
    v_mfma_f32_16x16x32_bf16 v[36:39], a[144:147], a[68:71], v[36:39]
    v_mfma_f32_16x16x32_bf16 v[40:43], a[144:147], a[72:75], v[40:43]
    ds_read_b64_tr_b16 a[184:185], v14 offset:256
    v_mfma_f32_16x16x32_bf16 v[44:47], a[144:147], a[76:79], v[44:47]
    ds_read_b64_tr_b16 a[186:187], v14 offset:2304
    v_mfma_f32_16x16x32_bf16 v[48:51], a[148:151], a[64:67], v[48:51]
    ds_read_b64_tr_b16 a[188:189], v15 offset:256
    v_mfma_f32_16x16x32_bf16 v[52:55], a[148:151], a[68:71], v[52:55]
    s_add_u32 m0, s31, 36864
    ds_read_b64_tr_b16 a[190:191], v15 offset:2304
    v_mfma_f32_16x16x32_bf16 v[56:59], a[148:151], a[72:75], v[56:59]
    buffer_load_dwordx4 v17, s[12:15], s32 offen offset:0  lds
    v_mfma_f32_16x16x32_bf16 v[60:63], a[148:151], a[76:79], v[60:63]
    s_add_u32 s27, s27, 128
    v_add_u32 v8, 0xffff0000, v8
    v_add_u32 v9, 0xffff0000, v9
    v_mfma_f32_16x16x32_bf16 v[64:67], a[152:155], a[64:67], v[64:67]
    s_xor_b32 s52, s27, s54
    v_add_u32 v10, 0xffff0000, v10
    v_add_u32 v11, 0xffff0000, v11
    v_mfma_f32_16x16x32_bf16 v[68:71], a[152:155], a[68:71], v[68:71]
    v_add_u32 v12, 0xffff0000, v12
    v_add_u32 v13, 0xffff0000, v13
    v_mfma_f32_16x16x32_bf16 v[72:75], a[152:155], a[72:75], v[72:75]
    v_add_u32 v14, 0xffff0000, v14
    v_add_u32 v15, 0xffff0000, v15
    v_mfma_f32_16x16x32_bf16 v[76:79], a[152:155], a[76:79], v[76:79]
    v_mfma_f32_16x16x32_bf16 v[80:83], a[156:159], a[64:67], v[80:83]
    buffer_load_dwordx4 v18, s[12:15], s32 offen offset:1024  lds
    v_mfma_f32_16x16x32_bf16 v[84:87], a[156:159], a[68:71], v[84:87]
    v_mfma_f32_16x16x32_bf16 v[88:91], a[156:159], a[72:75], v[88:91]
    s_waitcnt vmcnt(10) lgkmcnt(0)
    v_mfma_f32_16x16x32_bf16 v[92:95], a[156:159], a[76:79], v[92:95]
    s_barrier
    v_mfma_f32_16x16x32_bf16 v[96:99], a[160:163], a[64:67], v[96:99]
    ds_read_b64_tr_b16 a[128:129], v8 offset:0
    v_mfma_f32_16x16x32_bf16 v[100:103], a[160:163], a[68:71], v[100:103]
    ds_read_b64_tr_b16 a[130:131], v8 offset:2048
    v_mfma_f32_16x16x32_bf16 v[104:107], a[160:163], a[72:75], v[104:107]
    ds_read_b64_tr_b16 a[132:133], v9 offset:0
    v_mfma_f32_16x16x32_bf16 v[108:111], a[160:163], a[76:79], v[108:111]
    ds_read_b64_tr_b16 a[134:135], v9 offset:2048
    v_mfma_f32_16x16x32_bf16 v[112:115], a[164:167], a[64:67], v[112:115]
    buffer_load_dwordx4 v19, s[12:15], s32 offen offset:2048  lds
    v_mfma_f32_16x16x32_bf16 v[116:119], a[164:167], a[68:71], v[116:119]
    v_mfma_f32_16x16x32_bf16 v[120:123], a[164:167], a[72:75], v[120:123]
    ds_read_b64_tr_b16 a[136:137], v10 offset:0
    v_mfma_f32_16x16x32_bf16 v[124:127], a[164:167], a[76:79], v[124:127]
    ds_read_b64_tr_b16 a[138:139], v10 offset:2048
    v_mfma_f32_16x16x32_bf16 v[160:163], a[168:171], a[64:67], v[160:163]
    ds_read_b64_tr_b16 a[140:141], v11 offset:0
    v_mfma_f32_16x16x32_bf16 v[164:167], a[168:171], a[68:71], v[164:167]
    ds_read_b64_tr_b16 a[142:143], v11 offset:2048
    v_mfma_f32_16x16x32_bf16 v[168:171], a[168:171], a[72:75], v[168:171]
    buffer_load_dwordx4 v20, s[12:15], s32 offen offset:3072  lds
    v_mfma_f32_16x16x32_bf16 v[172:175], a[168:171], a[76:79], v[172:175]
    v_mfma_f32_16x16x32_bf16 v[176:179], a[172:175], a[64:67], v[176:179]
    ds_read_b64_tr_b16 a[144:145], v12 offset:0
    v_mfma_f32_16x16x32_bf16 v[180:183], a[172:175], a[68:71], v[180:183]
    ds_read_b64_tr_b16 a[146:147], v12 offset:2048
    v_mfma_f32_16x16x32_bf16 v[184:187], a[172:175], a[72:75], v[184:187]
    ds_read_b64_tr_b16 a[148:149], v13 offset:0
    v_mfma_f32_16x16x32_bf16 v[188:191], a[172:175], a[76:79], v[188:191]
    s_add_u32 m0, s30, 114688
    ds_read_b64_tr_b16 a[150:151], v13 offset:2048
    v_mfma_f32_16x16x32_bf16 v[192:195], a[176:179], a[64:67], v[192:195]
    buffer_load_dwordx4 v21, s[16:19], s53 offen offset:0  lds
    v_mfma_f32_16x16x32_bf16 v[196:199], a[176:179], a[68:71], v[196:199]
    v_mfma_f32_16x16x32_bf16 v[200:203], a[176:179], a[72:75], v[200:203]
    ds_read_b64_tr_b16 a[152:153], v14 offset:0
    v_mfma_f32_16x16x32_bf16 v[204:207], a[176:179], a[76:79], v[204:207]
    ds_read_b64_tr_b16 a[154:155], v14 offset:2048
    v_mfma_f32_16x16x32_bf16 v[208:211], a[180:183], a[64:67], v[208:211]
    ds_read_b64_tr_b16 a[156:157], v15 offset:0
    v_mfma_f32_16x16x32_bf16 v[212:215], a[180:183], a[68:71], v[212:215]
    ds_read_b64_tr_b16 a[158:159], v15 offset:2048
    v_mfma_f32_16x16x32_bf16 v[216:219], a[180:183], a[72:75], v[216:219]
    buffer_load_dwordx4 v22, s[16:19], s53 offen offset:1024  lds
    v_mfma_f32_16x16x32_bf16 v[220:223], a[180:183], a[76:79], v[220:223]
    v_mfma_f32_16x16x32_bf16 v[224:227], a[184:187], a[64:67], v[224:227]
    v_mfma_f32_16x16x32_bf16 v[228:231], a[184:187], a[68:71], v[228:231]
    v_mfma_f32_16x16x32_bf16 v[232:235], a[184:187], a[72:75], v[232:235]
    v_mfma_f32_16x16x32_bf16 v[236:239], a[184:187], a[76:79], v[236:239]
    v_mfma_f32_16x16x32_bf16 v[240:243], a[188:191], a[64:67], v[240:243]
    buffer_load_dwordx4 v23, s[16:19], s53 offen offset:2048  lds
    v_mfma_f32_16x16x32_bf16 v[244:247], a[188:191], a[68:71], v[244:247]
    v_mfma_f32_16x16x32_bf16 v[248:251], a[188:191], a[72:75], v[248:251]
    s_waitcnt lgkmcnt(10)
    v_mfma_f32_16x16x32_bf16 v[252:255], a[188:191], a[76:79], v[252:255]
    v_mfma_f32_16x16x32_bf16 a[224:227], a[128:131], a[80:83], a[224:227]
    ds_read_b64_tr_b16 a[160:161], v8 offset:256
    v_mfma_f32_16x16x32_bf16 a[228:231], a[128:131], a[84:87], a[228:231]
    ds_read_b64_tr_b16 a[162:163], v8 offset:2304
    v_mfma_f32_16x16x32_bf16 a[232:235], a[128:131], a[88:91], a[232:235]
    ds_read_b64_tr_b16 a[164:165], v9 offset:256
    v_mfma_f32_16x16x32_bf16 a[236:239], a[128:131], a[92:95], a[236:239]
    ds_read_b64_tr_b16 a[166:167], v9 offset:2304
    v_mfma_f32_16x16x32_bf16 a[240:243], a[132:135], a[80:83], a[240:243]
    buffer_load_dwordx4 v24, s[16:19], s53 offen offset:3072  lds
    s_add_u32 s28, s28, 262144
    s_xor_b32 s53, s28, s55
    s_add_u32 m0, s30, 131072
    v_mfma_f32_16x16x32_bf16 a[244:247], a[132:135], a[84:87], a[244:247]
    buffer_load_dwordx4 v21, s[16:19], s53 offen offset:0  lds
    v_mfma_f32_16x16x32_bf16 a[248:251], a[132:135], a[88:91], a[248:251]
    ds_read_b64_tr_b16 a[168:169], v10 offset:256
    v_mfma_f32_16x16x32_bf16 a[252:255], a[132:135], a[92:95], a[252:255]
    ds_read_b64_tr_b16 a[170:171], v10 offset:2304
    v_mfma_f32_16x16x32_bf16 v[128:131], a[136:139], a[80:83], v[128:131]
    ds_read_b64_tr_b16 a[172:173], v11 offset:256
    v_mfma_f32_16x16x32_bf16 v[132:135], a[136:139], a[84:87], v[132:135]
    ds_read_b64_tr_b16 a[174:175], v11 offset:2304
    v_mfma_f32_16x16x32_bf16 v[136:139], a[136:139], a[88:91], v[136:139]
    buffer_load_dwordx4 v22, s[16:19], s53 offen offset:1024  lds
    v_mfma_f32_16x16x32_bf16 v[140:143], a[136:139], a[92:95], v[140:143]
    s_waitcnt lgkmcnt(8)
    v_mfma_f32_16x16x32_bf16 v[144:147], a[140:143], a[80:83], v[144:147]
    ds_read_b64_tr_b16 a[176:177], v12 offset:256
    v_mfma_f32_16x16x32_bf16 v[148:151], a[140:143], a[84:87], v[148:151]
    ds_read_b64_tr_b16 a[178:179], v12 offset:2304
    v_mfma_f32_16x16x32_bf16 v[152:155], a[140:143], a[88:91], v[152:155]
    ds_read_b64_tr_b16 a[180:181], v13 offset:256
    v_mfma_f32_16x16x32_bf16 v[156:159], a[140:143], a[92:95], v[156:159]
    ds_read_b64_tr_b16 a[182:183], v13 offset:2304
    v_mfma_f32_16x16x32_bf16 v[32:35], a[144:147], a[80:83], v[32:35]
    buffer_load_dwordx4 v23, s[16:19], s53 offen offset:2048  lds
    v_mfma_f32_16x16x32_bf16 v[36:39], a[144:147], a[84:87], v[36:39]
    v_mfma_f32_16x16x32_bf16 v[40:43], a[144:147], a[88:91], v[40:43]
    ds_read_b64_tr_b16 a[184:185], v14 offset:256
    v_mfma_f32_16x16x32_bf16 v[44:47], a[144:147], a[92:95], v[44:47]
    ds_read_b64_tr_b16 a[186:187], v14 offset:2304
    v_mfma_f32_16x16x32_bf16 v[48:51], a[148:151], a[80:83], v[48:51]
    ds_read_b64_tr_b16 a[188:189], v15 offset:256
    v_mfma_f32_16x16x32_bf16 v[52:55], a[148:151], a[84:87], v[52:55]
    ds_read_b64_tr_b16 a[190:191], v15 offset:2304
    v_mfma_f32_16x16x32_bf16 v[56:59], a[148:151], a[88:91], v[56:59]
    buffer_load_dwordx4 v24, s[16:19], s53 offen offset:3072  lds
    v_mfma_f32_16x16x32_bf16 v[60:63], a[148:151], a[92:95], v[60:63]
    s_add_u32 s28, s28, 262144
    v_add_u32 v8, 0x4000, v8
    v_add_u32 v9, 0x4000, v9
    v_mfma_f32_16x16x32_bf16 v[64:67], a[152:155], a[80:83], v[64:67]
    s_xor_b32 s53, s28, s55
    v_add_u32 v10, 0x4000, v10
    v_add_u32 v11, 0x4000, v11
    v_mfma_f32_16x16x32_bf16 v[68:71], a[152:155], a[84:87], v[68:71]
    v_add_u32 v12, 0x4000, v12
    v_add_u32 v13, 0x4000, v13
    v_mfma_f32_16x16x32_bf16 v[72:75], a[152:155], a[88:91], v[72:75]
    v_add_u32 v14, 0x4000, v14
    v_add_u32 v15, 0x4000, v15
    v_mfma_f32_16x16x32_bf16 v[76:79], a[152:155], a[92:95], v[76:79]
    s_add_u32 m0, s31, 0
    v_mfma_f32_16x16x32_bf16 v[80:83], a[156:159], a[80:83], v[80:83]
    buffer_load_dwordx4 v17, s[12:15], s52 offen offset:0  lds
    v_mfma_f32_16x16x32_bf16 v[84:87], a[156:159], a[84:87], v[84:87]
    s_add_u32 s32, s52, 32768
    v_mfma_f32_16x16x32_bf16 v[88:91], a[156:159], a[88:91], v[88:91]
    s_waitcnt vmcnt(9) lgkmcnt(0)
    v_mfma_f32_16x16x32_bf16 v[92:95], a[156:159], a[92:95], v[92:95]
    s_barrier
    v_mfma_f32_16x16x32_bf16 v[96:99], a[160:163], a[80:83], v[96:99]
    ds_read_b128 a[96:99], v16 offset:32768
    v_mfma_f32_16x16x32_bf16 v[100:103], a[160:163], a[84:87], v[100:103]
    ds_read_b128 a[100:103], v16 offset:34816
    v_mfma_f32_16x16x32_bf16 v[104:107], a[160:163], a[88:91], v[104:107]
    ds_read_b128 a[104:107], v16 offset:36864
    v_mfma_f32_16x16x32_bf16 v[108:111], a[160:163], a[92:95], v[108:111]
    ds_read_b128 a[108:111], v16 offset:38912
    v_mfma_f32_16x16x32_bf16 v[112:115], a[164:167], a[80:83], v[112:115]
    ds_read_b64_tr_b16 a[128:129], v8 offset:0
    v_mfma_f32_16x16x32_bf16 v[116:119], a[164:167], a[84:87], v[116:119]
    buffer_load_dwordx4 v18, s[12:15], s52 offen offset:1024  lds
    v_mfma_f32_16x16x32_bf16 v[120:123], a[164:167], a[88:91], v[120:123]
    ds_read_b64_tr_b16 a[130:131], v8 offset:2048
    v_mfma_f32_16x16x32_bf16 v[124:127], a[164:167], a[92:95], v[124:127]
    ds_read_b64_tr_b16 a[132:133], v9 offset:0
    v_mfma_f32_16x16x32_bf16 v[160:163], a[168:171], a[80:83], v[160:163]
    ds_read_b64_tr_b16 a[134:135], v9 offset:2048
    v_mfma_f32_16x16x32_bf16 v[164:167], a[168:171], a[84:87], v[164:167]
    ds_read_b64_tr_b16 a[136:137], v10 offset:0
    v_mfma_f32_16x16x32_bf16 v[168:171], a[168:171], a[88:91], v[168:171]
    ds_read_b64_tr_b16 a[138:139], v10 offset:2048
    v_mfma_f32_16x16x32_bf16 v[172:175], a[168:171], a[92:95], v[172:175]
    buffer_load_dwordx4 v19, s[12:15], s52 offen offset:2048  lds
    v_mfma_f32_16x16x32_bf16 v[176:179], a[172:175], a[80:83], v[176:179]
    ds_read_b64_tr_b16 a[140:141], v11 offset:0
    v_mfma_f32_16x16x32_bf16 v[180:183], a[172:175], a[84:87], v[180:183]
    ds_read_b64_tr_b16 a[142:143], v11 offset:2048
    v_mfma_f32_16x16x32_bf16 v[184:187], a[172:175], a[88:91], v[184:187]
    ds_read_b128 a[112:115], v4 offset:32768
    v_mfma_f32_16x16x32_bf16 v[188:191], a[172:175], a[92:95], v[188:191]
    ds_read_b128 a[116:119], v4 offset:34816
    v_mfma_f32_16x16x32_bf16 v[192:195], a[176:179], a[80:83], v[192:195]
    ds_read_b128 a[120:123], v4 offset:36864
    v_mfma_f32_16x16x32_bf16 v[196:199], a[176:179], a[84:87], v[196:199]
    buffer_load_dwordx4 v20, s[12:15], s52 offen offset:3072  lds
    v_mfma_f32_16x16x32_bf16 v[200:203], a[176:179], a[88:91], v[200:203]
    ds_read_b128 a[124:127], v4 offset:38912
    v_mfma_f32_16x16x32_bf16 v[204:207], a[176:179], a[92:95], v[204:207]
    ds_read_b64_tr_b16 a[144:145], v12 offset:0
    v_mfma_f32_16x16x32_bf16 v[208:211], a[180:183], a[80:83], v[208:211]
    ds_read_b64_tr_b16 a[146:147], v12 offset:2048
    v_mfma_f32_16x16x32_bf16 v[212:215], a[180:183], a[84:87], v[212:215]
    ds_read_b64_tr_b16 a[148:149], v13 offset:0
    v_mfma_f32_16x16x32_bf16 v[216:219], a[180:183], a[88:91], v[216:219]
    s_add_u32 m0, s31, 4096
    ds_read_b64_tr_b16 a[150:151], v13 offset:2048
    v_mfma_f32_16x16x32_bf16 v[220:223], a[180:183], a[92:95], v[220:223]
    buffer_load_dwordx4 v17, s[12:15], s32 offen offset:0  lds
    v_mfma_f32_16x16x32_bf16 v[224:227], a[184:187], a[80:83], v[224:227]
    s_add_u32 s27, s27, 128
    ds_read_b64_tr_b16 a[152:153], v14 offset:0
    v_mfma_f32_16x16x32_bf16 v[228:231], a[184:187], a[84:87], v[228:231]
    s_xor_b32 s52, s27, s54
    ds_read_b64_tr_b16 a[154:155], v14 offset:2048
    v_mfma_f32_16x16x32_bf16 v[232:235], a[184:187], a[88:91], v[232:235]
    ds_read_b64_tr_b16 a[156:157], v15 offset:0
    v_mfma_f32_16x16x32_bf16 v[236:239], a[184:187], a[92:95], v[236:239]
    ds_read_b64_tr_b16 a[158:159], v15 offset:2048
    v_mfma_f32_16x16x32_bf16 v[240:243], a[188:191], a[80:83], v[240:243]
    v_mfma_f32_16x16x32_bf16 v[244:247], a[188:191], a[84:87], v[244:247]
    buffer_load_dwordx4 v18, s[12:15], s32 offen offset:1024  lds
    v_mfma_f32_16x16x32_bf16 v[248:251], a[188:191], a[88:91], v[248:251]
    s_waitcnt lgkmcnt(14)
    v_mfma_f32_16x16x32_bf16 v[252:255], a[188:191], a[92:95], v[252:255]
    v_mfma_f32_16x16x32_bf16 a[224:227], a[128:131], a[96:99], a[224:227]
    ds_read_b64_tr_b16 a[160:161], v8 offset:256
    v_mfma_f32_16x16x32_bf16 a[228:231], a[128:131], a[100:103], a[228:231]
    ds_read_b64_tr_b16 a[162:163], v8 offset:2304
    v_mfma_f32_16x16x32_bf16 a[232:235], a[128:131], a[104:107], a[232:235]
    ds_read_b64_tr_b16 a[164:165], v9 offset:256
    v_mfma_f32_16x16x32_bf16 a[236:239], a[128:131], a[108:111], a[236:239]
    ds_read_b64_tr_b16 a[166:167], v9 offset:2304
    v_mfma_f32_16x16x32_bf16 a[240:243], a[132:135], a[96:99], a[240:243]
    buffer_load_dwordx4 v19, s[12:15], s32 offen offset:2048  lds
    v_mfma_f32_16x16x32_bf16 a[244:247], a[132:135], a[100:103], a[244:247]
    buffer_load_dwordx4 v20, s[12:15], s32 offen offset:3072  lds
    v_mfma_f32_16x16x32_bf16 a[248:251], a[132:135], a[104:107], a[248:251]
    ds_read_b64_tr_b16 a[168:169], v10 offset:256
    v_mfma_f32_16x16x32_bf16 a[252:255], a[132:135], a[108:111], a[252:255]
    ds_read_b64_tr_b16 a[170:171], v10 offset:2304
    v_mfma_f32_16x16x32_bf16 v[128:131], a[136:139], a[96:99], v[128:131]
    ds_read_b64_tr_b16 a[172:173], v11 offset:256
    v_mfma_f32_16x16x32_bf16 v[132:135], a[136:139], a[100:103], v[132:135]
    s_add_u32 m0, s30, 147456
    ds_read_b64_tr_b16 a[174:175], v11 offset:2304
    v_mfma_f32_16x16x32_bf16 v[136:139], a[136:139], a[104:107], v[136:139]
    buffer_load_dwordx4 v21, s[16:19], s53 offen offset:0  lds
    v_mfma_f32_16x16x32_bf16 v[140:143], a[136:139], a[108:111], v[140:143]
    s_waitcnt lgkmcnt(8)
    v_mfma_f32_16x16x32_bf16 v[144:147], a[140:143], a[96:99], v[144:147]
    ds_read_b64_tr_b16 a[176:177], v12 offset:256
    v_mfma_f32_16x16x32_bf16 v[148:151], a[140:143], a[100:103], v[148:151]
    ds_read_b64_tr_b16 a[178:179], v12 offset:2304
    v_mfma_f32_16x16x32_bf16 v[152:155], a[140:143], a[104:107], v[152:155]
    ds_read_b64_tr_b16 a[180:181], v13 offset:256
    v_mfma_f32_16x16x32_bf16 v[156:159], a[140:143], a[108:111], v[156:159]
    ds_read_b64_tr_b16 a[182:183], v13 offset:2304
    v_mfma_f32_16x16x32_bf16 v[32:35], a[144:147], a[96:99], v[32:35]
    buffer_load_dwordx4 v22, s[16:19], s53 offen offset:1024  lds
    v_mfma_f32_16x16x32_bf16 v[36:39], a[144:147], a[100:103], v[36:39]
    v_mfma_f32_16x16x32_bf16 v[40:43], a[144:147], a[104:107], v[40:43]
    ds_read_b64_tr_b16 a[184:185], v14 offset:256
    v_mfma_f32_16x16x32_bf16 v[44:47], a[144:147], a[108:111], v[44:47]
    ds_read_b64_tr_b16 a[186:187], v14 offset:2304
    v_mfma_f32_16x16x32_bf16 v[48:51], a[148:151], a[96:99], v[48:51]
    ds_read_b64_tr_b16 a[188:189], v15 offset:256
    v_mfma_f32_16x16x32_bf16 v[52:55], a[148:151], a[100:103], v[52:55]
    ds_read_b64_tr_b16 a[190:191], v15 offset:2304
    v_mfma_f32_16x16x32_bf16 v[56:59], a[148:151], a[104:107], v[56:59]
    buffer_load_dwordx4 v23, s[16:19], s53 offen offset:2048  lds
    v_mfma_f32_16x16x32_bf16 v[60:63], a[148:151], a[108:111], v[60:63]
    v_add_u32 v8, 0x4000, v8
    v_add_u32 v9, 0x4000, v9
    v_mfma_f32_16x16x32_bf16 v[64:67], a[152:155], a[96:99], v[64:67]
    v_add_u32 v10, 0x4000, v10
    v_add_u32 v11, 0x4000, v11
    v_mfma_f32_16x16x32_bf16 v[68:71], a[152:155], a[100:103], v[68:71]
    v_add_u32 v12, 0x4000, v12
    v_add_u32 v13, 0x4000, v13
    v_mfma_f32_16x16x32_bf16 v[72:75], a[152:155], a[104:107], v[72:75]
    v_add_u32 v14, 0x4000, v14
    v_add_u32 v15, 0x4000, v15
    v_mfma_f32_16x16x32_bf16 v[76:79], a[152:155], a[108:111], v[76:79]
    v_mfma_f32_16x16x32_bf16 v[80:83], a[156:159], a[96:99], v[80:83]
    buffer_load_dwordx4 v24, s[16:19], s53 offen offset:3072  lds
    v_mfma_f32_16x16x32_bf16 v[84:87], a[156:159], a[100:103], v[84:87]
    s_add_u32 s28, s28, 262144
    buffer_load_dword v31, v30, s[92:95], s33 offen offset:0
    v_mfma_f32_16x16x32_bf16 v[88:91], a[156:159], a[104:107], v[88:91]
    s_waitcnt vmcnt(17) lgkmcnt(0)
    s_xor_b32 s53, s28, s55
    v_mfma_f32_16x16x32_bf16 v[92:95], a[156:159], a[108:111], v[92:95]
    s_barrier
    v_mfma_f32_16x16x32_bf16 v[96:99], a[160:163], a[96:99], v[96:99]
    ds_read_b64_tr_b16 a[128:129], v8 offset:0
    v_mfma_f32_16x16x32_bf16 v[100:103], a[160:163], a[100:103], v[100:103]
    ds_read_b64_tr_b16 a[130:131], v8 offset:2048
    v_mfma_f32_16x16x32_bf16 v[104:107], a[160:163], a[104:107], v[104:107]
    ds_read_b64_tr_b16 a[132:133], v9 offset:0
    v_mfma_f32_16x16x32_bf16 v[108:111], a[160:163], a[108:111], v[108:111]
    s_add_u32 m0, s30, 81920
    ds_read_b64_tr_b16 a[134:135], v9 offset:2048
    v_mfma_f32_16x16x32_bf16 v[112:115], a[164:167], a[96:99], v[112:115]
    buffer_load_dwordx4 v21, s[16:19], s53 offen offset:0  lds
    v_mfma_f32_16x16x32_bf16 v[116:119], a[164:167], a[100:103], v[116:119]
    v_mfma_f32_16x16x32_bf16 v[120:123], a[164:167], a[104:107], v[120:123]
    ds_read_b64_tr_b16 a[136:137], v10 offset:0
    v_mfma_f32_16x16x32_bf16 v[124:127], a[164:167], a[108:111], v[124:127]
    ds_read_b64_tr_b16 a[138:139], v10 offset:2048
    v_mfma_f32_16x16x32_bf16 v[160:163], a[168:171], a[96:99], v[160:163]
    ds_read_b64_tr_b16 a[140:141], v11 offset:0
    v_mfma_f32_16x16x32_bf16 v[164:167], a[168:171], a[100:103], v[164:167]
    ds_read_b64_tr_b16 a[142:143], v11 offset:2048
    v_mfma_f32_16x16x32_bf16 v[168:171], a[168:171], a[104:107], v[168:171]
    buffer_load_dwordx4 v22, s[16:19], s53 offen offset:1024  lds
    v_mfma_f32_16x16x32_bf16 v[172:175], a[168:171], a[108:111], v[172:175]
    v_mfma_f32_16x16x32_bf16 v[176:179], a[172:175], a[96:99], v[176:179]
    ds_read_b64_tr_b16 a[144:145], v12 offset:0
    v_mfma_f32_16x16x32_bf16 v[180:183], a[172:175], a[100:103], v[180:183]
    ds_read_b64_tr_b16 a[146:147], v12 offset:2048
    v_mfma_f32_16x16x32_bf16 v[184:187], a[172:175], a[104:107], v[184:187]
    ds_read_b64_tr_b16 a[148:149], v13 offset:0
    v_mfma_f32_16x16x32_bf16 v[188:191], a[172:175], a[108:111], v[188:191]
    ds_read_b64_tr_b16 a[150:151], v13 offset:2048
    v_mfma_f32_16x16x32_bf16 v[192:195], a[176:179], a[96:99], v[192:195]
    buffer_load_dwordx4 v23, s[16:19], s53 offen offset:2048  lds
    v_mfma_f32_16x16x32_bf16 v[196:199], a[176:179], a[100:103], v[196:199]
    v_mfma_f32_16x16x32_bf16 v[200:203], a[176:179], a[104:107], v[200:203]
    ds_read_b64_tr_b16 a[152:153], v14 offset:0
    v_mfma_f32_16x16x32_bf16 v[204:207], a[176:179], a[108:111], v[204:207]
    ds_read_b64_tr_b16 a[154:155], v14 offset:2048
    v_mfma_f32_16x16x32_bf16 v[208:211], a[180:183], a[96:99], v[208:211]
    ds_read_b64_tr_b16 a[156:157], v15 offset:0
    v_mfma_f32_16x16x32_bf16 v[212:215], a[180:183], a[100:103], v[212:215]
    ds_read_b64_tr_b16 a[158:159], v15 offset:2048
    v_mfma_f32_16x16x32_bf16 v[216:219], a[180:183], a[104:107], v[216:219]
    buffer_load_dwordx4 v24, s[16:19], s53 offen offset:3072  lds
    v_mfma_f32_16x16x32_bf16 v[220:223], a[180:183], a[108:111], v[220:223]
    s_add_u32 s28, s28, 262144
    v_mfma_f32_16x16x32_bf16 v[224:227], a[184:187], a[96:99], v[224:227]
    s_xor_b32 s53, s28, s55
    v_mfma_f32_16x16x32_bf16 v[228:231], a[184:187], a[100:103], v[228:231]
    v_mfma_f32_16x16x32_bf16 v[232:235], a[184:187], a[104:107], v[232:235]
    v_mfma_f32_16x16x32_bf16 v[236:239], a[184:187], a[108:111], v[236:239]
    s_add_u32 m0, s31, 32768
    v_mfma_f32_16x16x32_bf16 v[240:243], a[188:191], a[96:99], v[240:243]
    buffer_load_dwordx4 v17, s[12:15], s52 offen offset:0  lds
    v_mfma_f32_16x16x32_bf16 v[244:247], a[188:191], a[100:103], v[244:247]
    s_add_u32 s32, s52, 32768
    v_mfma_f32_16x16x32_bf16 v[248:251], a[188:191], a[104:107], v[248:251]
    s_waitcnt lgkmcnt(10)
    v_mfma_f32_16x16x32_bf16 v[252:255], a[188:191], a[108:111], v[252:255]
    v_mfma_f32_16x16x32_bf16 a[224:227], a[128:131], a[112:115], a[224:227]
    ds_read_b64_tr_b16 a[160:161], v8 offset:256
    v_mfma_f32_16x16x32_bf16 a[228:231], a[128:131], a[116:119], a[228:231]
    ds_read_b64_tr_b16 a[162:163], v8 offset:2304
    v_mfma_f32_16x16x32_bf16 a[232:235], a[128:131], a[120:123], a[232:235]
    ds_read_b64_tr_b16 a[164:165], v9 offset:256
    v_mfma_f32_16x16x32_bf16 a[236:239], a[128:131], a[124:127], a[236:239]
    ds_read_b64_tr_b16 a[166:167], v9 offset:2304
    v_mfma_f32_16x16x32_bf16 a[240:243], a[132:135], a[112:115], a[240:243]
    buffer_load_dwordx4 v18, s[12:15], s52 offen offset:1024  lds
    v_mfma_f32_16x16x32_bf16 a[244:247], a[132:135], a[116:119], a[244:247]
    buffer_load_dwordx4 v19, s[12:15], s52 offen offset:2048  lds
    v_mfma_f32_16x16x32_bf16 a[248:251], a[132:135], a[120:123], a[248:251]
    ds_read_b64_tr_b16 a[168:169], v10 offset:256
    v_mfma_f32_16x16x32_bf16 a[252:255], a[132:135], a[124:127], a[252:255]
    ds_read_b64_tr_b16 a[170:171], v10 offset:2304
    v_mfma_f32_16x16x32_bf16 v[128:131], a[136:139], a[112:115], v[128:131]
    ds_read_b64_tr_b16 a[172:173], v11 offset:256
    v_mfma_f32_16x16x32_bf16 v[132:135], a[136:139], a[116:119], v[132:135]
    ds_read_b64_tr_b16 a[174:175], v11 offset:2304
    v_mfma_f32_16x16x32_bf16 v[136:139], a[136:139], a[120:123], v[136:139]
    buffer_load_dwordx4 v20, s[12:15], s52 offen offset:3072  lds
    v_mfma_f32_16x16x32_bf16 v[140:143], a[136:139], a[124:127], v[140:143]
    s_waitcnt lgkmcnt(8)
    v_mfma_f32_16x16x32_bf16 v[144:147], a[140:143], a[112:115], v[144:147]
    ds_read_b64_tr_b16 a[176:177], v12 offset:256
    v_mfma_f32_16x16x32_bf16 v[148:151], a[140:143], a[116:119], v[148:151]
    ds_read_b64_tr_b16 a[178:179], v12 offset:2304
    v_mfma_f32_16x16x32_bf16 v[152:155], a[140:143], a[120:123], v[152:155]
    ds_read_b64_tr_b16 a[180:181], v13 offset:256
    v_mfma_f32_16x16x32_bf16 v[156:159], a[140:143], a[124:127], v[156:159]
    s_add_u32 m0, s31, 36864
    ds_read_b64_tr_b16 a[182:183], v13 offset:2304
    v_mfma_f32_16x16x32_bf16 v[32:35], a[144:147], a[112:115], v[32:35]
    buffer_load_dwordx4 v17, s[12:15], s32 offen offset:0  lds
    v_mfma_f32_16x16x32_bf16 v[36:39], a[144:147], a[116:119], v[36:39]
    s_add_u32 s27, s27, 128
    v_mfma_f32_16x16x32_bf16 v[40:43], a[144:147], a[120:123], v[40:43]
    s_xor_b32 s52, s27, s54
    ds_read_b64_tr_b16 a[184:185], v14 offset:256
    v_mfma_f32_16x16x32_bf16 v[44:47], a[144:147], a[124:127], v[44:47]
    ds_read_b64_tr_b16 a[186:187], v14 offset:2304
    v_mfma_f32_16x16x32_bf16 v[48:51], a[148:151], a[112:115], v[48:51]
    ds_read_b64_tr_b16 a[188:189], v15 offset:256
    v_mfma_f32_16x16x32_bf16 v[52:55], a[148:151], a[116:119], v[52:55]
    ds_read_b64_tr_b16 a[190:191], v15 offset:2304
    v_mfma_f32_16x16x32_bf16 v[56:59], a[148:151], a[120:123], v[56:59]
    buffer_load_dwordx4 v18, s[12:15], s32 offen offset:1024  lds
    v_mfma_f32_16x16x32_bf16 v[60:63], a[148:151], a[124:127], v[60:63]
    v_add_u32 v8, 0x4000, v8
    v_add_u32 v9, 0x4000, v9
    v_mfma_f32_16x16x32_bf16 v[64:67], a[152:155], a[112:115], v[64:67]
    v_add_u32 v10, 0x4000, v10
    v_add_u32 v11, 0x4000, v11
    v_mfma_f32_16x16x32_bf16 v[68:71], a[152:155], a[116:119], v[68:71]
    v_add_u32 v12, 0x4000, v12
    v_add_u32 v13, 0x4000, v13
    v_mfma_f32_16x16x32_bf16 v[72:75], a[152:155], a[120:123], v[72:75]
    v_add_u32 v14, 0x4000, v14
    v_add_u32 v15, 0x4000, v15
    v_mfma_f32_16x16x32_bf16 v[76:79], a[152:155], a[124:127], v[76:79]
    v_mfma_f32_16x16x32_bf16 v[80:83], a[156:159], a[112:115], v[80:83]
    buffer_load_dwordx4 v19, s[12:15], s32 offen offset:2048  lds
    v_mfma_f32_16x16x32_bf16 v[84:87], a[156:159], a[116:119], v[84:87]
    buffer_load_dword v31, v30, s[92:95], s33 offen offset:1024
    v_mfma_f32_16x16x32_bf16 v[88:91], a[156:159], a[120:123], v[88:91]
    s_waitcnt vmcnt(17) lgkmcnt(0)
    v_mfma_f32_16x16x32_bf16 v[92:95], a[156:159], a[124:127], v[92:95]
    s_barrier
    v_mfma_f32_16x16x32_bf16 v[96:99], a[160:163], a[112:115], v[96:99]
    ds_read_b128 a[192:195], v16 offset:0
    v_mfma_f32_16x16x32_bf16 v[100:103], a[160:163], a[116:119], v[100:103]
    ds_read_b128 a[196:199], v16 offset:2048
    v_mfma_f32_16x16x32_bf16 v[104:107], a[160:163], a[120:123], v[104:107]
    ds_read_b128 a[200:203], v16 offset:4096
    v_mfma_f32_16x16x32_bf16 v[108:111], a[160:163], a[124:127], v[108:111]
    ds_read_b128 a[204:207], v16 offset:6144
    v_mfma_f32_16x16x32_bf16 v[112:115], a[164:167], a[112:115], v[112:115]
    ds_read_b64_tr_b16 a[128:129], v8 offset:0
    v_mfma_f32_16x16x32_bf16 v[116:119], a[164:167], a[116:119], v[116:119]
    buffer_load_dwordx4 v20, s[12:15], s32 offen offset:3072  lds
    v_mfma_f32_16x16x32_bf16 v[120:123], a[164:167], a[120:123], v[120:123]
    ds_read_b64_tr_b16 a[130:131], v8 offset:2048
    v_mfma_f32_16x16x32_bf16 v[124:127], a[164:167], a[124:127], v[124:127]
    ds_read_b64_tr_b16 a[132:133], v9 offset:0
    v_mfma_f32_16x16x32_bf16 v[160:163], a[168:171], a[112:115], v[160:163]
    ds_read_b64_tr_b16 a[134:135], v9 offset:2048
    v_mfma_f32_16x16x32_bf16 v[164:167], a[168:171], a[116:119], v[164:167]
    ds_read_b64_tr_b16 a[136:137], v10 offset:0
    v_mfma_f32_16x16x32_bf16 v[168:171], a[168:171], a[120:123], v[168:171]
    s_add_u32 m0, s30, 98304
    ds_read_b64_tr_b16 a[138:139], v10 offset:2048
    v_mfma_f32_16x16x32_bf16 v[172:175], a[168:171], a[124:127], v[172:175]
    buffer_load_dwordx4 v21, s[16:19], s53 offen offset:0  lds
    v_mfma_f32_16x16x32_bf16 v[176:179], a[172:175], a[112:115], v[176:179]
    ds_read_b64_tr_b16 a[140:141], v11 offset:0
    v_mfma_f32_16x16x32_bf16 v[180:183], a[172:175], a[116:119], v[180:183]
    ds_read_b64_tr_b16 a[142:143], v11 offset:2048
    v_mfma_f32_16x16x32_bf16 v[184:187], a[172:175], a[120:123], v[184:187]
    ds_read_b128 a[208:211], v4 offset:0
    v_mfma_f32_16x16x32_bf16 v[188:191], a[172:175], a[124:127], v[188:191]
    ds_read_b128 a[212:215], v4 offset:2048
    v_mfma_f32_16x16x32_bf16 v[192:195], a[176:179], a[112:115], v[192:195]
    ds_read_b128 a[216:219], v4 offset:4096
    v_mfma_f32_16x16x32_bf16 v[196:199], a[176:179], a[116:119], v[196:199]
    buffer_load_dwordx4 v22, s[16:19], s53 offen offset:1024  lds
    v_mfma_f32_16x16x32_bf16 v[200:203], a[176:179], a[120:123], v[200:203]
    ds_read_b128 a[220:223], v4 offset:6144
    v_mfma_f32_16x16x32_bf16 v[204:207], a[176:179], a[124:127], v[204:207]
    ds_read_b64_tr_b16 a[144:145], v12 offset:0
    v_mfma_f32_16x16x32_bf16 v[208:211], a[180:183], a[112:115], v[208:211]
    ds_read_b64_tr_b16 a[146:147], v12 offset:2048
    v_mfma_f32_16x16x32_bf16 v[212:215], a[180:183], a[116:119], v[212:215]
    ds_read_b64_tr_b16 a[148:149], v13 offset:0
    v_mfma_f32_16x16x32_bf16 v[216:219], a[180:183], a[120:123], v[216:219]
    ds_read_b64_tr_b16 a[150:151], v13 offset:2048
    v_mfma_f32_16x16x32_bf16 v[220:223], a[180:183], a[124:127], v[220:223]
    buffer_load_dwordx4 v23, s[16:19], s53 offen offset:2048  lds
    v_mfma_f32_16x16x32_bf16 v[224:227], a[184:187], a[112:115], v[224:227]
    ds_read_b64_tr_b16 a[152:153], v14 offset:0
    v_mfma_f32_16x16x32_bf16 v[228:231], a[184:187], a[116:119], v[228:231]
    ds_read_b64_tr_b16 a[154:155], v14 offset:2048
    v_mfma_f32_16x16x32_bf16 v[232:235], a[184:187], a[120:123], v[232:235]
    ds_read_b64_tr_b16 a[156:157], v15 offset:0
    v_mfma_f32_16x16x32_bf16 v[236:239], a[184:187], a[124:127], v[236:239]
    ds_read_b64_tr_b16 a[158:159], v15 offset:2048
    v_mfma_f32_16x16x32_bf16 v[240:243], a[188:191], a[112:115], v[240:243]
    v_mfma_f32_16x16x32_bf16 v[244:247], a[188:191], a[116:119], v[244:247]
    buffer_load_dwordx4 v24, s[16:19], s53 offen offset:3072  lds
    v_mfma_f32_16x16x32_bf16 v[248:251], a[188:191], a[120:123], v[248:251]
    s_waitcnt lgkmcnt(14)
    s_add_u32 s28, s28, 262144
    v_mfma_f32_16x16x32_bf16 v[252:255], a[188:191], a[124:127], v[252:255]
    s_xor_b32 s53, s28, s55
    v_mfma_f32_16x16x32_bf16 a[224:227], a[128:131], a[192:195], a[224:227]
    ds_read_b64_tr_b16 a[160:161], v8 offset:256
    v_mfma_f32_16x16x32_bf16 a[228:231], a[128:131], a[196:199], a[228:231]
    ds_read_b64_tr_b16 a[162:163], v8 offset:2304
    v_mfma_f32_16x16x32_bf16 a[232:235], a[128:131], a[200:203], a[232:235]
    ds_read_b64_tr_b16 a[164:165], v9 offset:256
    v_mfma_f32_16x16x32_bf16 a[236:239], a[128:131], a[204:207], a[236:239]
    ds_read_b64_tr_b16 a[166:167], v9 offset:2304
    v_mfma_f32_16x16x32_bf16 a[240:243], a[132:135], a[192:195], a[240:243]
    v_mfma_f32_16x16x32_bf16 a[244:247], a[132:135], a[196:199], a[244:247]
    v_mfma_f32_16x16x32_bf16 a[248:251], a[132:135], a[200:203], a[248:251]
    ds_read_b64_tr_b16 a[168:169], v10 offset:256
    v_mfma_f32_16x16x32_bf16 a[252:255], a[132:135], a[204:207], a[252:255]
    ds_read_b64_tr_b16 a[170:171], v10 offset:2304
    v_mfma_f32_16x16x32_bf16 v[128:131], a[136:139], a[192:195], v[128:131]
    ds_read_b64_tr_b16 a[172:173], v11 offset:256
    v_mfma_f32_16x16x32_bf16 v[132:135], a[136:139], a[196:199], v[132:135]
    ds_read_b64_tr_b16 a[174:175], v11 offset:2304
    v_mfma_f32_16x16x32_bf16 v[136:139], a[136:139], a[200:203], v[136:139]
    v_mfma_f32_16x16x32_bf16 v[140:143], a[136:139], a[204:207], v[140:143]
    s_waitcnt lgkmcnt(8)
    v_mfma_f32_16x16x32_bf16 v[144:147], a[140:143], a[192:195], v[144:147]
    ds_read_b64_tr_b16 a[176:177], v12 offset:256
    v_mfma_f32_16x16x32_bf16 v[148:151], a[140:143], a[196:199], v[148:151]
    ds_read_b64_tr_b16 a[178:179], v12 offset:2304
    v_mfma_f32_16x16x32_bf16 v[152:155], a[140:143], a[200:203], v[152:155]
    ds_read_b64_tr_b16 a[180:181], v13 offset:256
    v_mfma_f32_16x16x32_bf16 v[156:159], a[140:143], a[204:207], v[156:159]
    ds_read_b64_tr_b16 a[182:183], v13 offset:2304
    v_mfma_f32_16x16x32_bf16 v[32:35], a[144:147], a[192:195], v[32:35]
    v_mfma_f32_16x16x32_bf16 v[36:39], a[144:147], a[196:199], v[36:39]
    v_mfma_f32_16x16x32_bf16 v[40:43], a[144:147], a[200:203], v[40:43]
    ds_read_b64_tr_b16 a[184:185], v14 offset:256
    v_mfma_f32_16x16x32_bf16 v[44:47], a[144:147], a[204:207], v[44:47]
    ds_read_b64_tr_b16 a[186:187], v14 offset:2304
    v_mfma_f32_16x16x32_bf16 v[48:51], a[148:151], a[192:195], v[48:51]
    ds_read_b64_tr_b16 a[188:189], v15 offset:256
    v_mfma_f32_16x16x32_bf16 v[52:55], a[148:151], a[196:199], v[52:55]
    ds_read_b64_tr_b16 a[190:191], v15 offset:2304
    v_mfma_f32_16x16x32_bf16 v[56:59], a[148:151], a[200:203], v[56:59]
    v_mfma_f32_16x16x32_bf16 v[60:63], a[148:151], a[204:207], v[60:63]
    v_add_u32 v8, 0x4000, v8
    v_add_u32 v9, 0x4000, v9
    v_mfma_f32_16x16x32_bf16 v[64:67], a[152:155], a[192:195], v[64:67]
    v_add_u32 v10, 0x4000, v10
    v_add_u32 v11, 0x4000, v11
    v_mfma_f32_16x16x32_bf16 v[68:71], a[152:155], a[196:199], v[68:71]
    v_add_u32 v12, 0x4000, v12
    v_add_u32 v13, 0x4000, v13
    v_mfma_f32_16x16x32_bf16 v[72:75], a[152:155], a[200:203], v[72:75]
    v_add_u32 v14, 0x4000, v14
    v_add_u32 v15, 0x4000, v15
    v_mfma_f32_16x16x32_bf16 v[76:79], a[152:155], a[204:207], v[76:79]
    v_mfma_f32_16x16x32_bf16 v[80:83], a[156:159], a[192:195], v[80:83]
    v_mfma_f32_16x16x32_bf16 v[84:87], a[156:159], a[196:199], v[84:87]
    buffer_load_dword v31, v30, s[92:95], s33 offen offset:2048
    v_mfma_f32_16x16x32_bf16 v[88:91], a[156:159], a[200:203], v[88:91]
    s_waitcnt vmcnt(19) lgkmcnt(0)
    v_mfma_f32_16x16x32_bf16 v[92:95], a[156:159], a[204:207], v[92:95]
    s_barrier
    v_mfma_f32_16x16x32_bf16 v[96:99], a[160:163], a[192:195], v[96:99]
    ds_read_b64_tr_b16 a[128:129], v8 offset:0
    v_mfma_f32_16x16x32_bf16 v[100:103], a[160:163], a[196:199], v[100:103]
    ds_read_b64_tr_b16 a[130:131], v8 offset:2048
    v_mfma_f32_16x16x32_bf16 v[104:107], a[160:163], a[200:203], v[104:107]
    ds_read_b64_tr_b16 a[132:133], v9 offset:0
    v_mfma_f32_16x16x32_bf16 v[108:111], a[160:163], a[204:207], v[108:111]
    s_add_u32 m0, s31, 0
    ds_read_b64_tr_b16 a[134:135], v9 offset:2048
    v_mfma_f32_16x16x32_bf16 v[112:115], a[164:167], a[192:195], v[112:115]
    buffer_load_dwordx4 v17, s[12:15], s52 offen offset:0  lds
    v_mfma_f32_16x16x32_bf16 v[116:119], a[164:167], a[196:199], v[116:119]
    s_add_u32 s32, s52, 32768
    v_mfma_f32_16x16x32_bf16 v[120:123], a[164:167], a[200:203], v[120:123]
    ds_read_b64_tr_b16 a[136:137], v10 offset:0
    v_mfma_f32_16x16x32_bf16 v[124:127], a[164:167], a[204:207], v[124:127]
    ds_read_b64_tr_b16 a[138:139], v10 offset:2048
    v_mfma_f32_16x16x32_bf16 v[160:163], a[168:171], a[192:195], v[160:163]
    ds_read_b64_tr_b16 a[140:141], v11 offset:0
    v_mfma_f32_16x16x32_bf16 v[164:167], a[168:171], a[196:199], v[164:167]
    ds_read_b64_tr_b16 a[142:143], v11 offset:2048
    v_mfma_f32_16x16x32_bf16 v[168:171], a[168:171], a[200:203], v[168:171]
    buffer_load_dwordx4 v18, s[12:15], s52 offen offset:1024  lds
    v_mfma_f32_16x16x32_bf16 v[172:175], a[168:171], a[204:207], v[172:175]
    v_mfma_f32_16x16x32_bf16 v[176:179], a[172:175], a[192:195], v[176:179]
    ds_read_b64_tr_b16 a[144:145], v12 offset:0
    v_mfma_f32_16x16x32_bf16 v[180:183], a[172:175], a[196:199], v[180:183]
    ds_read_b64_tr_b16 a[146:147], v12 offset:2048
    v_mfma_f32_16x16x32_bf16 v[184:187], a[172:175], a[200:203], v[184:187]
    ds_read_b64_tr_b16 a[148:149], v13 offset:0
    v_mfma_f32_16x16x32_bf16 v[188:191], a[172:175], a[204:207], v[188:191]
    ds_read_b64_tr_b16 a[150:151], v13 offset:2048
    v_mfma_f32_16x16x32_bf16 v[192:195], a[176:179], a[192:195], v[192:195]
    buffer_load_dwordx4 v19, s[12:15], s52 offen offset:2048  lds
    v_mfma_f32_16x16x32_bf16 v[196:199], a[176:179], a[196:199], v[196:199]
    v_mfma_f32_16x16x32_bf16 v[200:203], a[176:179], a[200:203], v[200:203]
    ds_read_b64_tr_b16 a[152:153], v14 offset:0
    v_mfma_f32_16x16x32_bf16 v[204:207], a[176:179], a[204:207], v[204:207]
    ds_read_b64_tr_b16 a[154:155], v14 offset:2048
    v_mfma_f32_16x16x32_bf16 v[208:211], a[180:183], a[192:195], v[208:211]
    ds_read_b64_tr_b16 a[156:157], v15 offset:0
    v_mfma_f32_16x16x32_bf16 v[212:215], a[180:183], a[196:199], v[212:215]
    ds_read_b64_tr_b16 a[158:159], v15 offset:2048
    v_mfma_f32_16x16x32_bf16 v[216:219], a[180:183], a[200:203], v[216:219]
    buffer_load_dwordx4 v20, s[12:15], s52 offen offset:3072  lds
    v_mfma_f32_16x16x32_bf16 v[220:223], a[180:183], a[204:207], v[220:223]
    v_mfma_f32_16x16x32_bf16 v[224:227], a[184:187], a[192:195], v[224:227]
    v_mfma_f32_16x16x32_bf16 v[228:231], a[184:187], a[196:199], v[228:231]
    v_mfma_f32_16x16x32_bf16 v[232:235], a[184:187], a[200:203], v[232:235]
    v_mfma_f32_16x16x32_bf16 v[236:239], a[184:187], a[204:207], v[236:239]
    s_add_u32 m0, s31, 4096
    v_mfma_f32_16x16x32_bf16 v[240:243], a[188:191], a[192:195], v[240:243]
    buffer_load_dwordx4 v17, s[12:15], s32 offen offset:0  lds
    v_mfma_f32_16x16x32_bf16 v[244:247], a[188:191], a[196:199], v[244:247]
    s_add_u32 s27, s27, 128
    v_mfma_f32_16x16x32_bf16 v[248:251], a[188:191], a[200:203], v[248:251]
    s_waitcnt lgkmcnt(10)
    s_xor_b32 s52, s27, s54
    v_mfma_f32_16x16x32_bf16 v[252:255], a[188:191], a[204:207], v[252:255]
    v_mfma_f32_16x16x32_bf16 a[224:227], a[128:131], a[208:211], a[224:227]
    ds_read_b64_tr_b16 a[160:161], v8 offset:256
    v_mfma_f32_16x16x32_bf16 a[228:231], a[128:131], a[212:215], a[228:231]
    ds_read_b64_tr_b16 a[162:163], v8 offset:2304
    v_mfma_f32_16x16x32_bf16 a[232:235], a[128:131], a[216:219], a[232:235]
    ds_read_b64_tr_b16 a[164:165], v9 offset:256
    v_mfma_f32_16x16x32_bf16 a[236:239], a[128:131], a[220:223], a[236:239]
    ds_read_b64_tr_b16 a[166:167], v9 offset:2304
    v_mfma_f32_16x16x32_bf16 a[240:243], a[132:135], a[208:211], a[240:243]
    buffer_load_dwordx4 v18, s[12:15], s32 offen offset:1024  lds
    v_mfma_f32_16x16x32_bf16 a[244:247], a[132:135], a[212:215], a[244:247]
    buffer_load_dwordx4 v19, s[12:15], s32 offen offset:2048  lds
    v_mfma_f32_16x16x32_bf16 a[248:251], a[132:135], a[216:219], a[248:251]
    ds_read_b64_tr_b16 a[168:169], v10 offset:256
    v_mfma_f32_16x16x32_bf16 a[252:255], a[132:135], a[220:223], a[252:255]
    ds_read_b64_tr_b16 a[170:171], v10 offset:2304
    v_mfma_f32_16x16x32_bf16 v[128:131], a[136:139], a[208:211], v[128:131]
    ds_read_b64_tr_b16 a[172:173], v11 offset:256
    v_mfma_f32_16x16x32_bf16 v[132:135], a[136:139], a[212:215], v[132:135]
    ds_read_b64_tr_b16 a[174:175], v11 offset:2304
    v_mfma_f32_16x16x32_bf16 v[136:139], a[136:139], a[216:219], v[136:139]
    buffer_load_dwordx4 v20, s[12:15], s32 offen offset:3072  lds
    v_mfma_f32_16x16x32_bf16 v[140:143], a[136:139], a[220:223], v[140:143]
    s_waitcnt lgkmcnt(8)
    v_mfma_f32_16x16x32_bf16 v[144:147], a[140:143], a[208:211], v[144:147]
    ds_read_b64_tr_b16 a[176:177], v12 offset:256
    v_mfma_f32_16x16x32_bf16 v[148:151], a[140:143], a[212:215], v[148:151]
    ds_read_b64_tr_b16 a[178:179], v12 offset:2304
    v_mfma_f32_16x16x32_bf16 v[152:155], a[140:143], a[216:219], v[152:155]
    ds_read_b64_tr_b16 a[180:181], v13 offset:256
    v_mfma_f32_16x16x32_bf16 v[156:159], a[140:143], a[220:223], v[156:159]
    s_add_u32 m0, s30, 114688
    ds_read_b64_tr_b16 a[182:183], v13 offset:2304
    v_mfma_f32_16x16x32_bf16 v[32:35], a[144:147], a[208:211], v[32:35]
    buffer_load_dwordx4 v21, s[16:19], s53 offen offset:0  lds
    v_mfma_f32_16x16x32_bf16 v[36:39], a[144:147], a[212:215], v[36:39]
    v_mfma_f32_16x16x32_bf16 v[40:43], a[144:147], a[216:219], v[40:43]
    ds_read_b64_tr_b16 a[184:185], v14 offset:256
    v_mfma_f32_16x16x32_bf16 v[44:47], a[144:147], a[220:223], v[44:47]
    ds_read_b64_tr_b16 a[186:187], v14 offset:2304
    v_mfma_f32_16x16x32_bf16 v[48:51], a[148:151], a[208:211], v[48:51]
    ds_read_b64_tr_b16 a[188:189], v15 offset:256
    v_mfma_f32_16x16x32_bf16 v[52:55], a[148:151], a[212:215], v[52:55]
    ds_read_b64_tr_b16 a[190:191], v15 offset:2304
    v_mfma_f32_16x16x32_bf16 v[56:59], a[148:151], a[216:219], v[56:59]
    buffer_load_dwordx4 v22, s[16:19], s53 offen offset:1024  lds
    v_mfma_f32_16x16x32_bf16 v[60:63], a[148:151], a[220:223], v[60:63]
    v_add_u32 v8, 0xffff0000, v8
    v_add_u32 v9, 0xffff0000, v9
    v_mfma_f32_16x16x32_bf16 v[64:67], a[152:155], a[208:211], v[64:67]
    v_add_u32 v10, 0xffff0000, v10
    v_add_u32 v11, 0xffff0000, v11
    v_mfma_f32_16x16x32_bf16 v[68:71], a[152:155], a[212:215], v[68:71]
    v_add_u32 v12, 0xffff0000, v12
    v_add_u32 v13, 0xffff0000, v13
    v_mfma_f32_16x16x32_bf16 v[72:75], a[152:155], a[216:219], v[72:75]
    v_add_u32 v14, 0xffff0000, v14
    v_add_u32 v15, 0xffff0000, v15
    v_mfma_f32_16x16x32_bf16 v[76:79], a[152:155], a[220:223], v[76:79]
    v_mfma_f32_16x16x32_bf16 v[80:83], a[156:159], a[208:211], v[80:83]
    buffer_load_dwordx4 v23, s[16:19], s53 offen offset:2048  lds
    v_mfma_f32_16x16x32_bf16 v[84:87], a[156:159], a[212:215], v[84:87]
    buffer_load_dword v31, v30, s[92:95], s33 offen offset:3072
    v_mfma_f32_16x16x32_bf16 v[88:91], a[156:159], a[216:219], v[88:91]
    s_waitcnt vmcnt(17) lgkmcnt(0)
    v_mfma_f32_16x16x32_bf16 v[92:95], a[156:159], a[220:223], v[92:95]
    s_barrier
    v_mfma_f32_16x16x32_bf16 v[96:99], a[160:163], a[208:211], v[96:99]
    ds_read_b128 a[64:67], v16 offset:32768
    v_mfma_f32_16x16x32_bf16 v[100:103], a[160:163], a[212:215], v[100:103]
    ds_read_b128 a[68:71], v16 offset:34816
    v_mfma_f32_16x16x32_bf16 v[104:107], a[160:163], a[216:219], v[104:107]
    ds_read_b128 a[72:75], v16 offset:36864
    v_mfma_f32_16x16x32_bf16 v[108:111], a[160:163], a[220:223], v[108:111]
    ds_read_b128 a[76:79], v16 offset:38912
    v_mfma_f32_16x16x32_bf16 v[112:115], a[164:167], a[208:211], v[112:115]
    ds_read_b64_tr_b16 a[128:129], v8 offset:0
    v_mfma_f32_16x16x32_bf16 v[116:119], a[164:167], a[212:215], v[116:119]
    buffer_load_dwordx4 v24, s[16:19], s53 offen offset:3072  lds
    v_mfma_f32_16x16x32_bf16 v[120:123], a[164:167], a[216:219], v[120:123]
    s_add_u32 s28, s28, 262144
    ds_read_b64_tr_b16 a[130:131], v8 offset:2048
    v_mfma_f32_16x16x32_bf16 v[124:127], a[164:167], a[220:223], v[124:127]
    s_xor_b32 s53, s28, s55
    ds_read_b64_tr_b16 a[132:133], v9 offset:0
    v_mfma_f32_16x16x32_bf16 v[160:163], a[168:171], a[208:211], v[160:163]
    ds_read_b64_tr_b16 a[134:135], v9 offset:2048
    v_mfma_f32_16x16x32_bf16 v[164:167], a[168:171], a[212:215], v[164:167]
    ds_read_b64_tr_b16 a[136:137], v10 offset:0
    v_mfma_f32_16x16x32_bf16 v[168:171], a[168:171], a[216:219], v[168:171]
    s_add_u32 m0, s30, 131072
    ds_read_b64_tr_b16 a[138:139], v10 offset:2048
    v_mfma_f32_16x16x32_bf16 v[172:175], a[168:171], a[220:223], v[172:175]
    buffer_load_dwordx4 v21, s[16:19], s53 offen offset:0  lds
    v_mfma_f32_16x16x32_bf16 v[176:179], a[172:175], a[208:211], v[176:179]
    ds_read_b64_tr_b16 a[140:141], v11 offset:0
    v_mfma_f32_16x16x32_bf16 v[180:183], a[172:175], a[212:215], v[180:183]
    ds_read_b64_tr_b16 a[142:143], v11 offset:2048
    v_mfma_f32_16x16x32_bf16 v[184:187], a[172:175], a[216:219], v[184:187]
    ds_read_b128 a[80:83], v4 offset:32768
    v_mfma_f32_16x16x32_bf16 v[188:191], a[172:175], a[220:223], v[188:191]
    ds_read_b128 a[84:87], v4 offset:34816
    v_mfma_f32_16x16x32_bf16 v[192:195], a[176:179], a[208:211], v[192:195]
    ds_read_b128 a[88:91], v4 offset:36864
    v_mfma_f32_16x16x32_bf16 v[196:199], a[176:179], a[212:215], v[196:199]
    buffer_load_dwordx4 v22, s[16:19], s53 offen offset:1024  lds
    v_mfma_f32_16x16x32_bf16 v[200:203], a[176:179], a[216:219], v[200:203]
    ds_read_b128 a[92:95], v4 offset:38912
    v_mfma_f32_16x16x32_bf16 v[204:207], a[176:179], a[220:223], v[204:207]
    ds_read_b64_tr_b16 a[144:145], v12 offset:0
    v_mfma_f32_16x16x32_bf16 v[208:211], a[180:183], a[208:211], v[208:211]
    ds_read_b64_tr_b16 a[146:147], v12 offset:2048
    v_mfma_f32_16x16x32_bf16 v[212:215], a[180:183], a[212:215], v[212:215]
    ds_read_b64_tr_b16 a[148:149], v13 offset:0
    v_mfma_f32_16x16x32_bf16 v[216:219], a[180:183], a[216:219], v[216:219]
    ds_read_b64_tr_b16 a[150:151], v13 offset:2048
    v_mfma_f32_16x16x32_bf16 v[220:223], a[180:183], a[220:223], v[220:223]
    buffer_load_dwordx4 v23, s[16:19], s53 offen offset:2048  lds
    v_mfma_f32_16x16x32_bf16 v[224:227], a[184:187], a[208:211], v[224:227]
    ds_read_b64_tr_b16 a[152:153], v14 offset:0
    v_mfma_f32_16x16x32_bf16 v[228:231], a[184:187], a[212:215], v[228:231]
    ds_read_b64_tr_b16 a[154:155], v14 offset:2048
    v_mfma_f32_16x16x32_bf16 v[232:235], a[184:187], a[216:219], v[232:235]
    ds_read_b64_tr_b16 a[156:157], v15 offset:0
    v_mfma_f32_16x16x32_bf16 v[236:239], a[184:187], a[220:223], v[236:239]
    ds_read_b64_tr_b16 a[158:159], v15 offset:2048
    v_mfma_f32_16x16x32_bf16 v[240:243], a[188:191], a[208:211], v[240:243]
    v_mfma_f32_16x16x32_bf16 v[244:247], a[188:191], a[212:215], v[244:247]
    buffer_load_dwordx4 v24, s[16:19], s53 offen offset:3072  lds
    v_mfma_f32_16x16x32_bf16 v[248:251], a[188:191], a[216:219], v[248:251]
    s_waitcnt lgkmcnt(14)
    s_add_u32 s28, s28, 262144
    s_mov_b32 s33, 4096
    v_mfma_f32_16x16x32_bf16 v[252:255], a[188:191], a[220:223], v[252:255]
    s_xor_b32 s53, s28, s55
    global_load_dword v31, v29, s[80:81]
    v_mfma_f32_16x16x32_bf16 a[224:227], a[128:131], a[64:67], a[224:227]
    ds_read_b64_tr_b16 a[160:161], v8 offset:256
    v_mfma_f32_16x16x32_bf16 a[228:231], a[128:131], a[68:71], a[228:231]
    ds_read_b64_tr_b16 a[162:163], v8 offset:2304
    v_mfma_f32_16x16x32_bf16 a[232:235], a[128:131], a[72:75], a[232:235]
    ds_read_b64_tr_b16 a[164:165], v9 offset:256
    v_mfma_f32_16x16x32_bf16 a[236:239], a[128:131], a[76:79], a[236:239]
    ds_read_b64_tr_b16 a[166:167], v9 offset:2304
    v_mfma_f32_16x16x32_bf16 a[240:243], a[132:135], a[64:67], a[240:243]
    v_mfma_f32_16x16x32_bf16 a[244:247], a[132:135], a[68:71], a[244:247]
    v_mfma_f32_16x16x32_bf16 a[248:251], a[132:135], a[72:75], a[248:251]
    ds_read_b64_tr_b16 a[168:169], v10 offset:256
    v_mfma_f32_16x16x32_bf16 a[252:255], a[132:135], a[76:79], a[252:255]
    ds_read_b64_tr_b16 a[170:171], v10 offset:2304
    v_mfma_f32_16x16x32_bf16 v[128:131], a[136:139], a[64:67], v[128:131]
    ds_read_b64_tr_b16 a[172:173], v11 offset:256
    v_mfma_f32_16x16x32_bf16 v[132:135], a[136:139], a[68:71], v[132:135]
    ds_read_b64_tr_b16 a[174:175], v11 offset:2304
    v_mfma_f32_16x16x32_bf16 v[136:139], a[136:139], a[72:75], v[136:139]
    v_mfma_f32_16x16x32_bf16 v[140:143], a[136:139], a[76:79], v[140:143]
    s_waitcnt lgkmcnt(8)
    v_mfma_f32_16x16x32_bf16 v[144:147], a[140:143], a[64:67], v[144:147]
    ds_read_b64_tr_b16 a[176:177], v12 offset:256
    v_mfma_f32_16x16x32_bf16 v[148:151], a[140:143], a[68:71], v[148:151]
    ds_read_b64_tr_b16 a[178:179], v12 offset:2304
    v_mfma_f32_16x16x32_bf16 v[152:155], a[140:143], a[72:75], v[152:155]
    ds_read_b64_tr_b16 a[180:181], v13 offset:256
    v_mfma_f32_16x16x32_bf16 v[156:159], a[140:143], a[76:79], v[156:159]
    ds_read_b64_tr_b16 a[182:183], v13 offset:2304
    v_mfma_f32_16x16x32_bf16 v[32:35], a[144:147], a[64:67], v[32:35]
    v_mfma_f32_16x16x32_bf16 v[36:39], a[144:147], a[68:71], v[36:39]
    v_mfma_f32_16x16x32_bf16 v[40:43], a[144:147], a[72:75], v[40:43]
    ds_read_b64_tr_b16 a[184:185], v14 offset:256
    v_mfma_f32_16x16x32_bf16 v[44:47], a[144:147], a[76:79], v[44:47]
    ds_read_b64_tr_b16 a[186:187], v14 offset:2304
    v_mfma_f32_16x16x32_bf16 v[48:51], a[148:151], a[64:67], v[48:51]
    ds_read_b64_tr_b16 a[188:189], v15 offset:256
    v_mfma_f32_16x16x32_bf16 v[52:55], a[148:151], a[68:71], v[52:55]
    ds_read_b64_tr_b16 a[190:191], v15 offset:2304
    v_mfma_f32_16x16x32_bf16 v[56:59], a[148:151], a[72:75], v[56:59]
    v_mfma_f32_16x16x32_bf16 v[60:63], a[148:151], a[76:79], v[60:63]
    v_add_u32 v8, 0x4000, v8
    v_add_u32 v9, 0x4000, v9
    v_mfma_f32_16x16x32_bf16 v[64:67], a[152:155], a[64:67], v[64:67]
    v_add_u32 v10, 0x4000, v10
    v_add_u32 v11, 0x4000, v11
    v_mfma_f32_16x16x32_bf16 v[68:71], a[152:155], a[68:71], v[68:71]
    v_add_u32 v12, 0x4000, v12
    v_add_u32 v13, 0x4000, v13
    v_mfma_f32_16x16x32_bf16 v[72:75], a[152:155], a[72:75], v[72:75]
    v_add_u32 v14, 0x4000, v14
    v_add_u32 v15, 0x4000, v15
    v_mfma_f32_16x16x32_bf16 v[76:79], a[152:155], a[76:79], v[76:79]
    v_mfma_f32_16x16x32_bf16 v[80:83], a[156:159], a[64:67], v[80:83]
    v_mfma_f32_16x16x32_bf16 v[84:87], a[156:159], a[68:71], v[84:87]
    buffer_load_dword v31, v30, s[92:95], s33 offen offset:0
    v_mfma_f32_16x16x32_bf16 v[88:91], a[156:159], a[72:75], v[88:91]
    s_waitcnt vmcnt(11) lgkmcnt(0)
    v_mfma_f32_16x16x32_bf16 v[92:95], a[156:159], a[76:79], v[92:95]
    s_barrier
    v_mfma_f32_16x16x32_bf16 v[96:99], a[160:163], a[64:67], v[96:99]
    ds_read_b128 a[96:99], v16 offset:0
    v_mfma_f32_16x16x32_bf16 v[100:103], a[160:163], a[68:71], v[100:103]
    ds_read_b128 a[100:103], v16 offset:2048
    v_mfma_f32_16x16x32_bf16 v[104:107], a[160:163], a[72:75], v[104:107]
    ds_read_b128 a[104:107], v16 offset:4096
    v_mfma_f32_16x16x32_bf16 v[108:111], a[160:163], a[76:79], v[108:111]
    ds_read_b128 a[108:111], v16 offset:6144
    v_mfma_f32_16x16x32_bf16 v[112:115], a[164:167], a[64:67], v[112:115]
    s_add_u32 m0, s31, 32768
    ds_read_b64_tr_b16 a[128:129], v8 offset:0
    v_mfma_f32_16x16x32_bf16 v[116:119], a[164:167], a[68:71], v[116:119]
    buffer_load_dwordx4 v17, s[12:15], s52 offen offset:0  lds
    v_mfma_f32_16x16x32_bf16 v[120:123], a[164:167], a[72:75], v[120:123]
    s_add_u32 s32, s52, 32768
    ds_read_b64_tr_b16 a[130:131], v8 offset:2048
    v_mfma_f32_16x16x32_bf16 v[124:127], a[164:167], a[76:79], v[124:127]
    ds_read_b64_tr_b16 a[132:133], v9 offset:0
    v_mfma_f32_16x16x32_bf16 v[160:163], a[168:171], a[64:67], v[160:163]
    ds_read_b64_tr_b16 a[134:135], v9 offset:2048
    v_mfma_f32_16x16x32_bf16 v[164:167], a[168:171], a[68:71], v[164:167]
    ds_read_b64_tr_b16 a[136:137], v10 offset:0
    v_mfma_f32_16x16x32_bf16 v[168:171], a[168:171], a[72:75], v[168:171]
    ds_read_b64_tr_b16 a[138:139], v10 offset:2048
    v_mfma_f32_16x16x32_bf16 v[172:175], a[168:171], a[76:79], v[172:175]
    buffer_load_dwordx4 v18, s[12:15], s52 offen offset:1024  lds
    v_mfma_f32_16x16x32_bf16 v[176:179], a[172:175], a[64:67], v[176:179]
    ds_read_b64_tr_b16 a[140:141], v11 offset:0
    v_mfma_f32_16x16x32_bf16 v[180:183], a[172:175], a[68:71], v[180:183]
    ds_read_b64_tr_b16 a[142:143], v11 offset:2048
    v_mfma_f32_16x16x32_bf16 v[184:187], a[172:175], a[72:75], v[184:187]
    ds_read_b128 a[112:115], v4 offset:0
    v_mfma_f32_16x16x32_bf16 v[188:191], a[172:175], a[76:79], v[188:191]
    ds_read_b128 a[116:119], v4 offset:2048
    v_mfma_f32_16x16x32_bf16 v[192:195], a[176:179], a[64:67], v[192:195]
    ds_read_b128 a[120:123], v4 offset:4096
    v_mfma_f32_16x16x32_bf16 v[196:199], a[176:179], a[68:71], v[196:199]
    buffer_load_dwordx4 v19, s[12:15], s52 offen offset:2048  lds
    v_mfma_f32_16x16x32_bf16 v[200:203], a[176:179], a[72:75], v[200:203]
    ds_read_b128 a[124:127], v4 offset:6144
    v_mfma_f32_16x16x32_bf16 v[204:207], a[176:179], a[76:79], v[204:207]
    ds_read_b64_tr_b16 a[144:145], v12 offset:0
    v_mfma_f32_16x16x32_bf16 v[208:211], a[180:183], a[64:67], v[208:211]
    ds_read_b64_tr_b16 a[146:147], v12 offset:2048
    v_mfma_f32_16x16x32_bf16 v[212:215], a[180:183], a[68:71], v[212:215]
    ds_read_b64_tr_b16 a[148:149], v13 offset:0
    v_mfma_f32_16x16x32_bf16 v[216:219], a[180:183], a[72:75], v[216:219]
    ds_read_b64_tr_b16 a[150:151], v13 offset:2048
    v_mfma_f32_16x16x32_bf16 v[220:223], a[180:183], a[76:79], v[220:223]
    buffer_load_dwordx4 v20, s[12:15], s52 offen offset:3072  lds
    v_mfma_f32_16x16x32_bf16 v[224:227], a[184:187], a[64:67], v[224:227]
    ds_read_b64_tr_b16 a[152:153], v14 offset:0
    v_mfma_f32_16x16x32_bf16 v[228:231], a[184:187], a[68:71], v[228:231]
    ds_read_b64_tr_b16 a[154:155], v14 offset:2048
    v_mfma_f32_16x16x32_bf16 v[232:235], a[184:187], a[72:75], v[232:235]
    ds_read_b64_tr_b16 a[156:157], v15 offset:0
    v_mfma_f32_16x16x32_bf16 v[236:239], a[184:187], a[76:79], v[236:239]
    ds_read_b64_tr_b16 a[158:159], v15 offset:2048
    v_mfma_f32_16x16x32_bf16 v[240:243], a[188:191], a[64:67], v[240:243]
    s_add_u32 m0, s31, 36864
    v_mfma_f32_16x16x32_bf16 v[244:247], a[188:191], a[68:71], v[244:247]
    buffer_load_dwordx4 v17, s[12:15], s32 offen offset:0  lds
    v_mfma_f32_16x16x32_bf16 v[248:251], a[188:191], a[72:75], v[248:251]
    s_waitcnt lgkmcnt(14)
    s_add_u32 s27, s27, 128
    v_mfma_f32_16x16x32_bf16 v[252:255], a[188:191], a[76:79], v[252:255]
    s_xor_b32 s52, s27, s54
    v_mfma_f32_16x16x32_bf16 a[224:227], a[128:131], a[80:83], a[224:227]
    ds_read_b64_tr_b16 a[160:161], v8 offset:256
    v_mfma_f32_16x16x32_bf16 a[228:231], a[128:131], a[84:87], a[228:231]
    ds_read_b64_tr_b16 a[162:163], v8 offset:2304
    v_mfma_f32_16x16x32_bf16 a[232:235], a[128:131], a[88:91], a[232:235]
    ds_read_b64_tr_b16 a[164:165], v9 offset:256
    v_mfma_f32_16x16x32_bf16 a[236:239], a[128:131], a[92:95], a[236:239]
    ds_read_b64_tr_b16 a[166:167], v9 offset:2304
    v_mfma_f32_16x16x32_bf16 a[240:243], a[132:135], a[80:83], a[240:243]
    buffer_load_dwordx4 v18, s[12:15], s32 offen offset:1024  lds
    v_mfma_f32_16x16x32_bf16 a[244:247], a[132:135], a[84:87], a[244:247]
    buffer_load_dwordx4 v19, s[12:15], s32 offen offset:2048  lds
    v_mfma_f32_16x16x32_bf16 a[248:251], a[132:135], a[88:91], a[248:251]
    ds_read_b64_tr_b16 a[168:169], v10 offset:256
    v_mfma_f32_16x16x32_bf16 a[252:255], a[132:135], a[92:95], a[252:255]
    ds_read_b64_tr_b16 a[170:171], v10 offset:2304
    v_mfma_f32_16x16x32_bf16 v[128:131], a[136:139], a[80:83], v[128:131]
    ds_read_b64_tr_b16 a[172:173], v11 offset:256
    v_mfma_f32_16x16x32_bf16 v[132:135], a[136:139], a[84:87], v[132:135]
    ds_read_b64_tr_b16 a[174:175], v11 offset:2304
    v_mfma_f32_16x16x32_bf16 v[136:139], a[136:139], a[88:91], v[136:139]
    buffer_load_dwordx4 v20, s[12:15], s32 offen offset:3072  lds
    v_mfma_f32_16x16x32_bf16 v[140:143], a[136:139], a[92:95], v[140:143]
    s_waitcnt lgkmcnt(8)
    v_mfma_f32_16x16x32_bf16 v[144:147], a[140:143], a[80:83], v[144:147]
    ds_read_b64_tr_b16 a[176:177], v12 offset:256
    v_mfma_f32_16x16x32_bf16 v[148:151], a[140:143], a[84:87], v[148:151]
    ds_read_b64_tr_b16 a[178:179], v12 offset:2304
    v_mfma_f32_16x16x32_bf16 v[152:155], a[140:143], a[88:91], v[152:155]
    ds_read_b64_tr_b16 a[180:181], v13 offset:256
    v_mfma_f32_16x16x32_bf16 v[156:159], a[140:143], a[92:95], v[156:159]
    s_add_u32 m0, s29, 65536
    ds_read_b64_tr_b16 a[182:183], v13 offset:2304
    v_mfma_f32_16x16x32_bf16 v[32:35], a[144:147], a[80:83], v[32:35]
    buffer_load_dwordx4 v27, s[8:11], s51 offen nt lds
    v_mfma_f32_16x16x32_bf16 v[36:39], a[144:147], a[84:87], v[36:39]
    v_mfma_f32_16x16x32_bf16 v[40:43], a[144:147], a[88:91], v[40:43]
    ds_read_b64_tr_b16 a[184:185], v14 offset:256
    v_mfma_f32_16x16x32_bf16 v[44:47], a[144:147], a[92:95], v[44:47]
    ds_read_b64_tr_b16 a[186:187], v14 offset:2304
    v_mfma_f32_16x16x32_bf16 v[48:51], a[148:151], a[80:83], v[48:51]
    ds_read_b64_tr_b16 a[188:189], v15 offset:256
    v_mfma_f32_16x16x32_bf16 v[52:55], a[148:151], a[84:87], v[52:55]
    ds_read_b64_tr_b16 a[190:191], v15 offset:2304
    v_mfma_f32_16x16x32_bf16 v[56:59], a[148:151], a[88:91], v[56:59]
    buffer_load_dwordx4 v28, s[8:11], s51 offen offset:1024 nt lds
    v_mfma_f32_16x16x32_bf16 v[60:63], a[148:151], a[92:95], v[60:63]
    s_add_u32 s26, s26, 8192
    v_add_u32 v8, 0x4000, v8
    v_add_u32 v9, 0x4000, v9
    v_mfma_f32_16x16x32_bf16 v[64:67], a[152:155], a[80:83], v[64:67]
    s_xor_b32 s51, s26, s49
    v_add_u32 v10, 0x4000, v10
    v_add_u32 v11, 0x4000, v11
    v_mfma_f32_16x16x32_bf16 v[68:71], a[152:155], a[84:87], v[68:71]
    v_add_u32 v12, 0x4000, v12
    v_add_u32 v13, 0x4000, v13
    v_mfma_f32_16x16x32_bf16 v[72:75], a[152:155], a[88:91], v[72:75]
    v_add_u32 v14, 0x4000, v14
    v_add_u32 v15, 0x4000, v15
    v_mfma_f32_16x16x32_bf16 v[76:79], a[152:155], a[92:95], v[76:79]
    s_add_u32 m0, s30, 147456
    v_mfma_f32_16x16x32_bf16 v[80:83], a[156:159], a[80:83], v[80:83]
    buffer_load_dwordx4 v21, s[16:19], s53 offen offset:0  lds
    v_mfma_f32_16x16x32_bf16 v[84:87], a[156:159], a[84:87], v[84:87]
    buffer_load_dword v31, v30, s[92:95], s33 offen offset:1024
    v_mfma_f32_16x16x32_bf16 v[88:91], a[156:159], a[88:91], v[88:91]
    s_waitcnt vmcnt(18) lgkmcnt(0)
    v_mfma_f32_16x16x32_bf16 v[92:95], a[156:159], a[92:95], v[92:95]
    s_barrier
    v_mfma_f32_16x16x32_bf16 v[96:99], a[160:163], a[80:83], v[96:99]
    ds_read_b64_tr_b16 a[128:129], v8 offset:0
    v_mfma_f32_16x16x32_bf16 v[100:103], a[160:163], a[84:87], v[100:103]
    ds_read_b64_tr_b16 a[130:131], v8 offset:2048
    v_mfma_f32_16x16x32_bf16 v[104:107], a[160:163], a[88:91], v[104:107]
    ds_read_b64_tr_b16 a[132:133], v9 offset:0
    v_mfma_f32_16x16x32_bf16 v[108:111], a[160:163], a[92:95], v[108:111]
    ds_read_b64_tr_b16 a[134:135], v9 offset:2048
    v_mfma_f32_16x16x32_bf16 v[112:115], a[164:167], a[80:83], v[112:115]
    buffer_load_dwordx4 v22, s[16:19], s53 offen offset:1024  lds
    v_mfma_f32_16x16x32_bf16 v[116:119], a[164:167], a[84:87], v[116:119]
    v_mfma_f32_16x16x32_bf16 v[120:123], a[164:167], a[88:91], v[120:123]
    ds_read_b64_tr_b16 a[136:137], v10 offset:0
    v_mfma_f32_16x16x32_bf16 v[124:127], a[164:167], a[92:95], v[124:127]
    ds_read_b64_tr_b16 a[138:139], v10 offset:2048
    v_mfma_f32_16x16x32_bf16 v[160:163], a[168:171], a[80:83], v[160:163]
    ds_read_b64_tr_b16 a[140:141], v11 offset:0
    v_mfma_f32_16x16x32_bf16 v[164:167], a[168:171], a[84:87], v[164:167]
    ds_read_b64_tr_b16 a[142:143], v11 offset:2048
    v_mfma_f32_16x16x32_bf16 v[168:171], a[168:171], a[88:91], v[168:171]
    buffer_load_dwordx4 v23, s[16:19], s53 offen offset:2048  lds
    v_mfma_f32_16x16x32_bf16 v[172:175], a[168:171], a[92:95], v[172:175]
    v_mfma_f32_16x16x32_bf16 v[176:179], a[172:175], a[80:83], v[176:179]
    ds_read_b64_tr_b16 a[144:145], v12 offset:0
    v_mfma_f32_16x16x32_bf16 v[180:183], a[172:175], a[84:87], v[180:183]
    ds_read_b64_tr_b16 a[146:147], v12 offset:2048
    v_mfma_f32_16x16x32_bf16 v[184:187], a[172:175], a[88:91], v[184:187]
    ds_read_b64_tr_b16 a[148:149], v13 offset:0
    v_mfma_f32_16x16x32_bf16 v[188:191], a[172:175], a[92:95], v[188:191]
    ds_read_b64_tr_b16 a[150:151], v13 offset:2048
    v_mfma_f32_16x16x32_bf16 v[192:195], a[176:179], a[80:83], v[192:195]
    buffer_load_dwordx4 v24, s[16:19], s53 offen offset:3072  lds
    v_mfma_f32_16x16x32_bf16 v[196:199], a[176:179], a[84:87], v[196:199]
    s_add_u32 s28, s28, 262144
    v_mfma_f32_16x16x32_bf16 v[200:203], a[176:179], a[88:91], v[200:203]
    s_xor_b32 s53, s28, s55
    ds_read_b64_tr_b16 a[152:153], v14 offset:0
    v_mfma_f32_16x16x32_bf16 v[204:207], a[176:179], a[92:95], v[204:207]
    ds_read_b64_tr_b16 a[154:155], v14 offset:2048
    v_mfma_f32_16x16x32_bf16 v[208:211], a[180:183], a[80:83], v[208:211]
    ds_read_b64_tr_b16 a[156:157], v15 offset:0
    v_mfma_f32_16x16x32_bf16 v[212:215], a[180:183], a[84:87], v[212:215]
    s_add_u32 m0, s30, 81920
    ds_read_b64_tr_b16 a[158:159], v15 offset:2048
    v_mfma_f32_16x16x32_bf16 v[216:219], a[180:183], a[88:91], v[216:219]
    buffer_load_dwordx4 v21, s[16:19], s53 offen offset:0  lds
    v_mfma_f32_16x16x32_bf16 v[220:223], a[180:183], a[92:95], v[220:223]
    v_mfma_f32_16x16x32_bf16 v[224:227], a[184:187], a[80:83], v[224:227]
    v_mfma_f32_16x16x32_bf16 v[228:231], a[184:187], a[84:87], v[228:231]
    v_mfma_f32_16x16x32_bf16 v[232:235], a[184:187], a[88:91], v[232:235]
    v_mfma_f32_16x16x32_bf16 v[236:239], a[184:187], a[92:95], v[236:239]
    v_mfma_f32_16x16x32_bf16 v[240:243], a[188:191], a[80:83], v[240:243]
    buffer_load_dwordx4 v22, s[16:19], s53 offen offset:1024  lds
    v_mfma_f32_16x16x32_bf16 v[244:247], a[188:191], a[84:87], v[244:247]
    v_mfma_f32_16x16x32_bf16 v[248:251], a[188:191], a[88:91], v[248:251]
    s_waitcnt lgkmcnt(10)
    v_mfma_f32_16x16x32_bf16 v[252:255], a[188:191], a[92:95], v[252:255]
    v_mfma_f32_16x16x32_bf16 a[224:227], a[128:131], a[96:99], a[224:227]
    ds_read_b64_tr_b16 a[160:161], v8 offset:256
    v_mfma_f32_16x16x32_bf16 a[228:231], a[128:131], a[100:103], a[228:231]
    ds_read_b64_tr_b16 a[162:163], v8 offset:2304
    v_mfma_f32_16x16x32_bf16 a[232:235], a[128:131], a[104:107], a[232:235]
    ds_read_b64_tr_b16 a[164:165], v9 offset:256
    v_mfma_f32_16x16x32_bf16 a[236:239], a[128:131], a[108:111], a[236:239]
    ds_read_b64_tr_b16 a[166:167], v9 offset:2304
    v_mfma_f32_16x16x32_bf16 a[240:243], a[132:135], a[96:99], a[240:243]
    buffer_load_dwordx4 v23, s[16:19], s53 offen offset:2048  lds
    v_mfma_f32_16x16x32_bf16 a[244:247], a[132:135], a[100:103], a[244:247]
    buffer_load_dwordx4 v24, s[16:19], s53 offen offset:3072  lds
    v_mfma_f32_16x16x32_bf16 a[248:251], a[132:135], a[104:107], a[248:251]
    s_add_u32 s28, s28, 262144
    ds_read_b64_tr_b16 a[168:169], v10 offset:256
    v_mfma_f32_16x16x32_bf16 a[252:255], a[132:135], a[108:111], a[252:255]
    s_xor_b32 s53, s28, s55
    ds_read_b64_tr_b16 a[170:171], v10 offset:2304
    v_mfma_f32_16x16x32_bf16 v[128:131], a[136:139], a[96:99], v[128:131]
    ds_read_b64_tr_b16 a[172:173], v11 offset:256
    v_mfma_f32_16x16x32_bf16 v[132:135], a[136:139], a[100:103], v[132:135]
    s_add_u32 m0, s31, 0
    ds_read_b64_tr_b16 a[174:175], v11 offset:2304
    v_mfma_f32_16x16x32_bf16 v[136:139], a[136:139], a[104:107], v[136:139]
    buffer_load_dwordx4 v17, s[12:15], s52 offen offset:0  lds
    v_mfma_f32_16x16x32_bf16 v[140:143], a[136:139], a[108:111], v[140:143]
    s_waitcnt lgkmcnt(8)
    s_add_u32 s32, s52, 32768
    v_mfma_f32_16x16x32_bf16 v[144:147], a[140:143], a[96:99], v[144:147]
    ds_read_b64_tr_b16 a[176:177], v12 offset:256
    v_mfma_f32_16x16x32_bf16 v[148:151], a[140:143], a[100:103], v[148:151]
    ds_read_b64_tr_b16 a[178:179], v12 offset:2304
    v_mfma_f32_16x16x32_bf16 v[152:155], a[140:143], a[104:107], v[152:155]
    ds_read_b64_tr_b16 a[180:181], v13 offset:256
    v_mfma_f32_16x16x32_bf16 v[156:159], a[140:143], a[108:111], v[156:159]
    ds_read_b64_tr_b16 a[182:183], v13 offset:2304
    v_mfma_f32_16x16x32_bf16 v[32:35], a[144:147], a[96:99], v[32:35]
    buffer_load_dwordx4 v18, s[12:15], s52 offen offset:1024  lds
    v_mfma_f32_16x16x32_bf16 v[36:39], a[144:147], a[100:103], v[36:39]
    v_mfma_f32_16x16x32_bf16 v[40:43], a[144:147], a[104:107], v[40:43]
    ds_read_b64_tr_b16 a[184:185], v14 offset:256
    v_mfma_f32_16x16x32_bf16 v[44:47], a[144:147], a[108:111], v[44:47]
    ds_read_b64_tr_b16 a[186:187], v14 offset:2304
    v_mfma_f32_16x16x32_bf16 v[48:51], a[148:151], a[96:99], v[48:51]
    ds_read_b64_tr_b16 a[188:189], v15 offset:256
    v_mfma_f32_16x16x32_bf16 v[52:55], a[148:151], a[100:103], v[52:55]
    ds_read_b64_tr_b16 a[190:191], v15 offset:2304
    v_mfma_f32_16x16x32_bf16 v[56:59], a[148:151], a[104:107], v[56:59]
    buffer_load_dwordx4 v19, s[12:15], s52 offen offset:2048  lds
    v_mfma_f32_16x16x32_bf16 v[60:63], a[148:151], a[108:111], v[60:63]
    v_add_u32 v8, 0x4000, v8
    v_add_u32 v9, 0x4000, v9
    v_mfma_f32_16x16x32_bf16 v[64:67], a[152:155], a[96:99], v[64:67]
    v_add_u32 v10, 0x4000, v10
    v_add_u32 v11, 0x4000, v11
    v_mfma_f32_16x16x32_bf16 v[68:71], a[152:155], a[100:103], v[68:71]
    v_add_u32 v12, 0x4000, v12
    v_add_u32 v13, 0x4000, v13
    v_mfma_f32_16x16x32_bf16 v[72:75], a[152:155], a[104:107], v[72:75]
    v_add_u32 v14, 0x4000, v14
    v_add_u32 v15, 0x4000, v15
    v_mfma_f32_16x16x32_bf16 v[76:79], a[152:155], a[108:111], v[76:79]
    v_mfma_f32_16x16x32_bf16 v[80:83], a[156:159], a[96:99], v[80:83]
    buffer_load_dwordx4 v20, s[12:15], s52 offen offset:3072  lds
    v_mfma_f32_16x16x32_bf16 v[84:87], a[156:159], a[100:103], v[84:87]
    buffer_load_dword v31, v30, s[92:95], s33 offen offset:2048
    v_mfma_f32_16x16x32_bf16 v[88:91], a[156:159], a[104:107], v[88:91]
    s_waitcnt vmcnt(16) lgkmcnt(0)
    v_mfma_f32_16x16x32_bf16 v[92:95], a[156:159], a[108:111], v[92:95]
    s_barrier
    v_mfma_f32_16x16x32_bf16 v[96:99], a[160:163], a[96:99], v[96:99]
    ds_read_b128 a[192:195], v16 offset:32768
    v_mfma_f32_16x16x32_bf16 v[100:103], a[160:163], a[100:103], v[100:103]
    ds_read_b128 a[196:199], v16 offset:34816
    v_mfma_f32_16x16x32_bf16 v[104:107], a[160:163], a[104:107], v[104:107]
    ds_read_b128 a[200:203], v16 offset:36864
    v_mfma_f32_16x16x32_bf16 v[108:111], a[160:163], a[108:111], v[108:111]
    ds_read_b128 a[204:207], v16 offset:38912
    v_mfma_f32_16x16x32_bf16 v[112:115], a[164:167], a[96:99], v[112:115]
    s_add_u32 m0, s31, 4096
    ds_read_b64_tr_b16 a[128:129], v8 offset:0
    v_mfma_f32_16x16x32_bf16 v[116:119], a[164:167], a[100:103], v[116:119]
    buffer_load_dwordx4 v17, s[12:15], s32 offen offset:0  lds
    v_mfma_f32_16x16x32_bf16 v[120:123], a[164:167], a[104:107], v[120:123]
    s_add_u32 s27, s27, 128
    ds_read_b64_tr_b16 a[130:131], v8 offset:2048
    v_mfma_f32_16x16x32_bf16 v[124:127], a[164:167], a[108:111], v[124:127]
    s_xor_b32 s52, s27, s54
    ds_read_b64_tr_b16 a[132:133], v9 offset:0
    v_mfma_f32_16x16x32_bf16 v[160:163], a[168:171], a[96:99], v[160:163]
    ds_read_b64_tr_b16 a[134:135], v9 offset:2048
    v_mfma_f32_16x16x32_bf16 v[164:167], a[168:171], a[100:103], v[164:167]
    ds_read_b64_tr_b16 a[136:137], v10 offset:0
    v_mfma_f32_16x16x32_bf16 v[168:171], a[168:171], a[104:107], v[168:171]
    ds_read_b64_tr_b16 a[138:139], v10 offset:2048
    v_mfma_f32_16x16x32_bf16 v[172:175], a[168:171], a[108:111], v[172:175]
    buffer_load_dwordx4 v18, s[12:15], s32 offen offset:1024  lds
    v_mfma_f32_16x16x32_bf16 v[176:179], a[172:175], a[96:99], v[176:179]
    ds_read_b64_tr_b16 a[140:141], v11 offset:0
    v_mfma_f32_16x16x32_bf16 v[180:183], a[172:175], a[100:103], v[180:183]
    ds_read_b64_tr_b16 a[142:143], v11 offset:2048
    v_mfma_f32_16x16x32_bf16 v[184:187], a[172:175], a[104:107], v[184:187]
    ds_read_b128 a[208:211], v4 offset:32768
    v_mfma_f32_16x16x32_bf16 v[188:191], a[172:175], a[108:111], v[188:191]
    ds_read_b128 a[212:215], v4 offset:34816
    v_mfma_f32_16x16x32_bf16 v[192:195], a[176:179], a[96:99], v[192:195]
    ds_read_b128 a[216:219], v4 offset:36864
    v_mfma_f32_16x16x32_bf16 v[196:199], a[176:179], a[100:103], v[196:199]
    buffer_load_dwordx4 v19, s[12:15], s32 offen offset:2048  lds
    v_mfma_f32_16x16x32_bf16 v[200:203], a[176:179], a[104:107], v[200:203]
    ds_read_b128 a[220:223], v4 offset:38912
    v_mfma_f32_16x16x32_bf16 v[204:207], a[176:179], a[108:111], v[204:207]
    ds_read_b64_tr_b16 a[144:145], v12 offset:0
    v_mfma_f32_16x16x32_bf16 v[208:211], a[180:183], a[96:99], v[208:211]
    ds_read_b64_tr_b16 a[146:147], v12 offset:2048
    v_mfma_f32_16x16x32_bf16 v[212:215], a[180:183], a[100:103], v[212:215]
    ds_read_b64_tr_b16 a[148:149], v13 offset:0
    v_mfma_f32_16x16x32_bf16 v[216:219], a[180:183], a[104:107], v[216:219]
    ds_read_b64_tr_b16 a[150:151], v13 offset:2048
    v_mfma_f32_16x16x32_bf16 v[220:223], a[180:183], a[108:111], v[220:223]
    buffer_load_dwordx4 v20, s[12:15], s32 offen offset:3072  lds
    v_mfma_f32_16x16x32_bf16 v[224:227], a[184:187], a[96:99], v[224:227]
    ds_read_b64_tr_b16 a[152:153], v14 offset:0
    v_mfma_f32_16x16x32_bf16 v[228:231], a[184:187], a[100:103], v[228:231]
    ds_read_b64_tr_b16 a[154:155], v14 offset:2048
    v_mfma_f32_16x16x32_bf16 v[232:235], a[184:187], a[104:107], v[232:235]
    ds_read_b64_tr_b16 a[156:157], v15 offset:0
    v_mfma_f32_16x16x32_bf16 v[236:239], a[184:187], a[108:111], v[236:239]
    ds_read_b64_tr_b16 a[158:159], v15 offset:2048
    v_mfma_f32_16x16x32_bf16 v[240:243], a[188:191], a[96:99], v[240:243]
    s_add_u32 m0, s29, 73728
    v_mfma_f32_16x16x32_bf16 v[244:247], a[188:191], a[100:103], v[244:247]
    buffer_load_dwordx4 v27, s[8:11], s51 offen nt lds
    v_mfma_f32_16x16x32_bf16 v[248:251], a[188:191], a[104:107], v[248:251]
    s_waitcnt lgkmcnt(14)
    v_mfma_f32_16x16x32_bf16 v[252:255], a[188:191], a[108:111], v[252:255]
    v_mfma_f32_16x16x32_bf16 a[224:227], a[128:131], a[112:115], a[224:227]
    ds_read_b64_tr_b16 a[160:161], v8 offset:256
    v_mfma_f32_16x16x32_bf16 a[228:231], a[128:131], a[116:119], a[228:231]
    ds_read_b64_tr_b16 a[162:163], v8 offset:2304
    v_mfma_f32_16x16x32_bf16 a[232:235], a[128:131], a[120:123], a[232:235]
    ds_read_b64_tr_b16 a[164:165], v9 offset:256
    v_mfma_f32_16x16x32_bf16 a[236:239], a[128:131], a[124:127], a[236:239]
    ds_read_b64_tr_b16 a[166:167], v9 offset:2304
    v_mfma_f32_16x16x32_bf16 a[240:243], a[132:135], a[112:115], a[240:243]
    buffer_load_dwordx4 v28, s[8:11], s51 offen offset:1024 nt lds
    s_add_u32 s26, s26, 8192
    s_xor_b32 s51, s26, s49
    s_add_u32 m0, s30, 98304
    v_mfma_f32_16x16x32_bf16 a[244:247], a[132:135], a[116:119], a[244:247]
    buffer_load_dwordx4 v21, s[16:19], s53 offen offset:0  lds
    v_mfma_f32_16x16x32_bf16 a[248:251], a[132:135], a[120:123], a[248:251]
    ds_read_b64_tr_b16 a[168:169], v10 offset:256
    v_mfma_f32_16x16x32_bf16 a[252:255], a[132:135], a[124:127], a[252:255]
    ds_read_b64_tr_b16 a[170:171], v10 offset:2304
    v_mfma_f32_16x16x32_bf16 v[128:131], a[136:139], a[112:115], v[128:131]
    ds_read_b64_tr_b16 a[172:173], v11 offset:256
    v_mfma_f32_16x16x32_bf16 v[132:135], a[136:139], a[116:119], v[132:135]
    ds_read_b64_tr_b16 a[174:175], v11 offset:2304
    v_mfma_f32_16x16x32_bf16 v[136:139], a[136:139], a[120:123], v[136:139]
    buffer_load_dwordx4 v22, s[16:19], s53 offen offset:1024  lds
    v_mfma_f32_16x16x32_bf16 v[140:143], a[136:139], a[124:127], v[140:143]
    s_waitcnt lgkmcnt(8)
    v_mfma_f32_16x16x32_bf16 v[144:147], a[140:143], a[112:115], v[144:147]
    ds_read_b64_tr_b16 a[176:177], v12 offset:256
    v_mfma_f32_16x16x32_bf16 v[148:151], a[140:143], a[116:119], v[148:151]
    ds_read_b64_tr_b16 a[178:179], v12 offset:2304
    v_mfma_f32_16x16x32_bf16 v[152:155], a[140:143], a[120:123], v[152:155]
    ds_read_b64_tr_b16 a[180:181], v13 offset:256
    v_mfma_f32_16x16x32_bf16 v[156:159], a[140:143], a[124:127], v[156:159]
    ds_read_b64_tr_b16 a[182:183], v13 offset:2304
    v_mfma_f32_16x16x32_bf16 v[32:35], a[144:147], a[112:115], v[32:35]
    buffer_load_dwordx4 v23, s[16:19], s53 offen offset:2048  lds
    v_mfma_f32_16x16x32_bf16 v[36:39], a[144:147], a[116:119], v[36:39]
    v_mfma_f32_16x16x32_bf16 v[40:43], a[144:147], a[120:123], v[40:43]
    ds_read_b64_tr_b16 a[184:185], v14 offset:256
    v_mfma_f32_16x16x32_bf16 v[44:47], a[144:147], a[124:127], v[44:47]
    ds_read_b64_tr_b16 a[186:187], v14 offset:2304
    v_mfma_f32_16x16x32_bf16 v[48:51], a[148:151], a[112:115], v[48:51]
    ds_read_b64_tr_b16 a[188:189], v15 offset:256
    v_mfma_f32_16x16x32_bf16 v[52:55], a[148:151], a[116:119], v[52:55]
    ds_read_b64_tr_b16 a[190:191], v15 offset:2304
    v_mfma_f32_16x16x32_bf16 v[56:59], a[148:151], a[120:123], v[56:59]
    buffer_load_dwordx4 v24, s[16:19], s53 offen offset:3072  lds
    v_mfma_f32_16x16x32_bf16 v[60:63], a[148:151], a[124:127], v[60:63]
    s_add_u32 s28, s28, 262144
    v_add_u32 v8, 0x4000, v8
    v_add_u32 v9, 0x4000, v9
    v_mfma_f32_16x16x32_bf16 v[64:67], a[152:155], a[112:115], v[64:67]
    s_xor_b32 s53, s28, s55
    v_add_u32 v10, 0x4000, v10
    v_add_u32 v11, 0x4000, v11
    v_mfma_f32_16x16x32_bf16 v[68:71], a[152:155], a[116:119], v[68:71]
    v_add_u32 v12, 0x4000, v12
    v_add_u32 v13, 0x4000, v13
    v_mfma_f32_16x16x32_bf16 v[72:75], a[152:155], a[120:123], v[72:75]
    v_add_u32 v14, 0x4000, v14
    v_add_u32 v15, 0x4000, v15
    v_mfma_f32_16x16x32_bf16 v[76:79], a[152:155], a[124:127], v[76:79]
    s_add_u32 m0, s30, 114688
    v_mfma_f32_16x16x32_bf16 v[80:83], a[156:159], a[112:115], v[80:83]
    buffer_load_dwordx4 v21, s[16:19], s53 offen offset:0  lds
    v_mfma_f32_16x16x32_bf16 v[84:87], a[156:159], a[116:119], v[84:87]
    buffer_load_dword v31, v30, s[92:95], s33 offen offset:3072
    v_mfma_f32_16x16x32_bf16 v[88:91], a[156:159], a[120:123], v[88:91]
    s_waitcnt vmcnt(21) lgkmcnt(0)
    v_mfma_f32_16x16x32_bf16 v[92:95], a[156:159], a[124:127], v[92:95]
    s_barrier
    v_mfma_f32_16x16x32_bf16 v[96:99], a[160:163], a[112:115], v[96:99]
    ds_read_b64_tr_b16 a[128:129], v8 offset:0
    v_mfma_f32_16x16x32_bf16 v[100:103], a[160:163], a[116:119], v[100:103]
    ds_read_b64_tr_b16 a[130:131], v8 offset:2048
    v_mfma_f32_16x16x32_bf16 v[104:107], a[160:163], a[120:123], v[104:107]
    ds_read_b64_tr_b16 a[132:133], v9 offset:0
    v_mfma_f32_16x16x32_bf16 v[108:111], a[160:163], a[124:127], v[108:111]
    ds_read_b64_tr_b16 a[134:135], v9 offset:2048
    v_mfma_f32_16x16x32_bf16 v[112:115], a[164:167], a[112:115], v[112:115]
    buffer_load_dwordx4 v22, s[16:19], s53 offen offset:1024  lds
    v_mfma_f32_16x16x32_bf16 v[116:119], a[164:167], a[116:119], v[116:119]
    v_mfma_f32_16x16x32_bf16 v[120:123], a[164:167], a[120:123], v[120:123]
    ds_read_b64_tr_b16 a[136:137], v10 offset:0
    v_mfma_f32_16x16x32_bf16 v[124:127], a[164:167], a[124:127], v[124:127]
    ds_read_b64_tr_b16 a[138:139], v10 offset:2048
    v_mfma_f32_16x16x32_bf16 v[160:163], a[168:171], a[112:115], v[160:163]
    ds_read_b64_tr_b16 a[140:141], v11 offset:0
    v_mfma_f32_16x16x32_bf16 v[164:167], a[168:171], a[116:119], v[164:167]
    ds_read_b64_tr_b16 a[142:143], v11 offset:2048
    v_mfma_f32_16x16x32_bf16 v[168:171], a[168:171], a[120:123], v[168:171]
    buffer_load_dwordx4 v23, s[16:19], s53 offen offset:2048  lds
    v_mfma_f32_16x16x32_bf16 v[172:175], a[168:171], a[124:127], v[172:175]
    v_mfma_f32_16x16x32_bf16 v[176:179], a[172:175], a[112:115], v[176:179]
    ds_read_b64_tr_b16 a[144:145], v12 offset:0
    v_mfma_f32_16x16x32_bf16 v[180:183], a[172:175], a[116:119], v[180:183]
    ds_read_b64_tr_b16 a[146:147], v12 offset:2048
    v_mfma_f32_16x16x32_bf16 v[184:187], a[172:175], a[120:123], v[184:187]
    ds_read_b64_tr_b16 a[148:149], v13 offset:0
    v_mfma_f32_16x16x32_bf16 v[188:191], a[172:175], a[124:127], v[188:191]
    ds_read_b64_tr_b16 a[150:151], v13 offset:2048
    v_mfma_f32_16x16x32_bf16 v[192:195], a[176:179], a[112:115], v[192:195]
    buffer_load_dwordx4 v24, s[16:19], s53 offen offset:3072  lds
    v_mfma_f32_16x16x32_bf16 v[196:199], a[176:179], a[116:119], v[196:199]
    s_add_u32 s28, s28, 262144
    v_mfma_f32_16x16x32_bf16 v[200:203], a[176:179], a[120:123], v[200:203]
    s_xor_b32 s53, s28, s55
    ds_read_b64_tr_b16 a[152:153], v14 offset:0
    v_mfma_f32_16x16x32_bf16 v[204:207], a[176:179], a[124:127], v[204:207]
    ds_read_b64_tr_b16 a[154:155], v14 offset:2048
    v_mfma_f32_16x16x32_bf16 v[208:211], a[180:183], a[112:115], v[208:211]
    ds_read_b64_tr_b16 a[156:157], v15 offset:0
    v_mfma_f32_16x16x32_bf16 v[212:215], a[180:183], a[116:119], v[212:215]
    s_add_u32 m0, s30, 131072
    ds_read_b64_tr_b16 a[158:159], v15 offset:2048
    v_mfma_f32_16x16x32_bf16 v[216:219], a[180:183], a[120:123], v[216:219]
    buffer_load_dwordx4 v21, s[16:19], s53 offen offset:0  lds
    v_mfma_f32_16x16x32_bf16 v[220:223], a[180:183], a[124:127], v[220:223]
    v_mfma_f32_16x16x32_bf16 v[224:227], a[184:187], a[112:115], v[224:227]
    v_mfma_f32_16x16x32_bf16 v[228:231], a[184:187], a[116:119], v[228:231]
    v_mfma_f32_16x16x32_bf16 v[232:235], a[184:187], a[120:123], v[232:235]
    v_mfma_f32_16x16x32_bf16 v[236:239], a[184:187], a[124:127], v[236:239]
    v_mfma_f32_16x16x32_bf16 v[240:243], a[188:191], a[112:115], v[240:243]
    buffer_load_dwordx4 v22, s[16:19], s53 offen offset:1024  lds
    v_mfma_f32_16x16x32_bf16 v[244:247], a[188:191], a[116:119], v[244:247]
    v_mfma_f32_16x16x32_bf16 v[248:251], a[188:191], a[120:123], v[248:251]
    s_waitcnt lgkmcnt(10)
    v_mfma_f32_16x16x32_bf16 v[252:255], a[188:191], a[124:127], v[252:255]
    v_mfma_f32_16x16x32_bf16 a[224:227], a[128:131], a[192:195], a[224:227]
    ds_read_b64_tr_b16 a[160:161], v8 offset:256
    v_mfma_f32_16x16x32_bf16 a[228:231], a[128:131], a[196:199], a[228:231]
    ds_read_b64_tr_b16 a[162:163], v8 offset:2304
    v_mfma_f32_16x16x32_bf16 a[232:235], a[128:131], a[200:203], a[232:235]
    ds_read_b64_tr_b16 a[164:165], v9 offset:256
    v_mfma_f32_16x16x32_bf16 a[236:239], a[128:131], a[204:207], a[236:239]
    ds_read_b64_tr_b16 a[166:167], v9 offset:2304
    v_mfma_f32_16x16x32_bf16 a[240:243], a[132:135], a[192:195], a[240:243]
    buffer_load_dwordx4 v23, s[16:19], s53 offen offset:2048  lds
    v_mfma_f32_16x16x32_bf16 a[244:247], a[132:135], a[196:199], a[244:247]
    buffer_load_dwordx4 v24, s[16:19], s53 offen offset:3072  lds
    v_mfma_f32_16x16x32_bf16 a[248:251], a[132:135], a[200:203], a[248:251]
    s_add_u32 s28, s28, 262144
    ds_read_b64_tr_b16 a[168:169], v10 offset:256
    v_mfma_f32_16x16x32_bf16 a[252:255], a[132:135], a[204:207], a[252:255]
    s_xor_b32 s53, s28, s55
    ds_read_b64_tr_b16 a[170:171], v10 offset:2304
    v_mfma_f32_16x16x32_bf16 v[128:131], a[136:139], a[192:195], v[128:131]
    ds_read_b64_tr_b16 a[172:173], v11 offset:256
    v_mfma_f32_16x16x32_bf16 v[132:135], a[136:139], a[196:199], v[132:135]
    s_add_u32 m0, s31, 32768
    ds_read_b64_tr_b16 a[174:175], v11 offset:2304
    v_mfma_f32_16x16x32_bf16 v[136:139], a[136:139], a[200:203], v[136:139]
    buffer_load_dwordx4 v17, s[12:15], s52 offen offset:0  lds
    v_mfma_f32_16x16x32_bf16 v[140:143], a[136:139], a[204:207], v[140:143]
    s_waitcnt lgkmcnt(8)
    s_add_u32 s32, s52, 32768
    v_mfma_f32_16x16x32_bf16 v[144:147], a[140:143], a[192:195], v[144:147]
    ds_read_b64_tr_b16 a[176:177], v12 offset:256
    v_mfma_f32_16x16x32_bf16 v[148:151], a[140:143], a[196:199], v[148:151]
    ds_read_b64_tr_b16 a[178:179], v12 offset:2304
    v_mfma_f32_16x16x32_bf16 v[152:155], a[140:143], a[200:203], v[152:155]
    ds_read_b64_tr_b16 a[180:181], v13 offset:256
    v_mfma_f32_16x16x32_bf16 v[156:159], a[140:143], a[204:207], v[156:159]
    ds_read_b64_tr_b16 a[182:183], v13 offset:2304
    v_mfma_f32_16x16x32_bf16 v[32:35], a[144:147], a[192:195], v[32:35]
    buffer_load_dwordx4 v18, s[12:15], s52 offen offset:1024  lds
    v_mfma_f32_16x16x32_bf16 v[36:39], a[144:147], a[196:199], v[36:39]
    v_mfma_f32_16x16x32_bf16 v[40:43], a[144:147], a[200:203], v[40:43]
    ds_read_b64_tr_b16 a[184:185], v14 offset:256
    v_mfma_f32_16x16x32_bf16 v[44:47], a[144:147], a[204:207], v[44:47]
    ds_read_b64_tr_b16 a[186:187], v14 offset:2304
    v_mfma_f32_16x16x32_bf16 v[48:51], a[148:151], a[192:195], v[48:51]
    ds_read_b64_tr_b16 a[188:189], v15 offset:256
    v_mfma_f32_16x16x32_bf16 v[52:55], a[148:151], a[196:199], v[52:55]
    ds_read_b64_tr_b16 a[190:191], v15 offset:2304
    v_mfma_f32_16x16x32_bf16 v[56:59], a[148:151], a[200:203], v[56:59]
    buffer_load_dwordx4 v19, s[12:15], s52 offen offset:2048  lds
    v_mfma_f32_16x16x32_bf16 v[60:63], a[148:151], a[204:207], v[60:63]
    v_add_u32 v8, 0xffff0000, v8
    v_add_u32 v9, 0xffff0000, v9
    v_mfma_f32_16x16x32_bf16 v[64:67], a[152:155], a[192:195], v[64:67]
    v_add_u32 v10, 0xffff0000, v10
    v_add_u32 v11, 0xffff0000, v11
    v_mfma_f32_16x16x32_bf16 v[68:71], a[152:155], a[196:199], v[68:71]
    v_add_u32 v12, 0xffff0000, v12
    v_add_u32 v13, 0xffff0000, v13
    v_mfma_f32_16x16x32_bf16 v[72:75], a[152:155], a[200:203], v[72:75]
    v_add_u32 v14, 0xffff0000, v14
    v_add_u32 v15, 0xffff0000, v15
    v_mfma_f32_16x16x32_bf16 v[76:79], a[152:155], a[204:207], v[76:79]
    v_mfma_f32_16x16x32_bf16 v[80:83], a[156:159], a[192:195], v[80:83]
    buffer_load_dwordx4 v20, s[12:15], s52 offen offset:3072  lds
    v_mfma_f32_16x16x32_bf16 v[84:87], a[156:159], a[196:199], v[84:87]
    v_mfma_f32_16x16x32_bf16 v[88:91], a[156:159], a[200:203], v[88:91]
    s_waitcnt vmcnt(19) lgkmcnt(0)
    v_mfma_f32_16x16x32_bf16 v[92:95], a[156:159], a[204:207], v[92:95]
    s_barrier
    v_mfma_f32_16x16x32_bf16 v[96:99], a[160:163], a[192:195], v[96:99]
    ds_read_b128 a[64:67], v16 offset:0
    v_mfma_f32_16x16x32_bf16 v[100:103], a[160:163], a[196:199], v[100:103]
    ds_read_b128 a[68:71], v16 offset:2048
    v_mfma_f32_16x16x32_bf16 v[104:107], a[160:163], a[200:203], v[104:107]
    ds_read_b128 a[72:75], v16 offset:4096
    v_mfma_f32_16x16x32_bf16 v[108:111], a[160:163], a[204:207], v[108:111]
    ds_read_b128 a[76:79], v16 offset:6144
    v_mfma_f32_16x16x32_bf16 v[112:115], a[164:167], a[192:195], v[112:115]
    s_add_u32 m0, s31, 36864
    ds_read_b64_tr_b16 a[128:129], v8 offset:0
    v_mfma_f32_16x16x32_bf16 v[116:119], a[164:167], a[196:199], v[116:119]
    buffer_load_dwordx4 v17, s[12:15], s32 offen offset:0  lds
    v_mfma_f32_16x16x32_bf16 v[120:123], a[164:167], a[200:203], v[120:123]
    s_add_u32 s27, s27, 128
    ds_read_b64_tr_b16 a[130:131], v8 offset:2048
    v_mfma_f32_16x16x32_bf16 v[124:127], a[164:167], a[204:207], v[124:127]
    s_xor_b32 s52, s27, s54
    ds_read_b64_tr_b16 a[132:133], v9 offset:0
    v_mfma_f32_16x16x32_bf16 v[160:163], a[168:171], a[192:195], v[160:163]
    ds_read_b64_tr_b16 a[134:135], v9 offset:2048
    v_mfma_f32_16x16x32_bf16 v[164:167], a[168:171], a[196:199], v[164:167]
    ds_read_b64_tr_b16 a[136:137], v10 offset:0
    v_mfma_f32_16x16x32_bf16 v[168:171], a[168:171], a[200:203], v[168:171]
    ds_read_b64_tr_b16 a[138:139], v10 offset:2048
    v_mfma_f32_16x16x32_bf16 v[172:175], a[168:171], a[204:207], v[172:175]
    buffer_load_dwordx4 v18, s[12:15], s32 offen offset:1024  lds
    v_mfma_f32_16x16x32_bf16 v[176:179], a[172:175], a[192:195], v[176:179]
    ds_read_b64_tr_b16 a[140:141], v11 offset:0
    v_mfma_f32_16x16x32_bf16 v[180:183], a[172:175], a[196:199], v[180:183]
    ds_read_b64_tr_b16 a[142:143], v11 offset:2048
    v_mfma_f32_16x16x32_bf16 v[184:187], a[172:175], a[200:203], v[184:187]
    ds_read_b128 a[80:83], v4 offset:0
    v_mfma_f32_16x16x32_bf16 v[188:191], a[172:175], a[204:207], v[188:191]
    ds_read_b128 a[84:87], v4 offset:2048
    v_mfma_f32_16x16x32_bf16 v[192:195], a[176:179], a[192:195], v[192:195]
    ds_read_b128 a[88:91], v4 offset:4096
    v_mfma_f32_16x16x32_bf16 v[196:199], a[176:179], a[196:199], v[196:199]
    buffer_load_dwordx4 v19, s[12:15], s32 offen offset:2048  lds
    v_mfma_f32_16x16x32_bf16 v[200:203], a[176:179], a[200:203], v[200:203]
    ds_read_b128 a[92:95], v4 offset:6144
    v_mfma_f32_16x16x32_bf16 v[204:207], a[176:179], a[204:207], v[204:207]
    ds_read_b64_tr_b16 a[144:145], v12 offset:0
    v_mfma_f32_16x16x32_bf16 v[208:211], a[180:183], a[192:195], v[208:211]
    ds_read_b64_tr_b16 a[146:147], v12 offset:2048
    v_mfma_f32_16x16x32_bf16 v[212:215], a[180:183], a[196:199], v[212:215]
    ds_read_b64_tr_b16 a[148:149], v13 offset:0
    v_mfma_f32_16x16x32_bf16 v[216:219], a[180:183], a[200:203], v[216:219]
    ds_read_b64_tr_b16 a[150:151], v13 offset:2048
    v_mfma_f32_16x16x32_bf16 v[220:223], a[180:183], a[204:207], v[220:223]
    buffer_load_dwordx4 v20, s[12:15], s32 offen offset:3072  lds
    v_mfma_f32_16x16x32_bf16 v[224:227], a[184:187], a[192:195], v[224:227]
    ds_read_b64_tr_b16 a[152:153], v14 offset:0
    v_mfma_f32_16x16x32_bf16 v[228:231], a[184:187], a[196:199], v[228:231]
    ds_read_b64_tr_b16 a[154:155], v14 offset:2048
    v_mfma_f32_16x16x32_bf16 v[232:235], a[184:187], a[200:203], v[232:235]
    ds_read_b64_tr_b16 a[156:157], v15 offset:0
    v_mfma_f32_16x16x32_bf16 v[236:239], a[184:187], a[204:207], v[236:239]
    ds_read_b64_tr_b16 a[158:159], v15 offset:2048
    v_mfma_f32_16x16x32_bf16 v[240:243], a[188:191], a[192:195], v[240:243]
    s_add_u32 m0, s30, 147456
    v_mfma_f32_16x16x32_bf16 v[244:247], a[188:191], a[196:199], v[244:247]
    buffer_load_dwordx4 v21, s[16:19], s53 offen offset:0  lds
    v_mfma_f32_16x16x32_bf16 v[248:251], a[188:191], a[200:203], v[248:251]
    s_waitcnt lgkmcnt(14)
    v_mfma_f32_16x16x32_bf16 v[252:255], a[188:191], a[204:207], v[252:255]
    global_load_dword v31, v29, s[80:81]
    v_mfma_f32_16x16x32_bf16 a[224:227], a[128:131], a[208:211], a[224:227]
    ds_read_b64_tr_b16 a[160:161], v8 offset:256
    v_mfma_f32_16x16x32_bf16 a[228:231], a[128:131], a[212:215], a[228:231]
    ds_read_b64_tr_b16 a[162:163], v8 offset:2304
    v_mfma_f32_16x16x32_bf16 a[232:235], a[128:131], a[216:219], a[232:235]
    ds_read_b64_tr_b16 a[164:165], v9 offset:256
    v_mfma_f32_16x16x32_bf16 a[236:239], a[128:131], a[220:223], a[236:239]
    ds_read_b64_tr_b16 a[166:167], v9 offset:2304
    v_mfma_f32_16x16x32_bf16 a[240:243], a[132:135], a[208:211], a[240:243]
    buffer_load_dwordx4 v22, s[16:19], s53 offen offset:1024  lds
    v_mfma_f32_16x16x32_bf16 a[244:247], a[132:135], a[212:215], a[244:247]
    buffer_load_dwordx4 v23, s[16:19], s53 offen offset:2048  lds
    v_mfma_f32_16x16x32_bf16 a[248:251], a[132:135], a[216:219], a[248:251]
    ds_read_b64_tr_b16 a[168:169], v10 offset:256
    v_mfma_f32_16x16x32_bf16 a[252:255], a[132:135], a[220:223], a[252:255]
    ds_read_b64_tr_b16 a[170:171], v10 offset:2304
    v_mfma_f32_16x16x32_bf16 v[128:131], a[136:139], a[208:211], v[128:131]
    ds_read_b64_tr_b16 a[172:173], v11 offset:256
    v_mfma_f32_16x16x32_bf16 v[132:135], a[136:139], a[212:215], v[132:135]
    ds_read_b64_tr_b16 a[174:175], v11 offset:2304
    v_mfma_f32_16x16x32_bf16 v[136:139], a[136:139], a[216:219], v[136:139]
    buffer_load_dwordx4 v24, s[16:19], s53 offen offset:3072  lds
    v_mfma_f32_16x16x32_bf16 v[140:143], a[136:139], a[220:223], v[140:143]
    s_waitcnt lgkmcnt(8)
    s_add_u32 s28, s28, 262144
    v_mfma_f32_16x16x32_bf16 v[144:147], a[140:143], a[208:211], v[144:147]
    s_xor_b32 s53, s28, s55
    ds_read_b64_tr_b16 a[176:177], v12 offset:256
    v_mfma_f32_16x16x32_bf16 v[148:151], a[140:143], a[212:215], v[148:151]
    ds_read_b64_tr_b16 a[178:179], v12 offset:2304
    v_mfma_f32_16x16x32_bf16 v[152:155], a[140:143], a[216:219], v[152:155]
    ds_read_b64_tr_b16 a[180:181], v13 offset:256
    v_mfma_f32_16x16x32_bf16 v[156:159], a[140:143], a[220:223], v[156:159]
    ds_read_b64_tr_b16 a[182:183], v13 offset:2304
    v_mfma_f32_16x16x32_bf16 v[32:35], a[144:147], a[208:211], v[32:35]
    v_mfma_f32_16x16x32_bf16 v[36:39], a[144:147], a[212:215], v[36:39]
    v_mfma_f32_16x16x32_bf16 v[40:43], a[144:147], a[216:219], v[40:43]
    ds_read_b64_tr_b16 a[184:185], v14 offset:256
    v_mfma_f32_16x16x32_bf16 v[44:47], a[144:147], a[220:223], v[44:47]
    ds_read_b64_tr_b16 a[186:187], v14 offset:2304
    v_mfma_f32_16x16x32_bf16 v[48:51], a[148:151], a[208:211], v[48:51]
    ds_read_b64_tr_b16 a[188:189], v15 offset:256
    v_mfma_f32_16x16x32_bf16 v[52:55], a[148:151], a[212:215], v[52:55]
    ds_read_b64_tr_b16 a[190:191], v15 offset:2304
    v_mfma_f32_16x16x32_bf16 v[56:59], a[148:151], a[216:219], v[56:59]
    v_mfma_f32_16x16x32_bf16 v[60:63], a[148:151], a[220:223], v[60:63]
    v_add_u32 v8, 0x4000, v8
    v_add_u32 v9, 0x4000, v9
    v_mfma_f32_16x16x32_bf16 v[64:67], a[152:155], a[208:211], v[64:67]
    v_add_u32 v10, 0x4000, v10
    v_add_u32 v11, 0x4000, v11
    v_mfma_f32_16x16x32_bf16 v[68:71], a[152:155], a[212:215], v[68:71]
    v_add_u32 v12, 0x4000, v12
    v_add_u32 v13, 0x4000, v13
    v_mfma_f32_16x16x32_bf16 v[72:75], a[152:155], a[216:219], v[72:75]
    v_add_u32 v14, 0x4000, v14
    v_add_u32 v15, 0x4000, v15
    v_mfma_f32_16x16x32_bf16 v[76:79], a[152:155], a[220:223], v[76:79]
    v_mfma_f32_16x16x32_bf16 v[80:83], a[156:159], a[208:211], v[80:83]
    v_mfma_f32_16x16x32_bf16 v[84:87], a[156:159], a[212:215], v[84:87]
    v_mfma_f32_16x16x32_bf16 v[88:91], a[156:159], a[216:219], v[88:91]
    s_waitcnt vmcnt(13) lgkmcnt(0)
    v_mfma_f32_16x16x32_bf16 v[92:95], a[156:159], a[220:223], v[92:95]
    s_barrier
    v_mfma_f32_16x16x32_bf16 v[96:99], a[160:163], a[208:211], v[96:99]
    ds_read_b64_tr_b16 a[32:33], v8 offset:0
    v_and_b32 v5, 15, v0
    v_mfma_f32_16x16x32_bf16 v[100:103], a[160:163], a[212:215], v[100:103]
    ds_read_b64_tr_b16 a[34:35], v8 offset:2048
    v_bfe_u32 v6, v0, 5, 1
    v_mfma_f32_16x16x32_bf16 v[104:107], a[160:163], a[216:219], v[104:107]
    ds_read_b64_tr_b16 a[48:49], v9 offset:0
    v_bfe_u32 v7, v0, 4, 1
    v_mfma_f32_16x16x32_bf16 v[108:111], a[160:163], a[220:223], v[108:111]
    ds_read_b64_tr_b16 a[50:51], v9 offset:2048
    v_lshl_or_b32 v6, v7, 1, v6
    v_mfma_f32_16x16x32_bf16 v[112:115], a[164:167], a[208:211], v[112:115]
    ds_read_b64_tr_b16 a[36:37], v8 offset:16384
    v_xor_b32 v6, v6, v5
    v_mfma_f32_16x16x32_bf16 v[116:119], a[164:167], a[212:215], v[116:119]
    ds_read_b64_tr_b16 a[38:39], v8 offset:18432
    v_lshlrev_b32 v6, 4, v6
    v_mfma_f32_16x16x32_bf16 v[120:123], a[164:167], a[216:219], v[120:123]
    ds_read_b64_tr_b16 a[52:53], v9 offset:16384
    v_lshl_add_u32 v17, v5, 8, v6
    v_mfma_f32_16x16x32_bf16 v[124:127], a[164:167], a[220:223], v[124:127]
    ds_read_b64_tr_b16 a[54:55], v9 offset:18432
    v_xor_b32 v18, 64, v17
    v_mfma_f32_16x16x32_bf16 v[160:163], a[168:171], a[208:211], v[160:163]
    ds_read_b64_tr_b16 a[40:41], v8 offset:32768
    v_xor_b32 v19, 0x80, v17
    v_mfma_f32_16x16x32_bf16 v[164:167], a[168:171], a[212:215], v[164:167]
    ds_read_b64_tr_b16 a[42:43], v8 offset:34816
    v_xor_b32 v20, 0xc0, v17
    v_mfma_f32_16x16x32_bf16 v[168:171], a[168:171], a[216:219], v[168:171]
    ds_read_b64_tr_b16 a[56:57], v9 offset:32768
    v_lshrrev_b32 v5, 2, v0
    v_mfma_f32_16x16x32_bf16 v[172:175], a[168:171], a[220:223], v[172:175]
    ds_read_b64_tr_b16 a[58:59], v9 offset:34816
    v_and_b32 v6, 7, v5
    v_mfma_f32_16x16x32_bf16 v[176:179], a[172:175], a[208:211], v[176:179]
    v_lshlrev_b32 v5, 8, v5
    v_lshl_add_u32 v5, v6, 5, v5
    v_mfma_f32_16x16x32_bf16 v[180:183], a[172:175], a[212:215], v[180:183]
    v_and_b32 v6, 3, v0
    v_lshl_add_u32 v5, v6, 3, v5
    v_mfma_f32_16x16x32_bf16 v[184:187], a[172:175], a[216:219], v[184:187]
    s_waitcnt vmcnt(0)
    v_add_u32 v5, 65536, v5
    v_mfma_f32_16x16x32_bf16 v[188:191], a[172:175], a[220:223], v[188:191]
    s_barrier
    v_mfma_f32_16x16x32_bf16 v[192:195], a[176:179], a[208:211], v[192:195]
    ds_read_b128 a[96:99], v16 offset:32768
    v_mfma_f32_16x16x32_bf16 v[196:199], a[176:179], a[212:215], v[196:199]
    ds_read_b128 a[112:115], v4 offset:32768
    v_mfma_f32_16x16x32_bf16 v[200:203], a[176:179], a[216:219], v[200:203]
    ds_read_b64_tr_b16 a[44:45], v8 offset:49152
    v_mfma_f32_16x16x32_bf16 v[204:207], a[176:179], a[220:223], v[204:207]
    ds_read_b64_tr_b16 a[46:47], v8 offset:51200
    v_mfma_f32_16x16x32_bf16 v[208:211], a[180:183], a[208:211], v[208:211]
    ds_read_b64_tr_b16 a[60:61], v9 offset:49152
    v_mfma_f32_16x16x32_bf16 v[212:215], a[180:183], a[212:215], v[212:215]
    ds_read_b64_tr_b16 a[62:63], v9 offset:51200
    v_mfma_f32_16x16x32_bf16 v[216:219], a[180:183], a[216:219], v[216:219]
    ds_read_b128 a[100:103], v16 offset:34816
    v_mfma_f32_16x16x32_bf16 v[220:223], a[180:183], a[220:223], v[220:223]
    ds_read_b128 a[116:119], v4 offset:34816
    v_mfma_f32_16x16x32_bf16 v[224:227], a[184:187], a[208:211], v[224:227]
    ds_read_b128 a[104:107], v16 offset:36864
    v_mfma_f32_16x16x32_bf16 v[228:231], a[184:187], a[212:215], v[228:231]
    ds_read_b128 a[120:123], v4 offset:36864
    v_mfma_f32_16x16x32_bf16 v[232:235], a[184:187], a[216:219], v[232:235]
    ds_read_b128 a[108:111], v16 offset:38912
    v_mfma_f32_16x16x32_bf16 v[236:239], a[184:187], a[220:223], v[236:239]
    ds_read_b128 a[124:127], v4 offset:38912
    v_mfma_f32_16x16x32_bf16 v[240:243], a[188:191], a[208:211], v[240:243]
    v_mfma_f32_16x16x32_bf16 v[244:247], a[188:191], a[212:215], v[244:247]
    v_mfma_f32_16x16x32_bf16 v[248:251], a[188:191], a[216:219], v[248:251]
    v_mfma_f32_16x16x32_bf16 v[252:255], a[188:191], a[220:223], v[252:255]
    s_waitcnt lgkmcnt(6)
    v_mfma_f32_16x16x32_bf16 a[224:227], a[32:35], a[64:67], a[224:227]
    v_mfma_f32_16x16x32_bf16 a[224:227], a[36:39], a[80:83], a[224:227]
    v_mfma_f32_16x16x32_bf16 a[224:227], a[40:43], a[96:99], a[224:227]
    v_mfma_f32_16x16x32_bf16 a[224:227], a[44:47], a[112:115], a[224:227]
    ds_read_b64_tr_b16 a[0:1], v10 offset:0
    v_mfma_f32_16x16x32_bf16 a[240:243], a[48:51], a[64:67], a[240:243]
    ds_read_b64_tr_b16 a[2:3], v10 offset:2048
    s_add_u32 m0, s29, 0
    v_mfma_f32_16x16x32_bf16 a[240:243], a[52:55], a[80:83], a[240:243]
    buffer_load_dwordx4 v25, s[4:7], s50 offen nt lds
    v_mfma_f32_16x16x32_bf16 a[240:243], a[56:59], a[96:99], a[240:243]
    ds_read_b64_tr_b16 a[4:5], v10 offset:16384
    v_mfma_f32_16x16x32_bf16 a[240:243], a[60:63], a[112:115], a[240:243]
    s_waitcnt lgkmcnt(7)
    ds_read_b64_tr_b16 a[6:7], v10 offset:18432
    v_mfma_f32_16x16x32_bf16 a[228:231], a[32:35], a[68:71], a[228:231]
    v_mfma_f32_16x16x32_bf16 a[228:231], a[36:39], a[84:87], a[228:231]
    ds_read_b64_tr_b16 a[8:9], v10 offset:32768
    v_mfma_f32_16x16x32_bf16 a[228:231], a[40:43], a[100:103], a[228:231]
    ds_read_b64_tr_b16 a[10:11], v10 offset:34816
    v_accvgpr_read_b32 v1, a224
    v_accvgpr_read_b32 v2, a225
    v_mfma_f32_16x16x32_bf16 a[228:231], a[44:47], a[116:119], a[228:231]
    v_accvgpr_read_b32 v3, a226
    v_accvgpr_read_b32 v4, a227
    v_accvgpr_read_b32 v21, a240
    v_mfma_f32_16x16x32_bf16 a[244:247], a[48:51], a[68:71], a[244:247]
    s_waitcnt lgkmcnt(6)
    ds_read_b64_tr_b16 a[12:13], v10 offset:49152
    v_accvgpr_read_b32 v22, a241
    v_accvgpr_read_b32 v23, a242
    v_mfma_f32_16x16x32_bf16 a[244:247], a[52:55], a[84:87], a[244:247]
    s_barrier
    ds_read_b64_tr_b16 a[14:15], v10 offset:51200
    v_accvgpr_read_b32 v24, a243
    v_cvt_pk_bf16_f32 v1, v1, v2
    v_mfma_f32_16x16x32_bf16 a[244:247], a[56:59], a[100:103], a[244:247]
    v_cvt_pk_bf16_f32 v21, v21, v22
    v_cvt_pk_bf16_f32 v3, v3, v4
    v_cvt_pk_bf16_f32 v23, v23, v24
    v_mfma_f32_16x16x32_bf16 a[244:247], a[60:63], a[116:119], a[244:247]
    ds_read_b64_tr_b16 a[16:17], v11 offset:0
    v_permlane16_swap_b32 v1, v21
    v_accvgpr_write_b32 a128, v1
    v_mfma_f32_16x16x32_bf16 a[232:235], a[32:35], a[72:75], a[232:235]
    ds_read_b64_tr_b16 a[18:19], v11 offset:2048
    v_accvgpr_write_b32 a130, v21
    v_permlane16_swap_b32 v3, v23
    v_mfma_f32_16x16x32_bf16 a[232:235], a[36:39], a[88:91], a[232:235]
    v_accvgpr_write_b32 a129, v3
    v_accvgpr_write_b32 a131, v23
    v_mfma_f32_16x16x32_bf16 a[232:235], a[40:43], a[104:107], a[232:235]
    ds_read_b64_tr_b16 a[20:21], v11 offset:16384
    v_accvgpr_read_b32 v1, a228
    v_accvgpr_read_b32 v2, a229
    v_mfma_f32_16x16x32_bf16 a[232:235], a[44:47], a[120:123], a[232:235]
    ds_read_b64_tr_b16 a[22:23], v11 offset:18432
    v_accvgpr_read_b32 v3, a230
    v_accvgpr_read_b32 v4, a231
    v_mfma_f32_16x16x32_bf16 a[248:251], a[48:51], a[72:75], a[248:251]
    v_accvgpr_read_b32 v21, a244
    v_accvgpr_read_b32 v22, a245
    v_accvgpr_read_b32 v23, a246
    v_mfma_f32_16x16x32_bf16 a[248:251], a[52:55], a[88:91], a[248:251]
    ds_read_b64_tr_b16 a[24:25], v11 offset:32768
    v_accvgpr_read_b32 v24, a247
    v_cvt_pk_bf16_f32 v1, v1, v2
    v_mfma_f32_16x16x32_bf16 a[248:251], a[56:59], a[104:107], a[248:251]
    ds_read_b64_tr_b16 a[26:27], v11 offset:34816
    v_cvt_pk_bf16_f32 v21, v21, v22
    v_cvt_pk_bf16_f32 v3, v3, v4
    v_mfma_f32_16x16x32_bf16 a[248:251], a[60:63], a[120:123], a[248:251]
    v_cvt_pk_bf16_f32 v23, v23, v24
    v_permlane16_swap_b32 v1, v21
    v_accvgpr_write_b32 a144, v1
    v_mfma_f32_16x16x32_bf16 a[236:239], a[32:35], a[76:79], a[236:239]
    ds_read_b64_tr_b16 a[28:29], v11 offset:49152
    v_accvgpr_write_b32 a146, v21
    v_permlane16_swap_b32 v3, v23
    v_mfma_f32_16x16x32_bf16 a[236:239], a[36:39], a[92:95], a[236:239]
    ds_read_b64_tr_b16 a[30:31], v11 offset:51200
    v_accvgpr_write_b32 a145, v3
    v_accvgpr_write_b32 a147, v23
    v_mfma_f32_16x16x32_bf16 a[236:239], a[40:43], a[108:111], a[236:239]
    v_accvgpr_read_b32 v1, a232
    v_accvgpr_read_b32 v2, a233
    v_accvgpr_read_b32 v3, a234
    v_mfma_f32_16x16x32_bf16 a[236:239], a[44:47], a[124:127], a[236:239]
    v_accvgpr_read_b32 v4, a235
    v_accvgpr_read_b32 v21, a248
    v_accvgpr_read_b32 v22, a249
    v_mfma_f32_16x16x32_bf16 a[252:255], a[48:51], a[76:79], a[252:255]
    buffer_load_dwordx4 v26, s[4:7], s50 offen offset:1024 nt lds
    s_add_u32 s25, s25, 8192
    s_xor_b32 s50, s25, s49
    v_mfma_f32_16x16x32_bf16 a[252:255], a[52:55], a[92:95], a[252:255]
    v_accvgpr_read_b32 v23, a250
    v_accvgpr_read_b32 v24, a251
    v_mfma_f32_16x16x32_bf16 a[252:255], a[56:59], a[108:111], a[252:255]
    v_cvt_pk_bf16_f32 v1, v1, v2
    v_cvt_pk_bf16_f32 v21, v21, v22
    v_cvt_pk_bf16_f32 v3, v3, v4
    v_mfma_f32_16x16x32_bf16 a[252:255], a[60:63], a[124:127], a[252:255]
    s_waitcnt lgkmcnt(0)
    v_cvt_pk_bf16_f32 v23, v23, v24
    v_permlane16_swap_b32 v1, v21
    v_accvgpr_write_b32 a160, v1
    v_mfma_f32_16x16x32_bf16 v[128:131], a[0:3], a[64:67], v[128:131]
    v_accvgpr_write_b32 a162, v21
    v_permlane16_swap_b32 v3, v23
    v_accvgpr_write_b32 a161, v3
    v_mfma_f32_16x16x32_bf16 v[128:131], a[4:7], a[80:83], v[128:131]
    ds_read_b64_tr_b16 a[32:33], v12 offset:0
    v_accvgpr_write_b32 a163, v23
    v_mfma_f32_16x16x32_bf16 v[128:131], a[8:11], a[96:99], v[128:131]
    ds_read_b64_tr_b16 a[34:35], v12 offset:2048
    v_accvgpr_read_b32 v1, a236
    v_accvgpr_read_b32 v2, a237
    v_mfma_f32_16x16x32_bf16 v[128:131], a[12:15], a[112:115], v[128:131]
    v_accvgpr_read_b32 v3, a238
    v_accvgpr_read_b32 v4, a239
    v_accvgpr_read_b32 v21, a252
    v_mfma_f32_16x16x32_bf16 v[144:147], a[16:19], a[64:67], v[144:147]
    ds_read_b64_tr_b16 a[36:37], v12 offset:16384
    v_accvgpr_read_b32 v22, a253
    v_accvgpr_read_b32 v23, a254
    v_mfma_f32_16x16x32_bf16 v[144:147], a[20:23], a[80:83], v[144:147]
    ds_read_b64_tr_b16 a[38:39], v12 offset:18432
    v_accvgpr_read_b32 v24, a255
    v_cvt_pk_bf16_f32 v1, v1, v2
    v_cvt_pk_bf16_f32 v21, v21, v22
    v_mfma_f32_16x16x32_bf16 v[144:147], a[24:27], a[96:99], v[144:147]
    v_cvt_pk_bf16_f32 v3, v3, v4
    v_cvt_pk_bf16_f32 v23, v23, v24
    v_permlane16_swap_b32 v1, v21
    v_mfma_f32_16x16x32_bf16 v[144:147], a[28:31], a[112:115], v[144:147]
    ds_read_b64_tr_b16 a[40:41], v12 offset:32768
    v_accvgpr_write_b32 a176, v1
    v_accvgpr_write_b32 a178, v21
    v_mfma_f32_16x16x32_bf16 v[132:135], a[0:3], a[68:71], v[132:135]
    ds_read_b64_tr_b16 a[42:43], v12 offset:34816
    s_add_u32 m0, s29, 8192
    v_permlane16_swap_b32 v3, v23
    v_mfma_f32_16x16x32_bf16 v[132:135], a[4:7], a[84:87], v[132:135]
    buffer_load_dwordx4 v25, s[4:7], s50 offen nt lds
    v_accvgpr_write_b32 a177, v3
    v_accvgpr_write_b32 a179, v23
    v_mfma_f32_16x16x32_bf16 v[132:135], a[8:11], a[100:103], v[132:135]
    ds_read_b64_tr_b16 a[44:45], v12 offset:49152
    v_cvt_pk_bf16_f32 v128, v128, v129
    v_mfma_f32_16x16x32_bf16 v[132:135], a[12:15], a[116:119], v[132:135]
    ds_read_b64_tr_b16 a[46:47], v12 offset:51200
    v_cvt_pk_bf16_f32 v144, v144, v145
    v_mfma_f32_16x16x32_bf16 v[148:151], a[16:19], a[68:71], v[148:151]
    v_cvt_pk_bf16_f32 v130, v130, v131
    v_cvt_pk_bf16_f32 v146, v146, v147
    v_mfma_f32_16x16x32_bf16 v[148:151], a[20:23], a[84:87], v[148:151]
    ds_read_b64_tr_b16 a[48:49], v13 offset:0
    v_permlane16_swap_b32 v128, v144
    v_mfma_f32_16x16x32_bf16 v[148:151], a[24:27], a[100:103], v[148:151]
    ds_read_b64_tr_b16 a[50:51], v13 offset:2048
    v_accvgpr_write_b32 a132, v128
    v_mfma_f32_16x16x32_bf16 v[148:151], a[28:31], a[116:119], v[148:151]
    v_accvgpr_write_b32 a134, v144
    v_permlane16_swap_b32 v130, v146
    v_mfma_f32_16x16x32_bf16 v[136:139], a[0:3], a[72:75], v[136:139]
    ds_read_b64_tr_b16 a[52:53], v13 offset:16384
    v_accvgpr_write_b32 a133, v130
    v_mfma_f32_16x16x32_bf16 v[136:139], a[4:7], a[88:91], v[136:139]
    ds_read_b64_tr_b16 a[54:55], v13 offset:18432
    v_accvgpr_write_b32 a135, v146
    v_mfma_f32_16x16x32_bf16 v[136:139], a[8:11], a[104:107], v[136:139]
    v_cvt_pk_bf16_f32 v132, v132, v133
    v_cvt_pk_bf16_f32 v148, v148, v149
    v_mfma_f32_16x16x32_bf16 v[136:139], a[12:15], a[120:123], v[136:139]
    ds_read_b64_tr_b16 a[56:57], v13 offset:32768
    v_cvt_pk_bf16_f32 v134, v134, v135
    v_mfma_f32_16x16x32_bf16 v[152:155], a[16:19], a[72:75], v[152:155]
    ds_read_b64_tr_b16 a[58:59], v13 offset:34816
    v_cvt_pk_bf16_f32 v150, v150, v151
    v_mfma_f32_16x16x32_bf16 v[152:155], a[20:23], a[88:91], v[152:155]
    v_permlane16_swap_b32 v132, v148
    v_accvgpr_write_b32 a148, v132
    v_mfma_f32_16x16x32_bf16 v[152:155], a[24:27], a[104:107], v[152:155]
    ds_read_b64_tr_b16 a[60:61], v13 offset:49152
    v_accvgpr_write_b32 a150, v148
    v_mfma_f32_16x16x32_bf16 v[152:155], a[28:31], a[120:123], v[152:155]
    ds_read_b64_tr_b16 a[62:63], v13 offset:51200
    v_permlane16_swap_b32 v134, v150
    v_mfma_f32_16x16x32_bf16 v[140:143], a[0:3], a[76:79], v[140:143]
    v_accvgpr_write_b32 a149, v134
    v_accvgpr_write_b32 a151, v150
    v_mfma_f32_16x16x32_bf16 v[140:143], a[4:7], a[92:95], v[140:143]
    v_mfma_f32_16x16x32_bf16 v[140:143], a[8:11], a[108:111], v[140:143]
    v_cvt_pk_bf16_f32 v136, v136, v137
    v_cvt_pk_bf16_f32 v152, v152, v153
    v_mfma_f32_16x16x32_bf16 v[140:143], a[12:15], a[124:127], v[140:143]
    buffer_load_dwordx4 v26, s[4:7], s50 offen offset:1024 nt lds
    s_add_u32 s25, s25, 8192
    s_xor_b32 s50, s25, s49
    v_mfma_f32_16x16x32_bf16 v[156:159], a[16:19], a[76:79], v[156:159]
    v_mfma_f32_16x16x32_bf16 v[156:159], a[20:23], a[92:95], v[156:159]
    v_cvt_pk_bf16_f32 v138, v138, v139
    v_cvt_pk_bf16_f32 v154, v154, v155
    v_mfma_f32_16x16x32_bf16 v[156:159], a[24:27], a[108:111], v[156:159]
    v_permlane16_swap_b32 v136, v152
    v_accvgpr_write_b32 a164, v136
    v_mfma_f32_16x16x32_bf16 v[156:159], a[28:31], a[124:127], v[156:159]
    s_waitcnt lgkmcnt(0)
    v_accvgpr_write_b32 a166, v152
    v_permlane16_swap_b32 v138, v154
    v_mfma_f32_16x16x32_bf16 v[32:35], a[32:35], a[64:67], v[32:35]
    v_accvgpr_write_b32 a165, v138
    v_accvgpr_write_b32 a167, v154
    v_mfma_f32_16x16x32_bf16 v[32:35], a[36:39], a[80:83], v[32:35]
    ds_read_b64_tr_b16 a[0:1], v14 offset:0
    v_mfma_f32_16x16x32_bf16 v[32:35], a[40:43], a[96:99], v[32:35]
    ds_read_b64_tr_b16 a[2:3], v14 offset:2048
    v_cvt_pk_bf16_f32 v140, v140, v141
    v_mfma_f32_16x16x32_bf16 v[32:35], a[44:47], a[112:115], v[32:35]
    v_cvt_pk_bf16_f32 v156, v156, v157
    v_cvt_pk_bf16_f32 v142, v142, v143
    v_mfma_f32_16x16x32_bf16 v[48:51], a[48:51], a[64:67], v[48:51]
    ds_read_b64_tr_b16 a[4:5], v14 offset:16384
    v_cvt_pk_bf16_f32 v158, v158, v159
    v_mfma_f32_16x16x32_bf16 v[48:51], a[52:55], a[80:83], v[48:51]
    ds_read_b64_tr_b16 a[6:7], v14 offset:18432
    v_permlane16_swap_b32 v140, v156
    v_mfma_f32_16x16x32_bf16 v[48:51], a[56:59], a[96:99], v[48:51]
    v_accvgpr_write_b32 a180, v140
    v_accvgpr_write_b32 a182, v156
    v_mfma_f32_16x16x32_bf16 v[48:51], a[60:63], a[112:115], v[48:51]
    ds_read_b64_tr_b16 a[8:9], v14 offset:32768
    v_permlane16_swap_b32 v142, v158
    v_mfma_f32_16x16x32_bf16 v[36:39], a[32:35], a[68:71], v[36:39]
    ds_read_b64_tr_b16 a[10:11], v14 offset:34816
    v_accvgpr_write_b32 a181, v142
    v_mfma_f32_16x16x32_bf16 v[36:39], a[36:39], a[84:87], v[36:39]
    v_accvgpr_write_b32 a183, v158
    v_mfma_f32_16x16x32_bf16 v[36:39], a[40:43], a[100:103], v[36:39]
    ds_read_b64_tr_b16 a[12:13], v14 offset:49152
    v_cvt_pk_bf16_f32 v32, v32, v33
    v_mfma_f32_16x16x32_bf16 v[36:39], a[44:47], a[116:119], v[36:39]
    ds_read_b64_tr_b16 a[14:15], v14 offset:51200
    v_cvt_pk_bf16_f32 v48, v48, v49
    v_mfma_f32_16x16x32_bf16 v[52:55], a[48:51], a[68:71], v[52:55]
    v_cvt_pk_bf16_f32 v34, v34, v35
    v_cvt_pk_bf16_f32 v50, v50, v51
    v_mfma_f32_16x16x32_bf16 v[52:55], a[52:55], a[84:87], v[52:55]
    ds_read_b64_tr_b16 a[16:17], v15 offset:0
    v_permlane16_swap_b32 v32, v48
    v_mfma_f32_16x16x32_bf16 v[52:55], a[56:59], a[100:103], v[52:55]
    ds_read_b64_tr_b16 a[18:19], v15 offset:2048
    v_accvgpr_write_b32 a136, v32
    v_mfma_f32_16x16x32_bf16 v[52:55], a[60:63], a[116:119], v[52:55]
    v_accvgpr_write_b32 a138, v48
    v_permlane16_swap_b32 v34, v50
    v_mfma_f32_16x16x32_bf16 v[40:43], a[32:35], a[72:75], v[40:43]
    ds_read_b64_tr_b16 a[20:21], v15 offset:16384
    v_accvgpr_write_b32 a137, v34
    v_mfma_f32_16x16x32_bf16 v[40:43], a[36:39], a[88:91], v[40:43]
    ds_read_b64_tr_b16 a[22:23], v15 offset:18432
    v_accvgpr_write_b32 a139, v50
    v_mfma_f32_16x16x32_bf16 v[40:43], a[40:43], a[104:107], v[40:43]
    v_cvt_pk_bf16_f32 v36, v36, v37
    v_cvt_pk_bf16_f32 v52, v52, v53
    v_mfma_f32_16x16x32_bf16 v[40:43], a[44:47], a[120:123], v[40:43]
    ds_read_b64_tr_b16 a[24:25], v15 offset:32768
    v_cvt_pk_bf16_f32 v38, v38, v39
    v_mfma_f32_16x16x32_bf16 v[56:59], a[48:51], a[72:75], v[56:59]
    ds_read_b64_tr_b16 a[26:27], v15 offset:34816
    v_cvt_pk_bf16_f32 v54, v54, v55
    v_mfma_f32_16x16x32_bf16 v[56:59], a[52:55], a[88:91], v[56:59]
    v_permlane16_swap_b32 v36, v52
    v_accvgpr_write_b32 a152, v36
    v_mfma_f32_16x16x32_bf16 v[56:59], a[56:59], a[104:107], v[56:59]
    ds_read_b64_tr_b16 a[28:29], v15 offset:49152
    v_accvgpr_write_b32 a154, v52
    v_mfma_f32_16x16x32_bf16 v[56:59], a[60:63], a[120:123], v[56:59]
    ds_read_b64_tr_b16 a[30:31], v15 offset:51200
    v_permlane16_swap_b32 v38, v54
    v_mfma_f32_16x16x32_bf16 v[44:47], a[32:35], a[76:79], v[44:47]
    v_accvgpr_write_b32 a153, v38
    v_accvgpr_write_b32 a155, v54
    v_mfma_f32_16x16x32_bf16 v[44:47], a[36:39], a[92:95], v[44:47]
    v_mfma_f32_16x16x32_bf16 v[44:47], a[40:43], a[108:111], v[44:47]
    v_cvt_pk_bf16_f32 v40, v40, v41
    v_cvt_pk_bf16_f32 v56, v56, v57
    v_mfma_f32_16x16x32_bf16 v[44:47], a[44:47], a[124:127], v[44:47]
    v_cvt_pk_bf16_f32 v42, v42, v43
    v_cvt_pk_bf16_f32 v58, v58, v59
    v_mfma_f32_16x16x32_bf16 v[60:63], a[48:51], a[76:79], v[60:63]
    v_permlane16_swap_b32 v40, v56
    v_accvgpr_write_b32 a168, v40
    v_mfma_f32_16x16x32_bf16 v[60:63], a[52:55], a[92:95], v[60:63]
    v_accvgpr_write_b32 a170, v56
    v_permlane16_swap_b32 v42, v58
    v_mfma_f32_16x16x32_bf16 v[60:63], a[56:59], a[108:111], v[60:63]
    v_accvgpr_write_b32 a169, v42
    v_accvgpr_write_b32 a171, v58
    v_mfma_f32_16x16x32_bf16 v[60:63], a[60:63], a[124:127], v[60:63]
    s_waitcnt lgkmcnt(0)
    v_mfma_f32_16x16x32_bf16 v[64:67], a[0:3], a[64:67], v[64:67]
    v_mfma_f32_16x16x32_bf16 v[64:67], a[4:7], a[80:83], v[64:67]
    ds_read_b64_tr_b16 a[32:33], v8 offset:256
    v_mfma_f32_16x16x32_bf16 v[64:67], a[8:11], a[96:99], v[64:67]
    ds_read_b64_tr_b16 a[34:35], v8 offset:2304
    v_cvt_pk_bf16_f32 v44, v44, v45
    v_mfma_f32_16x16x32_bf16 v[64:67], a[12:15], a[112:115], v[64:67]
    v_cvt_pk_bf16_f32 v60, v60, v61
    v_cvt_pk_bf16_f32 v46, v46, v47
    v_mfma_f32_16x16x32_bf16 v[80:83], a[16:19], a[64:67], v[80:83]
    ds_read_b64_tr_b16 a[36:37], v8 offset:16640
    v_cvt_pk_bf16_f32 v62, v62, v63
    v_mfma_f32_16x16x32_bf16 v[80:83], a[20:23], a[80:83], v[80:83]
    ds_read_b64_tr_b16 a[38:39], v8 offset:18688
    v_permlane16_swap_b32 v44, v60
    v_accvgpr_write_b32 a184, v44
    v_mfma_f32_16x16x32_bf16 v[80:83], a[24:27], a[96:99], v[80:83]
    v_accvgpr_write_b32 a186, v60
    v_permlane16_swap_b32 v46, v62
    v_mfma_f32_16x16x32_bf16 v[80:83], a[28:31], a[112:115], v[80:83]
    ds_read_b64_tr_b16 a[40:41], v8 offset:33024
    v_accvgpr_write_b32 a185, v46
    v_mfma_f32_16x16x32_bf16 v[68:71], a[0:3], a[68:71], v[68:71]
    ds_read_b64_tr_b16 a[42:43], v8 offset:35072
    s_add_u32 m0, s29, 16384
    v_mfma_f32_16x16x32_bf16 v[68:71], a[4:7], a[84:87], v[68:71]
    buffer_load_dwordx4 v25, s[4:7], s50 offen nt lds
    v_accvgpr_write_b32 a187, v62
    v_mfma_f32_16x16x32_bf16 v[68:71], a[8:11], a[100:103], v[68:71]
    ds_read_b64_tr_b16 a[44:45], v8 offset:49408
    v_cvt_pk_bf16_f32 v64, v64, v65
    v_mfma_f32_16x16x32_bf16 v[68:71], a[12:15], a[116:119], v[68:71]
    ds_read_b64_tr_b16 a[46:47], v8 offset:51456
    v_cvt_pk_bf16_f32 v80, v80, v81
    v_mfma_f32_16x16x32_bf16 v[84:87], a[16:19], a[68:71], v[84:87]
    v_cvt_pk_bf16_f32 v66, v66, v67
    v_cvt_pk_bf16_f32 v82, v82, v83
    v_mfma_f32_16x16x32_bf16 v[84:87], a[20:23], a[84:87], v[84:87]
    ds_read_b64_tr_b16 a[48:49], v9 offset:256
    v_permlane16_swap_b32 v64, v80
    v_mfma_f32_16x16x32_bf16 v[84:87], a[24:27], a[100:103], v[84:87]
    ds_read_b64_tr_b16 a[50:51], v9 offset:2304
    v_accvgpr_write_b32 a140, v64
    v_mfma_f32_16x16x32_bf16 v[84:87], a[28:31], a[116:119], v[84:87]
    v_accvgpr_write_b32 a142, v80
    v_permlane16_swap_b32 v66, v82
    v_mfma_f32_16x16x32_bf16 v[72:75], a[0:3], a[72:75], v[72:75]
    ds_read_b64_tr_b16 a[52:53], v9 offset:16640
    v_accvgpr_write_b32 a141, v66
    v_mfma_f32_16x16x32_bf16 v[72:75], a[4:7], a[88:91], v[72:75]
    ds_read_b64_tr_b16 a[54:55], v9 offset:18688
    v_accvgpr_write_b32 a143, v82
    v_mfma_f32_16x16x32_bf16 v[72:75], a[8:11], a[104:107], v[72:75]
    v_cvt_pk_bf16_f32 v68, v68, v69
    v_cvt_pk_bf16_f32 v84, v84, v85
    v_mfma_f32_16x16x32_bf16 v[72:75], a[12:15], a[120:123], v[72:75]
    ds_read_b64_tr_b16 a[56:57], v9 offset:33024
    v_cvt_pk_bf16_f32 v70, v70, v71
    v_mfma_f32_16x16x32_bf16 v[88:91], a[16:19], a[72:75], v[88:91]
    ds_read_b64_tr_b16 a[58:59], v9 offset:35072
    v_cvt_pk_bf16_f32 v86, v86, v87
    v_mfma_f32_16x16x32_bf16 v[88:91], a[20:23], a[88:91], v[88:91]
    v_permlane16_swap_b32 v68, v84
    v_accvgpr_write_b32 a156, v68
    v_mfma_f32_16x16x32_bf16 v[88:91], a[24:27], a[104:107], v[88:91]
    ds_read_b64_tr_b16 a[60:61], v9 offset:49408
    v_accvgpr_write_b32 a158, v84
    v_mfma_f32_16x16x32_bf16 v[88:91], a[28:31], a[120:123], v[88:91]
    ds_read_b64_tr_b16 a[62:63], v9 offset:51456
    v_permlane16_swap_b32 v70, v86
    v_mfma_f32_16x16x32_bf16 v[76:79], a[0:3], a[76:79], v[76:79]
    v_accvgpr_write_b32 a157, v70
    v_accvgpr_write_b32 a159, v86
    v_mfma_f32_16x16x32_bf16 v[76:79], a[4:7], a[92:95], v[76:79]
    v_mfma_f32_16x16x32_bf16 v[76:79], a[8:11], a[108:111], v[76:79]
    v_cvt_pk_bf16_f32 v72, v72, v73
    v_cvt_pk_bf16_f32 v88, v88, v89
    v_mfma_f32_16x16x32_bf16 v[76:79], a[12:15], a[124:127], v[76:79]
    buffer_load_dwordx4 v26, s[4:7], s50 offen offset:1024 nt lds
    s_add_u32 s25, s25, 8192
    s_xor_b32 s50, s25, s49
    v_mfma_f32_16x16x32_bf16 v[92:95], a[16:19], a[76:79], v[92:95]
    v_mfma_f32_16x16x32_bf16 v[92:95], a[20:23], a[92:95], v[92:95]
    v_cvt_pk_bf16_f32 v74, v74, v75
    v_cvt_pk_bf16_f32 v90, v90, v91
    v_mfma_f32_16x16x32_bf16 v[92:95], a[24:27], a[108:111], v[92:95]
    v_permlane16_swap_b32 v72, v88
    v_accvgpr_write_b32 a172, v72
    v_mfma_f32_16x16x32_bf16 v[92:95], a[28:31], a[124:127], v[92:95]
    s_waitcnt lgkmcnt(0)
    v_accvgpr_write_b32 a174, v88
    v_permlane16_swap_b32 v74, v90
    v_mfma_f32_16x16x32_bf16 v[96:99], a[32:35], a[64:67], v[96:99]
    s_cmp_eq_u32 s24, 3
    v_accvgpr_write_b32 a173, v74
    v_accvgpr_write_b32 a175, v90
    v_mfma_f32_16x16x32_bf16 v[96:99], a[36:39], a[80:83], v[96:99]
    s_mov_b32 s42, 0xff800000
    ds_read_b64_tr_b16 a[0:1], v10 offset:256
    v_mfma_f32_16x16x32_bf16 v[96:99], a[40:43], a[96:99], v[96:99]
    s_cselect_b32 s42, 0x44fa0000, s42
    ds_read_b64_tr_b16 a[2:3], v10 offset:2304
    v_cvt_pk_bf16_f32 v76, v76, v77
    v_mfma_f32_16x16x32_bf16 v[96:99], a[44:47], a[112:115], v[96:99]
    s_mov_b32 s36, 0
    v_cvt_pk_bf16_f32 v92, v92, v93
    v_cvt_pk_bf16_f32 v78, v78, v79
    v_mfma_f32_16x16x32_bf16 v[112:115], a[48:51], a[64:67], v[112:115]
    s_mov_b32 s27, 0
    ds_read_b64_tr_b16 a[4:5], v10 offset:16640
    v_cvt_pk_bf16_f32 v94, v94, v95
    v_mfma_f32_16x16x32_bf16 v[112:115], a[52:55], a[80:83], v[112:115]
    s_cselect_b32 s28, 0, -1
    ds_read_b64_tr_b16 a[6:7], v10 offset:18688
    v_permlane16_swap_b32 v76, v92
    v_accvgpr_write_b32 a188, v76
    v_mfma_f32_16x16x32_bf16 v[112:115], a[56:59], a[96:99], v[112:115]
    s_mov_b32 s33, 0x90
    v_accvgpr_write_b32 a190, v92
    v_permlane16_swap_b32 v78, v94
    v_mfma_f32_16x16x32_bf16 v[112:115], a[60:63], a[112:115], v[112:115]
    ds_read_b64_tr_b16 a[8:9], v10 offset:33024
    v_accvgpr_write_b32 a189, v78
    v_mfma_f32_16x16x32_bf16 v[100:103], a[32:35], a[68:71], v[100:103]
    ds_read_b64_tr_b16 a[10:11], v10 offset:35072
    s_add_u32 m0, s29, 24576
    v_mfma_f32_16x16x32_bf16 v[100:103], a[36:39], a[84:87], v[100:103]
    buffer_load_dwordx4 v25, s[4:7], s50 offen nt lds
    v_accvgpr_write_b32 a191, v94
    v_mfma_f32_16x16x32_bf16 v[100:103], a[40:43], a[100:103], v[100:103]
    ds_read_b64_tr_b16 a[12:13], v10 offset:49408
    v_cvt_pk_bf16_f32 v96, v96, v97
    v_mfma_f32_16x16x32_bf16 v[100:103], a[44:47], a[116:119], v[100:103]
    ds_read_b64_tr_b16 a[14:15], v10 offset:51456
    v_cvt_pk_bf16_f32 v112, v112, v113
    v_mfma_f32_16x16x32_bf16 v[116:119], a[48:51], a[68:71], v[116:119]
    v_cvt_pk_bf16_f32 v98, v98, v99
    v_cvt_pk_bf16_f32 v114, v114, v115
    v_mfma_f32_16x16x32_bf16 v[116:119], a[52:55], a[84:87], v[116:119]
    ds_read_b64_tr_b16 a[16:17], v11 offset:256
    v_permlane16_swap_b32 v96, v112
    v_mfma_f32_16x16x32_bf16 v[116:119], a[56:59], a[100:103], v[116:119]
    ds_read_b64_tr_b16 a[18:19], v11 offset:2304
    v_accvgpr_write_b32 a192, v96
    v_mfma_f32_16x16x32_bf16 v[116:119], a[60:63], a[116:119], v[116:119]
    v_accvgpr_write_b32 a194, v112
    v_permlane16_swap_b32 v98, v114
    v_mfma_f32_16x16x32_bf16 v[104:107], a[32:35], a[72:75], v[104:107]
    ds_read_b64_tr_b16 a[20:21], v11 offset:16640
    v_accvgpr_write_b32 a193, v98
    v_mfma_f32_16x16x32_bf16 v[104:107], a[36:39], a[88:91], v[104:107]
    ds_read_b64_tr_b16 a[22:23], v11 offset:18688
    v_accvgpr_write_b32 a195, v114
    v_mfma_f32_16x16x32_bf16 v[104:107], a[40:43], a[104:107], v[104:107]
    v_cvt_pk_bf16_f32 v100, v100, v101
    v_cvt_pk_bf16_f32 v116, v116, v117
    v_mfma_f32_16x16x32_bf16 v[104:107], a[44:47], a[120:123], v[104:107]
    ds_read_b64_tr_b16 a[24:25], v11 offset:33024
    v_cvt_pk_bf16_f32 v102, v102, v103
    v_mfma_f32_16x16x32_bf16 v[120:123], a[48:51], a[72:75], v[120:123]
    ds_read_b64_tr_b16 a[26:27], v11 offset:35072
    v_cvt_pk_bf16_f32 v118, v118, v119
    v_mfma_f32_16x16x32_bf16 v[120:123], a[52:55], a[88:91], v[120:123]
    v_permlane16_swap_b32 v100, v116
    v_accvgpr_write_b32 a208, v100
    v_mfma_f32_16x16x32_bf16 v[120:123], a[56:59], a[104:107], v[120:123]
    ds_read_b64_tr_b16 a[28:29], v11 offset:49408
    v_accvgpr_write_b32 a210, v116
    v_mfma_f32_16x16x32_bf16 v[120:123], a[60:63], a[120:123], v[120:123]
    ds_read_b64_tr_b16 a[30:31], v11 offset:51456
    v_permlane16_swap_b32 v102, v118
    v_mfma_f32_16x16x32_bf16 v[108:111], a[32:35], a[76:79], v[108:111]
    v_accvgpr_write_b32 a209, v102
    v_accvgpr_write_b32 a211, v118
    v_mfma_f32_16x16x32_bf16 v[108:111], a[36:39], a[92:95], v[108:111]
    v_mfma_f32_16x16x32_bf16 v[108:111], a[40:43], a[108:111], v[108:111]
    v_cvt_pk_bf16_f32 v104, v104, v105
    v_cvt_pk_bf16_f32 v120, v120, v121
    v_mfma_f32_16x16x32_bf16 v[108:111], a[44:47], a[124:127], v[108:111]
    buffer_load_dwordx4 v26, s[4:7], s50 offen offset:1024 nt lds
    s_add_u32 s25, s25, 8192
    s_xor_b32 s50, s25, s49
    v_mfma_f32_16x16x32_bf16 v[124:127], a[48:51], a[76:79], v[124:127]
    v_mfma_f32_16x16x32_bf16 v[124:127], a[52:55], a[92:95], v[124:127]
    v_cvt_pk_bf16_f32 v106, v106, v107
    v_cvt_pk_bf16_f32 v122, v122, v123
    v_mfma_f32_16x16x32_bf16 v[124:127], a[56:59], a[108:111], v[124:127]
    v_permlane16_swap_b32 v104, v120
    v_accvgpr_write_b32 a224, v104
    v_mfma_f32_16x16x32_bf16 v[124:127], a[60:63], a[124:127], v[124:127]
    s_waitcnt lgkmcnt(0)
    v_accvgpr_write_b32 a226, v120
    v_permlane16_swap_b32 v106, v122
    v_mfma_f32_16x16x32_bf16 v[160:163], a[0:3], a[64:67], v[160:163]
    s_waitcnt vmcnt(6)
    v_accvgpr_write_b32 a225, v106
    v_accvgpr_write_b32 a227, v122
    v_mfma_f32_16x16x32_bf16 v[160:163], a[4:7], a[80:83], v[160:163]
    s_barrier
    v_mfma_f32_16x16x32_bf16 v[160:163], a[8:11], a[96:99], v[160:163]
    v_cvt_pk_bf16_f32 v108, v108, v109
    v_cvt_pk_bf16_f32 v124, v124, v125
    v_mfma_f32_16x16x32_bf16 v[160:163], a[12:15], a[112:115], v[160:163]
    ds_read_b128 v[128:131], v17 offset:0
    s_add_u32 m0, s29, 81920
    v_mfma_f32_16x16x32_bf16 v[176:179], a[16:19], a[64:67], v[176:179]
    buffer_load_dwordx4 v27, s[8:11], s51 offen nt lds
    v_mfma_f32_16x16x32_bf16 v[176:179], a[20:23], a[80:83], v[176:179]
    v_cvt_pk_bf16_f32 v110, v110, v111
    v_cvt_pk_bf16_f32 v126, v126, v127
    v_mfma_f32_16x16x32_bf16 v[176:179], a[24:27], a[96:99], v[176:179]
    ds_read_b128 v[132:135], v18 offset:0
    v_permlane16_swap_b32 v108, v124
    v_mfma_f32_16x16x32_bf16 v[176:179], a[28:31], a[112:115], v[176:179]
    v_accvgpr_write_b32 a240, v108
    v_accvgpr_write_b32 a242, v124
    v_mfma_f32_16x16x32_bf16 v[164:167], a[0:3], a[68:71], v[164:167]
    v_permlane16_swap_b32 v110, v126
    v_accvgpr_write_b32 a241, v110
    v_mfma_f32_16x16x32_bf16 v[164:167], a[4:7], a[84:87], v[164:167]
    ds_read_b128 v[136:139], v19 offset:0
    v_accvgpr_write_b32 a243, v126
    v_mfma_f32_16x16x32_bf16 v[164:167], a[8:11], a[100:103], v[164:167]
    v_cvt_pk_bf16_f32 v160, v160, v161
    v_cvt_pk_bf16_f32 v176, v176, v177
    v_cvt_pk_bf16_f32 v162, v162, v163
    v_cvt_pk_bf16_f32 v178, v178, v179
    v_mfma_f32_16x16x32_bf16 v[164:167], a[12:15], a[116:119], v[164:167]
    v_permlane16_swap_b32 v160, v176
    v_accvgpr_write_b32 a196, v160
    v_accvgpr_write_b32 a198, v176
    v_permlane16_swap_b32 v162, v178
    v_mfma_f32_16x16x32_bf16 v[180:183], a[16:19], a[68:71], v[180:183]
    ds_read_b128 v[140:143], v20 offset:0
    v_accvgpr_write_b32 a197, v162
    v_accvgpr_write_b32 a199, v178
    v_and_b32 v6, 3, v0
    v_mfma_f32_16x16x32_bf16 v[180:183], a[20:23], a[84:87], v[180:183]
    v_cmp_eq_u32 vcc, 0, v6
    v_mov_b32 v7, 0x3f803f80
    v_mov_b32 v112, 0
    v_mov_b32 v113, 0
    v_cndmask_b32 v104, 0, v7, vcc
    v_mfma_f32_16x16x32_bf16 v[180:183], a[24:27], a[100:103], v[180:183]
    v_cndmask_b32 v105, 0, v7, vcc
    v_cndmask_b32 v106, 0, v7, vcc
    v_cndmask_b32 v107, 0, v7, vcc
    v_mov_b32 v108, 0xff800000
    v_mfma_f32_16x16x32_bf16 v[180:183], a[28:31], a[116:119], v[180:183]
    ds_read_b128 v[144:147], v17 offset:4096
    v_mov_b32 v109, 0xff800000
    v_mov_b32 v110, 0xff800000
    v_mov_b32 v111, s42
    v_mfma_f32_16x16x32_bf16 v[168:171], a[0:3], a[72:75], v[168:171]
    buffer_load_dwordx4 v28, s[8:11], s51 offen offset:1024 nt lds
    s_add_u32 s26, s26, 8192
    s_xor_b32 s51, s26, s49
    v_mfma_f32_16x16x32_bf16 v[168:171], a[4:7], a[88:91], v[168:171]
    v_mov_b32 v21, 0xff800000
    v_mov_b32 v22, 0xff800000
    v_mov_b32 v23, 0xff800000
    v_mov_b32 v24, s42
    v_mfma_f32_16x16x32_bf16 v[168:171], a[8:11], a[104:107], v[168:171]
    ds_read_b128 v[148:151], v18 offset:4096
    v_cvt_pk_bf16_f32 v164, v164, v165
    s_cmp_lt_u32 s90, 1073741824
    s_cbranch_scc1 L_announce
L_annback:
    s_cmp_eq_u32 s38, 2
    s_cbranch_scc1 L_mgload
L_mgback:
    v_mfma_f32_16x16x32_bf16 v[168:171], a[12:15], a[120:123], v[168:171]
    v_cvt_pk_bf16_f32 v180, v180, v181
    v_cvt_pk_bf16_f32 v166, v166, v167
    v_mfma_f32_16x16x32_bf16 v[184:187], a[16:19], a[72:75], v[184:187]
    v_cvt_pk_bf16_f32 v182, v182, v183
    v_permlane16_swap_b32 v164, v180
    v_mfma_f32_16x16x32_bf16 v[184:187], a[20:23], a[88:91], v[184:187]
    ds_read_b128 v[152:155], v19 offset:4096
    v_accvgpr_write_b32 a212, v164
    v_mfma_f32_16x16x32_bf16 v[184:187], a[24:27], a[104:107], v[184:187]
    v_accvgpr_write_b32 a214, v180
    v_permlane16_swap_b32 v166, v182
    v_mfma_f32_16x16x32_bf16 v[184:187], a[28:31], a[120:123], v[184:187]
    v_accvgpr_write_b32 a213, v166
    v_accvgpr_write_b32 a215, v182
    v_mfma_f32_16x16x32_bf16 v[172:175], a[0:3], a[76:79], v[172:175]
    ds_read_b128 v[156:159], v20 offset:4096
    v_mfma_f32_16x16x32_bf16 v[172:175], a[4:7], a[92:95], v[172:175]
    v_mfma_f32_16x16x32_bf16 v[172:175], a[8:11], a[108:111], v[172:175]
    v_cvt_pk_bf16_f32 v168, v168, v169
    s_nop 0
    v_cvt_pk_bf16_f32 v184, v184, v185
    v_mfma_f32_16x16x32_bf16 v[172:175], a[12:15], a[124:127], v[172:175]
    v_cvt_pk_bf16_f32 v170, v170, v171
    v_cvt_pk_bf16_f32 v186, v186, v187
    v_mfma_f32_16x16x32_bf16 v[188:191], a[16:19], a[76:79], v[188:191]
    v_permlane16_swap_b32 v168, v184
    v_accvgpr_write_b32 a228, v168
    v_mfma_f32_16x16x32_bf16 v[188:191], a[20:23], a[92:95], v[188:191]
    v_accvgpr_write_b32 a230, v184
    v_permlane16_swap_b32 v170, v186
    v_mfma_f32_16x16x32_bf16 v[188:191], a[24:27], a[108:111], v[188:191]
    v_accvgpr_write_b32 a229, v170
    v_accvgpr_write_b32 a231, v186
    v_mfma_f32_16x16x32_bf16 v[188:191], a[28:31], a[124:127], v[188:191]
    s_waitcnt lgkmcnt(0)
    v_mfma_f32_16x16x32_bf16 v[32:35], v[128:131], a[128:131], 0
    v_mfma_f32_16x16x32_bf16 v[32:35], v[132:135], a[132:135], v[32:35]
    ds_read_b64_tr_b16 a[32:33], v12 offset:256
    v_mfma_f32_16x16x32_bf16 v[32:35], v[136:139], a[136:139], v[32:35]
    ds_read_b64_tr_b16 a[34:35], v12 offset:2304
    v_cvt_pk_bf16_f32 v172, v172, v173
    v_mfma_f32_16x16x32_bf16 v[32:35], v[140:143], a[140:143], v[32:35]
    v_cvt_pk_bf16_f32 v188, v188, v189
    v_cvt_pk_bf16_f32 v174, v174, v175
    v_mfma_f32_16x16x32_bf16 v[36:39], v[144:147], a[128:131], 0
    ds_read_b64_tr_b16 a[36:37], v12 offset:16640
    v_cvt_pk_bf16_f32 v190, v190, v191
    v_mfma_f32_16x16x32_bf16 v[36:39], v[148:151], a[132:135], v[36:39]
    ds_read_b64_tr_b16 a[38:39], v12 offset:18688
    v_permlane16_swap_b32 v172, v188
    v_mfma_f32_16x16x32_bf16 v[36:39], v[152:155], a[136:139], v[36:39]
    v_accvgpr_write_b32 a244, v172
    v_accvgpr_write_b32 a246, v188
    v_mfma_f32_16x16x32_bf16 v[36:39], v[156:159], a[140:143], v[36:39]
    ds_read_b64_tr_b16 a[40:41], v12 offset:33024
    v_permlane16_swap_b32 v174, v190
    v_mfma_f32_16x16x32_bf16 v[40:43], v[128:131], a[144:147], 0
    ds_read_b64_tr_b16 a[42:43], v12 offset:35072
    v_accvgpr_write_b32 a245, v174
    v_mfma_f32_16x16x32_bf16 v[40:43], v[132:135], a[148:151], v[40:43]
    v_accvgpr_write_b32 a247, v190
    v_mfma_f32_16x16x32_bf16 v[40:43], v[136:139], a[152:155], v[40:43]
    ds_read_b64_tr_b16 a[44:45], v12 offset:49408
    v_max3_f32 v118, v32, v33, v108
    v_max3_f32 v119, v34, v35, v36
    v_mfma_f32_16x16x32_bf16 v[40:43], v[140:143], a[156:159], v[40:43]
    ds_read_b64_tr_b16 a[46:47], v12 offset:51456
    v_max3_f32 v118, v118, v37, v38
    v_max3_f32 v118, v118, v119, v39
    v_mfma_f32_16x16x32_bf16 v[44:47], v[144:147], a[144:147], 0
    v_mov_b32 v119, v118
    s_nop 1
    v_permlane16_swap_b32 v118, v119
    v_max_f32 v118, v118, v119
    v_mfma_f32_16x16x32_bf16 v[44:47], v[148:151], a[148:151], v[44:47]
    ds_read_b64_tr_b16 a[48:49], v13 offset:256
    v_mov_b32 v119, v118
    s_nop 1
    v_permlane32_swap_b32 v118, v119
    v_mfma_f32_16x16x32_bf16 v[44:47], v[152:155], a[152:155], v[44:47]
    ds_read_b64_tr_b16 a[50:51], v13 offset:2304
    v_max_f32 v118, v118, v119
    v_sub_f32 v32, v32, v118
    v_mfma_f32_16x16x32_bf16 v[44:47], v[156:159], a[156:159], v[44:47]
    v_sub_f32 v33, v33, v118
    v_sub_f32 v34, v34, v118
    v_sub_f32 v35, v35, v118
    v_mfma_f32_16x16x32_bf16 v[48:51], v[128:131], a[160:163], 0
    ds_read_b64_tr_b16 a[52:53], v13 offset:16640
    v_sub_f32 v36, v36, v118
    v_sub_f32 v37, v37, v118
    v_mfma_f32_16x16x32_bf16 v[48:51], v[132:135], a[164:167], v[48:51]
    ds_read_b64_tr_b16 a[54:55], v13 offset:18688
    v_sub_f32 v38, v38, v118
    v_sub_f32 v39, v39, v118
    v_mfma_f32_16x16x32_bf16 v[48:51], v[136:139], a[168:171], v[48:51]
    v_sub_f32 v80, 0, v118
    v_sub_f32 v81, 0, v118
    v_sub_f32 v82, 0, v118
    v_mfma_f32_16x16x32_bf16 v[48:51], v[140:143], a[172:175], v[48:51]
    ds_read_b64_tr_b16 a[56:57], v13 offset:33024
    v_sub_f32 v83, 0, v118
    v_mfma_f32_16x16x32_bf16 v[52:55], v[144:147], a[160:163], 0
    ds_read_b64_tr_b16 a[58:59], v13 offset:35072
    v_max3_f32 v118, v40, v41, v109
    v_mfma_f32_16x16x32_bf16 v[52:55], v[148:151], a[164:167], v[52:55]
    v_max3_f32 v119, v42, v43, v44
    v_max3_f32 v118, v118, v45, v46
    v_max3_f32 v118, v118, v119, v47
    v_mfma_f32_16x16x32_bf16 v[52:55], v[152:155], a[168:171], v[52:55]
    ds_read_b64_tr_b16 a[60:61], v13 offset:49408
    v_mov_b32 v119, v118
    v_mfma_f32_16x16x32_bf16 v[52:55], v[156:159], a[172:175], v[52:55]
    ds_read_b64_tr_b16 a[62:63], v13 offset:51456
    v_permlane16_swap_b32 v118, v119
    v_max_f32 v118, v118, v119
    v_mfma_f32_16x16x32_bf16 v[56:59], v[128:131], a[176:179], 0
    v_mov_b32 v119, v118
    s_nop 1
    v_permlane32_swap_b32 v118, v119
    v_mfma_f32_16x16x32_bf16 v[56:59], v[132:135], a[180:183], v[56:59]
    v_max_f32 v118, v118, v119
    v_sub_f32 v40, v40, v118
    v_sub_f32 v41, v41, v118
    v_mfma_f32_16x16x32_bf16 v[56:59], v[136:139], a[184:187], v[56:59]
    v_sub_f32 v42, v42, v118
    v_sub_f32 v43, v43, v118
    v_mfma_f32_16x16x32_bf16 v[56:59], v[140:143], a[188:191], v[56:59]
    v_sub_f32 v44, v44, v118
    v_sub_f32 v45, v45, v118
    v_sub_f32 v46, v46, v118
    v_mfma_f32_16x16x32_bf16 v[60:63], v[144:147], a[176:179], 0
    v_sub_f32 v47, v47, v118
    v_sub_f32 v84, 0, v118
    v_mfma_f32_16x16x32_bf16 v[60:63], v[148:151], a[180:183], v[60:63]
    v_sub_f32 v85, 0, v118
    v_sub_f32 v86, 0, v118
    v_sub_f32 v87, 0, v118
    v_mfma_f32_16x16x32_bf16 v[60:63], v[152:155], a[184:187], v[60:63]
    v_max3_f32 v118, v48, v49, v110
    v_max3_f32 v119, v50, v51, v52
    v_mfma_f32_16x16x32_bf16 v[60:63], v[156:159], a[188:191], v[60:63]
    s_waitcnt lgkmcnt(0)
    v_max3_f32 v118, v118, v53, v54
    v_max3_f32 v118, v118, v119, v55
    v_mov_b32 v119, v118
    v_mfma_f32_16x16x32_bf16 v[192:195], a[32:35], a[64:67], v[192:195]
    s_nop 0
    v_permlane16_swap_b32 v118, v119
    v_max_f32 v118, v118, v119
    v_mov_b32 v119, v118
    v_mfma_f32_16x16x32_bf16 v[192:195], a[36:39], a[80:83], v[192:195]
    ds_read_b64_tr_b16 a[0:1], v14 offset:256
    v_permlane32_swap_b32 v118, v119
    v_max_f32 v118, v118, v119
    v_mfma_f32_16x16x32_bf16 v[192:195], a[40:43], a[96:99], v[192:195]
    ds_read_b64_tr_b16 a[2:3], v14 offset:2304
    v_sub_f32 v48, v48, v118
    v_mfma_f32_16x16x32_bf16 v[192:195], a[44:47], a[112:115], v[192:195]
    v_sub_f32 v49, v49, v118
    v_sub_f32 v50, v50, v118
    v_sub_f32 v51, v51, v118
    v_mfma_f32_16x16x32_bf16 v[208:211], a[48:51], a[64:67], v[208:211]
    ds_read_b64_tr_b16 a[4:5], v14 offset:16640
    v_sub_f32 v52, v52, v118
    v_sub_f32 v53, v53, v118
    v_mfma_f32_16x16x32_bf16 v[208:211], a[52:55], a[80:83], v[208:211]
    ds_read_b64_tr_b16 a[6:7], v14 offset:18688
    v_sub_f32 v54, v54, v118
    v_sub_f32 v55, v55, v118
    v_mfma_f32_16x16x32_bf16 v[208:211], a[56:59], a[96:99], v[208:211]
    v_sub_f32 v88, 0, v118
    v_sub_f32 v89, 0, v118
    v_mfma_f32_16x16x32_bf16 v[208:211], a[60:63], a[112:115], v[208:211]
    ds_read_b64_tr_b16 a[8:9], v14 offset:33024
    v_sub_f32 v90, 0, v118
    v_sub_f32 v91, 0, v118
    v_mfma_f32_16x16x32_bf16 v[196:199], a[32:35], a[68:71], v[196:199]
    ds_read_b64_tr_b16 a[10:11], v14 offset:35072
    s_add_u32 m0, s29, 32768
    v_mfma_f32_16x16x32_bf16 v[196:199], a[36:39], a[84:87], v[196:199]
    buffer_load_dwordx4 v25, s[4:7], s50 offen nt lds
    v_mfma_f32_16x16x32_bf16 v[196:199], a[40:43], a[100:103], v[196:199]
    ds_read_b64_tr_b16 a[12:13], v14 offset:49408
    v_cvt_pk_bf16_f32 v192, v192, v193
    v_max3_f32 v118, v56, v57, v111
    v_mfma_f32_16x16x32_bf16 v[196:199], a[44:47], a[116:119], v[196:199]
    ds_read_b64_tr_b16 a[14:15], v14 offset:51456
    v_cvt_pk_bf16_f32 v208, v208, v209
    v_max3_f32 v119, v58, v59, v60
    v_max3_f32 v118, v118, v61, v62
    v_mfma_f32_16x16x32_bf16 v[212:215], a[48:51], a[68:71], v[212:215]
    v_cvt_pk_bf16_f32 v194, v194, v195
    v_cvt_pk_bf16_f32 v210, v210, v211
    v_max3_f32 v118, v118, v119, v63
    v_mfma_f32_16x16x32_bf16 v[212:215], a[52:55], a[84:87], v[212:215]
    ds_read_b64_tr_b16 a[16:17], v15 offset:256
    v_permlane16_swap_b32 v192, v208
    v_mov_b32 v119, v118
    s_nop 1
    v_permlane16_swap_b32 v118, v119
    v_mfma_f32_16x16x32_bf16 v[212:215], a[56:59], a[100:103], v[212:215]
    ds_read_b64_tr_b16 a[18:19], v15 offset:2304
    v_accvgpr_write_b32 a200, v192
    v_max_f32 v118, v118, v119
    v_mfma_f32_16x16x32_bf16 v[212:215], a[60:63], a[116:119], v[212:215]
    v_accvgpr_write_b32 a202, v208
    v_permlane16_swap_b32 v194, v210
    v_mov_b32 v119, v118
    s_nop 1
    v_permlane32_swap_b32 v118, v119
    v_mfma_f32_16x16x32_bf16 v[200:203], a[32:35], a[72:75], v[200:203]
    ds_read_b64_tr_b16 a[20:21], v15 offset:16640
    v_accvgpr_write_b32 a201, v194
    v_max_f32 v118, v118, v119
    v_mfma_f32_16x16x32_bf16 v[200:203], a[36:39], a[88:91], v[200:203]
    ds_read_b64_tr_b16 a[22:23], v15 offset:18688
    v_accvgpr_write_b32 a203, v210
    v_sub_f32 v56, v56, v118
    v_sub_f32 v57, v57, v118
    v_mfma_f32_16x16x32_bf16 v[200:203], a[40:43], a[104:107], v[200:203]
    v_cvt_pk_bf16_f32 v196, v196, v197
    v_cvt_pk_bf16_f32 v212, v212, v213
    v_sub_f32 v58, v58, v118
    v_mfma_f32_16x16x32_bf16 v[200:203], a[44:47], a[120:123], v[200:203]
    ds_read_b64_tr_b16 a[24:25], v15 offset:33024
    v_cvt_pk_bf16_f32 v198, v198, v199
    v_sub_f32 v59, v59, v118
    v_sub_f32 v60, v60, v118
    v_mfma_f32_16x16x32_bf16 v[216:219], a[48:51], a[72:75], v[216:219]
    ds_read_b64_tr_b16 a[26:27], v15 offset:35072
    v_cvt_pk_bf16_f32 v214, v214, v215
    v_sub_f32 v61, v61, v118
    v_mfma_f32_16x16x32_bf16 v[216:219], a[52:55], a[88:91], v[216:219]
    buffer_load_dwordx4 v26, s[4:7], s50 offen offset:1024 nt lds
    s_add_u32 s25, s25, 8192
    s_xor_b32 s50, s25, s49
    v_mfma_f32_16x16x32_bf16 v[216:219], a[56:59], a[104:107], v[216:219]
    ds_read_b64_tr_b16 a[28:29], v15 offset:49408
    v_sub_f32 v62, v62, v118
    v_sub_f32 v63, v63, v118
    v_mfma_f32_16x16x32_bf16 v[216:219], a[60:63], a[120:123], v[216:219]
    ds_read_b64_tr_b16 a[30:31], v15 offset:51456
    v_permlane16_swap_b32 v196, v212
    v_sub_f32 v92, 0, v118
    v_sub_f32 v93, 0, v118
    v_mfma_f32_16x16x32_bf16 v[204:207], a[32:35], a[76:79], v[204:207]
    v_accvgpr_write_b32 a216, v196
    v_accvgpr_write_b32 a218, v212
    v_sub_f32 v94, 0, v118
    v_mfma_f32_16x16x32_bf16 v[204:207], a[36:39], a[92:95], v[204:207]
    v_permlane16_swap_b32 v198, v214
    v_accvgpr_write_b32 a217, v198
    v_accvgpr_write_b32 a219, v214
    v_sub_f32 v95, 0, v118
    v_mfma_f32_16x16x32_bf16 v[204:207], a[40:43], a[108:111], v[204:207]
    v_cvt_pk_bf16_f32 v200, v200, v201
    v_cvt_pk_bf16_f32 v216, v216, v217
    v_mfma_f32_16x16x32_bf16 v[204:207], a[44:47], a[124:127], v[204:207]
    v_cvt_pk_bf16_f32 v202, v202, v203
    v_cvt_pk_bf16_f32 v218, v218, v219
    v_mov_b32 v110, v29
    v_mfma_f32_16x16x32_bf16 v[220:223], a[48:51], a[76:79], v[220:223]
    v_permlane16_swap_b32 v200, v216
    v_accvgpr_write_b32 a232, v200
    v_lshlrev_b32 v29, 4, v0
    v_mfma_f32_16x16x32_bf16 v[220:223], a[52:55], a[92:95], v[220:223]
    s_waitcnt vmcnt(6) lgkmcnt(0)
    v_accvgpr_write_b32 a234, v216
    v_permlane16_swap_b32 v202, v218
    v_xor_b32 v8, 0, v5
    v_mfma_f32_16x16x32_bf16 v[220:223], a[56:59], a[108:111], v[220:223]
    s_barrier
    v_accvgpr_write_b32 a233, v202
    v_accvgpr_write_b32 a235, v218
    v_mfma_f32_16x16x32_bf16 v[220:223], a[60:63], a[124:127], v[220:223]
    s_waitcnt lgkmcnt(0)
    v_xor_b32 v9, 32, v5
    v_xor_b32 v10, 64, v5
    v_xor_b32 v11, 96, v5
    v_mfma_f32_16x16x32_bf16 v[224:227], a[0:3], a[64:67], v[224:227]
    ds_read_b128 a[32:35], v17 offset:8192
    s_add_u32 m0, s29, 90112
    v_xor_b32 v12, 128, v5
    v_mfma_f32_16x16x32_bf16 v[224:227], a[4:7], a[80:83], v[224:227]
    buffer_load_dwordx4 v27, s[8:11], s51 offen nt lds
    v_xor_b32 v13, 160, v5
    v_mfma_f32_16x16x32_bf16 v[240:243], a[16:19], a[64:67], v[240:243]
    ds_read_b128 a[36:39], v18 offset:8192
    v_cvt_pk_bf16_f32 v204, v204, v205
    v_mfma_f32_16x16x32_bf16 v[240:243], a[20:23], a[80:83], v[240:243]
    v_cvt_pk_bf16_f32 v220, v220, v221
    v_cvt_pk_bf16_f32 v206, v206, v207
    v_xor_b32 v14, 192, v5
    v_mfma_f32_16x16x32_bf16 v[228:231], a[0:3], a[68:71], v[228:231]
    ds_read_b128 a[40:43], v19 offset:8192
    v_cvt_pk_bf16_f32 v222, v222, v223
    v_xor_b32 v15, 224, v5
    v_mfma_f32_16x16x32_bf16 v[228:231], a[4:7], a[84:87], v[228:231]
    v_permlane16_swap_b32 v204, v220
    v_accvgpr_write_b32 a248, v204
    v_accvgpr_write_b32 a250, v220
    v_mfma_f32_16x16x32_bf16 v[244:247], a[16:19], a[68:71], v[244:247]
    ds_read_b128 a[44:47], v20 offset:8192
    v_permlane16_swap_b32 v206, v222
    v_mfma_f32_16x16x32_bf16 v[244:247], a[20:23], a[84:87], v[244:247]
    v_accvgpr_write_b32 a249, v206
    v_accvgpr_write_b32 a251, v222
    v_mul_f32 v32, s46, v32
    v_mfma_f32_16x16x32_bf16 v[232:235], a[0:3], a[72:75], v[232:235]
    ds_read_b128 a[48:51], v17 offset:12288
    v_mfma_f32_16x16x32_bf16 v[232:235], a[4:7], a[88:91], v[232:235]
    buffer_load_dwordx4 v28, s[8:11], s51 offen offset:1024 nt lds
    s_add_u32 s26, s26, 8192
    s_xor_b32 s51, s26, s49
    v_mfma_f32_16x16x32_bf16 v[248:251], a[16:19], a[72:75], v[248:251]
    ds_read_b128 a[52:55], v18 offset:12288
    v_mfma_f32_16x16x32_bf16 v[248:251], a[20:23], a[88:91], v[248:251]
    v_exp_f32 v32, v32
    v_mul_f32 v33, s46, v33
    v_mfma_f32_16x16x32_bf16 v[236:239], a[0:3], a[76:79], v[236:239]
    ds_read_b128 a[56:59], v19 offset:12288
    v_exp_f32 v33, v33
    v_mfma_f32_16x16x32_bf16 v[236:239], a[4:7], a[92:95], v[236:239]
    v_mul_f32 v34, s46, v34
    v_add_f32 v112, v112, v32
    v_mfma_f32_16x16x32_bf16 v[252:255], a[16:19], a[76:79], v[252:255]
    ds_read_b128 a[60:63], v20 offset:12288
    v_exp_f32 v34, v34
    v_mfma_f32_16x16x32_bf16 v[252:255], a[20:23], a[92:95], v[252:255]
    v_mul_f32 v35, s46, v35
    v_add_f32 v112, v112, v33
    v_mfma_f32_16x16x32_bf16 v[224:227], a[8:11], a[96:99], v[224:227]
    ds_read_b64_tr_b16 a[64:65], v8 offset:0
    v_cvt_pk_bf16_f32 v64, v32, v33
    v_mfma_f32_16x16x32_bf16 v[224:227], a[12:15], a[112:115], v[224:227]
    ds_read_b64_tr_b16 a[66:67], v8 offset:4096
    v_exp_f32 v35, v35
    v_mfma_f32_16x16x32_bf16 v[240:243], a[24:27], a[96:99], v[240:243]
    ds_read_b64_tr_b16 a[68:69], v9 offset:0
    v_mul_f32 v36, s46, v36
    v_add_f32 v112, v112, v34
    v_mfma_f32_16x16x32_bf16 v[240:243], a[28:31], a[112:115], v[240:243]
    ds_read_b64_tr_b16 a[70:71], v9 offset:4096
    v_mfma_f32_16x16x32_bf16 v[228:231], a[8:11], a[100:103], v[228:231]
    ds_read_b64_tr_b16 a[72:73], v10 offset:0
    v_exp_f32 v36, v36
    v_mfma_f32_16x16x32_bf16 v[228:231], a[12:15], a[116:119], v[228:231]
    ds_read_b64_tr_b16 a[74:75], v10 offset:4096
    v_mul_f32 v37, s46, v37
    v_add_f32 v112, v112, v35
    v_mfma_f32_16x16x32_bf16 v[244:247], a[24:27], a[100:103], v[244:247]
    ds_read_b64_tr_b16 a[76:77], v11 offset:0
    v_cvt_pk_bf16_f32 v65, v34, v35
    v_mfma_f32_16x16x32_bf16 v[244:247], a[28:31], a[116:119], v[244:247]
    ds_read_b64_tr_b16 a[78:79], v11 offset:4096
    v_exp_f32 v37, v37
    v_mfma_f32_16x16x32_bf16 v[232:235], a[8:11], a[104:107], v[232:235]
    ds_read_b64_tr_b16 a[80:81], v12 offset:0
    v_mul_f32 v38, s46, v38
    v_mfma_f32_16x16x32_bf16 v[232:235], a[12:15], a[120:123], v[232:235]
    ds_read_b64_tr_b16 a[82:83], v12 offset:4096
    v_add_f32 v112, v112, v36
    v_mfma_f32_16x16x32_bf16 v[248:251], a[24:27], a[104:107], v[248:251]
    ds_read_b64_tr_b16 a[84:85], v13 offset:0
    v_exp_f32 v38, v38
    v_mfma_f32_16x16x32_bf16 v[248:251], a[28:31], a[120:123], v[248:251]
    ds_read_b64_tr_b16 a[86:87], v13 offset:4096
    v_mul_f32 v39, s46, v39
    v_add_f32 v112, v112, v37
    v_mfma_f32_16x16x32_bf16 v[236:239], a[8:11], a[108:111], v[236:239]
    ds_read_b64_tr_b16 a[88:89], v14 offset:0
    v_cvt_pk_bf16_f32 v66, v36, v37
    v_mfma_f32_16x16x32_bf16 v[236:239], a[12:15], a[124:127], v[236:239]
    ds_read_b64_tr_b16 a[90:91], v14 offset:4096
    v_exp_f32 v39, v39
    v_mfma_f32_16x16x32_bf16 v[252:255], a[24:27], a[108:111], v[252:255]
    ds_read_b64_tr_b16 a[92:93], v15 offset:0
    v_cvt_pk_bf16_f32 v67, v38, v39
    v_mfma_f32_16x16x32_bf16 v[252:255], a[28:31], a[124:127], v[252:255]
    s_waitcnt lgkmcnt(15)
    ds_read_b64_tr_b16 a[94:95], v15 offset:4096
    v_mfma_f32_16x16x32_bf16 v[32:35], a[32:35], a[128:131], v[80:83]
    v_mul_f32 v40, s46, v40
    v_exp_f32 v40, v40
    v_mul_f32 v41, s46, v41
    v_mfma_f32_16x16x32_bf16 v[32:35], a[36:39], a[132:135], v[32:35]
    ds_read_b128 a[0:3], v17 offset:16384
    v_add_f32 v112, v112, v38
    v_mfma_f32_16x16x32_bf16 v[32:35], a[40:43], a[136:139], v[32:35]
    v_exp_f32 v41, v41
    v_mul_f32 v42, s46, v42
    v_mfma_f32_16x16x32_bf16 v[32:35], a[44:47], a[140:143], v[32:35]
    s_waitcnt lgkmcnt(1)
    ds_read_b128 a[4:7], v18 offset:16384
    v_cvt_pk_bf16_f32 v68, v40, v41
    v_mfma_f32_16x16x32_bf16 v[128:131], a[64:67], v[64:67], 0
    v_exp_f32 v42, v42
    v_mul_f32 v43, s46, v43
    v_mfma_f32_16x16x32_bf16 v[132:135], a[68:71], v[64:67], 0
    ds_read_b128 a[8:11], v19 offset:16384
    v_add_f32 v112, v112, v39
    v_cvt_pk_bf16_f32 v224, v224, v225
    v_cvt_pk_bf16_f32 v240, v240, v241
    v_mfma_f32_16x16x32_bf16 v[136:139], a[72:75], v[64:67], 0
    v_exp_f32 v43, v43
    v_mul_f32 v44, s46, v44
    v_mfma_f32_16x16x32_bf16 v[140:143], a[76:79], v[64:67], 0
    ds_read_b128 a[12:15], v20 offset:16384
    v_cvt_pk_bf16_f32 v69, v42, v43
    v_cvt_pk_bf16_f32 v226, v226, v227
    v_cvt_pk_bf16_f32 v242, v242, v243
    v_mfma_f32_16x16x32_bf16 v[144:147], a[80:83], v[64:67], 0
    s_add_u32 m0, s29, 40960
    v_exp_f32 v44, v44
    v_mul_f32 v45, s46, v45
    v_mfma_f32_16x16x32_bf16 v[148:151], a[84:87], v[64:67], 0
    buffer_load_dwordx4 v25, s[4:7], s50 offen nt lds
    v_permlane16_swap_b32 v224, v240
    v_accvgpr_write_b32 a204, v224
    v_mfma_f32_16x16x32_bf16 v[152:155], a[88:91], v[64:67], 0
    v_exp_f32 v45, v45
    v_mul_f32 v46, s46, v46
    v_mfma_f32_16x16x32_bf16 v[156:159], a[92:95], v[64:67], 0
    s_waitcnt lgkmcnt(4)
    ds_read_b64_tr_b16 a[96:97], v8 offset:8192
    v_cvt_pk_bf16_f32 v70, v44, v45
    v_accvgpr_write_b32 a206, v240
    v_permlane16_swap_b32 v226, v242
    v_mfma_f32_16x16x32_bf16 v[36:39], a[48:51], a[128:131], v[80:83]
    s_add_u32 s25, s25, 8192
    v_exp_f32 v46, v46
    v_mul_f32 v47, s46, v47
    v_mfma_f32_16x16x32_bf16 v[36:39], a[52:55], a[132:135], v[36:39]
    buffer_load_dwordx4 v26, s[4:7], s50 offen offset:1024 nt lds
    v_accvgpr_write_b32 a205, v226
    v_accvgpr_write_b32 a207, v242
    v_mfma_f32_16x16x32_bf16 v[36:39], a[56:59], a[136:139], v[36:39]
    s_xor_b32 s50, s25, s49
    v_exp_f32 v47, v47
    v_cvt_pk_bf16_f32 v228, v228, v229
    v_mfma_f32_16x16x32_bf16 v[36:39], a[60:63], a[140:143], v[36:39]
    ds_read_b64_tr_b16 a[98:99], v8 offset:12288
    v_cvt_pk_bf16_f32 v71, v46, v47
    v_cvt_pk_bf16_f32 v244, v244, v245
    v_cvt_pk_bf16_f32 v230, v230, v231
    v_mfma_f32_16x16x32_bf16 v[40:43], a[32:35], a[144:147], v[84:87]
    v_mul_f32 v48, s46, v48
    v_exp_f32 v48, v48
    v_mul_f32 v49, s46, v49
    v_mfma_f32_16x16x32_bf16 v[40:43], a[36:39], a[148:151], v[40:43]
    ds_read_b64_tr_b16 a[100:101], v9 offset:8192
    v_add_f32 v113, v113, v48
    v_cvt_pk_bf16_f32 v246, v246, v247
    v_mfma_f32_16x16x32_bf16 v[40:43], a[40:43], a[152:155], v[40:43]
    v_exp_f32 v49, v49
    v_mul_f32 v50, s46, v50
    v_mfma_f32_16x16x32_bf16 v[40:43], a[44:47], a[156:159], v[40:43]
    v_add_f32 v113, v113, v49
    v_cvt_pk_bf16_f32 v72, v48, v49
    v_permlane16_swap_b32 v228, v244
    v_accvgpr_write_b32 a220, v228
    v_mfma_f32_16x16x32_bf16 v[160:163], a[64:67], v[68:71], 0
    v_exp_f32 v50, v50
    v_mul_f32 v51, s46, v51
    v_mfma_f32_16x16x32_bf16 v[164:167], a[68:71], v[68:71], 0
    ds_read_b64_tr_b16 a[102:103], v9 offset:12288
    v_add_f32 v113, v113, v50
    v_accvgpr_write_b32 a222, v244
    v_permlane16_swap_b32 v230, v246
    v_mfma_f32_16x16x32_bf16 v[168:171], a[72:75], v[68:71], 0
    v_exp_f32 v51, v51
    v_mul_f32 v52, s46, v52
    v_mfma_f32_16x16x32_bf16 v[172:175], a[76:79], v[68:71], 0
    ds_read_b64_tr_b16 a[104:105], v10 offset:8192
    v_cvt_pk_bf16_f32 v73, v50, v51
    v_accvgpr_write_b32 a221, v230
    v_accvgpr_write_b32 a223, v246
    v_mfma_f32_16x16x32_bf16 v[176:179], a[80:83], v[68:71], 0
    v_exp_f32 v52, v52
    v_mul_f32 v53, s46, v53
    v_mfma_f32_16x16x32_bf16 v[180:183], a[84:87], v[68:71], 0
    ds_read_b64_tr_b16 a[106:107], v10 offset:12288
    v_add_f32 v113, v113, v51
    v_cvt_pk_bf16_f32 v232, v232, v233
    v_cvt_pk_bf16_f32 v248, v248, v249
    v_mfma_f32_16x16x32_bf16 v[184:187], a[88:91], v[68:71], 0
    v_exp_f32 v53, v53
    v_mul_f32 v54, s46, v54
    v_mfma_f32_16x16x32_bf16 v[188:191], a[92:95], v[68:71], 0
    v_add_f32 v113, v113, v52
    v_cvt_pk_bf16_f32 v74, v52, v53
    v_cvt_pk_bf16_f32 v234, v234, v235
    v_cvt_pk_bf16_f32 v250, v250, v251
    v_mfma_f32_16x16x32_bf16 v[96:99], v[104:107], v[68:71], 0
    v_exp_f32 v54, v54
    v_mul_f32 v55, s46, v55
    v_mfma_f32_16x16x32_bf16 v[44:47], a[48:51], a[144:147], v[84:87]
    ds_read_b64_tr_b16 a[108:109], v11 offset:8192
    v_add_f32 v113, v113, v53
    v_permlane16_swap_b32 v232, v248
    v_accvgpr_write_b32 a236, v232
    v_mfma_f32_16x16x32_bf16 v[44:47], a[52:55], a[148:151], v[44:47]
    v_exp_f32 v55, v55
    v_accvgpr_write_b32 a238, v248
    v_mfma_f32_16x16x32_bf16 v[44:47], a[56:59], a[152:155], v[44:47]
    ds_read_b64_tr_b16 a[110:111], v11 offset:12288
    v_cvt_pk_bf16_f32 v75, v54, v55
    v_permlane16_swap_b32 v234, v250
    v_accvgpr_write_b32 a237, v234
    v_mfma_f32_16x16x32_bf16 v[44:47], a[60:63], a[156:159], v[44:47]
    v_add_f32 v113, v113, v54
    v_add_f32 v113, v113, v55
    v_accvgpr_write_b32 a239, v250
    v_mfma_f32_16x16x32_bf16 v[48:51], a[32:35], a[160:163], v[88:91]
    v_mul_f32 v56, s46, v56
    v_exp_f32 v56, v56
    v_mul_f32 v57, s46, v57
    v_mfma_f32_16x16x32_bf16 v[48:51], a[36:39], a[164:167], v[48:51]
    ds_read_b64_tr_b16 a[112:113], v12 offset:8192
    v_cvt_pk_bf16_f32 v236, v236, v237
    v_cvt_pk_bf16_f32 v252, v252, v253
    v_mfma_f32_16x16x32_bf16 v[48:51], a[40:43], a[168:171], v[48:51]
    v_exp_f32 v57, v57
    v_mul_f32 v58, s46, v58
    v_cvt_pk_bf16_f32 v238, v238, v239
    v_mfma_f32_16x16x32_bf16 v[48:51], a[44:47], a[172:175], v[48:51]
    ds_read_b64_tr_b16 a[114:115], v12 offset:12288
    v_cvt_pk_bf16_f32 v76, v56, v57
    v_cvt_pk_bf16_f32 v254, v254, v255
    v_mfma_f32_16x16x32_bf16 v[192:195], a[64:67], v[72:75], 0
    v_exp_f32 v58, v58
    v_mul_f32 v59, s46, v59
    v_permlane16_swap_b32 v236, v252
    v_mfma_f32_16x16x32_bf16 v[196:199], a[68:71], v[72:75], 0
    ds_read_b64_tr_b16 a[116:117], v13 offset:8192
    v_accvgpr_write_b32 a252, v236
    v_accvgpr_write_b32 a254, v252
    v_mfma_f32_16x16x32_bf16 v[200:203], a[72:75], v[72:75], 0
    v_exp_f32 v59, v59
    v_mul_f32 v60, s46, v60
    v_permlane16_swap_b32 v238, v254
    v_mfma_f32_16x16x32_bf16 v[204:207], a[76:79], v[72:75], 0
    ds_read_b64_tr_b16 a[118:119], v13 offset:12288
    v_cvt_pk_bf16_f32 v77, v58, v59
    v_accvgpr_write_b32 a253, v238
    v_mfma_f32_16x16x32_bf16 v[208:211], a[80:83], v[72:75], 0
    s_add_u32 m0, s29, 98304
    v_exp_f32 v60, v60
    v_mul_f32 v61, s46, v61
    v_accvgpr_write_b32 a255, v254
    v_mfma_f32_16x16x32_bf16 v[212:215], a[84:87], v[72:75], 0
    buffer_load_dwordx4 v27, s[8:11], s51 offen nt lds
    v_mfma_f32_16x16x32_bf16 v[216:219], a[88:91], v[72:75], 0
    v_exp_f32 v61, v61
    v_mul_f32 v62, s46, v62
    v_mfma_f32_16x16x32_bf16 v[220:223], a[92:95], v[72:75], 0
    ds_read_b64_tr_b16 a[120:121], v14 offset:8192
    v_cvt_pk_bf16_f32 v78, v60, v61
    v_mfma_f32_16x16x32_bf16 v[52:55], a[48:51], a[160:163], v[88:91]
    s_add_u32 s26, s26, 8192
    v_exp_f32 v62, v62
    v_mul_f32 v63, s46, v63
    v_mfma_f32_16x16x32_bf16 v[52:55], a[52:55], a[164:167], v[52:55]
    buffer_load_dwordx4 v28, s[8:11], s51 offen offset:1024 nt lds
    v_mfma_f32_16x16x32_bf16 v[52:55], a[56:59], a[168:171], v[52:55]
    s_xor_b32 s51, s26, s49
    v_exp_f32 v63, v63
    v_mfma_f32_16x16x32_bf16 v[52:55], a[60:63], a[172:175], v[52:55]
    ds_read_b64_tr_b16 a[122:123], v14 offset:12288
    v_cvt_pk_bf16_f32 v79, v62, v63
    v_mfma_f32_16x16x32_bf16 v[56:59], a[32:35], a[176:179], v[92:95]
    v_mul_f32 v32, s46, v32
    v_exp_f32 v32, v32
    v_mul_f32 v33, s46, v33
    v_mfma_f32_16x16x32_bf16 v[56:59], a[36:39], a[180:183], v[56:59]
    ds_read_b64_tr_b16 a[124:125], v15 offset:8192
    v_add_f32 v112, v112, v32
    v_mfma_f32_16x16x32_bf16 v[56:59], a[40:43], a[184:187], v[56:59]
    v_exp_f32 v33, v33
    v_mul_f32 v34, s46, v34
    v_mfma_f32_16x16x32_bf16 v[56:59], a[44:47], a[188:191], v[56:59]
    v_add_f32 v112, v112, v33
    v_cvt_pk_bf16_f32 v64, v32, v33
    v_mfma_f32_16x16x32_bf16 v[224:227], a[64:67], v[76:79], 0
    v_exp_f32 v34, v34
    v_mul_f32 v35, s46, v35
    v_mfma_f32_16x16x32_bf16 v[228:231], a[68:71], v[76:79], 0
    ds_read_b64_tr_b16 a[126:127], v15 offset:12288
    v_add_f32 v112, v112, v34
    v_mfma_f32_16x16x32_bf16 v[232:235], a[72:75], v[76:79], 0
    v_exp_f32 v35, v35
    v_mul_f32 v36, s46, v36
    v_mfma_f32_16x16x32_bf16 v[236:239], a[76:79], v[76:79], 0
    ds_read_b128 a[16:19], v17 offset:20480
    v_cvt_pk_bf16_f32 v65, v34, v35
    v_mfma_f32_16x16x32_bf16 v[240:243], a[80:83], v[76:79], 0
    v_exp_f32 v36, v36
    v_mul_f32 v37, s46, v37
    v_mfma_f32_16x16x32_bf16 v[244:247], a[84:87], v[76:79], 0
    ds_read_b128 a[20:23], v18 offset:20480
    v_add_f32 v112, v112, v35
    v_mfma_f32_16x16x32_bf16 v[248:251], a[88:91], v[76:79], 0
    v_exp_f32 v37, v37
    v_mul_f32 v38, s46, v38
    v_mfma_f32_16x16x32_bf16 v[252:255], a[92:95], v[76:79], 0
    v_add_f32 v112, v112, v36
    v_cvt_pk_bf16_f32 v66, v36, v37
    v_mfma_f32_16x16x32_bf16 v[100:103], v[104:107], v[76:79], 0
    v_exp_f32 v38, v38
    v_mul_f32 v39, s46, v39
    v_mfma_f32_16x16x32_bf16 v[60:63], a[48:51], a[176:179], v[92:95]
    ds_read_b128 a[24:27], v19 offset:20480
    v_add_f32 v112, v112, v37
    v_mfma_f32_16x16x32_bf16 v[60:63], a[52:55], a[180:183], v[60:63]
    v_exp_f32 v39, v39
    v_mfma_f32_16x16x32_bf16 v[60:63], a[56:59], a[184:187], v[60:63]
    s_waitcnt vmcnt(8) lgkmcnt(15)
    ds_read_b128 a[28:31], v20 offset:20480
    v_cvt_pk_bf16_f32 v67, v38, v39
    v_mfma_f32_16x16x32_bf16 v[60:63], a[60:63], a[188:191], v[60:63]
    s_barrier
    s_cmp_eq_u32 s24, 3
    s_cselect_b64 vcc, 1, 0
    s_cmp_eq_u32 s38, 1
    s_cbranch_scc1 L_maxpass
.p2align 3
L_loop:
    v_mfma_f32_16x16x32_bf16 v[32:35], a[0:3], a[128:131], v[80:83]
    v_mul_f32 v40, s46, v40
    v_exp_f32 v40, v40
    v_mul_f32 v41, s46, v41
    v_mfma_f32_16x16x32_bf16 v[32:35], a[4:7], a[132:135], v[32:35]
    ds_read_b128 a[32:35], v17 offset:24576
    v_add_f32 v112, v112, v38
    v_mfma_f32_16x16x32_bf16 v[32:35], a[8:11], a[136:139], v[32:35]
    v_exp_f32 v41, v41
    v_mul_f32 v42, s46, v42
    v_mfma_f32_16x16x32_bf16 v[32:35], a[12:15], a[140:143], v[32:35]
    s_waitcnt lgkmcnt(5)
    ds_read_b128 a[36:39], v18 offset:24576
    v_cvt_pk_bf16_f32 v68, v40, v41
    v_mfma_f32_16x16x32_bf16 v[128:131], a[96:99], v[64:67], v[128:131]
    v_exp_f32 v42, v42
    v_mul_f32 v43, s46, v43
    v_mfma_f32_16x16x32_bf16 v[132:135], a[100:103], v[64:67], v[132:135]
    ds_read_b128 a[40:43], v19 offset:24576
    v_add_f32 v112, v112, v39
    v_mfma_f32_16x16x32_bf16 v[136:139], a[104:107], v[64:67], v[136:139]
    v_exp_f32 v43, v43
    v_mul_f32 v44, s46, v44
    v_mfma_f32_16x16x32_bf16 v[140:143], a[108:111], v[64:67], v[140:143]
    ds_read_b128 a[44:47], v20 offset:24576
    v_cvt_pk_bf16_f32 v69, v42, v43
    v_mfma_f32_16x16x32_bf16 v[144:147], a[112:115], v[64:67], v[144:147]
    s_add_u32 m0, s29, 49152
    v_exp_f32 v44, v44
    v_mul_f32 v45, s46, v45
    v_mfma_f32_16x16x32_bf16 v[148:151], a[116:119], v[64:67], v[148:151]
    buffer_load_dwordx4 v25, s[4:7], s50 offen nt lds
    v_mfma_f32_16x16x32_bf16 v[152:155], a[120:123], v[64:67], v[152:155]
    v_exp_f32 v45, v45
    v_mul_f32 v46, s46, v46
    v_mfma_f32_16x16x32_bf16 v[156:159], a[124:127], v[64:67], v[156:159]
    s_waitcnt lgkmcnt(4)
    ds_read_b64_tr_b16 a[64:65], v8 offset:16384
    v_cvt_pk_bf16_f32 v70, v44, v45
    v_mfma_f32_16x16x32_bf16 v[36:39], a[16:19], a[128:131], v[80:83]
    s_add_u32 s25, s25, 8192
    v_exp_f32 v46, v46
    v_mul_f32 v47, s46, v47
    v_mfma_f32_16x16x32_bf16 v[36:39], a[20:23], a[132:135], v[36:39]
    buffer_load_dwordx4 v26, s[4:7], s50 offen offset:1024 nt lds
    v_mfma_f32_16x16x32_bf16 v[36:39], a[24:27], a[136:139], v[36:39]
    s_xor_b32 s50, s25, s49
    v_exp_f32 v47, v47
    v_mfma_f32_16x16x32_bf16 v[36:39], a[28:31], a[140:143], v[36:39]
    ds_read_b64_tr_b16 a[66:67], v8 offset:20480
    v_cvt_pk_bf16_f32 v71, v46, v47
    v_mfma_f32_16x16x32_bf16 v[40:43], a[0:3], a[144:147], v[84:87]
    v_mul_f32 v48, s46, v48
    v_exp_f32 v48, v48
    v_mul_f32 v49, s46, v49
    v_mfma_f32_16x16x32_bf16 v[40:43], a[4:7], a[148:151], v[40:43]
    ds_read_b64_tr_b16 a[68:69], v9 offset:16384
    v_add_f32 v113, v113, v48
    v_mfma_f32_16x16x32_bf16 v[40:43], a[8:11], a[152:155], v[40:43]
    v_exp_f32 v49, v49
    v_mul_f32 v50, s46, v50
    v_mfma_f32_16x16x32_bf16 v[40:43], a[12:15], a[156:159], v[40:43]
    v_add_f32 v113, v113, v49
    v_cvt_pk_bf16_f32 v72, v48, v49
    v_mfma_f32_16x16x32_bf16 v[160:163], a[96:99], v[68:71], v[160:163]
    v_exp_f32 v50, v50
    v_mul_f32 v51, s46, v51
    v_mfma_f32_16x16x32_bf16 v[164:167], a[100:103], v[68:71], v[164:167]
    ds_read_b64_tr_b16 a[70:71], v9 offset:20480
    v_add_f32 v113, v113, v50
    v_mfma_f32_16x16x32_bf16 v[168:171], a[104:107], v[68:71], v[168:171]
    v_exp_f32 v51, v51
    v_mul_f32 v52, s46, v52
    v_mfma_f32_16x16x32_bf16 v[172:175], a[108:111], v[68:71], v[172:175]
    ds_read_b64_tr_b16 a[72:73], v10 offset:16384
    v_cvt_pk_bf16_f32 v73, v50, v51
    v_mfma_f32_16x16x32_bf16 v[176:179], a[112:115], v[68:71], v[176:179]
    v_exp_f32 v52, v52
    v_mul_f32 v53, s46, v53
    v_mfma_f32_16x16x32_bf16 v[180:183], a[116:119], v[68:71], v[180:183]
    ds_read_b64_tr_b16 a[74:75], v10 offset:20480
    v_add_f32 v113, v113, v51
    v_mfma_f32_16x16x32_bf16 v[184:187], a[120:123], v[68:71], v[184:187]
    v_exp_f32 v53, v53
    v_mul_f32 v54, s46, v54
    v_mfma_f32_16x16x32_bf16 v[188:191], a[124:127], v[68:71], v[188:191]
    v_add_f32 v113, v113, v52
    v_cvt_pk_bf16_f32 v74, v52, v53
    v_mfma_f32_16x16x32_bf16 v[96:99], v[104:107], v[68:71], v[96:99]
    v_exp_f32 v54, v54
    v_mul_f32 v55, s46, v55
    v_mfma_f32_16x16x32_bf16 v[44:47], a[16:19], a[144:147], v[84:87]
    ds_read_b64_tr_b16 a[76:77], v11 offset:16384
    v_add_f32 v113, v113, v53
    v_mfma_f32_16x16x32_bf16 v[44:47], a[20:23], a[148:151], v[44:47]
    v_exp_f32 v55, v55
    v_mfma_f32_16x16x32_bf16 v[44:47], a[24:27], a[152:155], v[44:47]
    ds_read_b64_tr_b16 a[78:79], v11 offset:20480
    v_cvt_pk_bf16_f32 v75, v54, v55
    v_mfma_f32_16x16x32_bf16 v[44:47], a[28:31], a[156:159], v[44:47]
    v_add_f32 v113, v113, v54
    v_add_f32 v113, v113, v55
    v_mfma_f32_16x16x32_bf16 v[48:51], a[0:3], a[160:163], v[88:91]
    v_mul_f32 v56, s46, v56
    v_exp_f32 v56, v56
    v_mul_f32 v57, s46, v57
    v_mfma_f32_16x16x32_bf16 v[48:51], a[4:7], a[164:167], v[48:51]
    ds_read_b64_tr_b16 a[80:81], v12 offset:16384
    v_mfma_f32_16x16x32_bf16 v[48:51], a[8:11], a[168:171], v[48:51]
    v_exp_f32 v57, v57
    v_mul_f32 v58, s46, v58
    v_mfma_f32_16x16x32_bf16 v[48:51], a[12:15], a[172:175], v[48:51]
    ds_read_b64_tr_b16 a[82:83], v12 offset:20480
    v_cvt_pk_bf16_f32 v76, v56, v57
    v_mfma_f32_16x16x32_bf16 v[192:195], a[96:99], v[72:75], v[192:195]
    v_exp_f32 v58, v58
    v_mul_f32 v59, s46, v59
    v_mfma_f32_16x16x32_bf16 v[196:199], a[100:103], v[72:75], v[196:199]
    ds_read_b64_tr_b16 a[84:85], v13 offset:16384
    v_mfma_f32_16x16x32_bf16 v[200:203], a[104:107], v[72:75], v[200:203]
    v_exp_f32 v59, v59
    v_mul_f32 v60, s46, v60
    v_mfma_f32_16x16x32_bf16 v[204:207], a[108:111], v[72:75], v[204:207]
    ds_read_b64_tr_b16 a[86:87], v13 offset:20480
    v_cvt_pk_bf16_f32 v77, v58, v59
    v_mfma_f32_16x16x32_bf16 v[208:211], a[112:115], v[72:75], v[208:211]
    s_add_u32 m0, s29, 106496
    v_exp_f32 v60, v60
    v_mul_f32 v61, s46, v61
    v_mfma_f32_16x16x32_bf16 v[212:215], a[116:119], v[72:75], v[212:215]
    buffer_load_dwordx4 v27, s[8:11], s51 offen nt lds
    v_mfma_f32_16x16x32_bf16 v[216:219], a[120:123], v[72:75], v[216:219]
    v_exp_f32 v61, v61
    v_mul_f32 v62, s46, v62
    v_mfma_f32_16x16x32_bf16 v[220:223], a[124:127], v[72:75], v[220:223]
    ds_read_b64_tr_b16 a[88:89], v14 offset:16384
    v_cvt_pk_bf16_f32 v78, v60, v61
    v_mfma_f32_16x16x32_bf16 v[52:55], a[16:19], a[160:163], v[88:91]
    s_add_u32 s26, s26, 8192
    v_exp_f32 v62, v62
    v_mul_f32 v63, s46, v63
    v_mfma_f32_16x16x32_bf16 v[52:55], a[20:23], a[164:167], v[52:55]
    buffer_load_dwordx4 v28, s[8:11], s51 offen offset:1024 nt lds
    v_mfma_f32_16x16x32_bf16 v[52:55], a[24:27], a[168:171], v[52:55]
    s_xor_b32 s51, s26, s49
    v_exp_f32 v63, v63
    v_mfma_f32_16x16x32_bf16 v[52:55], a[28:31], a[172:175], v[52:55]
    ds_read_b64_tr_b16 a[90:91], v14 offset:20480
    v_cvt_pk_bf16_f32 v79, v62, v63
    s_cbranch_vccnz L_alt1
    v_mfma_f32_16x16x32_bf16 v[56:59], a[0:3], a[176:179], v[92:95]
    v_mul_f32 v32, s46, v32
    v_exp_f32 v32, v32
    v_mul_f32 v33, s46, v33
    v_mfma_f32_16x16x32_bf16 v[56:59], a[4:7], a[180:183], v[56:59]
    ds_read_b64_tr_b16 a[92:93], v15 offset:16384
    v_add_f32 v112, v112, v32
    v_mfma_f32_16x16x32_bf16 v[56:59], a[8:11], a[184:187], v[56:59]
    v_exp_f32 v33, v33
    v_mul_f32 v34, s46, v34
    v_mfma_f32_16x16x32_bf16 v[56:59], a[12:15], a[188:191], v[56:59]
    v_add_f32 v112, v112, v33
    v_cvt_pk_bf16_f32 v64, v32, v33
    v_mfma_f32_16x16x32_bf16 v[224:227], a[96:99], v[76:79], v[224:227]
    v_exp_f32 v34, v34
    v_mul_f32 v35, s46, v35
    v_mfma_f32_16x16x32_bf16 v[228:231], a[100:103], v[76:79], v[228:231]
    ds_read_b64_tr_b16 a[94:95], v15 offset:20480
    v_add_f32 v112, v112, v34
    v_mfma_f32_16x16x32_bf16 v[232:235], a[104:107], v[76:79], v[232:235]
    v_exp_f32 v35, v35
    v_mul_f32 v36, s46, v36
    v_mfma_f32_16x16x32_bf16 v[236:239], a[108:111], v[76:79], v[236:239]
    ds_read_b128 a[48:51], v17 offset:28672
    v_cvt_pk_bf16_f32 v65, v34, v35
    v_mfma_f32_16x16x32_bf16 v[240:243], a[112:115], v[76:79], v[240:243]
    v_exp_f32 v36, v36
    v_mul_f32 v37, s46, v37
    v_mfma_f32_16x16x32_bf16 v[244:247], a[116:119], v[76:79], v[244:247]
    ds_read_b128 a[52:55], v18 offset:28672
    v_add_f32 v112, v112, v35
    v_mfma_f32_16x16x32_bf16 v[248:251], a[120:123], v[76:79], v[248:251]
    v_exp_f32 v37, v37
    v_mul_f32 v38, s46, v38
    v_mfma_f32_16x16x32_bf16 v[252:255], a[124:127], v[76:79], v[252:255]
    v_add_f32 v112, v112, v36
    v_cvt_pk_bf16_f32 v66, v36, v37
    v_mfma_f32_16x16x32_bf16 v[100:103], v[104:107], v[76:79], v[100:103]
    v_exp_f32 v38, v38
    v_mul_f32 v39, s46, v39
    v_mfma_f32_16x16x32_bf16 v[60:63], a[16:19], a[176:179], v[92:95]
    ds_read_b128 a[56:59], v19 offset:28672
    v_add_f32 v112, v112, v37
    v_mfma_f32_16x16x32_bf16 v[60:63], a[20:23], a[180:183], v[60:63]
    v_exp_f32 v39, v39
    v_mfma_f32_16x16x32_bf16 v[60:63], a[24:27], a[184:187], v[60:63]
    s_waitcnt vmcnt(8) lgkmcnt(15)
    ds_read_b128 a[60:63], v20 offset:28672
    v_cvt_pk_bf16_f32 v67, v38, v39
    v_mfma_f32_16x16x32_bf16 v[60:63], a[28:31], a[188:191], v[60:63]
L_altb1:
    s_barrier
    v_mfma_f32_16x16x32_bf16 v[32:35], a[32:35], a[128:131], v[80:83]
    v_mul_f32 v40, s46, v40
    v_exp_f32 v40, v40
    v_mul_f32 v41, s46, v41
    v_mfma_f32_16x16x32_bf16 v[32:35], a[36:39], a[132:135], v[32:35]
    ds_read_b128 a[0:3], v17 offset:32768
    v_add_f32 v112, v112, v38
    v_mfma_f32_16x16x32_bf16 v[32:35], a[40:43], a[136:139], v[32:35]
    v_exp_f32 v41, v41
    v_mul_f32 v42, s46, v42
    v_mfma_f32_16x16x32_bf16 v[32:35], a[44:47], a[140:143], v[32:35]
    s_waitcnt lgkmcnt(5)
    ds_read_b128 a[4:7], v18 offset:32768
    v_cvt_pk_bf16_f32 v68, v40, v41
    v_mfma_f32_16x16x32_bf16 v[128:131], a[64:67], v[64:67], v[128:131]
    v_exp_f32 v42, v42
    v_mul_f32 v43, s46, v43
    v_mfma_f32_16x16x32_bf16 v[132:135], a[68:71], v[64:67], v[132:135]
    ds_read_b128 a[8:11], v19 offset:32768
    v_add_f32 v112, v112, v39
    v_mfma_f32_16x16x32_bf16 v[136:139], a[72:75], v[64:67], v[136:139]
    v_exp_f32 v43, v43
    v_mul_f32 v44, s46, v44
    v_mfma_f32_16x16x32_bf16 v[140:143], a[76:79], v[64:67], v[140:143]
    ds_read_b128 a[12:15], v20 offset:32768
    v_cvt_pk_bf16_f32 v69, v42, v43
    v_mfma_f32_16x16x32_bf16 v[144:147], a[80:83], v[64:67], v[144:147]
    s_add_u32 m0, s29, 57344
    v_exp_f32 v44, v44
    v_mul_f32 v45, s46, v45
    v_mfma_f32_16x16x32_bf16 v[148:151], a[84:87], v[64:67], v[148:151]
    buffer_load_dwordx4 v25, s[4:7], s50 offen nt lds
    v_mfma_f32_16x16x32_bf16 v[152:155], a[88:91], v[64:67], v[152:155]
    v_exp_f32 v45, v45
    v_mul_f32 v46, s46, v46
    v_mfma_f32_16x16x32_bf16 v[156:159], a[92:95], v[64:67], v[156:159]
    s_waitcnt lgkmcnt(4)
    ds_read_b64_tr_b16 a[96:97], v8 offset:24576
    v_cvt_pk_bf16_f32 v70, v44, v45
    v_mfma_f32_16x16x32_bf16 v[36:39], a[48:51], a[128:131], v[80:83]
    s_add_u32 s25, s25, 8192
    v_exp_f32 v46, v46
    v_mul_f32 v47, s46, v47
    v_mfma_f32_16x16x32_bf16 v[36:39], a[52:55], a[132:135], v[36:39]
    buffer_load_dwordx4 v26, s[4:7], s50 offen offset:1024 nt lds
    v_mfma_f32_16x16x32_bf16 v[36:39], a[56:59], a[136:139], v[36:39]
    s_xor_b32 s50, s25, s49
    v_exp_f32 v47, v47
    v_mfma_f32_16x16x32_bf16 v[36:39], a[60:63], a[140:143], v[36:39]
    ds_read_b64_tr_b16 a[98:99], v8 offset:28672
    v_cvt_pk_bf16_f32 v71, v46, v47
    v_mfma_f32_16x16x32_bf16 v[40:43], a[32:35], a[144:147], v[84:87]
    v_mul_f32 v48, s46, v48
    v_exp_f32 v48, v48
    v_mul_f32 v49, s46, v49
    v_mfma_f32_16x16x32_bf16 v[40:43], a[36:39], a[148:151], v[40:43]
    ds_read_b64_tr_b16 a[100:101], v9 offset:24576
    v_add_f32 v113, v113, v48
    v_mfma_f32_16x16x32_bf16 v[40:43], a[40:43], a[152:155], v[40:43]
    v_exp_f32 v49, v49
    v_mul_f32 v50, s46, v50
    v_mfma_f32_16x16x32_bf16 v[40:43], a[44:47], a[156:159], v[40:43]
    v_add_f32 v113, v113, v49
    v_cvt_pk_bf16_f32 v72, v48, v49
    v_mfma_f32_16x16x32_bf16 v[160:163], a[64:67], v[68:71], v[160:163]
    v_exp_f32 v50, v50
    v_mul_f32 v51, s46, v51
    v_mfma_f32_16x16x32_bf16 v[164:167], a[68:71], v[68:71], v[164:167]
    ds_read_b64_tr_b16 a[102:103], v9 offset:28672
    v_add_f32 v113, v113, v50
    v_mfma_f32_16x16x32_bf16 v[168:171], a[72:75], v[68:71], v[168:171]
    v_exp_f32 v51, v51
    v_mul_f32 v52, s46, v52
    v_mfma_f32_16x16x32_bf16 v[172:175], a[76:79], v[68:71], v[172:175]
    ds_read_b64_tr_b16 a[104:105], v10 offset:24576
    v_cvt_pk_bf16_f32 v73, v50, v51
    v_mfma_f32_16x16x32_bf16 v[176:179], a[80:83], v[68:71], v[176:179]
    v_exp_f32 v52, v52
    v_mul_f32 v53, s46, v53
    v_mfma_f32_16x16x32_bf16 v[180:183], a[84:87], v[68:71], v[180:183]
    ds_read_b64_tr_b16 a[106:107], v10 offset:28672
    v_add_f32 v113, v113, v51
    v_mfma_f32_16x16x32_bf16 v[184:187], a[88:91], v[68:71], v[184:187]
    v_exp_f32 v53, v53
    v_mul_f32 v54, s46, v54
    v_mfma_f32_16x16x32_bf16 v[188:191], a[92:95], v[68:71], v[188:191]
    v_add_f32 v113, v113, v52
    v_cvt_pk_bf16_f32 v74, v52, v53
    v_mfma_f32_16x16x32_bf16 v[96:99], v[104:107], v[68:71], v[96:99]
    v_exp_f32 v54, v54
    v_mul_f32 v55, s46, v55
    v_mfma_f32_16x16x32_bf16 v[44:47], a[48:51], a[144:147], v[84:87]
    ds_read_b64_tr_b16 a[108:109], v11 offset:24576
    v_add_f32 v113, v113, v53
    v_mfma_f32_16x16x32_bf16 v[44:47], a[52:55], a[148:151], v[44:47]
    v_exp_f32 v55, v55
    v_mfma_f32_16x16x32_bf16 v[44:47], a[56:59], a[152:155], v[44:47]
    ds_read_b64_tr_b16 a[110:111], v11 offset:28672
    v_cvt_pk_bf16_f32 v75, v54, v55
    v_mfma_f32_16x16x32_bf16 v[44:47], a[60:63], a[156:159], v[44:47]
    v_add_f32 v113, v113, v54
    v_add_f32 v113, v113, v55
    v_mfma_f32_16x16x32_bf16 v[48:51], a[32:35], a[160:163], v[88:91]
    v_mul_f32 v56, s46, v56
    v_exp_f32 v56, v56
    v_mul_f32 v57, s46, v57
    v_mfma_f32_16x16x32_bf16 v[48:51], a[36:39], a[164:167], v[48:51]
    ds_read_b64_tr_b16 a[112:113], v12 offset:24576
    v_mfma_f32_16x16x32_bf16 v[48:51], a[40:43], a[168:171], v[48:51]
    v_exp_f32 v57, v57
    v_mul_f32 v58, s46, v58
    v_mfma_f32_16x16x32_bf16 v[48:51], a[44:47], a[172:175], v[48:51]
    ds_read_b64_tr_b16 a[114:115], v12 offset:28672
    v_cvt_pk_bf16_f32 v76, v56, v57
    v_mfma_f32_16x16x32_bf16 v[192:195], a[64:67], v[72:75], v[192:195]
    v_exp_f32 v58, v58
    v_mul_f32 v59, s46, v59
    v_mfma_f32_16x16x32_bf16 v[196:199], a[68:71], v[72:75], v[196:199]
    ds_read_b64_tr_b16 a[116:117], v13 offset:24576
    v_mfma_f32_16x16x32_bf16 v[200:203], a[72:75], v[72:75], v[200:203]
    v_exp_f32 v59, v59
    v_mul_f32 v60, s46, v60
    v_mfma_f32_16x16x32_bf16 v[204:207], a[76:79], v[72:75], v[204:207]
    ds_read_b64_tr_b16 a[118:119], v13 offset:28672
    v_cvt_pk_bf16_f32 v77, v58, v59
    v_mfma_f32_16x16x32_bf16 v[208:211], a[80:83], v[72:75], v[208:211]
    s_add_u32 m0, s29, 114688
    v_exp_f32 v60, v60
    v_mul_f32 v61, s46, v61
    v_mfma_f32_16x16x32_bf16 v[212:215], a[84:87], v[72:75], v[212:215]
    buffer_load_dwordx4 v27, s[8:11], s51 offen nt lds
    v_mfma_f32_16x16x32_bf16 v[216:219], a[88:91], v[72:75], v[216:219]
    v_exp_f32 v61, v61
    v_mul_f32 v62, s46, v62
    v_mfma_f32_16x16x32_bf16 v[220:223], a[92:95], v[72:75], v[220:223]
    ds_read_b64_tr_b16 a[120:121], v14 offset:24576
    v_cvt_pk_bf16_f32 v78, v60, v61
    v_mfma_f32_16x16x32_bf16 v[52:55], a[48:51], a[160:163], v[88:91]
    s_add_u32 s26, s26, 8192
    v_exp_f32 v62, v62
    v_mul_f32 v63, s46, v63
    v_mfma_f32_16x16x32_bf16 v[52:55], a[52:55], a[164:167], v[52:55]
    buffer_load_dwordx4 v28, s[8:11], s51 offen offset:1024 nt lds
    v_mfma_f32_16x16x32_bf16 v[52:55], a[56:59], a[168:171], v[52:55]
    s_xor_b32 s51, s26, s49
    v_exp_f32 v63, v63
    v_mfma_f32_16x16x32_bf16 v[52:55], a[60:63], a[172:175], v[52:55]
    ds_read_b64_tr_b16 a[122:123], v14 offset:28672
    v_cvt_pk_bf16_f32 v79, v62, v63
    s_cbranch_vccnz L_alt2
    v_mfma_f32_16x16x32_bf16 v[56:59], a[32:35], a[176:179], v[92:95]
    v_mul_f32 v32, s46, v32
    v_exp_f32 v32, v32
    v_mul_f32 v33, s46, v33
    v_mfma_f32_16x16x32_bf16 v[56:59], a[36:39], a[180:183], v[56:59]
    ds_read_b64_tr_b16 a[124:125], v15 offset:24576
    v_add_f32 v112, v112, v32
    v_mfma_f32_16x16x32_bf16 v[56:59], a[40:43], a[184:187], v[56:59]
    v_exp_f32 v33, v33
    v_mul_f32 v34, s46, v34
    v_mfma_f32_16x16x32_bf16 v[56:59], a[44:47], a[188:191], v[56:59]
    v_add_f32 v112, v112, v33
    v_cvt_pk_bf16_f32 v64, v32, v33
    v_mfma_f32_16x16x32_bf16 v[224:227], a[64:67], v[76:79], v[224:227]
    v_exp_f32 v34, v34
    v_mul_f32 v35, s46, v35
    v_mfma_f32_16x16x32_bf16 v[228:231], a[68:71], v[76:79], v[228:231]
    ds_read_b64_tr_b16 a[126:127], v15 offset:28672
    v_add_f32 v112, v112, v34
    v_mfma_f32_16x16x32_bf16 v[232:235], a[72:75], v[76:79], v[232:235]
    v_exp_f32 v35, v35
    v_mul_f32 v36, s46, v36
    v_mfma_f32_16x16x32_bf16 v[236:239], a[76:79], v[76:79], v[236:239]
    ds_read_b128 a[16:19], v17 offset:36864
    v_cvt_pk_bf16_f32 v65, v34, v35
    v_mfma_f32_16x16x32_bf16 v[240:243], a[80:83], v[76:79], v[240:243]
    v_exp_f32 v36, v36
    v_mul_f32 v37, s46, v37
    v_mfma_f32_16x16x32_bf16 v[244:247], a[84:87], v[76:79], v[244:247]
    ds_read_b128 a[20:23], v18 offset:36864
    v_add_f32 v112, v112, v35
    v_mfma_f32_16x16x32_bf16 v[248:251], a[88:91], v[76:79], v[248:251]
    v_exp_f32 v37, v37
    v_mul_f32 v38, s46, v38
    v_mfma_f32_16x16x32_bf16 v[252:255], a[92:95], v[76:79], v[252:255]
    v_add_f32 v112, v112, v36
    v_cvt_pk_bf16_f32 v66, v36, v37
    v_mfma_f32_16x16x32_bf16 v[100:103], v[104:107], v[76:79], v[100:103]
    v_exp_f32 v38, v38
    v_mul_f32 v39, s46, v39
    v_mfma_f32_16x16x32_bf16 v[60:63], a[48:51], a[176:179], v[92:95]
    ds_read_b128 a[24:27], v19 offset:36864
    v_add_f32 v112, v112, v37
    v_mfma_f32_16x16x32_bf16 v[60:63], a[52:55], a[180:183], v[60:63]
    v_exp_f32 v39, v39
    v_mfma_f32_16x16x32_bf16 v[60:63], a[56:59], a[184:187], v[60:63]
    s_waitcnt vmcnt(8) lgkmcnt(15)
    ds_read_b128 a[28:31], v20 offset:36864
    v_cvt_pk_bf16_f32 v67, v38, v39
    v_mfma_f32_16x16x32_bf16 v[60:63], a[60:63], a[188:191], v[60:63]
L_altb2:
    s_barrier
    v_mfma_f32_16x16x32_bf16 v[32:35], a[0:3], a[128:131], v[80:83]
    v_mul_f32 v40, s46, v40
    v_exp_f32 v40, v40
    v_mul_f32 v41, s46, v41
    v_mfma_f32_16x16x32_bf16 v[32:35], a[4:7], a[132:135], v[32:35]
    ds_read_b128 a[32:35], v17 offset:40960
    v_add_f32 v112, v112, v38
    v_mfma_f32_16x16x32_bf16 v[32:35], a[8:11], a[136:139], v[32:35]
    v_exp_f32 v41, v41
    v_mul_f32 v42, s46, v42
    v_mfma_f32_16x16x32_bf16 v[32:35], a[12:15], a[140:143], v[32:35]
    s_waitcnt lgkmcnt(5)
    ds_read_b128 a[36:39], v18 offset:40960
    v_cvt_pk_bf16_f32 v68, v40, v41
    v_mfma_f32_16x16x32_bf16 v[128:131], a[96:99], v[64:67], v[128:131]
    v_exp_f32 v42, v42
    v_mul_f32 v43, s46, v43
    v_mfma_f32_16x16x32_bf16 v[132:135], a[100:103], v[64:67], v[132:135]
    ds_read_b128 a[40:43], v19 offset:40960
    v_add_f32 v112, v112, v39
    v_mfma_f32_16x16x32_bf16 v[136:139], a[104:107], v[64:67], v[136:139]
    v_exp_f32 v43, v43
    v_mul_f32 v44, s46, v44
    v_mfma_f32_16x16x32_bf16 v[140:143], a[108:111], v[64:67], v[140:143]
    ds_read_b128 a[44:47], v20 offset:40960
    v_cvt_pk_bf16_f32 v69, v42, v43
    v_mfma_f32_16x16x32_bf16 v[144:147], a[112:115], v[64:67], v[144:147]
    s_add_u32 m0, s29, 0
    v_exp_f32 v44, v44
    v_mul_f32 v45, s46, v45
    v_mfma_f32_16x16x32_bf16 v[148:151], a[116:119], v[64:67], v[148:151]
    buffer_load_dwordx4 v25, s[4:7], s50 offen nt lds
    v_mfma_f32_16x16x32_bf16 v[152:155], a[120:123], v[64:67], v[152:155]
    v_exp_f32 v45, v45
    v_mul_f32 v46, s46, v46
    v_mfma_f32_16x16x32_bf16 v[156:159], a[124:127], v[64:67], v[156:159]
    s_waitcnt lgkmcnt(4)
    ds_read_b64_tr_b16 a[64:65], v8 offset:32768
    v_cvt_pk_bf16_f32 v70, v44, v45
    v_mfma_f32_16x16x32_bf16 v[36:39], a[16:19], a[128:131], v[80:83]
    s_add_u32 s25, s25, 8192
    v_exp_f32 v46, v46
    v_mul_f32 v47, s46, v47
    v_mfma_f32_16x16x32_bf16 v[36:39], a[20:23], a[132:135], v[36:39]
    buffer_load_dwordx4 v26, s[4:7], s50 offen offset:1024 nt lds
    v_mfma_f32_16x16x32_bf16 v[36:39], a[24:27], a[136:139], v[36:39]
    s_xor_b32 s50, s25, s49
    v_exp_f32 v47, v47
    v_mfma_f32_16x16x32_bf16 v[36:39], a[28:31], a[140:143], v[36:39]
    ds_read_b64_tr_b16 a[66:67], v8 offset:36864
    v_cvt_pk_bf16_f32 v71, v46, v47
    v_mfma_f32_16x16x32_bf16 v[40:43], a[0:3], a[144:147], v[84:87]
    v_mul_f32 v48, s46, v48
    v_exp_f32 v48, v48
    v_mul_f32 v49, s46, v49
    v_mfma_f32_16x16x32_bf16 v[40:43], a[4:7], a[148:151], v[40:43]
    ds_read_b64_tr_b16 a[68:69], v9 offset:32768
    v_add_f32 v113, v113, v48
    v_mfma_f32_16x16x32_bf16 v[40:43], a[8:11], a[152:155], v[40:43]
    v_exp_f32 v49, v49
    v_mul_f32 v50, s46, v50
    v_mfma_f32_16x16x32_bf16 v[40:43], a[12:15], a[156:159], v[40:43]
    v_add_f32 v113, v113, v49
    v_cvt_pk_bf16_f32 v72, v48, v49
    v_mfma_f32_16x16x32_bf16 v[160:163], a[96:99], v[68:71], v[160:163]
    v_exp_f32 v50, v50
    v_mul_f32 v51, s46, v51
    v_mfma_f32_16x16x32_bf16 v[164:167], a[100:103], v[68:71], v[164:167]
    ds_read_b64_tr_b16 a[70:71], v9 offset:36864
    v_add_f32 v113, v113, v50
    v_mfma_f32_16x16x32_bf16 v[168:171], a[104:107], v[68:71], v[168:171]
    v_exp_f32 v51, v51
    v_mul_f32 v52, s46, v52
    v_mfma_f32_16x16x32_bf16 v[172:175], a[108:111], v[68:71], v[172:175]
    ds_read_b64_tr_b16 a[72:73], v10 offset:32768
    v_cvt_pk_bf16_f32 v73, v50, v51
    v_mfma_f32_16x16x32_bf16 v[176:179], a[112:115], v[68:71], v[176:179]
    v_exp_f32 v52, v52
    v_mul_f32 v53, s46, v53
    v_mfma_f32_16x16x32_bf16 v[180:183], a[116:119], v[68:71], v[180:183]
    ds_read_b64_tr_b16 a[74:75], v10 offset:36864
    v_add_f32 v113, v113, v51
    v_mfma_f32_16x16x32_bf16 v[184:187], a[120:123], v[68:71], v[184:187]
    v_exp_f32 v53, v53
    v_mul_f32 v54, s46, v54
    v_mfma_f32_16x16x32_bf16 v[188:191], a[124:127], v[68:71], v[188:191]
    v_add_f32 v113, v113, v52
    v_cvt_pk_bf16_f32 v74, v52, v53
    v_mfma_f32_16x16x32_bf16 v[96:99], v[104:107], v[68:71], v[96:99]
    v_exp_f32 v54, v54
    v_mul_f32 v55, s46, v55
    v_mfma_f32_16x16x32_bf16 v[44:47], a[16:19], a[144:147], v[84:87]
    ds_read_b64_tr_b16 a[76:77], v11 offset:32768
    v_add_f32 v113, v113, v53
    v_mfma_f32_16x16x32_bf16 v[44:47], a[20:23], a[148:151], v[44:47]
    v_exp_f32 v55, v55
    v_mfma_f32_16x16x32_bf16 v[44:47], a[24:27], a[152:155], v[44:47]
    ds_read_b64_tr_b16 a[78:79], v11 offset:36864
    v_cvt_pk_bf16_f32 v75, v54, v55
    v_mfma_f32_16x16x32_bf16 v[44:47], a[28:31], a[156:159], v[44:47]
    global_load_dword v31, v110, s[80:81]
    v_mfma_f32_16x16x32_bf16 v[48:51], a[0:3], a[160:163], v[88:91]
    v_mul_f32 v56, s46, v56
    v_exp_f32 v56, v56
    v_mul_f32 v57, s46, v57
    v_mfma_f32_16x16x32_bf16 v[48:51], a[4:7], a[164:167], v[48:51]
    ds_read_b64_tr_b16 a[80:81], v12 offset:32768
    v_add_f32 v113, v113, v54
    v_mfma_f32_16x16x32_bf16 v[48:51], a[8:11], a[168:171], v[48:51]
    v_exp_f32 v57, v57
    v_mul_f32 v58, s46, v58
    v_mfma_f32_16x16x32_bf16 v[48:51], a[12:15], a[172:175], v[48:51]
    ds_read_b64_tr_b16 a[82:83], v12 offset:36864
    v_cvt_pk_bf16_f32 v76, v56, v57
    v_mfma_f32_16x16x32_bf16 v[192:195], a[96:99], v[72:75], v[192:195]
    v_exp_f32 v58, v58
    v_mul_f32 v59, s46, v59
    v_mfma_f32_16x16x32_bf16 v[196:199], a[100:103], v[72:75], v[196:199]
    ds_read_b64_tr_b16 a[84:85], v13 offset:32768
    v_add_f32 v113, v113, v55
    v_mfma_f32_16x16x32_bf16 v[200:203], a[104:107], v[72:75], v[200:203]
    v_exp_f32 v59, v59
    v_mul_f32 v60, s46, v60
    v_mfma_f32_16x16x32_bf16 v[204:207], a[108:111], v[72:75], v[204:207]
    ds_read_b64_tr_b16 a[86:87], v13 offset:36864
    v_cvt_pk_bf16_f32 v77, v58, v59
    v_mfma_f32_16x16x32_bf16 v[208:211], a[112:115], v[72:75], v[208:211]
    s_add_u32 m0, s29, 122880
    v_exp_f32 v60, v60
    v_mul_f32 v61, s46, v61
    v_mfma_f32_16x16x32_bf16 v[212:215], a[116:119], v[72:75], v[212:215]
    buffer_load_dwordx4 v27, s[8:11], s51 offen nt lds
    v_mfma_f32_16x16x32_bf16 v[216:219], a[120:123], v[72:75], v[216:219]
    v_exp_f32 v61, v61
    v_mul_f32 v62, s46, v62
    v_mfma_f32_16x16x32_bf16 v[220:223], a[124:127], v[72:75], v[220:223]
    ds_read_b64_tr_b16 a[88:89], v14 offset:32768
    v_cvt_pk_bf16_f32 v78, v60, v61
    v_mfma_f32_16x16x32_bf16 v[52:55], a[16:19], a[160:163], v[88:91]
    s_add_u32 s26, s26, 8192
    v_exp_f32 v62, v62
    v_mul_f32 v63, s46, v63
    v_mfma_f32_16x16x32_bf16 v[52:55], a[20:23], a[164:167], v[52:55]
    buffer_load_dwordx4 v28, s[8:11], s51 offen offset:1024 nt lds
    v_mfma_f32_16x16x32_bf16 v[52:55], a[24:27], a[168:171], v[52:55]
    s_xor_b32 s51, s26, s49
    v_exp_f32 v63, v63
    v_mfma_f32_16x16x32_bf16 v[52:55], a[28:31], a[172:175], v[52:55]
    ds_read_b64_tr_b16 a[90:91], v14 offset:36864
    v_cvt_pk_bf16_f32 v79, v62, v63
    s_cbranch_vccnz L_alt3
    v_mfma_f32_16x16x32_bf16 v[56:59], a[0:3], a[176:179], v[92:95]
    v_mul_f32 v32, s46, v32
    v_exp_f32 v32, v32
    v_mul_f32 v33, s46, v33
    v_mfma_f32_16x16x32_bf16 v[56:59], a[4:7], a[180:183], v[56:59]
    ds_read_b64_tr_b16 a[92:93], v15 offset:32768
    v_add_f32 v112, v112, v32
    v_mfma_f32_16x16x32_bf16 v[56:59], a[8:11], a[184:187], v[56:59]
    v_exp_f32 v33, v33
    v_mul_f32 v34, s46, v34
    v_mfma_f32_16x16x32_bf16 v[56:59], a[12:15], a[188:191], v[56:59]
    v_add_f32 v112, v112, v33
    v_cvt_pk_bf16_f32 v64, v32, v33
    v_mfma_f32_16x16x32_bf16 v[224:227], a[96:99], v[76:79], v[224:227]
    v_exp_f32 v34, v34
    v_mul_f32 v35, s46, v35
    v_mfma_f32_16x16x32_bf16 v[228:231], a[100:103], v[76:79], v[228:231]
    ds_read_b64_tr_b16 a[94:95], v15 offset:36864
    v_add_f32 v112, v112, v34
    v_mfma_f32_16x16x32_bf16 v[232:235], a[104:107], v[76:79], v[232:235]
    v_exp_f32 v35, v35
    v_mul_f32 v36, s46, v36
    v_mfma_f32_16x16x32_bf16 v[236:239], a[108:111], v[76:79], v[236:239]
    ds_read_b128 a[48:51], v17 offset:45056
    v_cvt_pk_bf16_f32 v65, v34, v35
    v_mfma_f32_16x16x32_bf16 v[240:243], a[112:115], v[76:79], v[240:243]
    v_exp_f32 v36, v36
    v_mul_f32 v37, s46, v37
    v_mfma_f32_16x16x32_bf16 v[244:247], a[116:119], v[76:79], v[244:247]
    ds_read_b128 a[52:55], v18 offset:45056
    v_add_f32 v112, v112, v35
    v_mfma_f32_16x16x32_bf16 v[248:251], a[120:123], v[76:79], v[248:251]
    v_exp_f32 v37, v37
    v_mul_f32 v38, s46, v38
    v_mfma_f32_16x16x32_bf16 v[252:255], a[124:127], v[76:79], v[252:255]
    v_add_f32 v112, v112, v36
    v_cvt_pk_bf16_f32 v66, v36, v37
    v_mfma_f32_16x16x32_bf16 v[100:103], v[104:107], v[76:79], v[100:103]
    v_exp_f32 v38, v38
    v_mul_f32 v39, s46, v39
    v_mfma_f32_16x16x32_bf16 v[60:63], a[16:19], a[176:179], v[92:95]
    ds_read_b128 a[56:59], v19 offset:45056
    v_add_f32 v112, v112, v37
    v_mfma_f32_16x16x32_bf16 v[60:63], a[20:23], a[180:183], v[60:63]
    v_exp_f32 v39, v39
    v_mfma_f32_16x16x32_bf16 v[60:63], a[24:27], a[184:187], v[60:63]
    s_waitcnt vmcnt(9) lgkmcnt(15)
    ds_read_b128 a[60:63], v20 offset:45056
    v_cvt_pk_bf16_f32 v67, v38, v39
    v_mfma_f32_16x16x32_bf16 v[60:63], a[28:31], a[188:191], v[60:63]
L_altb3:
    s_barrier
    v_mfma_f32_16x16x32_bf16 v[32:35], a[32:35], a[128:131], v[80:83]
    v_mul_f32 v40, s46, v40
    v_exp_f32 v40, v40
    v_mul_f32 v41, s46, v41
    v_mfma_f32_16x16x32_bf16 v[32:35], a[36:39], a[132:135], v[32:35]
    ds_read_b128 a[0:3], v17 offset:49152
    v_add_f32 v112, v112, v38
    v_mfma_f32_16x16x32_bf16 v[32:35], a[40:43], a[136:139], v[32:35]
    v_exp_f32 v41, v41
    v_mul_f32 v42, s46, v42
    v_mfma_f32_16x16x32_bf16 v[32:35], a[44:47], a[140:143], v[32:35]
    s_waitcnt lgkmcnt(5)
    ds_read_b128 a[4:7], v18 offset:49152
    v_cvt_pk_bf16_f32 v68, v40, v41
    v_mfma_f32_16x16x32_bf16 v[128:131], a[64:67], v[64:67], v[128:131]
    v_exp_f32 v42, v42
    v_mul_f32 v43, s46, v43
    v_mfma_f32_16x16x32_bf16 v[132:135], a[68:71], v[64:67], v[132:135]
    ds_read_b128 a[8:11], v19 offset:49152
    v_add_f32 v112, v112, v39
    v_mfma_f32_16x16x32_bf16 v[136:139], a[72:75], v[64:67], v[136:139]
    v_exp_f32 v43, v43
    v_mul_f32 v44, s46, v44
    v_mfma_f32_16x16x32_bf16 v[140:143], a[76:79], v[64:67], v[140:143]
    ds_read_b128 a[12:15], v20 offset:49152
    v_cvt_pk_bf16_f32 v69, v42, v43
    v_mfma_f32_16x16x32_bf16 v[144:147], a[80:83], v[64:67], v[144:147]
    s_add_u32 m0, s29, 8192
    v_exp_f32 v44, v44
    v_mul_f32 v45, s46, v45
    v_mfma_f32_16x16x32_bf16 v[148:151], a[84:87], v[64:67], v[148:151]
    buffer_load_dwordx4 v25, s[4:7], s50 offen nt lds
    v_mfma_f32_16x16x32_bf16 v[152:155], a[88:91], v[64:67], v[152:155]
    v_exp_f32 v45, v45
    v_mul_f32 v46, s46, v46
    v_mfma_f32_16x16x32_bf16 v[156:159], a[92:95], v[64:67], v[156:159]
    s_waitcnt lgkmcnt(4)
    ds_read_b64_tr_b16 a[96:97], v8 offset:40960
    v_cvt_pk_bf16_f32 v70, v44, v45
    v_mfma_f32_16x16x32_bf16 v[36:39], a[48:51], a[128:131], v[80:83]
    s_add_u32 s25, s25, 8192
    v_exp_f32 v46, v46
    v_mul_f32 v47, s46, v47
    v_mfma_f32_16x16x32_bf16 v[36:39], a[52:55], a[132:135], v[36:39]
    buffer_load_dwordx4 v26, s[4:7], s50 offen offset:1024 nt lds
    v_mfma_f32_16x16x32_bf16 v[36:39], a[56:59], a[136:139], v[36:39]
    s_xor_b32 s50, s25, s49
    v_exp_f32 v47, v47
    v_mfma_f32_16x16x32_bf16 v[36:39], a[60:63], a[140:143], v[36:39]
    ds_read_b64_tr_b16 a[98:99], v8 offset:45056
    v_cvt_pk_bf16_f32 v71, v46, v47
    v_mfma_f32_16x16x32_bf16 v[40:43], a[32:35], a[144:147], v[84:87]
    v_mul_f32 v48, s46, v48
    v_exp_f32 v48, v48
    v_mul_f32 v49, s46, v49
    v_mfma_f32_16x16x32_bf16 v[40:43], a[36:39], a[148:151], v[40:43]
    ds_read_b64_tr_b16 a[100:101], v9 offset:40960
    v_add_f32 v113, v113, v48
    v_mfma_f32_16x16x32_bf16 v[40:43], a[40:43], a[152:155], v[40:43]
    v_exp_f32 v49, v49
    v_mul_f32 v50, s46, v50
    v_mfma_f32_16x16x32_bf16 v[40:43], a[44:47], a[156:159], v[40:43]
    v_add_f32 v113, v113, v49
    v_cvt_pk_bf16_f32 v72, v48, v49
    v_mfma_f32_16x16x32_bf16 v[160:163], a[64:67], v[68:71], v[160:163]
    v_exp_f32 v50, v50
    v_mul_f32 v51, s46, v51
    v_mfma_f32_16x16x32_bf16 v[164:167], a[68:71], v[68:71], v[164:167]
    ds_read_b64_tr_b16 a[102:103], v9 offset:45056
    v_add_f32 v113, v113, v50
    v_mfma_f32_16x16x32_bf16 v[168:171], a[72:75], v[68:71], v[168:171]
    v_exp_f32 v51, v51
    v_mul_f32 v52, s46, v52
    v_mfma_f32_16x16x32_bf16 v[172:175], a[76:79], v[68:71], v[172:175]
    ds_read_b64_tr_b16 a[104:105], v10 offset:40960
    v_cvt_pk_bf16_f32 v73, v50, v51
    v_mfma_f32_16x16x32_bf16 v[176:179], a[80:83], v[68:71], v[176:179]
    v_exp_f32 v52, v52
    v_mul_f32 v53, s46, v53
    v_mfma_f32_16x16x32_bf16 v[180:183], a[84:87], v[68:71], v[180:183]
    ds_read_b64_tr_b16 a[106:107], v10 offset:45056
    v_add_f32 v113, v113, v51
    v_mfma_f32_16x16x32_bf16 v[184:187], a[88:91], v[68:71], v[184:187]
    v_exp_f32 v53, v53
    v_mul_f32 v54, s46, v54
    v_mfma_f32_16x16x32_bf16 v[188:191], a[92:95], v[68:71], v[188:191]
    v_add_f32 v113, v113, v52
    v_cvt_pk_bf16_f32 v74, v52, v53
    v_mfma_f32_16x16x32_bf16 v[96:99], v[104:107], v[68:71], v[96:99]
    v_exp_f32 v54, v54
    v_mul_f32 v55, s46, v55
    v_mfma_f32_16x16x32_bf16 v[44:47], a[48:51], a[144:147], v[84:87]
    ds_read_b64_tr_b16 a[108:109], v11 offset:40960
    v_add_f32 v113, v113, v53
    v_mfma_f32_16x16x32_bf16 v[44:47], a[52:55], a[148:151], v[44:47]
    v_exp_f32 v55, v55
    v_mfma_f32_16x16x32_bf16 v[44:47], a[56:59], a[152:155], v[44:47]
    ds_read_b64_tr_b16 a[110:111], v11 offset:45056
    v_cvt_pk_bf16_f32 v75, v54, v55
    v_mfma_f32_16x16x32_bf16 v[44:47], a[60:63], a[156:159], v[44:47]
    v_add_f32 v113, v113, v54
    v_add_f32 v113, v113, v55
    v_mfma_f32_16x16x32_bf16 v[48:51], a[32:35], a[160:163], v[88:91]
    v_mul_f32 v56, s46, v56
    v_exp_f32 v56, v56
    v_mul_f32 v57, s46, v57
    v_mfma_f32_16x16x32_bf16 v[48:51], a[36:39], a[164:167], v[48:51]
    ds_read_b64_tr_b16 a[112:113], v12 offset:40960
    v_mfma_f32_16x16x32_bf16 v[48:51], a[40:43], a[168:171], v[48:51]
    v_exp_f32 v57, v57
    v_mul_f32 v58, s46, v58
    v_mfma_f32_16x16x32_bf16 v[48:51], a[44:47], a[172:175], v[48:51]
    ds_read_b64_tr_b16 a[114:115], v12 offset:45056
    v_cvt_pk_bf16_f32 v76, v56, v57
    v_mfma_f32_16x16x32_bf16 v[192:195], a[64:67], v[72:75], v[192:195]
    v_exp_f32 v58, v58
    v_mul_f32 v59, s46, v59
    v_mfma_f32_16x16x32_bf16 v[196:199], a[68:71], v[72:75], v[196:199]
    ds_read_b64_tr_b16 a[116:117], v13 offset:40960
    v_mfma_f32_16x16x32_bf16 v[200:203], a[72:75], v[72:75], v[200:203]
    v_exp_f32 v59, v59
    v_mul_f32 v60, s46, v60
    v_mfma_f32_16x16x32_bf16 v[204:207], a[76:79], v[72:75], v[204:207]
    ds_read_b64_tr_b16 a[118:119], v13 offset:45056
    v_cvt_pk_bf16_f32 v77, v58, v59
    v_mfma_f32_16x16x32_bf16 v[208:211], a[80:83], v[72:75], v[208:211]
    s_add_u32 m0, s29, 65536
    v_exp_f32 v60, v60
    v_mul_f32 v61, s46, v61
    v_mfma_f32_16x16x32_bf16 v[212:215], a[84:87], v[72:75], v[212:215]
    buffer_load_dwordx4 v27, s[8:11], s51 offen nt lds
    v_mfma_f32_16x16x32_bf16 v[216:219], a[88:91], v[72:75], v[216:219]
    v_exp_f32 v61, v61
    v_mul_f32 v62, s46, v62
    v_mfma_f32_16x16x32_bf16 v[220:223], a[92:95], v[72:75], v[220:223]
    ds_read_b64_tr_b16 a[120:121], v14 offset:40960
    v_cvt_pk_bf16_f32 v78, v60, v61
    v_mfma_f32_16x16x32_bf16 v[52:55], a[48:51], a[160:163], v[88:91]
    s_add_u32 s26, s26, 8192
    v_exp_f32 v62, v62
    v_mul_f32 v63, s46, v63
    v_mfma_f32_16x16x32_bf16 v[52:55], a[52:55], a[164:167], v[52:55]
    buffer_load_dwordx4 v28, s[8:11], s51 offen offset:1024 nt lds
    v_mfma_f32_16x16x32_bf16 v[52:55], a[56:59], a[168:171], v[52:55]
    s_xor_b32 s51, s26, s49
    v_exp_f32 v63, v63
    v_mfma_f32_16x16x32_bf16 v[52:55], a[60:63], a[172:175], v[52:55]
    ds_read_b64_tr_b16 a[122:123], v14 offset:45056
    v_cvt_pk_bf16_f32 v79, v62, v63
    s_cbranch_vccnz L_alt4
    v_mfma_f32_16x16x32_bf16 v[56:59], a[32:35], a[176:179], v[92:95]
    v_mul_f32 v32, s46, v32
    v_exp_f32 v32, v32
    v_mul_f32 v33, s46, v33
    v_mfma_f32_16x16x32_bf16 v[56:59], a[36:39], a[180:183], v[56:59]
    ds_read_b64_tr_b16 a[124:125], v15 offset:40960
    v_add_f32 v112, v112, v32
    v_mfma_f32_16x16x32_bf16 v[56:59], a[40:43], a[184:187], v[56:59]
    v_exp_f32 v33, v33
    v_mul_f32 v34, s46, v34
    v_mfma_f32_16x16x32_bf16 v[56:59], a[44:47], a[188:191], v[56:59]
    v_add_f32 v112, v112, v33
    v_cvt_pk_bf16_f32 v64, v32, v33
    v_mfma_f32_16x16x32_bf16 v[224:227], a[64:67], v[76:79], v[224:227]
    v_exp_f32 v34, v34
    v_mul_f32 v35, s46, v35
    v_mfma_f32_16x16x32_bf16 v[228:231], a[68:71], v[76:79], v[228:231]
    ds_read_b64_tr_b16 a[126:127], v15 offset:45056
    v_add_f32 v112, v112, v34
    v_mfma_f32_16x16x32_bf16 v[232:235], a[72:75], v[76:79], v[232:235]
    v_exp_f32 v35, v35
    v_mul_f32 v36, s46, v36
    v_mfma_f32_16x16x32_bf16 v[236:239], a[76:79], v[76:79], v[236:239]
    ds_read_b128 a[16:19], v17 offset:53248
    v_cvt_pk_bf16_f32 v65, v34, v35
    v_mfma_f32_16x16x32_bf16 v[240:243], a[80:83], v[76:79], v[240:243]
    v_exp_f32 v36, v36
    v_mul_f32 v37, s46, v37
    v_mfma_f32_16x16x32_bf16 v[244:247], a[84:87], v[76:79], v[244:247]
    ds_read_b128 a[20:23], v18 offset:53248
    v_add_f32 v112, v112, v35
    v_mfma_f32_16x16x32_bf16 v[248:251], a[88:91], v[76:79], v[248:251]
    v_exp_f32 v37, v37
    v_mul_f32 v38, s46, v38
    v_mfma_f32_16x16x32_bf16 v[252:255], a[92:95], v[76:79], v[252:255]
    v_add_f32 v112, v112, v36
    v_cvt_pk_bf16_f32 v66, v36, v37
    v_mfma_f32_16x16x32_bf16 v[100:103], v[104:107], v[76:79], v[100:103]
    v_exp_f32 v38, v38
    v_mul_f32 v39, s46, v39
    v_mfma_f32_16x16x32_bf16 v[60:63], a[48:51], a[176:179], v[92:95]
    ds_read_b128 a[24:27], v19 offset:53248
    v_add_f32 v112, v112, v37
    v_mfma_f32_16x16x32_bf16 v[60:63], a[52:55], a[180:183], v[60:63]
    v_exp_f32 v39, v39
    v_mfma_f32_16x16x32_bf16 v[60:63], a[56:59], a[184:187], v[60:63]
    s_waitcnt vmcnt(9) lgkmcnt(15)
    ds_read_b128 a[28:31], v20 offset:53248
    v_cvt_pk_bf16_f32 v67, v38, v39
    v_mfma_f32_16x16x32_bf16 v[60:63], a[60:63], a[188:191], v[60:63]
L_altb4:
    s_barrier
    v_mfma_f32_16x16x32_bf16 v[32:35], a[0:3], a[128:131], v[80:83]
    v_mul_f32 v40, s46, v40
    v_exp_f32 v40, v40
    v_mul_f32 v41, s46, v41
    v_mfma_f32_16x16x32_bf16 v[32:35], a[4:7], a[132:135], v[32:35]
    ds_read_b128 a[32:35], v17 offset:57344
    v_add_f32 v112, v112, v38
    v_mfma_f32_16x16x32_bf16 v[32:35], a[8:11], a[136:139], v[32:35]
    v_exp_f32 v41, v41
    v_mul_f32 v42, s46, v42
    v_mfma_f32_16x16x32_bf16 v[32:35], a[12:15], a[140:143], v[32:35]
    s_waitcnt lgkmcnt(5)
    ds_read_b128 a[36:39], v18 offset:57344
    v_cvt_pk_bf16_f32 v68, v40, v41
    v_mfma_f32_16x16x32_bf16 v[128:131], a[96:99], v[64:67], v[128:131]
    v_exp_f32 v42, v42
    v_mul_f32 v43, s46, v43
    v_mfma_f32_16x16x32_bf16 v[132:135], a[100:103], v[64:67], v[132:135]
    ds_read_b128 a[40:43], v19 offset:57344
    v_add_f32 v112, v112, v39
    v_mfma_f32_16x16x32_bf16 v[136:139], a[104:107], v[64:67], v[136:139]
    v_exp_f32 v43, v43
    v_mul_f32 v44, s46, v44
    v_mfma_f32_16x16x32_bf16 v[140:143], a[108:111], v[64:67], v[140:143]
    ds_read_b128 a[44:47], v20 offset:57344
    v_cvt_pk_bf16_f32 v69, v42, v43
    v_mfma_f32_16x16x32_bf16 v[144:147], a[112:115], v[64:67], v[144:147]
    s_add_u32 m0, s29, 16384
    v_exp_f32 v44, v44
    v_mul_f32 v45, s46, v45
    v_mfma_f32_16x16x32_bf16 v[148:151], a[116:119], v[64:67], v[148:151]
    buffer_load_dwordx4 v25, s[4:7], s50 offen nt lds
    v_mfma_f32_16x16x32_bf16 v[152:155], a[120:123], v[64:67], v[152:155]
    v_exp_f32 v45, v45
    v_mul_f32 v46, s46, v46
    v_mfma_f32_16x16x32_bf16 v[156:159], a[124:127], v[64:67], v[156:159]
    s_waitcnt lgkmcnt(4)
    ds_read_b64_tr_b16 a[64:65], v8 offset:49152
    v_cvt_pk_bf16_f32 v70, v44, v45
    v_mfma_f32_16x16x32_bf16 v[36:39], a[16:19], a[128:131], v[80:83]
    s_add_u32 s25, s25, 8192
    v_exp_f32 v46, v46
    v_mul_f32 v47, s46, v47
    v_mfma_f32_16x16x32_bf16 v[36:39], a[20:23], a[132:135], v[36:39]
    buffer_load_dwordx4 v26, s[4:7], s50 offen offset:1024 nt lds
    v_mfma_f32_16x16x32_bf16 v[36:39], a[24:27], a[136:139], v[36:39]
    s_xor_b32 s50, s25, s49
    v_exp_f32 v47, v47
    v_mfma_f32_16x16x32_bf16 v[36:39], a[28:31], a[140:143], v[36:39]
    ds_read_b64_tr_b16 a[66:67], v8 offset:53248
    v_cvt_pk_bf16_f32 v71, v46, v47
    v_mfma_f32_16x16x32_bf16 v[40:43], a[0:3], a[144:147], v[84:87]
    v_mul_f32 v48, s46, v48
    v_exp_f32 v48, v48
    v_mul_f32 v49, s46, v49
    v_mfma_f32_16x16x32_bf16 v[40:43], a[4:7], a[148:151], v[40:43]
    ds_read_b64_tr_b16 a[68:69], v9 offset:49152
    v_add_f32 v113, v113, v48
    v_mfma_f32_16x16x32_bf16 v[40:43], a[8:11], a[152:155], v[40:43]
    v_exp_f32 v49, v49
    v_mul_f32 v50, s46, v50
    v_mfma_f32_16x16x32_bf16 v[40:43], a[12:15], a[156:159], v[40:43]
    v_add_f32 v113, v113, v49
    v_cvt_pk_bf16_f32 v72, v48, v49
    v_mfma_f32_16x16x32_bf16 v[160:163], a[96:99], v[68:71], v[160:163]
    v_exp_f32 v50, v50
    v_mul_f32 v51, s46, v51
    v_mfma_f32_16x16x32_bf16 v[164:167], a[100:103], v[68:71], v[164:167]
    ds_read_b64_tr_b16 a[70:71], v9 offset:53248
    v_add_f32 v113, v113, v50
    v_mfma_f32_16x16x32_bf16 v[168:171], a[104:107], v[68:71], v[168:171]
    v_exp_f32 v51, v51
    v_mul_f32 v52, s46, v52
    v_mfma_f32_16x16x32_bf16 v[172:175], a[108:111], v[68:71], v[172:175]
    ds_read_b64_tr_b16 a[72:73], v10 offset:49152
    v_cvt_pk_bf16_f32 v73, v50, v51
    v_mfma_f32_16x16x32_bf16 v[176:179], a[112:115], v[68:71], v[176:179]
    v_exp_f32 v52, v52
    v_mul_f32 v53, s46, v53
    v_mfma_f32_16x16x32_bf16 v[180:183], a[116:119], v[68:71], v[180:183]
    ds_read_b64_tr_b16 a[74:75], v10 offset:53248
    v_add_f32 v113, v113, v51
    v_mfma_f32_16x16x32_bf16 v[184:187], a[120:123], v[68:71], v[184:187]
    v_exp_f32 v53, v53
    v_mul_f32 v54, s46, v54
    v_mfma_f32_16x16x32_bf16 v[188:191], a[124:127], v[68:71], v[188:191]
    v_add_f32 v113, v113, v52
    v_cvt_pk_bf16_f32 v74, v52, v53
    v_mfma_f32_16x16x32_bf16 v[96:99], v[104:107], v[68:71], v[96:99]
    v_exp_f32 v54, v54
    v_mul_f32 v55, s46, v55
    v_mfma_f32_16x16x32_bf16 v[44:47], a[16:19], a[144:147], v[84:87]
    ds_read_b64_tr_b16 a[76:77], v11 offset:49152
    v_add_f32 v113, v113, v53
    v_mfma_f32_16x16x32_bf16 v[44:47], a[20:23], a[148:151], v[44:47]
    v_exp_f32 v55, v55
    v_mfma_f32_16x16x32_bf16 v[44:47], a[24:27], a[152:155], v[44:47]
    ds_read_b64_tr_b16 a[78:79], v11 offset:53248
    v_cvt_pk_bf16_f32 v75, v54, v55
    v_mfma_f32_16x16x32_bf16 v[44:47], a[28:31], a[156:159], v[44:47]
    v_add_f32 v113, v113, v54
    v_add_f32 v113, v113, v55
    v_mfma_f32_16x16x32_bf16 v[48:51], a[0:3], a[160:163], v[88:91]
    v_mul_f32 v56, s46, v56
    v_exp_f32 v56, v56
    v_mul_f32 v57, s46, v57
    v_mfma_f32_16x16x32_bf16 v[48:51], a[4:7], a[164:167], v[48:51]
    ds_read_b64_tr_b16 a[80:81], v12 offset:49152
    v_mfma_f32_16x16x32_bf16 v[48:51], a[8:11], a[168:171], v[48:51]
    v_exp_f32 v57, v57
    v_mul_f32 v58, s46, v58
    v_mfma_f32_16x16x32_bf16 v[48:51], a[12:15], a[172:175], v[48:51]
    ds_read_b64_tr_b16 a[82:83], v12 offset:53248
    v_cvt_pk_bf16_f32 v76, v56, v57
    v_mfma_f32_16x16x32_bf16 v[192:195], a[96:99], v[72:75], v[192:195]
    v_exp_f32 v58, v58
    v_mul_f32 v59, s46, v59
    v_mfma_f32_16x16x32_bf16 v[196:199], a[100:103], v[72:75], v[196:199]
    ds_read_b64_tr_b16 a[84:85], v13 offset:49152
    v_mfma_f32_16x16x32_bf16 v[200:203], a[104:107], v[72:75], v[200:203]
    v_exp_f32 v59, v59
    v_mul_f32 v60, s46, v60
    v_mfma_f32_16x16x32_bf16 v[204:207], a[108:111], v[72:75], v[204:207]
    ds_read_b64_tr_b16 a[86:87], v13 offset:53248
    v_cvt_pk_bf16_f32 v77, v58, v59
    v_mfma_f32_16x16x32_bf16 v[208:211], a[112:115], v[72:75], v[208:211]
    s_add_u32 m0, s29, 73728
    v_exp_f32 v60, v60
    v_mul_f32 v61, s46, v61
    v_mfma_f32_16x16x32_bf16 v[212:215], a[116:119], v[72:75], v[212:215]
    buffer_load_dwordx4 v27, s[8:11], s51 offen nt lds
    v_mfma_f32_16x16x32_bf16 v[216:219], a[120:123], v[72:75], v[216:219]
    v_exp_f32 v61, v61
    v_mul_f32 v62, s46, v62
    v_mfma_f32_16x16x32_bf16 v[220:223], a[124:127], v[72:75], v[220:223]
    ds_read_b64_tr_b16 a[88:89], v14 offset:49152
    v_cvt_pk_bf16_f32 v78, v60, v61
    v_mfma_f32_16x16x32_bf16 v[52:55], a[16:19], a[160:163], v[88:91]
    s_add_u32 s26, s26, 8192
    v_exp_f32 v62, v62
    v_mul_f32 v63, s46, v63
    v_mfma_f32_16x16x32_bf16 v[52:55], a[20:23], a[164:167], v[52:55]
    buffer_load_dwordx4 v28, s[8:11], s51 offen offset:1024 nt lds
    v_mfma_f32_16x16x32_bf16 v[52:55], a[24:27], a[168:171], v[52:55]
    s_xor_b32 s51, s26, s49
    v_exp_f32 v63, v63
    v_mfma_f32_16x16x32_bf16 v[52:55], a[28:31], a[172:175], v[52:55]
    ds_read_b64_tr_b16 a[90:91], v14 offset:53248
    v_cvt_pk_bf16_f32 v79, v62, v63
    s_cbranch_vccnz L_alt5
    v_mfma_f32_16x16x32_bf16 v[56:59], a[0:3], a[176:179], v[92:95]
    v_mul_f32 v32, s46, v32
    v_exp_f32 v32, v32
    v_mul_f32 v33, s46, v33
    v_mfma_f32_16x16x32_bf16 v[56:59], a[4:7], a[180:183], v[56:59]
    ds_read_b64_tr_b16 a[92:93], v15 offset:49152
    v_add_f32 v112, v112, v32
    v_mfma_f32_16x16x32_bf16 v[56:59], a[8:11], a[184:187], v[56:59]
    v_exp_f32 v33, v33
    v_mul_f32 v34, s46, v34
    v_mfma_f32_16x16x32_bf16 v[56:59], a[12:15], a[188:191], v[56:59]
    v_add_f32 v112, v112, v33
    v_cvt_pk_bf16_f32 v64, v32, v33
    v_mfma_f32_16x16x32_bf16 v[224:227], a[96:99], v[76:79], v[224:227]
    v_exp_f32 v34, v34
    v_mul_f32 v35, s46, v35
    v_mfma_f32_16x16x32_bf16 v[228:231], a[100:103], v[76:79], v[228:231]
    ds_read_b64_tr_b16 a[94:95], v15 offset:53248
    v_add_f32 v112, v112, v34
    v_mfma_f32_16x16x32_bf16 v[232:235], a[104:107], v[76:79], v[232:235]
    v_exp_f32 v35, v35
    v_mul_f32 v36, s46, v36
    v_mfma_f32_16x16x32_bf16 v[236:239], a[108:111], v[76:79], v[236:239]
    ds_read_b128 a[48:51], v17 offset:61440
    v_cvt_pk_bf16_f32 v65, v34, v35
    v_mfma_f32_16x16x32_bf16 v[240:243], a[112:115], v[76:79], v[240:243]
    v_exp_f32 v36, v36
    v_mul_f32 v37, s46, v37
    v_mfma_f32_16x16x32_bf16 v[244:247], a[116:119], v[76:79], v[244:247]
    ds_read_b128 a[52:55], v18 offset:61440
    v_add_f32 v112, v112, v35
    v_mfma_f32_16x16x32_bf16 v[248:251], a[120:123], v[76:79], v[248:251]
    v_exp_f32 v37, v37
    v_mul_f32 v38, s46, v38
    v_mfma_f32_16x16x32_bf16 v[252:255], a[124:127], v[76:79], v[252:255]
    v_add_f32 v112, v112, v36
    v_cvt_pk_bf16_f32 v66, v36, v37
    v_mfma_f32_16x16x32_bf16 v[100:103], v[104:107], v[76:79], v[100:103]
    v_exp_f32 v38, v38
    v_mul_f32 v39, s46, v39
    v_mfma_f32_16x16x32_bf16 v[60:63], a[16:19], a[176:179], v[92:95]
    ds_read_b128 a[56:59], v19 offset:61440
    v_add_f32 v112, v112, v37
    v_mfma_f32_16x16x32_bf16 v[60:63], a[20:23], a[180:183], v[60:63]
    v_exp_f32 v39, v39
    v_mfma_f32_16x16x32_bf16 v[60:63], a[24:27], a[184:187], v[60:63]
    s_waitcnt vmcnt(8) lgkmcnt(15)
    ds_read_b128 a[60:63], v20 offset:61440
    v_cvt_pk_bf16_f32 v67, v38, v39
    v_mfma_f32_16x16x32_bf16 v[60:63], a[28:31], a[188:191], v[60:63]
L_altb5:
    s_barrier
    v_mfma_f32_16x16x32_bf16 v[32:35], a[32:35], a[128:131], v[80:83]
    v_mul_f32 v40, s46, v40
    v_exp_f32 v40, v40
    v_mul_f32 v41, s46, v41
    v_mfma_f32_16x16x32_bf16 v[32:35], a[36:39], a[132:135], v[32:35]
    ds_read_b128 a[0:3], v17 offset:0
    v_add_f32 v112, v112, v38
    v_mfma_f32_16x16x32_bf16 v[32:35], a[40:43], a[136:139], v[32:35]
    v_exp_f32 v41, v41
    v_mul_f32 v42, s46, v42
    v_mfma_f32_16x16x32_bf16 v[32:35], a[44:47], a[140:143], v[32:35]
    s_waitcnt lgkmcnt(5)
    ds_read_b128 a[4:7], v18 offset:0
    v_cvt_pk_bf16_f32 v68, v40, v41
    v_mfma_f32_16x16x32_bf16 v[128:131], a[64:67], v[64:67], v[128:131]
    v_exp_f32 v42, v42
    v_mul_f32 v43, s46, v43
    v_mfma_f32_16x16x32_bf16 v[132:135], a[68:71], v[64:67], v[132:135]
    ds_read_b128 a[8:11], v19 offset:0
    v_add_f32 v112, v112, v39
    v_mfma_f32_16x16x32_bf16 v[136:139], a[72:75], v[64:67], v[136:139]
    v_exp_f32 v43, v43
    v_mul_f32 v44, s46, v44
    v_mfma_f32_16x16x32_bf16 v[140:143], a[76:79], v[64:67], v[140:143]
    ds_read_b128 a[12:15], v20 offset:0
    v_cvt_pk_bf16_f32 v69, v42, v43
    v_mfma_f32_16x16x32_bf16 v[144:147], a[80:83], v[64:67], v[144:147]
    s_add_u32 m0, s29, 24576
    v_exp_f32 v44, v44
    v_mul_f32 v45, s46, v45
    v_mfma_f32_16x16x32_bf16 v[148:151], a[84:87], v[64:67], v[148:151]
    buffer_load_dwordx4 v25, s[4:7], s50 offen nt lds
    v_mfma_f32_16x16x32_bf16 v[152:155], a[88:91], v[64:67], v[152:155]
    v_exp_f32 v45, v45
    v_mul_f32 v46, s46, v46
    v_mfma_f32_16x16x32_bf16 v[156:159], a[92:95], v[64:67], v[156:159]
    s_waitcnt lgkmcnt(4)
    ds_read_b64_tr_b16 a[96:97], v8 offset:57344
    v_cvt_pk_bf16_f32 v70, v44, v45
    v_mfma_f32_16x16x32_bf16 v[36:39], a[48:51], a[128:131], v[80:83]
    s_add_u32 s25, s25, 8192
    v_exp_f32 v46, v46
    v_mul_f32 v47, s46, v47
    v_mfma_f32_16x16x32_bf16 v[36:39], a[52:55], a[132:135], v[36:39]
    buffer_load_dwordx4 v26, s[4:7], s50 offen offset:1024 nt lds
    v_mfma_f32_16x16x32_bf16 v[36:39], a[56:59], a[136:139], v[36:39]
    s_xor_b32 s50, s25, s49
    v_exp_f32 v47, v47
    v_mfma_f32_16x16x32_bf16 v[36:39], a[60:63], a[140:143], v[36:39]
    ds_read_b64_tr_b16 a[98:99], v8 offset:61440
    v_cvt_pk_bf16_f32 v71, v46, v47
    v_mfma_f32_16x16x32_bf16 v[40:43], a[32:35], a[144:147], v[84:87]
    v_mul_f32 v48, s46, v48
    v_exp_f32 v48, v48
    v_mul_f32 v49, s46, v49
    v_mfma_f32_16x16x32_bf16 v[40:43], a[36:39], a[148:151], v[40:43]
    ds_read_b64_tr_b16 a[100:101], v9 offset:57344
    v_add_f32 v113, v113, v48
    v_mfma_f32_16x16x32_bf16 v[40:43], a[40:43], a[152:155], v[40:43]
    v_exp_f32 v49, v49
    v_mul_f32 v50, s46, v50
    v_mfma_f32_16x16x32_bf16 v[40:43], a[44:47], a[156:159], v[40:43]
    v_add_f32 v113, v113, v49
    v_cvt_pk_bf16_f32 v72, v48, v49
    v_mfma_f32_16x16x32_bf16 v[160:163], a[64:67], v[68:71], v[160:163]
    v_exp_f32 v50, v50
    v_mul_f32 v51, s46, v51
    v_mfma_f32_16x16x32_bf16 v[164:167], a[68:71], v[68:71], v[164:167]
    ds_read_b64_tr_b16 a[102:103], v9 offset:61440
    v_add_f32 v113, v113, v50
    v_mfma_f32_16x16x32_bf16 v[168:171], a[72:75], v[68:71], v[168:171]
    v_exp_f32 v51, v51
    v_mul_f32 v52, s46, v52
    v_mfma_f32_16x16x32_bf16 v[172:175], a[76:79], v[68:71], v[172:175]
    ds_read_b64_tr_b16 a[104:105], v10 offset:57344
    v_cvt_pk_bf16_f32 v73, v50, v51
    v_mfma_f32_16x16x32_bf16 v[176:179], a[80:83], v[68:71], v[176:179]
    v_exp_f32 v52, v52
    v_mul_f32 v53, s46, v53
    v_mfma_f32_16x16x32_bf16 v[180:183], a[84:87], v[68:71], v[180:183]
    ds_read_b64_tr_b16 a[106:107], v10 offset:61440
    v_add_f32 v113, v113, v51
    v_mfma_f32_16x16x32_bf16 v[184:187], a[88:91], v[68:71], v[184:187]
    v_exp_f32 v53, v53
    v_mul_f32 v54, s46, v54
    v_mfma_f32_16x16x32_bf16 v[188:191], a[92:95], v[68:71], v[188:191]
    v_add_f32 v113, v113, v52
    v_cvt_pk_bf16_f32 v74, v52, v53
    v_mfma_f32_16x16x32_bf16 v[96:99], v[104:107], v[68:71], v[96:99]
    v_exp_f32 v54, v54
    v_mul_f32 v55, s46, v55
    v_mfma_f32_16x16x32_bf16 v[44:47], a[48:51], a[144:147], v[84:87]
    ds_read_b64_tr_b16 a[108:109], v11 offset:57344
    v_add_f32 v113, v113, v53
    v_mfma_f32_16x16x32_bf16 v[44:47], a[52:55], a[148:151], v[44:47]
    v_exp_f32 v55, v55
    v_mfma_f32_16x16x32_bf16 v[44:47], a[56:59], a[152:155], v[44:47]
    ds_read_b64_tr_b16 a[110:111], v11 offset:61440
    v_cvt_pk_bf16_f32 v75, v54, v55
    v_mfma_f32_16x16x32_bf16 v[44:47], a[60:63], a[156:159], v[44:47]
    v_add_f32 v113, v113, v54
    v_add_f32 v113, v113, v55
    v_mfma_f32_16x16x32_bf16 v[48:51], a[32:35], a[160:163], v[88:91]
    v_mul_f32 v56, s46, v56
    v_exp_f32 v56, v56
    v_mul_f32 v57, s46, v57
    v_mfma_f32_16x16x32_bf16 v[48:51], a[36:39], a[164:167], v[48:51]
    ds_read_b64_tr_b16 a[112:113], v12 offset:57344
    v_mfma_f32_16x16x32_bf16 v[48:51], a[40:43], a[168:171], v[48:51]
    v_exp_f32 v57, v57
    v_mul_f32 v58, s46, v58
    v_mfma_f32_16x16x32_bf16 v[48:51], a[44:47], a[172:175], v[48:51]
    ds_read_b64_tr_b16 a[114:115], v12 offset:61440
    v_cvt_pk_bf16_f32 v76, v56, v57
    v_mfma_f32_16x16x32_bf16 v[192:195], a[64:67], v[72:75], v[192:195]
    v_exp_f32 v58, v58
    v_mul_f32 v59, s46, v59
    v_mfma_f32_16x16x32_bf16 v[196:199], a[68:71], v[72:75], v[196:199]
    ds_read_b64_tr_b16 a[116:117], v13 offset:57344
    v_mfma_f32_16x16x32_bf16 v[200:203], a[72:75], v[72:75], v[200:203]
    v_exp_f32 v59, v59
    v_mul_f32 v60, s46, v60
    v_mfma_f32_16x16x32_bf16 v[204:207], a[76:79], v[72:75], v[204:207]
    ds_read_b64_tr_b16 a[118:119], v13 offset:61440
    v_cvt_pk_bf16_f32 v77, v58, v59
    v_mfma_f32_16x16x32_bf16 v[208:211], a[80:83], v[72:75], v[208:211]
    s_add_u32 m0, s29, 81920
    v_exp_f32 v60, v60
    v_mul_f32 v61, s46, v61
    v_mfma_f32_16x16x32_bf16 v[212:215], a[84:87], v[72:75], v[212:215]
    buffer_load_dwordx4 v27, s[8:11], s51 offen nt lds
    v_mfma_f32_16x16x32_bf16 v[216:219], a[88:91], v[72:75], v[216:219]
    v_exp_f32 v61, v61
    v_mul_f32 v62, s46, v62
    v_mfma_f32_16x16x32_bf16 v[220:223], a[92:95], v[72:75], v[220:223]
    ds_read_b64_tr_b16 a[120:121], v14 offset:57344
    v_cvt_pk_bf16_f32 v78, v60, v61
    v_mfma_f32_16x16x32_bf16 v[52:55], a[48:51], a[160:163], v[88:91]
    s_add_u32 s26, s26, 8192
    v_exp_f32 v62, v62
    v_mul_f32 v63, s46, v63
    v_mfma_f32_16x16x32_bf16 v[52:55], a[52:55], a[164:167], v[52:55]
    buffer_load_dwordx4 v28, s[8:11], s51 offen offset:1024 nt lds
    v_mfma_f32_16x16x32_bf16 v[52:55], a[56:59], a[168:171], v[52:55]
    s_xor_b32 s51, s26, s49
    v_exp_f32 v63, v63
    v_mfma_f32_16x16x32_bf16 v[52:55], a[60:63], a[172:175], v[52:55]
    ds_read_b64_tr_b16 a[122:123], v14 offset:61440
    v_cvt_pk_bf16_f32 v79, v62, v63
    s_cbranch_vccnz L_alt6
    v_mfma_f32_16x16x32_bf16 v[56:59], a[32:35], a[176:179], v[92:95]
    v_mul_f32 v32, s46, v32
    v_exp_f32 v32, v32
    v_mul_f32 v33, s46, v33
    v_mfma_f32_16x16x32_bf16 v[56:59], a[36:39], a[180:183], v[56:59]
    ds_read_b64_tr_b16 a[124:125], v15 offset:57344
    v_add_f32 v112, v112, v32
    v_mfma_f32_16x16x32_bf16 v[56:59], a[40:43], a[184:187], v[56:59]
    v_exp_f32 v33, v33
    v_mul_f32 v34, s46, v34
    v_mfma_f32_16x16x32_bf16 v[56:59], a[44:47], a[188:191], v[56:59]
    v_add_f32 v112, v112, v33
    v_cvt_pk_bf16_f32 v64, v32, v33
    v_mfma_f32_16x16x32_bf16 v[224:227], a[64:67], v[76:79], v[224:227]
    v_exp_f32 v34, v34
    v_mul_f32 v35, s46, v35
    v_mfma_f32_16x16x32_bf16 v[228:231], a[68:71], v[76:79], v[228:231]
    ds_read_b64_tr_b16 a[126:127], v15 offset:61440
    v_add_f32 v112, v112, v34
    v_mfma_f32_16x16x32_bf16 v[232:235], a[72:75], v[76:79], v[232:235]
    v_exp_f32 v35, v35
    v_mul_f32 v36, s46, v36
    v_mfma_f32_16x16x32_bf16 v[236:239], a[76:79], v[76:79], v[236:239]
    ds_read_b128 a[16:19], v17 offset:4096
    v_cvt_pk_bf16_f32 v65, v34, v35
    v_mfma_f32_16x16x32_bf16 v[240:243], a[80:83], v[76:79], v[240:243]
    v_exp_f32 v36, v36
    v_mul_f32 v37, s46, v37
    v_mfma_f32_16x16x32_bf16 v[244:247], a[84:87], v[76:79], v[244:247]
    ds_read_b128 a[20:23], v18 offset:4096
    v_add_f32 v112, v112, v35
    v_mfma_f32_16x16x32_bf16 v[248:251], a[88:91], v[76:79], v[248:251]
    v_exp_f32 v37, v37
    v_mul_f32 v38, s46, v38
    v_mfma_f32_16x16x32_bf16 v[252:255], a[92:95], v[76:79], v[252:255]
    v_add_f32 v112, v112, v36
    v_cvt_pk_bf16_f32 v66, v36, v37
    v_mfma_f32_16x16x32_bf16 v[100:103], v[104:107], v[76:79], v[100:103]
    s_add_u32 s36, s36, 1
    v_exp_f32 v38, v38
    v_mul_f32 v39, s46, v39
    v_mfma_f32_16x16x32_bf16 v[60:63], a[48:51], a[176:179], v[92:95]
    ds_read_b128 a[24:27], v19 offset:4096
    v_add_f32 v112, v112, v37
    v_mfma_f32_16x16x32_bf16 v[60:63], a[52:55], a[180:183], v[60:63]
    s_bitcmp0_b32 s33, s36
    v_exp_f32 v39, v39
    v_mfma_f32_16x16x32_bf16 v[60:63], a[56:59], a[184:187], v[60:63]
    s_waitcnt vmcnt(8) lgkmcnt(15)
    ds_read_b128 a[28:31], v20 offset:4096
    v_cvt_pk_bf16_f32 v67, v38, v39
    v_mfma_f32_16x16x32_bf16 v[60:63], a[60:63], a[188:191], v[60:63]
L_altb6:
    s_barrier
    s_cbranch_scc0 L_exit
    v_mfma_f32_16x16x32_bf16 v[32:35], a[0:3], a[128:131], v[80:83]
    v_mul_f32 v40, s46, v40
    v_exp_f32 v40, v40
    v_mul_f32 v41, s46, v41
    v_mfma_f32_16x16x32_bf16 v[32:35], a[4:7], a[132:135], v[32:35]
    ds_read_b128 a[32:35], v17 offset:8192
    v_add_f32 v112, v112, v38
    v_mfma_f32_16x16x32_bf16 v[32:35], a[8:11], a[136:139], v[32:35]
    v_exp_f32 v41, v41
    v_mul_f32 v42, s46, v42
    v_mfma_f32_16x16x32_bf16 v[32:35], a[12:15], a[140:143], v[32:35]
    s_waitcnt lgkmcnt(5)
    ds_read_b128 a[36:39], v18 offset:8192
    v_cvt_pk_bf16_f32 v68, v40, v41
    v_mfma_f32_16x16x32_bf16 v[128:131], a[96:99], v[64:67], v[128:131]
    v_exp_f32 v42, v42
    v_mul_f32 v43, s46, v43
    v_mfma_f32_16x16x32_bf16 v[132:135], a[100:103], v[64:67], v[132:135]
    ds_read_b128 a[40:43], v19 offset:8192
    v_add_f32 v112, v112, v39
    v_mfma_f32_16x16x32_bf16 v[136:139], a[104:107], v[64:67], v[136:139]
    v_exp_f32 v43, v43
    v_mul_f32 v44, s46, v44
    v_mfma_f32_16x16x32_bf16 v[140:143], a[108:111], v[64:67], v[140:143]
    ds_read_b128 a[44:47], v20 offset:8192
    v_cvt_pk_bf16_f32 v69, v42, v43
    v_mfma_f32_16x16x32_bf16 v[144:147], a[112:115], v[64:67], v[144:147]
    s_add_u32 m0, s29, 32768
    v_exp_f32 v44, v44
    v_mul_f32 v45, s46, v45
    v_mfma_f32_16x16x32_bf16 v[148:151], a[116:119], v[64:67], v[148:151]
    buffer_load_dwordx4 v25, s[4:7], s50 offen nt lds
    v_mfma_f32_16x16x32_bf16 v[152:155], a[120:123], v[64:67], v[152:155]
    v_exp_f32 v45, v45
    v_mul_f32 v46, s46, v46
    v_mfma_f32_16x16x32_bf16 v[156:159], a[124:127], v[64:67], v[156:159]
    s_waitcnt lgkmcnt(4)
    ds_read_b64_tr_b16 a[64:65], v8 offset:0
    v_cvt_pk_bf16_f32 v70, v44, v45
    v_mfma_f32_16x16x32_bf16 v[36:39], a[16:19], a[128:131], v[80:83]
    s_add_u32 s25, s25, 8192
    v_exp_f32 v46, v46
    v_mul_f32 v47, s46, v47
    v_mfma_f32_16x16x32_bf16 v[36:39], a[20:23], a[132:135], v[36:39]
    buffer_load_dwordx4 v26, s[4:7], s50 offen offset:1024 nt lds
    v_mfma_f32_16x16x32_bf16 v[36:39], a[24:27], a[136:139], v[36:39]
    s_xor_b32 s50, s25, s49
    v_exp_f32 v47, v47
    v_mfma_f32_16x16x32_bf16 v[36:39], a[28:31], a[140:143], v[36:39]
    ds_read_b64_tr_b16 a[66:67], v8 offset:4096
    v_cvt_pk_bf16_f32 v71, v46, v47
    v_mfma_f32_16x16x32_bf16 v[40:43], a[0:3], a[144:147], v[84:87]
    v_mul_f32 v48, s46, v48
    v_exp_f32 v48, v48
    v_mul_f32 v49, s46, v49
    v_mfma_f32_16x16x32_bf16 v[40:43], a[4:7], a[148:151], v[40:43]
    ds_read_b64_tr_b16 a[68:69], v9 offset:0
    v_add_f32 v113, v113, v48
    v_mfma_f32_16x16x32_bf16 v[40:43], a[8:11], a[152:155], v[40:43]
    v_exp_f32 v49, v49
    v_mul_f32 v50, s46, v50
    v_mfma_f32_16x16x32_bf16 v[40:43], a[12:15], a[156:159], v[40:43]
    v_add_f32 v113, v113, v49
    v_cvt_pk_bf16_f32 v72, v48, v49
    v_mfma_f32_16x16x32_bf16 v[160:163], a[96:99], v[68:71], v[160:163]
    v_exp_f32 v50, v50
    v_mul_f32 v51, s46, v51
    v_mfma_f32_16x16x32_bf16 v[164:167], a[100:103], v[68:71], v[164:167]
    ds_read_b64_tr_b16 a[70:71], v9 offset:4096
    v_add_f32 v113, v113, v50
    v_mfma_f32_16x16x32_bf16 v[168:171], a[104:107], v[68:71], v[168:171]
    v_exp_f32 v51, v51
    v_mul_f32 v52, s46, v52
    v_mfma_f32_16x16x32_bf16 v[172:175], a[108:111], v[68:71], v[172:175]
    ds_read_b64_tr_b16 a[72:73], v10 offset:0
    v_cvt_pk_bf16_f32 v73, v50, v51
    v_mfma_f32_16x16x32_bf16 v[176:179], a[112:115], v[68:71], v[176:179]
    v_exp_f32 v52, v52
    v_mul_f32 v53, s46, v53
    v_mfma_f32_16x16x32_bf16 v[180:183], a[116:119], v[68:71], v[180:183]
    ds_read_b64_tr_b16 a[74:75], v10 offset:4096
    v_add_f32 v113, v113, v51
    v_mfma_f32_16x16x32_bf16 v[184:187], a[120:123], v[68:71], v[184:187]
    v_exp_f32 v53, v53
    v_mul_f32 v54, s46, v54
    v_mfma_f32_16x16x32_bf16 v[188:191], a[124:127], v[68:71], v[188:191]
    v_add_f32 v113, v113, v52
    v_cvt_pk_bf16_f32 v74, v52, v53
    v_mfma_f32_16x16x32_bf16 v[96:99], v[104:107], v[68:71], v[96:99]
    v_exp_f32 v54, v54
    v_mul_f32 v55, s46, v55
    v_mfma_f32_16x16x32_bf16 v[44:47], a[16:19], a[144:147], v[84:87]
    ds_read_b64_tr_b16 a[76:77], v11 offset:0
    v_add_f32 v113, v113, v53
    v_mfma_f32_16x16x32_bf16 v[44:47], a[20:23], a[148:151], v[44:47]
    v_exp_f32 v55, v55
    v_mfma_f32_16x16x32_bf16 v[44:47], a[24:27], a[152:155], v[44:47]
    ds_read_b64_tr_b16 a[78:79], v11 offset:4096
    v_cvt_pk_bf16_f32 v75, v54, v55
    v_mfma_f32_16x16x32_bf16 v[44:47], a[28:31], a[156:159], v[44:47]
    v_add_f32 v113, v113, v54
    v_add_f32 v113, v113, v55
    v_mfma_f32_16x16x32_bf16 v[48:51], a[0:3], a[160:163], v[88:91]
    v_mul_f32 v56, s46, v56
    v_exp_f32 v56, v56
    v_mul_f32 v57, s46, v57
    v_mfma_f32_16x16x32_bf16 v[48:51], a[4:7], a[164:167], v[48:51]
    ds_read_b64_tr_b16 a[80:81], v12 offset:0
    v_mfma_f32_16x16x32_bf16 v[48:51], a[8:11], a[168:171], v[48:51]
    v_exp_f32 v57, v57
    v_mul_f32 v58, s46, v58
    v_mfma_f32_16x16x32_bf16 v[48:51], a[12:15], a[172:175], v[48:51]
    ds_read_b64_tr_b16 a[82:83], v12 offset:4096
    v_cvt_pk_bf16_f32 v76, v56, v57
    v_mfma_f32_16x16x32_bf16 v[192:195], a[96:99], v[72:75], v[192:195]
    v_exp_f32 v58, v58
    v_mul_f32 v59, s46, v59
    v_mfma_f32_16x16x32_bf16 v[196:199], a[100:103], v[72:75], v[196:199]
    ds_read_b64_tr_b16 a[84:85], v13 offset:0
    v_mfma_f32_16x16x32_bf16 v[200:203], a[104:107], v[72:75], v[200:203]
    v_exp_f32 v59, v59
    v_mul_f32 v60, s46, v60
    v_mfma_f32_16x16x32_bf16 v[204:207], a[108:111], v[72:75], v[204:207]
    ds_read_b64_tr_b16 a[86:87], v13 offset:4096
    v_cvt_pk_bf16_f32 v77, v58, v59
    v_mfma_f32_16x16x32_bf16 v[208:211], a[112:115], v[72:75], v[208:211]
    s_add_u32 m0, s29, 90112
    v_exp_f32 v60, v60
    v_mul_f32 v61, s46, v61
    v_mfma_f32_16x16x32_bf16 v[212:215], a[116:119], v[72:75], v[212:215]
    buffer_load_dwordx4 v27, s[8:11], s51 offen nt lds
    v_mfma_f32_16x16x32_bf16 v[216:219], a[120:123], v[72:75], v[216:219]
    v_exp_f32 v61, v61
    v_mul_f32 v62, s46, v62
    v_mfma_f32_16x16x32_bf16 v[220:223], a[124:127], v[72:75], v[220:223]
    ds_read_b64_tr_b16 a[88:89], v14 offset:0
    v_cvt_pk_bf16_f32 v78, v60, v61
    v_mfma_f32_16x16x32_bf16 v[52:55], a[16:19], a[160:163], v[88:91]
    s_add_u32 s26, s26, 8192
    v_exp_f32 v62, v62
    v_mul_f32 v63, s46, v63
    v_mfma_f32_16x16x32_bf16 v[52:55], a[20:23], a[164:167], v[52:55]
    buffer_load_dwordx4 v28, s[8:11], s51 offen offset:1024 nt lds
    v_mfma_f32_16x16x32_bf16 v[52:55], a[24:27], a[168:171], v[52:55]
    s_xor_b32 s51, s26, s49
    v_exp_f32 v63, v63
    v_mfma_f32_16x16x32_bf16 v[52:55], a[28:31], a[172:175], v[52:55]
    ds_read_b64_tr_b16 a[90:91], v14 offset:4096
    v_cvt_pk_bf16_f32 v79, v62, v63
    s_cbranch_vccnz L_alt7
    v_mfma_f32_16x16x32_bf16 v[56:59], a[0:3], a[176:179], v[92:95]
    v_mul_f32 v32, s46, v32
    v_exp_f32 v32, v32
    v_mul_f32 v33, s46, v33
    v_mfma_f32_16x16x32_bf16 v[56:59], a[4:7], a[180:183], v[56:59]
    ds_read_b64_tr_b16 a[92:93], v15 offset:0
    v_add_f32 v112, v112, v32
    v_mfma_f32_16x16x32_bf16 v[56:59], a[8:11], a[184:187], v[56:59]
    v_exp_f32 v33, v33
    v_mul_f32 v34, s46, v34
    v_mfma_f32_16x16x32_bf16 v[56:59], a[12:15], a[188:191], v[56:59]
    v_add_f32 v112, v112, v33
    v_cvt_pk_bf16_f32 v64, v32, v33
    v_mfma_f32_16x16x32_bf16 v[224:227], a[96:99], v[76:79], v[224:227]
    v_exp_f32 v34, v34
    v_mul_f32 v35, s46, v35
    v_mfma_f32_16x16x32_bf16 v[228:231], a[100:103], v[76:79], v[228:231]
    ds_read_b64_tr_b16 a[94:95], v15 offset:4096
    v_add_f32 v112, v112, v34
    v_mfma_f32_16x16x32_bf16 v[232:235], a[104:107], v[76:79], v[232:235]
    v_exp_f32 v35, v35
    v_mul_f32 v36, s46, v36
    v_mfma_f32_16x16x32_bf16 v[236:239], a[108:111], v[76:79], v[236:239]
    ds_read_b128 a[48:51], v17 offset:12288
    v_cvt_pk_bf16_f32 v65, v34, v35
    v_mfma_f32_16x16x32_bf16 v[240:243], a[112:115], v[76:79], v[240:243]
    v_exp_f32 v36, v36
    v_mul_f32 v37, s46, v37
    v_mfma_f32_16x16x32_bf16 v[244:247], a[116:119], v[76:79], v[244:247]
    ds_read_b128 a[52:55], v18 offset:12288
    v_add_f32 v112, v112, v35
    v_mfma_f32_16x16x32_bf16 v[248:251], a[120:123], v[76:79], v[248:251]
    v_exp_f32 v37, v37
    v_mul_f32 v38, s46, v38
    v_mfma_f32_16x16x32_bf16 v[252:255], a[124:127], v[76:79], v[252:255]
    v_add_f32 v112, v112, v36
    v_cvt_pk_bf16_f32 v66, v36, v37
    v_mfma_f32_16x16x32_bf16 v[100:103], v[104:107], v[76:79], v[100:103]
    v_exp_f32 v38, v38
    v_mul_f32 v39, s46, v39
    v_mfma_f32_16x16x32_bf16 v[60:63], a[16:19], a[176:179], v[92:95]
    ds_read_b128 a[56:59], v19 offset:12288
    v_add_f32 v112, v112, v37
    v_mfma_f32_16x16x32_bf16 v[60:63], a[20:23], a[180:183], v[60:63]
    v_exp_f32 v39, v39
    v_mfma_f32_16x16x32_bf16 v[60:63], a[24:27], a[184:187], v[60:63]
    s_waitcnt vmcnt(8) lgkmcnt(15)
    ds_read_b128 a[60:63], v20 offset:12288
    v_cvt_pk_bf16_f32 v67, v38, v39
    v_mfma_f32_16x16x32_bf16 v[60:63], a[28:31], a[188:191], v[60:63]
L_altb7:
    s_barrier
    v_mfma_f32_16x16x32_bf16 v[32:35], a[32:35], a[128:131], v[80:83]
    v_mul_f32 v40, s46, v40
    v_exp_f32 v40, v40
    v_mul_f32 v41, s46, v41
    v_mfma_f32_16x16x32_bf16 v[32:35], a[36:39], a[132:135], v[32:35]
    ds_read_b128 a[0:3], v17 offset:16384
    v_add_f32 v112, v112, v38
    v_mfma_f32_16x16x32_bf16 v[32:35], a[40:43], a[136:139], v[32:35]
    v_exp_f32 v41, v41
    v_mul_f32 v42, s46, v42
    v_mfma_f32_16x16x32_bf16 v[32:35], a[44:47], a[140:143], v[32:35]
    s_waitcnt lgkmcnt(5)
    ds_read_b128 a[4:7], v18 offset:16384
    v_cvt_pk_bf16_f32 v68, v40, v41
    v_mfma_f32_16x16x32_bf16 v[128:131], a[64:67], v[64:67], v[128:131]
    v_exp_f32 v42, v42
    v_mul_f32 v43, s46, v43
    v_mfma_f32_16x16x32_bf16 v[132:135], a[68:71], v[64:67], v[132:135]
    ds_read_b128 a[8:11], v19 offset:16384
    v_add_f32 v112, v112, v39
    v_mfma_f32_16x16x32_bf16 v[136:139], a[72:75], v[64:67], v[136:139]
    v_exp_f32 v43, v43
    v_mul_f32 v44, s46, v44
    v_mfma_f32_16x16x32_bf16 v[140:143], a[76:79], v[64:67], v[140:143]
    ds_read_b128 a[12:15], v20 offset:16384
    v_cvt_pk_bf16_f32 v69, v42, v43
    v_mfma_f32_16x16x32_bf16 v[144:147], a[80:83], v[64:67], v[144:147]
    s_add_u32 m0, s29, 40960
    v_exp_f32 v44, v44
    v_mul_f32 v45, s46, v45
    v_mfma_f32_16x16x32_bf16 v[148:151], a[84:87], v[64:67], v[148:151]
    buffer_load_dwordx4 v25, s[4:7], s50 offen nt lds
    v_mfma_f32_16x16x32_bf16 v[152:155], a[88:91], v[64:67], v[152:155]
    v_exp_f32 v45, v45
    v_mul_f32 v46, s46, v46
    v_mfma_f32_16x16x32_bf16 v[156:159], a[92:95], v[64:67], v[156:159]
    s_waitcnt lgkmcnt(4)
    ds_read_b64_tr_b16 a[96:97], v8 offset:8192
    v_cvt_pk_bf16_f32 v70, v44, v45
    v_mfma_f32_16x16x32_bf16 v[36:39], a[48:51], a[128:131], v[80:83]
    s_add_u32 s25, s25, 8192
    v_exp_f32 v46, v46
    v_mul_f32 v47, s46, v47
    v_mfma_f32_16x16x32_bf16 v[36:39], a[52:55], a[132:135], v[36:39]
    buffer_load_dwordx4 v26, s[4:7], s50 offen offset:1024 nt lds
    v_mfma_f32_16x16x32_bf16 v[36:39], a[56:59], a[136:139], v[36:39]
    s_xor_b32 s50, s25, s49
    v_exp_f32 v47, v47
    v_mfma_f32_16x16x32_bf16 v[36:39], a[60:63], a[140:143], v[36:39]
    ds_read_b64_tr_b16 a[98:99], v8 offset:12288
    v_cvt_pk_bf16_f32 v71, v46, v47
    v_mfma_f32_16x16x32_bf16 v[40:43], a[32:35], a[144:147], v[84:87]
    v_mul_f32 v48, s46, v48
    v_exp_f32 v48, v48
    v_mul_f32 v49, s46, v49
    v_mfma_f32_16x16x32_bf16 v[40:43], a[36:39], a[148:151], v[40:43]
    ds_read_b64_tr_b16 a[100:101], v9 offset:8192
    v_add_f32 v113, v113, v48
    v_mfma_f32_16x16x32_bf16 v[40:43], a[40:43], a[152:155], v[40:43]
    v_exp_f32 v49, v49
    v_mul_f32 v50, s46, v50
    v_mfma_f32_16x16x32_bf16 v[40:43], a[44:47], a[156:159], v[40:43]
    v_add_f32 v113, v113, v49
    v_cvt_pk_bf16_f32 v72, v48, v49
    v_mfma_f32_16x16x32_bf16 v[160:163], a[64:67], v[68:71], v[160:163]
    v_exp_f32 v50, v50
    v_mul_f32 v51, s46, v51
    v_mfma_f32_16x16x32_bf16 v[164:167], a[68:71], v[68:71], v[164:167]
    ds_read_b64_tr_b16 a[102:103], v9 offset:12288
    v_add_f32 v113, v113, v50
    v_mfma_f32_16x16x32_bf16 v[168:171], a[72:75], v[68:71], v[168:171]
    v_exp_f32 v51, v51
    v_mul_f32 v52, s46, v52
    v_mfma_f32_16x16x32_bf16 v[172:175], a[76:79], v[68:71], v[172:175]
    ds_read_b64_tr_b16 a[104:105], v10 offset:8192
    v_cvt_pk_bf16_f32 v73, v50, v51
    v_mfma_f32_16x16x32_bf16 v[176:179], a[80:83], v[68:71], v[176:179]
    v_exp_f32 v52, v52
    v_mul_f32 v53, s46, v53
    v_mfma_f32_16x16x32_bf16 v[180:183], a[84:87], v[68:71], v[180:183]
    ds_read_b64_tr_b16 a[106:107], v10 offset:12288
    v_add_f32 v113, v113, v51
    v_mfma_f32_16x16x32_bf16 v[184:187], a[88:91], v[68:71], v[184:187]
    v_exp_f32 v53, v53
    v_mul_f32 v54, s46, v54
    v_mfma_f32_16x16x32_bf16 v[188:191], a[92:95], v[68:71], v[188:191]
    v_add_f32 v113, v113, v52
    v_cvt_pk_bf16_f32 v74, v52, v53
    v_mfma_f32_16x16x32_bf16 v[96:99], v[104:107], v[68:71], v[96:99]
    v_exp_f32 v54, v54
    v_mul_f32 v55, s46, v55
    v_mfma_f32_16x16x32_bf16 v[44:47], a[48:51], a[144:147], v[84:87]
    ds_read_b64_tr_b16 a[108:109], v11 offset:8192
    v_add_f32 v113, v113, v53
    v_mfma_f32_16x16x32_bf16 v[44:47], a[52:55], a[148:151], v[44:47]
    v_exp_f32 v55, v55
    v_mfma_f32_16x16x32_bf16 v[44:47], a[56:59], a[152:155], v[44:47]
    ds_read_b64_tr_b16 a[110:111], v11 offset:12288
    v_cvt_pk_bf16_f32 v75, v54, v55
    v_mfma_f32_16x16x32_bf16 v[44:47], a[60:63], a[156:159], v[44:47]
    v_add_f32 v113, v113, v54
    v_add_f32 v113, v113, v55
    v_mfma_f32_16x16x32_bf16 v[48:51], a[32:35], a[160:163], v[88:91]
    v_mul_f32 v56, s46, v56
    v_exp_f32 v56, v56
    v_mul_f32 v57, s46, v57
    v_mfma_f32_16x16x32_bf16 v[48:51], a[36:39], a[164:167], v[48:51]
    ds_read_b64_tr_b16 a[112:113], v12 offset:8192
    v_mfma_f32_16x16x32_bf16 v[48:51], a[40:43], a[168:171], v[48:51]
    v_exp_f32 v57, v57
    v_mul_f32 v58, s46, v58
    v_mfma_f32_16x16x32_bf16 v[48:51], a[44:47], a[172:175], v[48:51]
    ds_read_b64_tr_b16 a[114:115], v12 offset:12288
    v_cvt_pk_bf16_f32 v76, v56, v57
    v_mfma_f32_16x16x32_bf16 v[192:195], a[64:67], v[72:75], v[192:195]
    v_exp_f32 v58, v58
    v_mul_f32 v59, s46, v59
    v_mfma_f32_16x16x32_bf16 v[196:199], a[68:71], v[72:75], v[196:199]
    ds_read_b64_tr_b16 a[116:117], v13 offset:8192
    v_mfma_f32_16x16x32_bf16 v[200:203], a[72:75], v[72:75], v[200:203]
    v_exp_f32 v59, v59
    v_mul_f32 v60, s46, v60
    v_mfma_f32_16x16x32_bf16 v[204:207], a[76:79], v[72:75], v[204:207]
    ds_read_b64_tr_b16 a[118:119], v13 offset:12288
    v_cvt_pk_bf16_f32 v77, v58, v59
    v_mfma_f32_16x16x32_bf16 v[208:211], a[80:83], v[72:75], v[208:211]
    s_add_u32 m0, s29, 98304
    v_exp_f32 v60, v60
    v_mul_f32 v61, s46, v61
    v_mfma_f32_16x16x32_bf16 v[212:215], a[84:87], v[72:75], v[212:215]
    buffer_load_dwordx4 v27, s[8:11], s51 offen nt lds
    v_mfma_f32_16x16x32_bf16 v[216:219], a[88:91], v[72:75], v[216:219]
    v_exp_f32 v61, v61
    v_mul_f32 v62, s46, v62
    v_mfma_f32_16x16x32_bf16 v[220:223], a[92:95], v[72:75], v[220:223]
    ds_read_b64_tr_b16 a[120:121], v14 offset:8192
    v_cvt_pk_bf16_f32 v78, v60, v61
    v_mfma_f32_16x16x32_bf16 v[52:55], a[48:51], a[160:163], v[88:91]
    s_add_u32 s26, s26, 8192
    v_exp_f32 v62, v62
    v_mul_f32 v63, s46, v63
    v_mfma_f32_16x16x32_bf16 v[52:55], a[52:55], a[164:167], v[52:55]
    buffer_load_dwordx4 v28, s[8:11], s51 offen offset:1024 nt lds
    v_mfma_f32_16x16x32_bf16 v[52:55], a[56:59], a[168:171], v[52:55]
    s_xor_b32 s51, s26, s49
    v_exp_f32 v63, v63
    v_mfma_f32_16x16x32_bf16 v[52:55], a[60:63], a[172:175], v[52:55]
    ds_read_b64_tr_b16 a[122:123], v14 offset:12288
    v_cvt_pk_bf16_f32 v79, v62, v63
    s_cbranch_vccnz L_alt0
    v_mfma_f32_16x16x32_bf16 v[56:59], a[32:35], a[176:179], v[92:95]
    v_mul_f32 v32, s46, v32
    v_exp_f32 v32, v32
    v_mul_f32 v33, s46, v33
    v_mfma_f32_16x16x32_bf16 v[56:59], a[36:39], a[180:183], v[56:59]
    ds_read_b64_tr_b16 a[124:125], v15 offset:8192
    v_add_f32 v112, v112, v32
    v_mfma_f32_16x16x32_bf16 v[56:59], a[40:43], a[184:187], v[56:59]
    v_exp_f32 v33, v33
    v_mul_f32 v34, s46, v34
    v_mfma_f32_16x16x32_bf16 v[56:59], a[44:47], a[188:191], v[56:59]
    v_add_f32 v112, v112, v33
    v_cvt_pk_bf16_f32 v64, v32, v33
    v_mfma_f32_16x16x32_bf16 v[224:227], a[64:67], v[76:79], v[224:227]
    v_exp_f32 v34, v34
    v_mul_f32 v35, s46, v35
    v_mfma_f32_16x16x32_bf16 v[228:231], a[68:71], v[76:79], v[228:231]
    ds_read_b64_tr_b16 a[126:127], v15 offset:12288
    v_add_f32 v112, v112, v34
    v_mfma_f32_16x16x32_bf16 v[232:235], a[72:75], v[76:79], v[232:235]
    v_exp_f32 v35, v35
    v_mul_f32 v36, s46, v36
    v_mfma_f32_16x16x32_bf16 v[236:239], a[76:79], v[76:79], v[236:239]
    ds_read_b128 a[16:19], v17 offset:20480
    v_cvt_pk_bf16_f32 v65, v34, v35
    v_mfma_f32_16x16x32_bf16 v[240:243], a[80:83], v[76:79], v[240:243]
    v_exp_f32 v36, v36
    v_mul_f32 v37, s46, v37
    v_mfma_f32_16x16x32_bf16 v[244:247], a[84:87], v[76:79], v[244:247]
    ds_read_b128 a[20:23], v18 offset:20480
    v_add_f32 v112, v112, v35
    v_mfma_f32_16x16x32_bf16 v[248:251], a[88:91], v[76:79], v[248:251]
    v_exp_f32 v37, v37
    v_mul_f32 v38, s46, v38
    v_mfma_f32_16x16x32_bf16 v[252:255], a[92:95], v[76:79], v[252:255]
    v_add_f32 v112, v112, v36
    v_cvt_pk_bf16_f32 v66, v36, v37
    v_mfma_f32_16x16x32_bf16 v[100:103], v[104:107], v[76:79], v[100:103]
    v_exp_f32 v38, v38
    v_mul_f32 v39, s46, v39
    v_mfma_f32_16x16x32_bf16 v[60:63], a[48:51], a[176:179], v[92:95]
    ds_read_b128 a[24:27], v19 offset:20480
    v_add_f32 v112, v112, v37
    v_mfma_f32_16x16x32_bf16 v[60:63], a[52:55], a[180:183], v[60:63]
    v_exp_f32 v39, v39
    v_mfma_f32_16x16x32_bf16 v[60:63], a[56:59], a[184:187], v[60:63]
    s_waitcnt vmcnt(8) lgkmcnt(15)
    ds_read_b128 a[28:31], v20 offset:20480
    v_cvt_pk_bf16_f32 v67, v38, v39
    v_mfma_f32_16x16x32_bf16 v[60:63], a[60:63], a[188:191], v[60:63]
L_altb0:
    s_barrier
    s_branch L_loop
L_exit:
    s_cmp_ge_u32 s36, 7
    s_cbranch_scc1 L_final
    v_mfma_f32_16x16x32_bf16 v[32:35], a[0:3], a[192:195], 0
    v_mul_f32 v40, s46, v40
    v_exp_f32 v40, v40
    v_mul_f32 v41, s46, v41
    v_accvgpr_mov_b32 a128, a192
    v_accvgpr_mov_b32 a129, a193
    v_mfma_f32_16x16x32_bf16 v[32:35], a[4:7], a[196:199], v[32:35]
    ds_read_b128 a[32:35], v17 offset:8192
    v_add_f32 v112, v112, v38
    v_mov_b32 v120, 0
    v_accvgpr_mov_b32 a130, a194
    v_accvgpr_mov_b32 a131, a195
    v_accvgpr_mov_b32 a132, a196
    v_mfma_f32_16x16x32_bf16 v[32:35], a[8:11], a[200:203], v[32:35]
    s_add_u32 s41, s39, 4096
    v_exp_f32 v41, v41
    v_mul_f32 v42, s46, v42
    v_accvgpr_mov_b32 a133, a197
    v_accvgpr_mov_b32 a134, a198
    v_accvgpr_mov_b32 a135, a199
    v_mfma_f32_16x16x32_bf16 v[32:35], a[12:15], a[204:207], v[32:35]
    s_waitcnt lgkmcnt(5)
    ds_read_b128 a[36:39], v18 offset:8192
    v_cvt_pk_bf16_f32 v68, v40, v41
    v_accvgpr_mov_b32 a136, a200
    v_accvgpr_mov_b32 a137, a201
    v_accvgpr_mov_b32 a138, a202
    v_accvgpr_mov_b32 a139, a203
    v_mfma_f32_16x16x32_bf16 v[128:131], a[96:99], v[64:67], v[128:131]
    s_add_u32 s42, s39, 8192
    v_exp_f32 v42, v42
    v_mul_f32 v43, s46, v43
    v_accvgpr_mov_b32 a140, a204
    v_accvgpr_mov_b32 a141, a205
    v_accvgpr_mov_b32 a142, a206
    v_mfma_f32_16x16x32_bf16 v[132:135], a[100:103], v[64:67], v[132:135]
    s_add_u32 s43, s39, 12288
    ds_read_b128 a[40:43], v19 offset:8192
    v_add_f32 v112, v112, v39
    v_accvgpr_mov_b32 a143, a207
    v_accvgpr_mov_b32 a144, a208
    v_accvgpr_mov_b32 a145, a209
    v_accvgpr_mov_b32 a146, a210
    v_mfma_f32_16x16x32_bf16 v[136:139], a[104:107], v[64:67], v[136:139]
    s_cmp_eq_u32 s24, 3
    v_exp_f32 v43, v43
    v_mul_f32 v44, s46, v44
    v_accvgpr_mov_b32 a147, a211
    v_accvgpr_mov_b32 a148, a212
    v_accvgpr_mov_b32 a149, a213
    v_mfma_f32_16x16x32_bf16 v[140:143], a[108:111], v[64:67], v[140:143]
    s_cselect_b32 s43, 15728640, s43
    ds_read_b128 a[44:47], v20 offset:8192
    v_cvt_pk_bf16_f32 v69, v42, v43
    v_accvgpr_mov_b32 a150, a214
    v_accvgpr_mov_b32 a151, a215
    v_accvgpr_mov_b32 a152, a216
    v_accvgpr_mov_b32 a153, a217
    v_mfma_f32_16x16x32_bf16 v[144:147], a[112:115], v[64:67], v[144:147]
    s_add_u32 m0, s29, 32768
    v_exp_f32 v44, v44
    v_mul_f32 v45, s46, v45
    v_accvgpr_mov_b32 a154, a218
    v_accvgpr_mov_b32 a155, a219
    v_accvgpr_mov_b32 a156, a220
    v_mfma_f32_16x16x32_bf16 v[148:151], a[116:119], v[64:67], v[148:151]
    buffer_load_dwordx4 v25, s[4:7], s50 offen nt lds
    v_accvgpr_mov_b32 a157, a221
    v_accvgpr_mov_b32 a158, a222
    v_accvgpr_mov_b32 a159, a223
    v_accvgpr_mov_b32 a160, a224
    v_mfma_f32_16x16x32_bf16 v[152:155], a[120:123], v[64:67], v[152:155]
    v_exp_f32 v45, v45
    v_mul_f32 v46, s46, v46
    v_accvgpr_mov_b32 a161, a225
    v_accvgpr_mov_b32 a162, a226
    v_accvgpr_mov_b32 a163, a227
    v_mfma_f32_16x16x32_bf16 v[156:159], a[124:127], v[64:67], v[156:159]
    s_waitcnt lgkmcnt(4)
    ds_read_b64_tr_b16 a[64:65], v8 offset:0
    v_cvt_pk_bf16_f32 v70, v44, v45
    v_accvgpr_mov_b32 a164, a228
    v_accvgpr_mov_b32 a165, a229
    v_accvgpr_mov_b32 a166, a230
    v_accvgpr_mov_b32 a167, a231
    v_mfma_f32_16x16x32_bf16 v[36:39], a[16:19], a[192:195], 0
    s_add_u32 s25, s25, 8192
    v_exp_f32 v46, v46
    v_mul_f32 v47, s46, v47
    v_accvgpr_mov_b32 a168, a232
    v_accvgpr_mov_b32 a169, a233
    v_accvgpr_mov_b32 a170, a234
    v_mfma_f32_16x16x32_bf16 v[36:39], a[20:23], a[196:199], v[36:39]
    buffer_load_dwordx4 v26, s[4:7], s50 offen offset:1024 nt lds
    v_accvgpr_mov_b32 a171, a235
    v_accvgpr_mov_b32 a172, a236
    v_accvgpr_mov_b32 a173, a237
    v_accvgpr_mov_b32 a174, a238
    v_mfma_f32_16x16x32_bf16 v[36:39], a[24:27], a[200:203], v[36:39]
    s_xor_b32 s50, s25, s49
    v_exp_f32 v47, v47
    v_accvgpr_mov_b32 a175, a239
    v_accvgpr_mov_b32 a176, a240
    v_accvgpr_mov_b32 a177, a241
    v_accvgpr_mov_b32 a178, a242
    v_mfma_f32_16x16x32_bf16 v[36:39], a[28:31], a[204:207], v[36:39]
    ds_read_b64_tr_b16 a[66:67], v8 offset:4096
    v_cvt_pk_bf16_f32 v71, v46, v47
    v_accvgpr_mov_b32 a179, a243
    v_accvgpr_mov_b32 a180, a244
    v_accvgpr_mov_b32 a181, a245
    v_accvgpr_mov_b32 a182, a246
    v_mfma_f32_16x16x32_bf16 v[40:43], a[0:3], a[208:211], 0
    v_mul_f32 v48, s46, v48
    v_exp_f32 v48, v48
    v_mul_f32 v49, s46, v49
    v_accvgpr_mov_b32 a183, a247
    v_accvgpr_mov_b32 a184, a248
    v_mfma_f32_16x16x32_bf16 v[40:43], a[4:7], a[212:215], v[40:43]
    ds_read_b64_tr_b16 a[68:69], v9 offset:0
    v_add_f32 v113, v113, v48
    v_accvgpr_mov_b32 a185, a249
    v_accvgpr_mov_b32 a186, a250
    v_accvgpr_mov_b32 a187, a251
    v_accvgpr_mov_b32 a188, a252
    v_mfma_f32_16x16x32_bf16 v[40:43], a[8:11], a[216:219], v[40:43]
    v_exp_f32 v49, v49
    v_mul_f32 v50, s46, v50
    v_accvgpr_mov_b32 a189, a253
    v_accvgpr_mov_b32 a190, a254
    v_accvgpr_mov_b32 a191, a255
    v_mfma_f32_16x16x32_bf16 v[40:43], a[12:15], a[220:223], v[40:43]
    global_load_dword v16, v120, s[84:85]
    v_add_f32 v113, v113, v49
    v_cvt_pk_bf16_f32 v72, v48, v49
    v_max3_f32 v118, v32, v33, v21
    v_max3_f32 v119, v34, v35, v36
    v_mfma_f32_16x16x32_bf16 v[160:163], a[96:99], v[68:71], v[160:163]
    v_exp_f32 v50, v50
    v_mul_f32 v51, s46, v51
    v_max3_f32 v118, v118, v37, v38
    v_max3_f32 v118, v118, v119, v39
    v_mov_b32 v119, v118
    s_nop 1
    v_permlane16_swap_b32 v118, v119
    v_mfma_f32_16x16x32_bf16 v[164:167], a[100:103], v[68:71], v[164:167]
    ds_read_b64_tr_b16 a[70:71], v9 offset:4096
    v_add_f32 v113, v113, v50
    v_max_f32 v118, v118, v119
    v_mov_b32 v119, v118
    s_nop 1
    v_permlane32_swap_b32 v118, v119
    v_max_f32 v118, v118, v119
    v_mfma_f32_16x16x32_bf16 v[168:171], a[104:107], v[68:71], v[168:171]
    v_exp_f32 v51, v51
    v_mul_f32 v52, s46, v52
    v_sub_f32 v32, v32, v118
    v_sub_f32 v33, v33, v118
    v_sub_f32 v34, v34, v118
    v_sub_f32 v35, v35, v118
    v_mfma_f32_16x16x32_bf16 v[172:175], a[108:111], v[68:71], v[172:175]
    ds_read_b64_tr_b16 a[72:73], v10 offset:0
    v_cvt_pk_bf16_f32 v73, v50, v51
    v_sub_f32 v36, v36, v118
    v_sub_f32 v37, v37, v118
    v_sub_f32 v38, v38, v118
    v_sub_f32 v39, v39, v118
    v_mfma_f32_16x16x32_bf16 v[176:179], a[112:115], v[68:71], v[176:179]
    v_exp_f32 v52, v52
    v_mul_f32 v53, s46, v53
    v_sub_f32 v80, 0, v118
    v_sub_f32 v81, 0, v118
    v_sub_f32 v82, 0, v118
    v_sub_f32 v83, 0, v118
    v_mfma_f32_16x16x32_bf16 v[180:183], a[116:119], v[68:71], v[180:183]
    ds_read_b64_tr_b16 a[74:75], v10 offset:4096
    v_add_f32 v113, v113, v51
    v_mov_b32 v114, v112
    s_nop 1
    v_permlane16_swap_b32 v112, v114
    v_add_f32 v112, v112, v114
    v_mov_b32 v114, v112
    v_mfma_f32_16x16x32_bf16 v[184:187], a[120:123], v[68:71], v[184:187]
    v_exp_f32 v53, v53
    v_mul_f32 v54, s46, v54
    v_permlane32_swap_b32 v112, v114
    v_add_f32 v112, v112, v114
    v_cmp_nge_f32 vcc, s48, v112
    v_mfma_f32_16x16x32_bf16 v[188:191], a[124:127], v[68:71], v[188:191]
    v_add_f32 v113, v113, v52
    v_cvt_pk_bf16_f32 v74, v52, v53
    v_rcp_f32 v114, v112
    v_mov_b32 v112, 0
    v_mul_f32 v128, v114, v128
    v_mul_f32 v129, v114, v129
    v_mfma_f32_16x16x32_bf16 v[96:99], v[104:107], v[68:71], v[96:99]
    v_exp_f32 v54, v54
    v_mul_f32 v55, s46, v55
    v_cvt_pk_bf16_f32 v120, v128, v129
    s_or_b32 s47, s47, vcc_lo
    s_or_b32 s47, s47, vcc_hi
    v_accvgpr_write_b32 a192, v120
    v_mul_f32 v130, v114, v130
    v_mul_f32 v131, v114, v131
    v_mfma_f32_16x16x32_bf16 v[44:47], a[16:19], a[208:211], 0
    ds_read_b64_tr_b16 a[76:77], v11 offset:0
    v_add_f32 v113, v113, v53
    v_cvt_pk_bf16_f32 v121, v130, v131
    v_accvgpr_write_b32 a193, v121
    v_mul_f32 v132, v114, v132
    v_mul_f32 v133, v114, v133
    v_mfma_f32_16x16x32_bf16 v[44:47], a[20:23], a[212:215], v[44:47]
    v_exp_f32 v55, v55
    v_cvt_pk_bf16_f32 v122, v132, v133
    v_accvgpr_write_b32 a194, v122
    v_mul_f32 v134, v114, v134
    v_mul_f32 v135, v114, v135
    v_cvt_pk_bf16_f32 v123, v134, v135
    v_mfma_f32_16x16x32_bf16 v[44:47], a[24:27], a[216:219], v[44:47]
    ds_read_b64_tr_b16 a[78:79], v11 offset:4096
    v_cvt_pk_bf16_f32 v75, v54, v55
    v_accvgpr_write_b32 a195, v123
    v_mul_f32 v136, v114, v136
    v_mul_f32 v137, v114, v137
    v_cvt_pk_bf16_f32 v124, v136, v137
    v_mfma_f32_16x16x32_bf16 v[44:47], a[28:31], a[220:223], v[44:47]
    v_add_f32 v113, v113, v54
    v_add_f32 v113, v113, v55
    v_accvgpr_write_b32 a196, v124
    v_mul_f32 v138, v114, v138
    v_mul_f32 v139, v114, v139
    v_cvt_pk_bf16_f32 v125, v138, v139
    v_accvgpr_write_b32 a197, v125
    v_mfma_f32_16x16x32_bf16 v[48:51], a[0:3], a[224:227], 0
    v_mul_f32 v56, s46, v56
    v_exp_f32 v56, v56
    v_mul_f32 v57, s46, v57
    v_mul_f32 v140, v114, v140
    v_mul_f32 v141, v114, v141
    v_mfma_f32_16x16x32_bf16 v[48:51], a[4:7], a[228:231], v[48:51]
    ds_read_b64_tr_b16 a[80:81], v12 offset:0
    v_cvt_pk_bf16_f32 v126, v140, v141
    v_accvgpr_write_b32 a198, v126
    v_mul_f32 v142, v114, v142
    v_mul_f32 v143, v114, v143
    v_cvt_pk_bf16_f32 v127, v142, v143
    v_accvgpr_write_b32 a199, v127
    v_mfma_f32_16x16x32_bf16 v[48:51], a[8:11], a[232:235], v[48:51]
    v_exp_f32 v57, v57
    v_mul_f32 v58, s46, v58
    v_mul_f32 v144, v114, v144
    v_mul_f32 v145, v114, v145
    v_cvt_pk_bf16_f32 v120, v144, v145
    v_mfma_f32_16x16x32_bf16 v[48:51], a[12:15], a[236:239], v[48:51]
    ds_read_b64_tr_b16 a[82:83], v12 offset:4096
    v_cvt_pk_bf16_f32 v76, v56, v57
    v_accvgpr_write_b32 a200, v120
    v_mul_f32 v146, v114, v146
    v_mul_f32 v147, v114, v147
    v_cvt_pk_bf16_f32 v121, v146, v147
    v_accvgpr_write_b32 a201, v121
    v_mfma_f32_16x16x32_bf16 v[192:195], a[96:99], v[72:75], v[192:195]
    v_exp_f32 v58, v58
    v_mul_f32 v59, s46, v59
    v_mul_f32 v148, v114, v148
    v_mul_f32 v149, v114, v149
    v_cvt_pk_bf16_f32 v122, v148, v149
    v_mfma_f32_16x16x32_bf16 v[196:199], a[100:103], v[72:75], v[196:199]
    ds_read_b64_tr_b16 a[84:85], v13 offset:0
    v_accvgpr_write_b32 a202, v122
    v_mul_f32 v150, v114, v150
    v_mul_f32 v151, v114, v151
    v_cvt_pk_bf16_f32 v123, v150, v151
    v_accvgpr_write_b32 a203, v123
    v_mul_f32 v152, v114, v152
    v_mfma_f32_16x16x32_bf16 v[200:203], a[104:107], v[72:75], v[200:203]
    v_exp_f32 v59, v59
    v_mul_f32 v60, s46, v60
    v_mul_f32 v153, v114, v153
    v_cvt_pk_bf16_f32 v124, v152, v153
    v_accvgpr_write_b32 a204, v124
    v_mfma_f32_16x16x32_bf16 v[204:207], a[108:111], v[72:75], v[204:207]
    ds_read_b64_tr_b16 a[86:87], v13 offset:4096
    v_cvt_pk_bf16_f32 v77, v58, v59
    v_mul_f32 v154, v114, v154
    v_mul_f32 v155, v114, v155
    v_cvt_pk_bf16_f32 v125, v154, v155
    v_accvgpr_write_b32 a205, v125
    v_mul_f32 v156, v114, v156
    v_mfma_f32_16x16x32_bf16 v[208:211], a[112:115], v[72:75], v[208:211]
    s_add_u32 m0, s29, 90112
    v_exp_f32 v60, v60
    v_mul_f32 v61, s46, v61
    v_mul_f32 v157, v114, v157
    v_cvt_pk_bf16_f32 v126, v156, v157
    v_accvgpr_write_b32 a206, v126
    v_mfma_f32_16x16x32_bf16 v[212:215], a[116:119], v[72:75], v[212:215]
    buffer_load_dwordx4 v27, s[8:11], s51 offen nt lds
    v_mul_f32 v158, v114, v158
    v_mul_f32 v159, v114, v159
    v_cvt_pk_bf16_f32 v127, v158, v159
    v_accvgpr_write_b32 a207, v127
    v_mfma_f32_16x16x32_bf16 v[216:219], a[120:123], v[72:75], v[216:219]
    v_exp_f32 v61, v61
    v_mul_f32 v62, s46, v62
    v_mfma_f32_16x16x32_bf16 v[220:223], a[124:127], v[72:75], v[220:223]
    ds_read_b64_tr_b16 a[88:89], v14 offset:0
    v_cvt_pk_bf16_f32 v78, v60, v61
    v_max3_f32 v118, v40, v41, v22
    v_max3_f32 v119, v42, v43, v44
    v_max3_f32 v118, v118, v45, v46
    v_max3_f32 v118, v118, v119, v47
    v_mfma_f32_16x16x32_bf16 v[52:55], a[16:19], a[224:227], 0
    s_add_u32 s26, s26, 8192
    v_exp_f32 v62, v62
    v_mul_f32 v63, s46, v63
    v_mov_b32 v119, v118
    s_nop 1
    v_permlane16_swap_b32 v118, v119
    v_max_f32 v118, v118, v119
    v_mfma_f32_16x16x32_bf16 v[52:55], a[20:23], a[228:231], v[52:55]
    buffer_load_dwordx4 v28, s[8:11], s51 offen offset:1024 nt lds
    v_mov_b32 v119, v118
    s_nop 1
    v_permlane32_swap_b32 v118, v119
    v_max_f32 v118, v118, v119
    v_sub_f32 v40, v40, v118
    v_mfma_f32_16x16x32_bf16 v[52:55], a[24:27], a[232:235], v[52:55]
    s_xor_b32 s51, s26, s49
    v_exp_f32 v63, v63
    v_sub_f32 v41, v41, v118
    v_sub_f32 v42, v42, v118
    v_sub_f32 v43, v43, v118
    v_sub_f32 v44, v44, v118
    v_sub_f32 v45, v45, v118
    v_mfma_f32_16x16x32_bf16 v[52:55], a[28:31], a[236:239], v[52:55]
    ds_read_b64_tr_b16 a[90:91], v14 offset:4096
    v_cvt_pk_bf16_f32 v79, v62, v63
    v_sub_f32 v46, v46, v118
    v_sub_f32 v47, v47, v118
    v_sub_f32 v84, 0, v118
    v_sub_f32 v85, 0, v118
    v_mfma_f32_16x16x32_bf16 v[56:59], a[0:3], a[240:243], 0
    v_mul_f32 v32, s46, v32
    v_exp_f32 v32, v32
    v_mul_f32 v33, s46, v33
    v_sub_f32 v86, 0, v118
    v_sub_f32 v87, 0, v118
    v_mfma_f32_16x16x32_bf16 v[56:59], a[4:7], a[244:247], v[56:59]
    ds_read_b64_tr_b16 a[92:93], v15 offset:0
    v_add_f32 v112, v112, v32
    v_cmp_nge_f32 vcc, s48, v96
    v_rcp_f32 v115, v96
    s_nop 0
    v_mul_f32 v160, v115, v160
    v_mfma_f32_16x16x32_bf16 v[56:59], a[8:11], a[248:251], v[56:59]
    v_exp_f32 v33, v33
    v_mul_f32 v34, s46, v34
    v_mul_f32 v161, v115, v161
    v_cvt_pk_bf16_f32 v120, v160, v161
    s_or_b32 s47, s47, vcc_lo
    s_or_b32 s47, s47, vcc_hi
    v_accvgpr_write_b32 a208, v120
    v_mfma_f32_16x16x32_bf16 v[56:59], a[12:15], a[252:255], v[56:59]
    v_add_f32 v112, v112, v33
    v_cvt_pk_bf16_f32 v64, v32, v33
    v_mul_f32 v162, v115, v162
    v_mul_f32 v163, v115, v163
    v_cvt_pk_bf16_f32 v121, v162, v163
    v_accvgpr_write_b32 a209, v121
    v_mfma_f32_16x16x32_bf16 v[224:227], a[96:99], v[76:79], v[224:227]
    v_exp_f32 v34, v34
    v_mul_f32 v35, s46, v35
    v_mul_f32 v164, v115, v164
    v_mul_f32 v165, v115, v165
    v_cvt_pk_bf16_f32 v122, v164, v165
    v_mfma_f32_16x16x32_bf16 v[228:231], a[100:103], v[76:79], v[228:231]
    ds_read_b64_tr_b16 a[94:95], v15 offset:4096
    v_add_f32 v112, v112, v34
    v_accvgpr_write_b32 a210, v122
    v_mul_f32 v166, v115, v166
    v_mul_f32 v167, v115, v167
    v_cvt_pk_bf16_f32 v123, v166, v167
    v_mfma_f32_16x16x32_bf16 v[232:235], a[104:107], v[76:79], v[232:235]
    v_exp_f32 v35, v35
    v_mul_f32 v36, s46, v36
    v_accvgpr_write_b32 a211, v123
    v_mul_f32 v168, v115, v168
    v_mul_f32 v169, v115, v169
    v_mfma_f32_16x16x32_bf16 v[236:239], a[108:111], v[76:79], v[236:239]
    ds_read_b128 a[48:51], v17 offset:12288
    v_cvt_pk_bf16_f32 v65, v34, v35
    v_cvt_pk_bf16_f32 v124, v168, v169
    v_accvgpr_write_b32 a212, v124
    v_mul_f32 v170, v115, v170
    v_mul_f32 v171, v115, v171
    v_mfma_f32_16x16x32_bf16 v[240:243], a[112:115], v[76:79], v[240:243]
    v_exp_f32 v36, v36
    v_mul_f32 v37, s46, v37
    v_cvt_pk_bf16_f32 v125, v170, v171
    v_accvgpr_write_b32 a213, v125
    v_mul_f32 v172, v115, v172
    v_mfma_f32_16x16x32_bf16 v[244:247], a[116:119], v[76:79], v[244:247]
    ds_read_b128 a[52:55], v18 offset:12288
    v_add_f32 v112, v112, v35
    v_mul_f32 v173, v115, v173
    v_cvt_pk_bf16_f32 v126, v172, v173
    v_accvgpr_write_b32 a214, v126
    v_mul_f32 v174, v115, v174
    v_mfma_f32_16x16x32_bf16 v[248:251], a[120:123], v[76:79], v[248:251]
    v_exp_f32 v37, v37
    v_mul_f32 v38, s46, v38
    v_mul_f32 v175, v115, v175
    v_cvt_pk_bf16_f32 v127, v174, v175
    v_accvgpr_write_b32 a215, v127
    v_mfma_f32_16x16x32_bf16 v[252:255], a[124:127], v[76:79], v[252:255]
    v_add_f32 v112, v112, v36
    v_cvt_pk_bf16_f32 v66, v36, v37
    v_mul_f32 v176, v115, v176
    v_mul_f32 v177, v115, v177
    v_cvt_pk_bf16_f32 v120, v176, v177
    v_accvgpr_write_b32 a216, v120
    v_mfma_f32_16x16x32_bf16 v[100:103], v[104:107], v[76:79], v[100:103]
    v_exp_f32 v38, v38
    v_mul_f32 v39, s46, v39
    v_mul_f32 v178, v115, v178
    v_mul_f32 v179, v115, v179
    v_cvt_pk_bf16_f32 v121, v178, v179
    v_mfma_f32_16x16x32_bf16 v[60:63], a[16:19], a[240:243], 0
    ds_read_b128 a[56:59], v19 offset:12288
    v_add_f32 v112, v112, v37
    v_accvgpr_write_b32 a217, v121
    v_mul_f32 v180, v115, v180
    v_mul_f32 v181, v115, v181
    v_cvt_pk_bf16_f32 v122, v180, v181
    v_mfma_f32_16x16x32_bf16 v[60:63], a[20:23], a[244:247], v[60:63]
    v_exp_f32 v39, v39
    v_accvgpr_write_b32 a218, v122
    v_mul_f32 v182, v115, v182
    v_mul_f32 v183, v115, v183
    v_cvt_pk_bf16_f32 v123, v182, v183
    v_mfma_f32_16x16x32_bf16 v[60:63], a[24:27], a[248:251], v[60:63]
    s_waitcnt vmcnt(9) lgkmcnt(15)
    ds_read_b128 a[60:63], v20 offset:12288
    v_cvt_pk_bf16_f32 v67, v38, v39
    v_accvgpr_write_b32 a219, v123
    v_mul_f32 v184, v115, v184
    v_mul_f32 v185, v115, v185
    v_cvt_pk_bf16_f32 v124, v184, v185
    v_mfma_f32_16x16x32_bf16 v[60:63], a[28:31], a[252:255], v[60:63]
    s_barrier
    v_accvgpr_write_b32 a220, v124
    v_mul_f32 v186, v115, v186
    v_mul_f32 v187, v115, v187
    v_cvt_pk_bf16_f32 v125, v186, v187
    v_accvgpr_write_b32 a221, v125
    v_mul_f32 v188, v115, v188
    v_mfma_f32_16x16x32_bf16 v[32:35], a[32:35], a[128:131], v[80:83]
    v_mul_f32 v40, s46, v40
    v_exp_f32 v40, v40
    v_mul_f32 v41, s46, v41
    v_mul_f32 v189, v115, v189
    v_cvt_pk_bf16_f32 v126, v188, v189
    v_mfma_f32_16x16x32_bf16 v[32:35], a[36:39], a[132:135], v[32:35]
    ds_read_b128 a[0:3], v17 offset:16384
    v_add_f32 v112, v112, v38
    v_accvgpr_write_b32 a222, v126
    v_mul_f32 v190, v115, v190
    v_mul_f32 v191, v115, v191
    v_cvt_pk_bf16_f32 v127, v190, v191
    v_mfma_f32_16x16x32_bf16 v[32:35], a[40:43], a[136:139], v[32:35]
    v_exp_f32 v41, v41
    v_mul_f32 v42, s46, v42
    v_accvgpr_write_b32 a223, v127
    v_mfma_f32_16x16x32_bf16 v[32:35], a[44:47], a[140:143], v[32:35]
    s_waitcnt lgkmcnt(5)
    ds_read_b128 a[4:7], v18 offset:16384
    v_cvt_pk_bf16_f32 v68, v40, v41
    v_max3_f32 v118, v48, v49, v23
    v_max3_f32 v119, v50, v51, v52
    v_max3_f32 v118, v118, v53, v54
    v_max3_f32 v118, v118, v119, v55
    v_mfma_f32_16x16x32_bf16 v[128:131], a[64:67], v[64:67], 0
    v_exp_f32 v42, v42
    v_mul_f32 v43, s46, v43
    v_mov_b32 v119, v118
    s_nop 1
    v_permlane16_swap_b32 v118, v119
    v_max_f32 v118, v118, v119
    v_mfma_f32_16x16x32_bf16 v[132:135], a[68:71], v[64:67], 0
    ds_read_b128 a[8:11], v19 offset:16384
    v_add_f32 v112, v112, v39
    v_mov_b32 v119, v118
    s_nop 1
    v_permlane32_swap_b32 v118, v119
    v_max_f32 v118, v118, v119
    v_sub_f32 v48, v48, v118
    v_mfma_f32_16x16x32_bf16 v[136:139], a[72:75], v[64:67], 0
    v_exp_f32 v43, v43
    v_mul_f32 v44, s46, v44
    v_sub_f32 v49, v49, v118
    v_sub_f32 v50, v50, v118
    v_sub_f32 v51, v51, v118
    v_mfma_f32_16x16x32_bf16 v[140:143], a[76:79], v[64:67], 0
    ds_read_b128 a[12:15], v20 offset:16384
    v_cvt_pk_bf16_f32 v69, v42, v43
    v_sub_f32 v52, v52, v118
    v_sub_f32 v53, v53, v118
    v_sub_f32 v54, v54, v118
    v_sub_f32 v55, v55, v118
    v_mfma_f32_16x16x32_bf16 v[144:147], a[80:83], v[64:67], 0
    s_add_u32 m0, s29, 40960
    v_exp_f32 v44, v44
    v_mul_f32 v45, s46, v45
    v_sub_f32 v88, 0, v118
    v_sub_f32 v89, 0, v118
    v_sub_f32 v90, 0, v118
    v_mfma_f32_16x16x32_bf16 v[148:151], a[84:87], v[64:67], 0
    buffer_load_dwordx4 v25, s[4:7], s50 offen nt lds
    v_sub_f32 v91, 0, v118
    v_mov_b32 v116, v113
    s_nop 1
    v_permlane16_swap_b32 v113, v116
    v_add_f32 v113, v113, v116
    v_mfma_f32_16x16x32_bf16 v[152:155], a[88:91], v[64:67], 0
    v_exp_f32 v45, v45
    v_mul_f32 v46, s46, v46
    v_mov_b32 v116, v113
    s_nop 1
    v_permlane32_swap_b32 v113, v116
    v_add_f32 v113, v113, v116
    v_mfma_f32_16x16x32_bf16 v[156:159], a[92:95], v[64:67], 0
    s_waitcnt lgkmcnt(4)
    ds_read_b64_tr_b16 a[96:97], v8 offset:8192
    v_cvt_pk_bf16_f32 v70, v44, v45
    v_cmp_nge_f32 vcc, s48, v113
    v_rcp_f32 v116, v113
    v_mov_b32 v113, 0
    v_mfma_f32_16x16x32_bf16 v[36:39], a[48:51], a[128:131], v[80:83]
    s_add_u32 s25, s25, 8192
    v_exp_f32 v46, v46
    v_mul_f32 v47, s46, v47
    v_mul_f32 v192, v116, v192
    v_mul_f32 v193, v116, v193
    v_cvt_pk_bf16_f32 v120, v192, v193
    s_or_b32 s47, s47, vcc_lo
    s_or_b32 s47, s47, vcc_hi
    v_mfma_f32_16x16x32_bf16 v[36:39], a[52:55], a[132:135], v[36:39]
    buffer_load_dwordx4 v26, s[4:7], s50 offen offset:1024 nt lds
    v_max3_f32 v118, v56, v57, v24
    v_max3_f32 v119, v58, v59, v60
    v_max3_f32 v118, v118, v61, v62
    v_max3_f32 v118, v118, v119, v63
    v_mfma_f32_16x16x32_bf16 v[36:39], a[56:59], a[136:139], v[36:39]
    s_xor_b32 s50, s25, s49
    v_exp_f32 v47, v47
    v_mov_b32 v119, v118
    s_nop 1
    v_permlane16_swap_b32 v118, v119
    v_max_f32 v118, v118, v119
    v_mov_b32 v119, v118
    v_mfma_f32_16x16x32_bf16 v[36:39], a[60:63], a[140:143], v[36:39]
    ds_read_b64_tr_b16 a[98:99], v8 offset:12288
    v_cvt_pk_bf16_f32 v71, v46, v47
    v_permlane32_swap_b32 v118, v119
    v_max_f32 v118, v118, v119
    v_sub_f32 v56, v56, v118
    v_sub_f32 v57, v57, v118
    v_mfma_f32_16x16x32_bf16 v[40:43], a[32:35], a[144:147], v[84:87]
    v_mul_f32 v48, s46, v48
    v_exp_f32 v48, v48
    v_mul_f32 v49, s46, v49
    v_sub_f32 v58, v58, v118
    v_sub_f32 v59, v59, v118
    v_sub_f32 v60, v60, v118
    v_mfma_f32_16x16x32_bf16 v[40:43], a[36:39], a[148:151], v[40:43]
    ds_read_b64_tr_b16 a[100:101], v9 offset:8192
    v_add_f32 v113, v113, v48
    v_sub_f32 v61, v61, v118
    v_sub_f32 v62, v62, v118
    v_sub_f32 v63, v63, v118
    v_sub_f32 v92, 0, v118
    v_mfma_f32_16x16x32_bf16 v[40:43], a[40:43], a[152:155], v[40:43]
    v_exp_f32 v49, v49
    v_mul_f32 v50, s46, v50
    v_sub_f32 v93, 0, v118
    v_sub_f32 v94, 0, v118
    v_sub_f32 v95, 0, v118
    v_mfma_f32_16x16x32_bf16 v[40:43], a[44:47], a[156:159], v[40:43]
    v_add_f32 v113, v113, v49
    v_cvt_pk_bf16_f32 v72, v48, v49
    v_accvgpr_write_b32 a224, v120
    v_mul_f32 v194, v116, v194
    v_mul_f32 v195, v116, v195
    v_cvt_pk_bf16_f32 v121, v194, v195
    v_mfma_f32_16x16x32_bf16 v[160:163], a[64:67], v[68:71], 0
    v_exp_f32 v50, v50
    v_mul_f32 v51, s46, v51
    v_accvgpr_write_b32 a225, v121
    v_mul_f32 v196, v116, v196
    v_mul_f32 v197, v116, v197
    v_mfma_f32_16x16x32_bf16 v[164:167], a[68:71], v[68:71], 0
    ds_read_b64_tr_b16 a[102:103], v9 offset:12288
    v_add_f32 v113, v113, v50
    v_cvt_pk_bf16_f32 v122, v196, v197
    v_accvgpr_write_b32 a226, v122
    v_mul_f32 v198, v116, v198
    v_mul_f32 v199, v116, v199
    v_mfma_f32_16x16x32_bf16 v[168:171], a[72:75], v[68:71], 0
    v_exp_f32 v51, v51
    v_mul_f32 v52, s46, v52
    v_cvt_pk_bf16_f32 v123, v198, v199
    v_accvgpr_write_b32 a227, v123
    v_mul_f32 v200, v116, v200
    v_mul_f32 v201, v116, v201
    v_mfma_f32_16x16x32_bf16 v[172:175], a[76:79], v[68:71], 0
    ds_read_b64_tr_b16 a[104:105], v10 offset:8192
    v_cvt_pk_bf16_f32 v73, v50, v51
    v_cvt_pk_bf16_f32 v124, v200, v201
    v_accvgpr_write_b32 a228, v124
    v_mul_f32 v202, v116, v202
    v_mul_f32 v203, v116, v203
    v_mfma_f32_16x16x32_bf16 v[176:179], a[80:83], v[68:71], 0
    v_exp_f32 v52, v52
    v_mul_f32 v53, s46, v53
    v_cvt_pk_bf16_f32 v125, v202, v203
    v_accvgpr_write_b32 a229, v125
    v_mul_f32 v204, v116, v204
    v_mfma_f32_16x16x32_bf16 v[180:183], a[84:87], v[68:71], 0
    ds_read_b64_tr_b16 a[106:107], v10 offset:12288
    v_add_f32 v113, v113, v51
    v_mul_f32 v205, v116, v205
    v_cvt_pk_bf16_f32 v126, v204, v205
    v_accvgpr_write_b32 a230, v126
    v_mul_f32 v206, v116, v206
    v_mfma_f32_16x16x32_bf16 v[184:187], a[88:91], v[68:71], 0
    v_exp_f32 v53, v53
    v_mul_f32 v54, s46, v54
    v_mul_f32 v207, v116, v207
    v_cvt_pk_bf16_f32 v127, v206, v207
    v_accvgpr_write_b32 a231, v127
    v_mul_f32 v208, v116, v208
    v_mfma_f32_16x16x32_bf16 v[188:191], a[92:95], v[68:71], 0
    v_add_f32 v113, v113, v52
    v_cvt_pk_bf16_f32 v74, v52, v53
    v_mul_f32 v209, v116, v209
    v_cvt_pk_bf16_f32 v120, v208, v209
    v_accvgpr_write_b32 a232, v120
    v_mul_f32 v210, v116, v210
    v_mfma_f32_16x16x32_bf16 v[96:99], v[104:107], v[68:71], 0
    v_exp_f32 v54, v54
    v_mul_f32 v55, s46, v55
    v_mul_f32 v211, v116, v211
    v_cvt_pk_bf16_f32 v121, v210, v211
    v_accvgpr_write_b32 a233, v121
    v_mfma_f32_16x16x32_bf16 v[44:47], a[48:51], a[144:147], v[84:87]
    ds_read_b64_tr_b16 a[108:109], v11 offset:8192
    v_add_f32 v113, v113, v53
    v_mul_f32 v212, v116, v212
    v_mul_f32 v213, v116, v213
    v_cvt_pk_bf16_f32 v122, v212, v213
    v_accvgpr_write_b32 a234, v122
    v_mfma_f32_16x16x32_bf16 v[44:47], a[52:55], a[148:151], v[44:47]
    v_exp_f32 v55, v55
    v_mul_f32 v214, v116, v214
    v_mul_f32 v215, v116, v215
    v_cvt_pk_bf16_f32 v123, v214, v215
    v_accvgpr_write_b32 a235, v123
    v_mul_f32 v216, v116, v216
    v_mfma_f32_16x16x32_bf16 v[44:47], a[56:59], a[152:155], v[44:47]
    ds_read_b64_tr_b16 a[110:111], v11 offset:12288
    v_cvt_pk_bf16_f32 v75, v54, v55
    v_mul_f32 v217, v116, v217
    v_cvt_pk_bf16_f32 v124, v216, v217
    v_accvgpr_write_b32 a236, v124
    v_mul_f32 v218, v116, v218
    v_mfma_f32_16x16x32_bf16 v[44:47], a[60:63], a[156:159], v[44:47]
    v_add_f32 v113, v113, v54
    v_add_f32 v113, v113, v55
    v_mul_f32 v219, v116, v219
    v_cvt_pk_bf16_f32 v125, v218, v219
    v_accvgpr_write_b32 a237, v125
    v_mul_f32 v220, v116, v220
    v_mfma_f32_16x16x32_bf16 v[48:51], a[32:35], a[160:163], v[88:91]
    s_lshl_b32 s40, s24, 2
    v_mul_f32 v56, s46, v56
    v_exp_f32 v56, v56
    v_mul_f32 v57, s46, v57
    v_mul_f32 v221, v116, v221
    v_cvt_pk_bf16_f32 v126, v220, v221
    v_mfma_f32_16x16x32_bf16 v[48:51], a[36:39], a[164:167], v[48:51]
    s_add_u32 s40, s40, 131072
    ds_read_b64_tr_b16 a[112:113], v12 offset:8192
    v_accvgpr_write_b32 a238, v126
    v_mul_f32 v222, v116, v222
    v_mul_f32 v223, v116, v223
    v_cvt_pk_bf16_f32 v127, v222, v223
    v_accvgpr_write_b32 a239, v127
    v_mfma_f32_16x16x32_bf16 v[48:51], a[40:43], a[168:171], v[48:51]
    v_exp_f32 v57, v57
    v_mul_f32 v58, s46, v58
    v_cmp_nge_f32 vcc, s48, v100
    v_rcp_f32 v117, v100
    v_mfma_f32_16x16x32_bf16 v[48:51], a[44:47], a[172:175], v[48:51]
    ds_read_b64_tr_b16 a[114:115], v12 offset:12288
    v_cvt_pk_bf16_f32 v76, v56, v57
    v_mul_f32 v224, v117, v224
    v_mul_f32 v225, v117, v225
    v_cvt_pk_bf16_f32 v120, v224, v225
    s_or_b32 vcc_lo, vcc_lo, vcc_hi
    s_and_b32 vcc_lo, vcc_lo, s28
    s_or_b32 s47, s47, vcc_lo
    v_accvgpr_write_b32 a240, v120
    v_mul_f32 v226, v117, v226
    v_mfma_f32_16x16x32_bf16 v[192:195], a[64:67], v[72:75], 0
    v_exp_f32 v58, v58
    v_mul_f32 v59, s46, v59
    v_mul_f32 v227, v117, v227
    v_cvt_pk_bf16_f32 v121, v226, v227
    v_mov_b32 v1, s47
    v_mov_b32 v2, s40
    v_mfma_f32_16x16x32_bf16 v[196:199], a[68:71], v[72:75], 0
    ds_read_b64_tr_b16 a[116:117], v13 offset:8192
    v_mov_b32 v3, 131072
    v_accvgpr_write_b32 a241, v121
    v_mul_f32 v228, v117, v228
    v_mul_f32 v229, v117, v229
    v_cvt_pk_bf16_f32 v122, v228, v229
    v_accvgpr_write_b32 a242, v122
    v_mfma_f32_16x16x32_bf16 v[200:203], a[72:75], v[72:75], 0
    v_exp_f32 v59, v59
    v_mul_f32 v60, s46, v60
    v_mul_f32 v230, v117, v230
    v_mul_f32 v231, v117, v231
    v_cvt_pk_bf16_f32 v123, v230, v231
    v_mfma_f32_16x16x32_bf16 v[204:207], a[76:79], v[72:75], 0
    ds_read_b64_tr_b16 a[118:119], v13 offset:12288
    v_cvt_pk_bf16_f32 v77, v58, v59
    v_accvgpr_write_b32 a243, v123
    v_mul_f32 v232, v117, v232
    v_mul_f32 v233, v117, v233
    v_cvt_pk_bf16_f32 v124, v232, v233
    v_accvgpr_write_b32 a244, v124
    v_mfma_f32_16x16x32_bf16 v[208:211], a[80:83], v[72:75], 0
    s_add_u32 m0, s29, 98304
    v_exp_f32 v60, v60
    v_mul_f32 v61, s46, v61
    v_mul_f32 v234, v117, v234
    v_mul_f32 v235, v117, v235
    v_cvt_pk_bf16_f32 v125, v234, v235
    v_accvgpr_write_b32 a245, v125
    v_mfma_f32_16x16x32_bf16 v[212:215], a[84:87], v[72:75], 0
    buffer_load_dwordx4 v27, s[8:11], s51 offen nt lds
    v_mul_f32 v236, v117, v236
    v_mul_f32 v237, v117, v237
    v_cvt_pk_bf16_f32 v126, v236, v237
    v_accvgpr_write_b32 a246, v126
    v_mul_f32 v238, v117, v238
    v_mfma_f32_16x16x32_bf16 v[216:219], a[88:91], v[72:75], 0
    v_exp_f32 v61, v61
    v_mul_f32 v62, s46, v62
    v_mul_f32 v239, v117, v239
    v_cvt_pk_bf16_f32 v127, v238, v239
    v_accvgpr_write_b32 a247, v127
    v_mfma_f32_16x16x32_bf16 v[220:223], a[92:95], v[72:75], 0
    ds_read_b64_tr_b16 a[120:121], v14 offset:8192
    v_cvt_pk_bf16_f32 v78, v60, v61
    v_mul_f32 v240, v117, v240
    v_mul_f32 v241, v117, v241
    v_cvt_pk_bf16_f32 v120, v240, v241
    v_accvgpr_write_b32 a248, v120
    v_mul_f32 v242, v117, v242
    v_mfma_f32_16x16x32_bf16 v[52:55], a[48:51], a[160:163], v[88:91]
    s_add_u32 s26, s26, 8192
    v_exp_f32 v62, v62
    v_mul_f32 v63, s46, v63
    v_mul_f32 v243, v117, v243
    v_cvt_pk_bf16_f32 v121, v242, v243
    v_accvgpr_write_b32 a249, v121
    v_mul_f32 v244, v117, v244
    v_mfma_f32_16x16x32_bf16 v[52:55], a[52:55], a[164:167], v[52:55]
    buffer_load_dwordx4 v28, s[8:11], s51 offen offset:1024 nt lds
    v_mul_f32 v245, v117, v245
    v_cvt_pk_bf16_f32 v122, v244, v245
    v_accvgpr_write_b32 a250, v122
    v_mul_f32 v246, v117, v246
    v_mul_f32 v247, v117, v247
    v_mfma_f32_16x16x32_bf16 v[52:55], a[56:59], a[168:171], v[52:55]
    s_xor_b32 s51, s26, s49
    v_exp_f32 v63, v63
    v_cvt_pk_bf16_f32 v123, v246, v247
    v_accvgpr_write_b32 a251, v123
    v_mul_f32 v248, v117, v248
    v_mul_f32 v249, v117, v249
    v_mfma_f32_16x16x32_bf16 v[52:55], a[60:63], a[172:175], v[52:55]
    ds_read_b64_tr_b16 a[122:123], v14 offset:12288
    v_cvt_pk_bf16_f32 v79, v62, v63
    v_cvt_pk_bf16_f32 v124, v248, v249
    v_accvgpr_write_b32 a252, v124
    v_mul_f32 v250, v117, v250
    v_mul_f32 v251, v117, v251
    v_cvt_pk_bf16_f32 v125, v250, v251
    v_mfma_f32_16x16x32_bf16 v[56:59], a[32:35], a[176:179], v[92:95]
    v_mul_f32 v32, s46, v32
    v_exp_f32 v32, v32
    v_mul_f32 v33, s46, v33
    v_accvgpr_write_b32 a253, v125
    v_mul_f32 v252, v117, v252
    v_mul_f32 v253, v117, v253
    v_mfma_f32_16x16x32_bf16 v[56:59], a[36:39], a[180:183], v[56:59]
    ds_read_b64_tr_b16 a[124:125], v15 offset:8192
    v_add_f32 v112, v112, v32
    v_cvt_pk_bf16_f32 v126, v252, v253
    v_accvgpr_write_b32 a254, v126
    v_mul_f32 v254, v117, v254
    v_mul_f32 v255, v117, v255
    v_cvt_pk_bf16_f32 v127, v254, v255
    v_mfma_f32_16x16x32_bf16 v[56:59], a[40:43], a[184:187], v[56:59]
    v_exp_f32 v33, v33
    v_mul_f32 v34, s46, v34
    v_accvgpr_write_b32 a255, v127
    v_mfma_f32_16x16x32_bf16 v[56:59], a[44:47], a[188:191], v[56:59]
    ds_write_b32 v2, v1
    v_add_f32 v112, v112, v33
    v_cvt_pk_bf16_f32 v64, v32, v33
    v_mfma_f32_16x16x32_bf16 v[224:227], a[64:67], v[76:79], 0
    v_exp_f32 v34, v34
    v_mul_f32 v35, s46, v35
    v_mfma_f32_16x16x32_bf16 v[228:231], a[68:71], v[76:79], 0
    ds_read_b64_tr_b16 a[126:127], v15 offset:12288
    v_add_f32 v112, v112, v34
    v_lshrrev_b32 v118, 4, v0
    v_lshlrev_b32 v119, 1, v118
    v_mfma_f32_16x16x32_bf16 v[232:235], a[72:75], v[76:79], 0
    v_exp_f32 v35, v35
    v_mul_f32 v36, s46, v36
    v_mfma_f32_16x16x32_bf16 v[236:239], a[76:79], v[76:79], 0
    ds_read_b128 a[16:19], v17 offset:20480
    v_cvt_pk_bf16_f32 v65, v34, v35
    v_xor_b32 v119, v119, v0
    v_and_b32 v119, 15, v119
    v_mfma_f32_16x16x32_bf16 v[240:243], a[80:83], v[76:79], 0
    s_waitcnt lgkmcnt(2)
    v_exp_f32 v36, v36
    v_mul_f32 v37, s46, v37
    v_mfma_f32_16x16x32_bf16 v[244:247], a[84:87], v[76:79], 0
    ds_read_b128 a[20:23], v18 offset:20480
    v_add_f32 v112, v112, v35
    v_lshlrev_b32 v119, 4, v119
    v_lshl_add_u32 v21, v118, 10, v119
    v_mfma_f32_16x16x32_bf16 v[248:251], a[88:91], v[76:79], 0
    s_barrier
    v_exp_f32 v37, v37
    v_mul_f32 v38, s46, v38
    v_mfma_f32_16x16x32_bf16 v[252:255], a[92:95], v[76:79], 0
    ds_read_b128 v[4:7], v3
    v_add_f32 v112, v112, v36
    v_cvt_pk_bf16_f32 v66, v36, v37
    v_xor_b32 v119, 0x80, v21
    v_mfma_f32_16x16x32_bf16 v[100:103], v[104:107], v[76:79], 0
    v_exp_f32 v38, v38
    v_mul_f32 v39, s46, v39
    v_mfma_f32_16x16x32_bf16 v[60:63], a[48:51], a[176:179], v[92:95]
    ds_read_b128 a[24:27], v19 offset:20480
    v_add_f32 v112, v112, v37
    v_add_u32 v22, 3072, v119
    v_add_u32 v23, 6144, v21
    v_mfma_f32_16x16x32_bf16 v[60:63], a[52:55], a[180:183], v[60:63]
    v_exp_f32 v39, v39
    v_add_u32 v24, 9216, v119
    v_mfma_f32_16x16x32_bf16 v[60:63], a[56:59], a[184:187], v[60:63]
    s_waitcnt vmcnt(9) lgkmcnt(15)
    ds_read_b128 a[28:31], v20 offset:20480
    v_cvt_pk_bf16_f32 v67, v38, v39
    v_mfma_f32_16x16x32_bf16 v[60:63], a[60:63], a[188:191], v[60:63]
    s_barrier
    s_cmp_eq_u32 s24, 3
    s_cselect_b64 vcc, 1, 0
    s_waitcnt vmcnt(6)
    v_readfirstlane_b32 s40, v16
    s_nop 1
    s_cmp_ge_u32 s40, s91
    s_cbranch_scc0 L_spin2
L_spin2b:
    s_waitcnt lgkmcnt(2)
    v_or3_b32 v4, v4, v5, v6
    v_or_b32 v4, v4, v7
    s_nop 0
    v_readfirstlane_b32 s40, v4
    s_nop 1
    s_cmp_eq_u32 s40, 0
    s_cbranch_scc1 L_loop
    s_cmp_eq_u32 s38, 0
    s_cbranch_scc0 L_loop
    s_branch L_restart
L_final:
    v_mfma_f32_16x16x32_bf16 v[32:35], a[0:3], a[128:131], v[80:83]
    v_mul_f32 v40, s46, v40
    v_exp_f32 v40, v40
    v_mul_f32 v41, s46, v41
    v_mfma_f32_16x16x32_bf16 v[32:35], a[4:7], a[132:135], v[32:35]
    ds_read_b128 a[32:35], v17 offset:8192
    v_add_f32 v112, v112, v38
    v_mfma_f32_16x16x32_bf16 v[32:35], a[8:11], a[136:139], v[32:35]
    v_exp_f32 v41, v41
    v_mul_f32 v42, s46, v42
    v_mfma_f32_16x16x32_bf16 v[32:35], a[12:15], a[140:143], v[32:35]
    s_waitcnt lgkmcnt(5)
    ds_read_b128 a[36:39], v18 offset:8192
    v_cvt_pk_bf16_f32 v68, v40, v41
    v_mfma_f32_16x16x32_bf16 v[128:131], a[96:99], v[64:67], v[128:131]
    v_exp_f32 v42, v42
    v_mul_f32 v43, s46, v43
    v_mfma_f32_16x16x32_bf16 v[132:135], a[100:103], v[64:67], v[132:135]
    ds_read_b128 a[40:43], v19 offset:8192
    v_add_f32 v112, v112, v39
    v_mfma_f32_16x16x32_bf16 v[136:139], a[104:107], v[64:67], v[136:139]
    v_exp_f32 v43, v43
    v_mul_f32 v44, s46, v44
    v_mfma_f32_16x16x32_bf16 v[140:143], a[108:111], v[64:67], v[140:143]
    ds_read_b128 a[44:47], v20 offset:8192
    v_cvt_pk_bf16_f32 v69, v42, v43
    v_mfma_f32_16x16x32_bf16 v[144:147], a[112:115], v[64:67], v[144:147]
    s_add_u32 m0, s29, 32768
    v_exp_f32 v44, v44
    v_mul_f32 v45, s46, v45
    v_mfma_f32_16x16x32_bf16 v[148:151], a[116:119], v[64:67], v[148:151]
    buffer_load_dwordx4 v25, s[4:7], s50 offen nt lds
    v_mfma_f32_16x16x32_bf16 v[152:155], a[120:123], v[64:67], v[152:155]
    v_exp_f32 v45, v45
    v_mul_f32 v46, s46, v46
    v_mfma_f32_16x16x32_bf16 v[156:159], a[124:127], v[64:67], v[156:159]
    s_waitcnt lgkmcnt(4)
    ds_read_b64_tr_b16 a[64:65], v8 offset:0
    v_cvt_pk_bf16_f32 v70, v44, v45
    v_mfma_f32_16x16x32_bf16 v[36:39], a[16:19], a[128:131], v[80:83]
    s_add_u32 s25, s25, 8192
    v_exp_f32 v46, v46
    v_mul_f32 v47, s46, v47
    v_mfma_f32_16x16x32_bf16 v[36:39], a[20:23], a[132:135], v[36:39]
    buffer_load_dwordx4 v26, s[4:7], s50 offen offset:1024 nt lds
    v_mfma_f32_16x16x32_bf16 v[36:39], a[24:27], a[136:139], v[36:39]
    s_xor_b32 s50, s25, s49
    v_exp_f32 v47, v47
    v_mfma_f32_16x16x32_bf16 v[36:39], a[28:31], a[140:143], v[36:39]
    ds_read_b64_tr_b16 a[66:67], v8 offset:4096
    v_cvt_pk_bf16_f32 v71, v46, v47
    v_mfma_f32_16x16x32_bf16 v[40:43], a[0:3], a[144:147], v[84:87]
    v_mul_f32 v48, s46, v48
    v_exp_f32 v48, v48
    v_mul_f32 v49, s46, v49
    v_mfma_f32_16x16x32_bf16 v[40:43], a[4:7], a[148:151], v[40:43]
    ds_read_b64_tr_b16 a[68:69], v9 offset:0
    v_add_f32 v113, v113, v48
    v_mfma_f32_16x16x32_bf16 v[40:43], a[8:11], a[152:155], v[40:43]
    v_exp_f32 v49, v49
    v_mul_f32 v50, s46, v50
    v_mfma_f32_16x16x32_bf16 v[40:43], a[12:15], a[156:159], v[40:43]
    buffer_store_dwordx4 a[192:195], v29, s[20:23], s39 offen offset:0 sc1
    v_add_f32 v113, v113, v49
    v_cvt_pk_bf16_f32 v72, v48, v49
    v_mfma_f32_16x16x32_bf16 v[160:163], a[96:99], v[68:71], v[160:163]
    v_exp_f32 v50, v50
    v_mul_f32 v51, s46, v51
    v_mfma_f32_16x16x32_bf16 v[164:167], a[100:103], v[68:71], v[164:167]
    ds_read_b64_tr_b16 a[70:71], v9 offset:4096
    v_add_f32 v113, v113, v50
    v_mfma_f32_16x16x32_bf16 v[168:171], a[104:107], v[68:71], v[168:171]
    v_exp_f32 v51, v51
    v_mul_f32 v52, s46, v52
    v_mfma_f32_16x16x32_bf16 v[172:175], a[108:111], v[68:71], v[172:175]
    ds_read_b64_tr_b16 a[72:73], v10 offset:0
    v_cvt_pk_bf16_f32 v73, v50, v51
    v_mfma_f32_16x16x32_bf16 v[176:179], a[112:115], v[68:71], v[176:179]
    v_exp_f32 v52, v52
    v_mul_f32 v53, s46, v53
    v_mfma_f32_16x16x32_bf16 v[180:183], a[116:119], v[68:71], v[180:183]
    ds_read_b64_tr_b16 a[74:75], v10 offset:4096
    v_add_f32 v113, v113, v51
    v_mfma_f32_16x16x32_bf16 v[184:187], a[120:123], v[68:71], v[184:187]
    v_exp_f32 v53, v53
    v_mul_f32 v54, s46, v54
    v_mfma_f32_16x16x32_bf16 v[188:191], a[124:127], v[68:71], v[188:191]
    buffer_store_dwordx4 a[196:199], v29, s[20:23], s39 offen offset:1024 sc1
    v_add_f32 v113, v113, v52
    v_cvt_pk_bf16_f32 v74, v52, v53
    v_mfma_f32_16x16x32_bf16 v[96:99], v[104:107], v[68:71], v[96:99]
    v_exp_f32 v54, v54
    v_mul_f32 v55, s46, v55
    v_mfma_f32_16x16x32_bf16 v[44:47], a[16:19], a[144:147], v[84:87]
    ds_read_b64_tr_b16 a[76:77], v11 offset:0
    v_add_f32 v113, v113, v53
    v_mfma_f32_16x16x32_bf16 v[44:47], a[20:23], a[148:151], v[44:47]
    v_exp_f32 v55, v55
    v_mfma_f32_16x16x32_bf16 v[44:47], a[24:27], a[152:155], v[44:47]
    ds_read_b64_tr_b16 a[78:79], v11 offset:4096
    v_cvt_pk_bf16_f32 v75, v54, v55
    v_mfma_f32_16x16x32_bf16 v[44:47], a[28:31], a[156:159], v[44:47]
    v_add_f32 v113, v113, v54
    v_add_f32 v113, v113, v55
    v_mfma_f32_16x16x32_bf16 v[48:51], a[0:3], a[160:163], v[88:91]
    v_mul_f32 v56, s46, v56
    v_exp_f32 v56, v56
    v_mul_f32 v57, s46, v57
    v_mfma_f32_16x16x32_bf16 v[48:51], a[4:7], a[164:167], v[48:51]
    ds_read_b64_tr_b16 a[80:81], v12 offset:0
    v_mfma_f32_16x16x32_bf16 v[48:51], a[8:11], a[168:171], v[48:51]
    v_exp_f32 v57, v57
    v_mul_f32 v58, s46, v58
    v_mfma_f32_16x16x32_bf16 v[48:51], a[12:15], a[172:175], v[48:51]
    ds_read_b64_tr_b16 a[82:83], v12 offset:4096
    v_cvt_pk_bf16_f32 v76, v56, v57
    v_mfma_f32_16x16x32_bf16 v[192:195], a[96:99], v[72:75], v[192:195]
    v_exp_f32 v58, v58
    v_mul_f32 v59, s46, v59
    v_mfma_f32_16x16x32_bf16 v[196:199], a[100:103], v[72:75], v[196:199]
    ds_read_b64_tr_b16 a[84:85], v13 offset:0
    v_mfma_f32_16x16x32_bf16 v[200:203], a[104:107], v[72:75], v[200:203]
    v_exp_f32 v59, v59
    v_mul_f32 v60, s46, v60
    v_mfma_f32_16x16x32_bf16 v[204:207], a[108:111], v[72:75], v[204:207]
    ds_read_b64_tr_b16 a[86:87], v13 offset:4096
    v_cvt_pk_bf16_f32 v77, v58, v59
    v_mfma_f32_16x16x32_bf16 v[208:211], a[112:115], v[72:75], v[208:211]
    s_add_u32 m0, s29, 90112
    v_exp_f32 v60, v60
    v_mul_f32 v61, s46, v61
    v_mfma_f32_16x16x32_bf16 v[212:215], a[116:119], v[72:75], v[212:215]
    buffer_load_dwordx4 v27, s[8:11], s51 offen nt lds
    v_mfma_f32_16x16x32_bf16 v[216:219], a[120:123], v[72:75], v[216:219]
    v_exp_f32 v61, v61
    v_mul_f32 v62, s46, v62
    v_mfma_f32_16x16x32_bf16 v[220:223], a[124:127], v[72:75], v[220:223]
    ds_read_b64_tr_b16 a[88:89], v14 offset:0
    v_cvt_pk_bf16_f32 v78, v60, v61
    v_mfma_f32_16x16x32_bf16 v[52:55], a[16:19], a[160:163], v[88:91]
    s_add_u32 s26, s26, 8192
    v_exp_f32 v62, v62
    v_mul_f32 v63, s46, v63
    v_mfma_f32_16x16x32_bf16 v[52:55], a[20:23], a[164:167], v[52:55]
    buffer_load_dwordx4 v28, s[8:11], s51 offen offset:1024 nt lds
    v_mfma_f32_16x16x32_bf16 v[52:55], a[24:27], a[168:171], v[52:55]
    s_xor_b32 s51, s26, s49
    v_exp_f32 v63, v63
    v_mfma_f32_16x16x32_bf16 v[52:55], a[28:31], a[172:175], v[52:55]
    ds_read_b64_tr_b16 a[90:91], v14 offset:4096
    v_cvt_pk_bf16_f32 v79, v62, v63
    v_mfma_f32_16x16x32_bf16 v[56:59], a[0:3], a[176:179], v[92:95]
    v_mul_f32 v32, s46, v32
    v_exp_f32 v32, v32
    v_mul_f32 v33, s46, v33
    v_mfma_f32_16x16x32_bf16 v[56:59], a[4:7], a[180:183], v[56:59]
    ds_read_b64_tr_b16 a[92:93], v15 offset:0
    v_add_f32 v112, v112, v32
    v_mfma_f32_16x16x32_bf16 v[56:59], a[8:11], a[184:187], v[56:59]
    v_exp_f32 v33, v33
    v_mul_f32 v34, s46, v34
    v_mfma_f32_16x16x32_bf16 v[56:59], a[12:15], a[188:191], v[56:59]
    buffer_store_dwordx4 a[200:203], v29, s[20:23], s39 offen offset:2048 sc1
    v_add_f32 v112, v112, v33
    v_cvt_pk_bf16_f32 v64, v32, v33
    v_mfma_f32_16x16x32_bf16 v[224:227], a[96:99], v[76:79], v[224:227]
    v_exp_f32 v34, v34
    v_mul_f32 v35, s46, v35
    v_mfma_f32_16x16x32_bf16 v[228:231], a[100:103], v[76:79], v[228:231]
    ds_read_b64_tr_b16 a[94:95], v15 offset:4096
    v_add_f32 v112, v112, v34
    v_mfma_f32_16x16x32_bf16 v[232:235], a[104:107], v[76:79], v[232:235]
    v_exp_f32 v35, v35
    v_mul_f32 v36, s46, v36
    v_mfma_f32_16x16x32_bf16 v[236:239], a[108:111], v[76:79], v[236:239]
    ds_read_b128 a[48:51], v17 offset:12288
    v_cvt_pk_bf16_f32 v65, v34, v35
    v_mfma_f32_16x16x32_bf16 v[240:243], a[112:115], v[76:79], v[240:243]
    v_exp_f32 v36, v36
    v_mul_f32 v37, s46, v37
    v_mfma_f32_16x16x32_bf16 v[244:247], a[116:119], v[76:79], v[244:247]
    ds_read_b128 a[52:55], v18 offset:12288
    v_add_f32 v112, v112, v35
    v_mfma_f32_16x16x32_bf16 v[248:251], a[120:123], v[76:79], v[248:251]
    v_exp_f32 v37, v37
    v_mul_f32 v38, s46, v38
    v_mfma_f32_16x16x32_bf16 v[252:255], a[124:127], v[76:79], v[252:255]
    buffer_store_dwordx4 a[204:207], v29, s[20:23], s39 offen offset:3072 sc1
    v_add_f32 v112, v112, v36
    v_cvt_pk_bf16_f32 v66, v36, v37
    v_mfma_f32_16x16x32_bf16 v[100:103], v[104:107], v[76:79], v[100:103]
    v_exp_f32 v38, v38
    v_mul_f32 v39, s46, v39
    v_mfma_f32_16x16x32_bf16 v[60:63], a[16:19], a[176:179], v[92:95]
    ds_read_b128 a[56:59], v19 offset:12288
    v_add_f32 v112, v112, v37
    v_mfma_f32_16x16x32_bf16 v[60:63], a[20:23], a[180:183], v[60:63]
    v_exp_f32 v39, v39
    v_mfma_f32_16x16x32_bf16 v[60:63], a[24:27], a[184:187], v[60:63]
    s_waitcnt vmcnt(12) lgkmcnt(15)
    ds_read_b128 a[60:63], v20 offset:12288
    v_cvt_pk_bf16_f32 v67, v38, v39
    v_mfma_f32_16x16x32_bf16 v[60:63], a[28:31], a[188:191], v[60:63]
    s_barrier
    v_mfma_f32_16x16x32_bf16 v[32:35], a[32:35], a[128:131], v[80:83]
    v_mul_f32 v40, s46, v40
    v_exp_f32 v40, v40
    v_mul_f32 v41, s46, v41
    v_mfma_f32_16x16x32_bf16 v[32:35], a[36:39], a[132:135], v[32:35]
    ds_read_b128 a[0:3], v17 offset:16384
    v_add_f32 v112, v112, v38
    v_mfma_f32_16x16x32_bf16 v[32:35], a[40:43], a[136:139], v[32:35]
    v_exp_f32 v41, v41
    v_mul_f32 v42, s46, v42
    v_mfma_f32_16x16x32_bf16 v[32:35], a[44:47], a[140:143], v[32:35]
    s_waitcnt lgkmcnt(5)
    ds_read_b128 a[4:7], v18 offset:16384
    v_cvt_pk_bf16_f32 v68, v40, v41
    v_mfma_f32_16x16x32_bf16 v[128:131], a[64:67], v[64:67], v[128:131]
    v_exp_f32 v42, v42
    v_mul_f32 v43, s46, v43
    v_mfma_f32_16x16x32_bf16 v[132:135], a[68:71], v[64:67], v[132:135]
    ds_read_b128 a[8:11], v19 offset:16384
    v_add_f32 v112, v112, v39
    v_mfma_f32_16x16x32_bf16 v[136:139], a[72:75], v[64:67], v[136:139]
    v_exp_f32 v43, v43
    v_mul_f32 v44, s46, v44
    v_mfma_f32_16x16x32_bf16 v[140:143], a[76:79], v[64:67], v[140:143]
    ds_read_b128 a[12:15], v20 offset:16384
    v_cvt_pk_bf16_f32 v69, v42, v43
    v_mfma_f32_16x16x32_bf16 v[144:147], a[80:83], v[64:67], v[144:147]
    s_add_u32 m0, s29, 40960
    v_exp_f32 v44, v44
    v_mul_f32 v45, s46, v45
    v_mfma_f32_16x16x32_bf16 v[148:151], a[84:87], v[64:67], v[148:151]
    buffer_load_dwordx4 v25, s[4:7], s50 offen nt lds
    v_mfma_f32_16x16x32_bf16 v[152:155], a[88:91], v[64:67], v[152:155]
    v_exp_f32 v45, v45
    v_mul_f32 v46, s46, v46
    v_mfma_f32_16x16x32_bf16 v[156:159], a[92:95], v[64:67], v[156:159]
    s_waitcnt lgkmcnt(4)
    ds_read_b64_tr_b16 a[96:97], v8 offset:8192
    v_cvt_pk_bf16_f32 v70, v44, v45
    v_mfma_f32_16x16x32_bf16 v[36:39], a[48:51], a[128:131], v[80:83]
    s_add_u32 s25, s25, 8192
    v_exp_f32 v46, v46
    v_mul_f32 v47, s46, v47
    v_mfma_f32_16x16x32_bf16 v[36:39], a[52:55], a[132:135], v[36:39]
    buffer_load_dwordx4 v26, s[4:7], s50 offen offset:1024 nt lds
    v_mfma_f32_16x16x32_bf16 v[36:39], a[56:59], a[136:139], v[36:39]
    s_xor_b32 s50, s25, s49
    v_exp_f32 v47, v47
    v_mfma_f32_16x16x32_bf16 v[36:39], a[60:63], a[140:143], v[36:39]
    ds_read_b64_tr_b16 a[98:99], v8 offset:12288
    v_cvt_pk_bf16_f32 v71, v46, v47
    v_mfma_f32_16x16x32_bf16 v[40:43], a[32:35], a[144:147], v[84:87]
    v_mul_f32 v48, s46, v48
    v_exp_f32 v48, v48
    v_mul_f32 v49, s46, v49
    v_mfma_f32_16x16x32_bf16 v[40:43], a[36:39], a[148:151], v[40:43]
    ds_read_b64_tr_b16 a[100:101], v9 offset:8192
    v_add_f32 v113, v113, v48
    v_mfma_f32_16x16x32_bf16 v[40:43], a[40:43], a[152:155], v[40:43]
    v_exp_f32 v49, v49
    v_mul_f32 v50, s46, v50
    v_mfma_f32_16x16x32_bf16 v[40:43], a[44:47], a[156:159], v[40:43]
    buffer_store_dwordx4 a[208:211], v29, s[20:23], s41 offen offset:0 sc1
    v_add_f32 v113, v113, v49
    v_cvt_pk_bf16_f32 v72, v48, v49
    v_mfma_f32_16x16x32_bf16 v[160:163], a[64:67], v[68:71], v[160:163]
    v_exp_f32 v50, v50
    v_mul_f32 v51, s46, v51
    v_mfma_f32_16x16x32_bf16 v[164:167], a[68:71], v[68:71], v[164:167]
    ds_read_b64_tr_b16 a[102:103], v9 offset:12288
    v_add_f32 v113, v113, v50
    v_mfma_f32_16x16x32_bf16 v[168:171], a[72:75], v[68:71], v[168:171]
    v_exp_f32 v51, v51
    v_mul_f32 v52, s46, v52
    v_mfma_f32_16x16x32_bf16 v[172:175], a[76:79], v[68:71], v[172:175]
    ds_read_b64_tr_b16 a[104:105], v10 offset:8192
    v_cvt_pk_bf16_f32 v73, v50, v51
    v_mfma_f32_16x16x32_bf16 v[176:179], a[80:83], v[68:71], v[176:179]
    v_exp_f32 v52, v52
    v_mul_f32 v53, s46, v53
    v_mfma_f32_16x16x32_bf16 v[180:183], a[84:87], v[68:71], v[180:183]
    ds_read_b64_tr_b16 a[106:107], v10 offset:12288
    v_add_f32 v113, v113, v51
    v_mfma_f32_16x16x32_bf16 v[184:187], a[88:91], v[68:71], v[184:187]
    v_exp_f32 v53, v53
    v_mul_f32 v54, s46, v54
    v_mfma_f32_16x16x32_bf16 v[188:191], a[92:95], v[68:71], v[188:191]
    buffer_store_dwordx4 a[212:215], v29, s[20:23], s41 offen offset:1024 sc1
    v_add_f32 v113, v113, v52
    v_cvt_pk_bf16_f32 v74, v52, v53
    v_mfma_f32_16x16x32_bf16 v[96:99], v[104:107], v[68:71], v[96:99]
    v_exp_f32 v54, v54
    v_mul_f32 v55, s46, v55
    v_mfma_f32_16x16x32_bf16 v[44:47], a[48:51], a[144:147], v[84:87]
    ds_read_b64_tr_b16 a[108:109], v11 offset:8192
    v_add_f32 v113, v113, v53
    v_mfma_f32_16x16x32_bf16 v[44:47], a[52:55], a[148:151], v[44:47]
    v_exp_f32 v55, v55
    v_mfma_f32_16x16x32_bf16 v[44:47], a[56:59], a[152:155], v[44:47]
    ds_read_b64_tr_b16 a[110:111], v11 offset:12288
    v_cvt_pk_bf16_f32 v75, v54, v55
    v_mfma_f32_16x16x32_bf16 v[44:47], a[60:63], a[156:159], v[44:47]
    v_add_f32 v113, v113, v54
    v_add_f32 v113, v113, v55
    v_mfma_f32_16x16x32_bf16 v[48:51], a[32:35], a[160:163], v[88:91]
    v_mul_f32 v56, s46, v56
    v_exp_f32 v56, v56
    v_mul_f32 v57, s46, v57
    v_mfma_f32_16x16x32_bf16 v[48:51], a[36:39], a[164:167], v[48:51]
    ds_read_b64_tr_b16 a[112:113], v12 offset:8192
    v_mfma_f32_16x16x32_bf16 v[48:51], a[40:43], a[168:171], v[48:51]
    v_exp_f32 v57, v57
    v_mul_f32 v58, s46, v58
    v_mfma_f32_16x16x32_bf16 v[48:51], a[44:47], a[172:175], v[48:51]
    ds_read_b64_tr_b16 a[114:115], v12 offset:12288
    v_cvt_pk_bf16_f32 v76, v56, v57
    v_mfma_f32_16x16x32_bf16 v[192:195], a[64:67], v[72:75], v[192:195]
    v_exp_f32 v58, v58
    v_mul_f32 v59, s46, v59
    v_mfma_f32_16x16x32_bf16 v[196:199], a[68:71], v[72:75], v[196:199]
    ds_read_b64_tr_b16 a[116:117], v13 offset:8192
    v_mfma_f32_16x16x32_bf16 v[200:203], a[72:75], v[72:75], v[200:203]
    v_exp_f32 v59, v59
    v_mul_f32 v60, s46, v60
    v_mfma_f32_16x16x32_bf16 v[204:207], a[76:79], v[72:75], v[204:207]
    ds_read_b64_tr_b16 a[118:119], v13 offset:12288
    v_cvt_pk_bf16_f32 v77, v58, v59
    v_mfma_f32_16x16x32_bf16 v[208:211], a[80:83], v[72:75], v[208:211]
    s_add_u32 m0, s29, 98304
    v_exp_f32 v60, v60
    v_mul_f32 v61, s46, v61
    v_mfma_f32_16x16x32_bf16 v[212:215], a[84:87], v[72:75], v[212:215]
    buffer_load_dwordx4 v27, s[8:11], s51 offen nt lds
    v_mfma_f32_16x16x32_bf16 v[216:219], a[88:91], v[72:75], v[216:219]
    v_exp_f32 v61, v61
    v_mul_f32 v62, s46, v62
    v_mfma_f32_16x16x32_bf16 v[220:223], a[92:95], v[72:75], v[220:223]
    ds_read_b64_tr_b16 a[120:121], v14 offset:8192
    v_cvt_pk_bf16_f32 v78, v60, v61
    v_mfma_f32_16x16x32_bf16 v[52:55], a[48:51], a[160:163], v[88:91]
    s_add_u32 s26, s26, 8192
    v_exp_f32 v62, v62
    v_mul_f32 v63, s46, v63
    v_mfma_f32_16x16x32_bf16 v[52:55], a[52:55], a[164:167], v[52:55]
    buffer_load_dwordx4 v28, s[8:11], s51 offen offset:1024 nt lds
    v_mfma_f32_16x16x32_bf16 v[52:55], a[56:59], a[168:171], v[52:55]
    s_xor_b32 s51, s26, s49
    v_exp_f32 v63, v63
    v_mfma_f32_16x16x32_bf16 v[52:55], a[60:63], a[172:175], v[52:55]
    ds_read_b64_tr_b16 a[122:123], v14 offset:12288
    v_cvt_pk_bf16_f32 v79, v62, v63
    v_mfma_f32_16x16x32_bf16 v[56:59], a[32:35], a[176:179], v[92:95]
    v_mul_f32 v32, s46, v32
    v_exp_f32 v32, v32
    v_mul_f32 v33, s46, v33
    v_mfma_f32_16x16x32_bf16 v[56:59], a[36:39], a[180:183], v[56:59]
    ds_read_b64_tr_b16 a[124:125], v15 offset:8192
    v_add_f32 v112, v112, v32
    v_mfma_f32_16x16x32_bf16 v[56:59], a[40:43], a[184:187], v[56:59]
    v_exp_f32 v33, v33
    v_mul_f32 v34, s46, v34
    v_mfma_f32_16x16x32_bf16 v[56:59], a[44:47], a[188:191], v[56:59]
    buffer_store_dwordx4 a[216:219], v29, s[20:23], s41 offen offset:2048 sc1
    v_add_f32 v112, v112, v33
    v_cvt_pk_bf16_f32 v64, v32, v33
    v_mfma_f32_16x16x32_bf16 v[224:227], a[64:67], v[76:79], v[224:227]
    v_exp_f32 v34, v34
    v_mul_f32 v35, s46, v35
    v_mfma_f32_16x16x32_bf16 v[228:231], a[68:71], v[76:79], v[228:231]
    ds_read_b64_tr_b16 a[126:127], v15 offset:12288
    v_add_f32 v112, v112, v34
    v_mfma_f32_16x16x32_bf16 v[232:235], a[72:75], v[76:79], v[232:235]
    v_exp_f32 v35, v35
    v_mul_f32 v36, s46, v36
    v_mfma_f32_16x16x32_bf16 v[236:239], a[76:79], v[76:79], v[236:239]
    ds_read_b128 a[16:19], v17 offset:20480
    v_cvt_pk_bf16_f32 v65, v34, v35
    v_mfma_f32_16x16x32_bf16 v[240:243], a[80:83], v[76:79], v[240:243]
    v_exp_f32 v36, v36
    v_mul_f32 v37, s46, v37
    v_mfma_f32_16x16x32_bf16 v[244:247], a[84:87], v[76:79], v[244:247]
    ds_read_b128 a[20:23], v18 offset:20480
    v_add_f32 v112, v112, v35
    v_mfma_f32_16x16x32_bf16 v[248:251], a[88:91], v[76:79], v[248:251]
    v_exp_f32 v37, v37
    v_mul_f32 v38, s46, v38
    v_mfma_f32_16x16x32_bf16 v[252:255], a[92:95], v[76:79], v[252:255]
    buffer_store_dwordx4 a[220:223], v29, s[20:23], s41 offen offset:3072 sc1
    v_add_f32 v112, v112, v36
    v_cvt_pk_bf16_f32 v66, v36, v37
    v_mfma_f32_16x16x32_bf16 v[100:103], v[104:107], v[76:79], v[100:103]
    v_exp_f32 v38, v38
    v_mul_f32 v39, s46, v39
    v_mfma_f32_16x16x32_bf16 v[60:63], a[48:51], a[176:179], v[92:95]
    ds_read_b128 a[24:27], v19 offset:20480
    v_add_f32 v112, v112, v37
    v_mfma_f32_16x16x32_bf16 v[60:63], a[52:55], a[180:183], v[60:63]
    v_exp_f32 v39, v39
    v_mfma_f32_16x16x32_bf16 v[60:63], a[56:59], a[184:187], v[60:63]
    s_waitcnt vmcnt(16) lgkmcnt(15)
    ds_read_b128 a[28:31], v20 offset:20480
    v_cvt_pk_bf16_f32 v67, v38, v39
    v_mfma_f32_16x16x32_bf16 v[60:63], a[60:63], a[188:191], v[60:63]
    s_barrier
    v_mfma_f32_16x16x32_bf16 v[32:35], a[0:3], a[128:131], v[80:83]
    v_mul_f32 v40, s46, v40
    v_exp_f32 v40, v40
    v_mul_f32 v41, s46, v41
    v_mfma_f32_16x16x32_bf16 v[32:35], a[4:7], a[132:135], v[32:35]
    ds_read_b128 a[32:35], v17 offset:24576
    v_add_f32 v112, v112, v38
    v_mfma_f32_16x16x32_bf16 v[32:35], a[8:11], a[136:139], v[32:35]
    v_exp_f32 v41, v41
    v_mul_f32 v42, s46, v42
    v_mfma_f32_16x16x32_bf16 v[32:35], a[12:15], a[140:143], v[32:35]
    s_waitcnt lgkmcnt(5)
    ds_read_b128 a[36:39], v18 offset:24576
    v_cvt_pk_bf16_f32 v68, v40, v41
    v_mfma_f32_16x16x32_bf16 v[128:131], a[96:99], v[64:67], v[128:131]
    v_exp_f32 v42, v42
    v_mul_f32 v43, s46, v43
    v_mfma_f32_16x16x32_bf16 v[132:135], a[100:103], v[64:67], v[132:135]
    ds_read_b128 a[40:43], v19 offset:24576
    v_add_f32 v112, v112, v39
    v_mfma_f32_16x16x32_bf16 v[136:139], a[104:107], v[64:67], v[136:139]
    v_exp_f32 v43, v43
    v_mul_f32 v44, s46, v44
    v_mfma_f32_16x16x32_bf16 v[140:143], a[108:111], v[64:67], v[140:143]
    ds_read_b128 a[44:47], v20 offset:24576
    v_cvt_pk_bf16_f32 v69, v42, v43
    v_mfma_f32_16x16x32_bf16 v[144:147], a[112:115], v[64:67], v[144:147]
    s_add_u32 m0, s29, 49152
    v_exp_f32 v44, v44
    v_mul_f32 v45, s46, v45
    v_mfma_f32_16x16x32_bf16 v[148:151], a[116:119], v[64:67], v[148:151]
    buffer_load_dwordx4 v25, s[4:7], s50 offen nt lds
    v_mfma_f32_16x16x32_bf16 v[152:155], a[120:123], v[64:67], v[152:155]
    v_exp_f32 v45, v45
    v_mul_f32 v46, s46, v46
    v_mfma_f32_16x16x32_bf16 v[156:159], a[124:127], v[64:67], v[156:159]
    s_waitcnt lgkmcnt(4)
    ds_read_b64_tr_b16 a[64:65], v8 offset:16384
    v_cvt_pk_bf16_f32 v70, v44, v45
    v_mfma_f32_16x16x32_bf16 v[36:39], a[16:19], a[128:131], v[80:83]
    s_add_u32 s25, s25, 8192
    v_exp_f32 v46, v46
    v_mul_f32 v47, s46, v47
    v_mfma_f32_16x16x32_bf16 v[36:39], a[20:23], a[132:135], v[36:39]
    buffer_load_dwordx4 v26, s[4:7], s50 offen offset:1024 nt lds
    v_mfma_f32_16x16x32_bf16 v[36:39], a[24:27], a[136:139], v[36:39]
    s_xor_b32 s50, s25, s49
    v_exp_f32 v47, v47
    v_mfma_f32_16x16x32_bf16 v[36:39], a[28:31], a[140:143], v[36:39]
    ds_read_b64_tr_b16 a[66:67], v8 offset:20480
    v_cvt_pk_bf16_f32 v71, v46, v47
    v_mfma_f32_16x16x32_bf16 v[40:43], a[0:3], a[144:147], v[84:87]
    v_mul_f32 v48, s46, v48
    v_exp_f32 v48, v48
    v_mul_f32 v49, s46, v49
    v_mfma_f32_16x16x32_bf16 v[40:43], a[4:7], a[148:151], v[40:43]
    ds_read_b64_tr_b16 a[68:69], v9 offset:16384
    v_add_f32 v113, v113, v48
    v_mfma_f32_16x16x32_bf16 v[40:43], a[8:11], a[152:155], v[40:43]
    v_exp_f32 v49, v49
    v_mul_f32 v50, s46, v50
    v_mfma_f32_16x16x32_bf16 v[40:43], a[12:15], a[156:159], v[40:43]
    buffer_store_dwordx4 a[224:227], v29, s[20:23], s42 offen offset:0 sc1
    v_add_f32 v113, v113, v49
    v_cvt_pk_bf16_f32 v72, v48, v49
    v_mfma_f32_16x16x32_bf16 v[160:163], a[96:99], v[68:71], v[160:163]
    v_exp_f32 v50, v50
    v_mul_f32 v51, s46, v51
    v_mfma_f32_16x16x32_bf16 v[164:167], a[100:103], v[68:71], v[164:167]
    ds_read_b64_tr_b16 a[70:71], v9 offset:20480
    v_add_f32 v113, v113, v50
    v_mfma_f32_16x16x32_bf16 v[168:171], a[104:107], v[68:71], v[168:171]
    v_exp_f32 v51, v51
    v_mul_f32 v52, s46, v52
    v_mfma_f32_16x16x32_bf16 v[172:175], a[108:111], v[68:71], v[172:175]
    ds_read_b64_tr_b16 a[72:73], v10 offset:16384
    v_cvt_pk_bf16_f32 v73, v50, v51
    v_mfma_f32_16x16x32_bf16 v[176:179], a[112:115], v[68:71], v[176:179]
    v_exp_f32 v52, v52
    v_mul_f32 v53, s46, v53
    v_mfma_f32_16x16x32_bf16 v[180:183], a[116:119], v[68:71], v[180:183]
    ds_read_b64_tr_b16 a[74:75], v10 offset:20480
    v_add_f32 v113, v113, v51
    v_mfma_f32_16x16x32_bf16 v[184:187], a[120:123], v[68:71], v[184:187]
    v_exp_f32 v53, v53
    v_mul_f32 v54, s46, v54
    v_mfma_f32_16x16x32_bf16 v[188:191], a[124:127], v[68:71], v[188:191]
    buffer_store_dwordx4 a[228:231], v29, s[20:23], s42 offen offset:1024 sc1
    v_add_f32 v113, v113, v52
    v_cvt_pk_bf16_f32 v74, v52, v53
    v_mfma_f32_16x16x32_bf16 v[96:99], v[104:107], v[68:71], v[96:99]
    v_exp_f32 v54, v54
    v_mul_f32 v55, s46, v55
    v_mfma_f32_16x16x32_bf16 v[44:47], a[16:19], a[144:147], v[84:87]
    ds_read_b64_tr_b16 a[76:77], v11 offset:16384
    v_add_f32 v113, v113, v53
    v_mfma_f32_16x16x32_bf16 v[44:47], a[20:23], a[148:151], v[44:47]
    v_exp_f32 v55, v55
    v_mfma_f32_16x16x32_bf16 v[44:47], a[24:27], a[152:155], v[44:47]
    ds_read_b64_tr_b16 a[78:79], v11 offset:20480
    v_cvt_pk_bf16_f32 v75, v54, v55
    v_mfma_f32_16x16x32_bf16 v[44:47], a[28:31], a[156:159], v[44:47]
    v_add_f32 v113, v113, v54
    v_add_f32 v113, v113, v55
    v_mfma_f32_16x16x32_bf16 v[48:51], a[0:3], a[160:163], v[88:91]
    v_mul_f32 v56, s46, v56
    v_exp_f32 v56, v56
    v_mul_f32 v57, s46, v57
    v_mfma_f32_16x16x32_bf16 v[48:51], a[4:7], a[164:167], v[48:51]
    ds_read_b64_tr_b16 a[80:81], v12 offset:16384
    v_mfma_f32_16x16x32_bf16 v[48:51], a[8:11], a[168:171], v[48:51]
    v_exp_f32 v57, v57
    v_mul_f32 v58, s46, v58
    v_mfma_f32_16x16x32_bf16 v[48:51], a[12:15], a[172:175], v[48:51]
    ds_read_b64_tr_b16 a[82:83], v12 offset:20480
    v_cvt_pk_bf16_f32 v76, v56, v57
    v_mfma_f32_16x16x32_bf16 v[192:195], a[96:99], v[72:75], v[192:195]
    v_exp_f32 v58, v58
    v_mul_f32 v59, s46, v59
    v_mfma_f32_16x16x32_bf16 v[196:199], a[100:103], v[72:75], v[196:199]
    ds_read_b64_tr_b16 a[84:85], v13 offset:16384
    v_mfma_f32_16x16x32_bf16 v[200:203], a[104:107], v[72:75], v[200:203]
    v_exp_f32 v59, v59
    v_mul_f32 v60, s46, v60
    v_mfma_f32_16x16x32_bf16 v[204:207], a[108:111], v[72:75], v[204:207]
    ds_read_b64_tr_b16 a[86:87], v13 offset:20480
    v_cvt_pk_bf16_f32 v77, v58, v59
    v_mfma_f32_16x16x32_bf16 v[208:211], a[112:115], v[72:75], v[208:211]
    s_add_u32 m0, s29, 106496
    v_exp_f32 v60, v60
    v_mul_f32 v61, s46, v61
    v_mfma_f32_16x16x32_bf16 v[212:215], a[116:119], v[72:75], v[212:215]
    buffer_load_dwordx4 v27, s[8:11], s51 offen nt lds
    v_mfma_f32_16x16x32_bf16 v[216:219], a[120:123], v[72:75], v[216:219]
    v_exp_f32 v61, v61
    v_mul_f32 v62, s46, v62
    v_mfma_f32_16x16x32_bf16 v[220:223], a[124:127], v[72:75], v[220:223]
    ds_read_b64_tr_b16 a[88:89], v14 offset:16384
    v_cvt_pk_bf16_f32 v78, v60, v61
    v_mfma_f32_16x16x32_bf16 v[52:55], a[16:19], a[160:163], v[88:91]
    s_add_u32 s26, s26, 8192
    v_exp_f32 v62, v62
    v_mul_f32 v63, s46, v63
    v_mfma_f32_16x16x32_bf16 v[52:55], a[20:23], a[164:167], v[52:55]
    buffer_load_dwordx4 v28, s[8:11], s51 offen offset:1024 nt lds
    v_mfma_f32_16x16x32_bf16 v[52:55], a[24:27], a[168:171], v[52:55]
    s_xor_b32 s51, s26, s49
    v_exp_f32 v63, v63
    v_mfma_f32_16x16x32_bf16 v[52:55], a[28:31], a[172:175], v[52:55]
    ds_read_b64_tr_b16 a[90:91], v14 offset:20480
    v_cvt_pk_bf16_f32 v79, v62, v63
    v_mfma_f32_16x16x32_bf16 v[56:59], a[0:3], a[176:179], v[92:95]
    v_mul_f32 v32, s46, v32
    v_exp_f32 v32, v32
    v_mul_f32 v33, s46, v33
    v_mfma_f32_16x16x32_bf16 v[56:59], a[4:7], a[180:183], v[56:59]
    ds_read_b64_tr_b16 a[92:93], v15 offset:16384
    v_add_f32 v112, v112, v32
    v_mfma_f32_16x16x32_bf16 v[56:59], a[8:11], a[184:187], v[56:59]
    v_exp_f32 v33, v33
    v_mul_f32 v34, s46, v34
    v_mfma_f32_16x16x32_bf16 v[56:59], a[12:15], a[188:191], v[56:59]
    buffer_store_dwordx4 a[232:235], v29, s[20:23], s42 offen offset:2048 sc1
    v_add_f32 v112, v112, v33
    v_cvt_pk_bf16_f32 v64, v32, v33
    v_mfma_f32_16x16x32_bf16 v[224:227], a[96:99], v[76:79], v[224:227]
    v_exp_f32 v34, v34
    v_mul_f32 v35, s46, v35
    v_mfma_f32_16x16x32_bf16 v[228:231], a[100:103], v[76:79], v[228:231]
    ds_read_b64_tr_b16 a[94:95], v15 offset:20480
    v_add_f32 v112, v112, v34
    v_mfma_f32_16x16x32_bf16 v[232:235], a[104:107], v[76:79], v[232:235]
    v_exp_f32 v35, v35
    v_mul_f32 v36, s46, v36
    v_mfma_f32_16x16x32_bf16 v[236:239], a[108:111], v[76:79], v[236:239]
    ds_read_b128 a[48:51], v17 offset:28672
    v_cvt_pk_bf16_f32 v65, v34, v35
    v_mfma_f32_16x16x32_bf16 v[240:243], a[112:115], v[76:79], v[240:243]
    v_exp_f32 v36, v36
    v_mul_f32 v37, s46, v37
    v_mfma_f32_16x16x32_bf16 v[244:247], a[116:119], v[76:79], v[244:247]
    ds_read_b128 a[52:55], v18 offset:28672
    v_add_f32 v112, v112, v35
    v_mfma_f32_16x16x32_bf16 v[248:251], a[120:123], v[76:79], v[248:251]
    v_exp_f32 v37, v37
    v_mul_f32 v38, s46, v38
    v_mfma_f32_16x16x32_bf16 v[252:255], a[124:127], v[76:79], v[252:255]
    buffer_store_dwordx4 a[236:239], v29, s[20:23], s42 offen offset:3072 sc1
    v_add_f32 v112, v112, v36
    v_cvt_pk_bf16_f32 v66, v36, v37
    v_mfma_f32_16x16x32_bf16 v[100:103], v[104:107], v[76:79], v[100:103]
    v_exp_f32 v38, v38
    v_mul_f32 v39, s46, v39
    v_mfma_f32_16x16x32_bf16 v[60:63], a[16:19], a[176:179], v[92:95]
    ds_read_b128 a[56:59], v19 offset:28672
    v_add_f32 v112, v112, v37
    v_mfma_f32_16x16x32_bf16 v[60:63], a[20:23], a[180:183], v[60:63]
    v_exp_f32 v39, v39
    v_mfma_f32_16x16x32_bf16 v[60:63], a[24:27], a[184:187], v[60:63]
    s_waitcnt vmcnt(18) lgkmcnt(15)
    ds_read_b128 a[60:63], v20 offset:28672
    v_cvt_pk_bf16_f32 v67, v38, v39
    v_mfma_f32_16x16x32_bf16 v[60:63], a[28:31], a[188:191], v[60:63]
    s_barrier
    v_mfma_f32_16x16x32_bf16 v[32:35], a[32:35], a[128:131], v[80:83]
    v_mul_f32 v40, s46, v40
    v_exp_f32 v40, v40
    v_mul_f32 v41, s46, v41
    v_mfma_f32_16x16x32_bf16 v[32:35], a[36:39], a[132:135], v[32:35]
    ds_read_b128 a[0:3], v17 offset:32768
    v_add_f32 v112, v112, v38
    v_mfma_f32_16x16x32_bf16 v[32:35], a[40:43], a[136:139], v[32:35]
    v_exp_f32 v41, v41
    v_mul_f32 v42, s46, v42
    v_mfma_f32_16x16x32_bf16 v[32:35], a[44:47], a[140:143], v[32:35]
    s_waitcnt lgkmcnt(5)
    ds_read_b128 a[4:7], v18 offset:32768
    v_cvt_pk_bf16_f32 v68, v40, v41
    v_mfma_f32_16x16x32_bf16 v[128:131], a[64:67], v[64:67], v[128:131]
    v_exp_f32 v42, v42
    v_mul_f32 v43, s46, v43
    v_mfma_f32_16x16x32_bf16 v[132:135], a[68:71], v[64:67], v[132:135]
    ds_read_b128 a[8:11], v19 offset:32768
    v_add_f32 v112, v112, v39
    v_mfma_f32_16x16x32_bf16 v[136:139], a[72:75], v[64:67], v[136:139]
    v_exp_f32 v43, v43
    v_mul_f32 v44, s46, v44
    v_mfma_f32_16x16x32_bf16 v[140:143], a[76:79], v[64:67], v[140:143]
    ds_read_b128 a[12:15], v20 offset:32768
    v_cvt_pk_bf16_f32 v69, v42, v43
    v_mfma_f32_16x16x32_bf16 v[144:147], a[80:83], v[64:67], v[144:147]
    s_add_u32 m0, s29, 57344
    v_exp_f32 v44, v44
    v_mul_f32 v45, s46, v45
    v_mfma_f32_16x16x32_bf16 v[148:151], a[84:87], v[64:67], v[148:151]
    buffer_load_dwordx4 v25, s[4:7], s50 offen nt lds
    v_mfma_f32_16x16x32_bf16 v[152:155], a[88:91], v[64:67], v[152:155]
    v_exp_f32 v45, v45
    v_mul_f32 v46, s46, v46
    v_mfma_f32_16x16x32_bf16 v[156:159], a[92:95], v[64:67], v[156:159]
    s_waitcnt lgkmcnt(4)
    ds_read_b64_tr_b16 a[96:97], v8 offset:24576
    v_cvt_pk_bf16_f32 v70, v44, v45
    v_mfma_f32_16x16x32_bf16 v[36:39], a[48:51], a[128:131], v[80:83]
    s_add_u32 s25, s25, 8192
    v_exp_f32 v46, v46
    v_mul_f32 v47, s46, v47
    v_mfma_f32_16x16x32_bf16 v[36:39], a[52:55], a[132:135], v[36:39]
    buffer_load_dwordx4 v26, s[4:7], s50 offen offset:1024 nt lds
    v_mfma_f32_16x16x32_bf16 v[36:39], a[56:59], a[136:139], v[36:39]
    s_xor_b32 s50, s25, s49
    v_exp_f32 v47, v47
    v_mfma_f32_16x16x32_bf16 v[36:39], a[60:63], a[140:143], v[36:39]
    ds_read_b64_tr_b16 a[98:99], v8 offset:28672
    v_cvt_pk_bf16_f32 v71, v46, v47
    v_mfma_f32_16x16x32_bf16 v[40:43], a[32:35], a[144:147], v[84:87]
    s_bfe_u32 s54, s2, 65536
    v_mul_f32 v48, s46, v48
    v_exp_f32 v48, v48
    v_mul_f32 v49, s46, v49
    v_mfma_f32_16x16x32_bf16 v[40:43], a[36:39], a[148:151], v[40:43]
    s_mul_i32 s52, s54, 983040
    ds_read_b64_tr_b16 a[100:101], v9 offset:24576
    v_add_f32 v113, v113, v48
    v_mfma_f32_16x16x32_bf16 v[40:43], a[40:43], a[152:155], v[40:43]
    s_add_u32 s52, s52, s56
    v_exp_f32 v49, v49
    v_mul_f32 v50, s46, v50
    v_mfma_f32_16x16x32_bf16 v[40:43], a[44:47], a[156:159], v[40:43]
    s_mul_i32 s53, s54, 262016
    buffer_store_dwordx4 a[240:243], v29, s[20:23], s43 offen offset:0 sc1
    v_add_f32 v113, v113, v49
    v_cvt_pk_bf16_f32 v72, v48, v49
    v_mfma_f32_16x16x32_bf16 v[160:163], a[64:67], v[68:71], v[160:163]
    s_add_u32 s53, s53, s57
    v_exp_f32 v50, v50
    v_mul_f32 v51, s46, v51
    v_mfma_f32_16x16x32_bf16 v[164:167], a[68:71], v[68:71], v[164:167]
    s_bfe_u32 s55, s2, 0x30003
    ds_read_b64_tr_b16 a[102:103], v9 offset:28672
    v_add_f32 v113, v113, v50
    v_mfma_f32_16x16x32_bf16 v[168:171], a[72:75], v[68:71], v[168:171]
    s_lshl_b32 s55, s55, 1
    v_exp_f32 v51, v51
    v_mul_f32 v52, s46, v52
    v_mfma_f32_16x16x32_bf16 v[172:175], a[76:79], v[68:71], v[172:175]
    s_add_u32 s55, s55, s54
    ds_read_b64_tr_b16 a[104:105], v10 offset:24576
    v_cvt_pk_bf16_f32 v73, v50, v51
    v_mfma_f32_16x16x32_bf16 v[176:179], a[80:83], v[68:71], v[176:179]
    s_lshr_b32 s54, s2, 3
    v_exp_f32 v52, v52
    v_mul_f32 v53, s46, v53
    v_mfma_f32_16x16x32_bf16 v[180:183], a[84:87], v[68:71], v[180:183]
    s_lshr_b32 s32, s2, 5
    ds_read_b64_tr_b16 a[106:107], v10 offset:28672
    v_add_f32 v113, v113, v51
    v_mfma_f32_16x16x32_bf16 v[184:187], a[88:91], v[68:71], v[184:187]
    s_add_u32 s54, s54, s32
    v_exp_f32 v53, v53
    v_mul_f32 v54, s46, v54
    v_mfma_f32_16x16x32_bf16 v[188:191], a[92:95], v[68:71], v[188:191]
    s_and_b32 s54, s54, 3
    buffer_store_dwordx4 a[244:247], v29, s[20:23], s43 offen offset:1024 sc1
    v_add_f32 v113, v113, v52
    v_cvt_pk_bf16_f32 v74, v52, v53
    v_mfma_f32_16x16x32_bf16 v[96:99], v[104:107], v[68:71], v[96:99]
    s_mov_b32 s61, s54
    v_exp_f32 v54, v54
    v_mul_f32 v55, s46, v55
    v_mfma_f32_16x16x32_bf16 v[44:47], a[48:51], a[144:147], v[84:87]
    s_add_u32 s55, s55, 2
    ds_read_b64_tr_b16 a[108:109], v11 offset:24576
    v_add_f32 v113, v113, v53
    v_mfma_f32_16x16x32_bf16 v[44:47], a[52:55], a[148:151], v[44:47]
    s_lshl_b32 s55, s55, 8
    v_exp_f32 v55, v55
    v_mfma_f32_16x16x32_bf16 v[44:47], a[56:59], a[152:155], v[44:47]
    s_lshl_b32 s32, s2, 15
    ds_read_b64_tr_b16 a[110:111], v11 offset:28672
    v_cvt_pk_bf16_f32 v75, v54, v55
    v_mfma_f32_16x16x32_bf16 v[44:47], a[60:63], a[156:159], v[44:47]
    s_add_u32 s32, s32, s31
    v_add_f32 v113, v113, v54
    v_add_f32 v113, v113, v55
    v_mfma_f32_16x16x32_bf16 v[48:51], a[32:35], a[160:163], v[88:91]
    s_add_u32 s32, s32, 4194304
    v_mul_f32 v56, s46, v56
    v_exp_f32 v56, v56
    v_mul_f32 v57, s46, v57
    v_mfma_f32_16x16x32_bf16 v[48:51], a[36:39], a[164:167], v[48:51]
    s_mov_b32 s60, 0xfab460
    ds_read_b64_tr_b16 a[112:113], v12 offset:24576
    v_mfma_f32_16x16x32_bf16 v[48:51], a[40:43], a[168:171], v[48:51]
    s_cmp_eq_u32 s54, 1
    v_exp_f32 v57, v57
    v_mul_f32 v58, s46, v58
    v_mfma_f32_16x16x32_bf16 v[48:51], a[44:47], a[172:175], v[48:51]
    s_cselect_b32 s60, 0xdda941, s60
    ds_read_b64_tr_b16 a[114:115], v12 offset:28672
    v_cvt_pk_bf16_f32 v76, v56, v57
    v_mfma_f32_16x16x32_bf16 v[192:195], a[64:67], v[72:75], v[192:195]
    s_cmp_eq_u32 s54, 2
    v_exp_f32 v58, v58
    v_mul_f32 v59, s46, v59
    v_mfma_f32_16x16x32_bf16 v[196:199], a[68:71], v[72:75], v[196:199]
    s_cselect_b32 s60, 0x87dc1a, s60
    ds_read_b64_tr_b16 a[116:117], v13 offset:24576
    v_mfma_f32_16x16x32_bf16 v[200:203], a[72:75], v[72:75], v[200:203]
    s_cmp_eq_u32 s54, 3
    v_exp_f32 v59, v59
    v_mul_f32 v60, s46, v60
    v_mfma_f32_16x16x32_bf16 v[204:207], a[76:79], v[72:75], v[204:207]
    s_cselect_b32 s60, 0xa37313, s60
    ds_read_b64_tr_b16 a[118:119], v13 offset:28672
    v_cvt_pk_bf16_f32 v77, v58, v59
    v_mfma_f32_16x16x32_bf16 v[208:211], a[80:83], v[72:75], v[208:211]
    s_add_u32 m0, s29, 114688
    v_exp_f32 v60, v60
    v_mul_f32 v61, s46, v61
    v_mfma_f32_16x16x32_bf16 v[212:215], a[84:87], v[72:75], v[212:215]
    buffer_load_dwordx4 v27, s[8:11], s51 offen nt lds
    v_mfma_f32_16x16x32_bf16 v[216:219], a[88:91], v[72:75], v[216:219]
    v_exp_f32 v61, v61
    v_mul_f32 v62, s46, v62
    v_mfma_f32_16x16x32_bf16 v[220:223], a[92:95], v[72:75], v[220:223]
    ds_read_b64_tr_b16 a[120:121], v14 offset:24576
    v_cvt_pk_bf16_f32 v78, v60, v61
    v_mfma_f32_16x16x32_bf16 v[52:55], a[48:51], a[160:163], v[88:91]
    s_add_u32 s26, s26, 8192
    v_exp_f32 v62, v62
    v_mul_f32 v63, s46, v63
    v_mfma_f32_16x16x32_bf16 v[52:55], a[52:55], a[164:167], v[52:55]
    buffer_load_dwordx4 v28, s[8:11], s51 offen offset:1024 nt lds
    v_mfma_f32_16x16x32_bf16 v[52:55], a[56:59], a[168:171], v[52:55]
    s_xor_b32 s51, s26, s49
    v_exp_f32 v63, v63
    v_mfma_f32_16x16x32_bf16 v[52:55], a[60:63], a[172:175], v[52:55]
    ds_read_b64_tr_b16 a[122:123], v14 offset:28672
    v_cvt_pk_bf16_f32 v79, v62, v63
    v_mfma_f32_16x16x32_bf16 v[56:59], a[32:35], a[176:179], v[92:95]
    v_mul_f32 v32, s46, v32
    v_exp_f32 v32, v32
    v_mul_f32 v33, s46, v33
    v_mfma_f32_16x16x32_bf16 v[56:59], a[36:39], a[180:183], v[56:59]
    ds_read_b64_tr_b16 a[124:125], v15 offset:24576
    v_add_f32 v112, v112, v32
    v_mfma_f32_16x16x32_bf16 v[56:59], a[40:43], a[184:187], v[56:59]
    v_exp_f32 v33, v33
    v_mul_f32 v34, s46, v34
    v_mfma_f32_16x16x32_bf16 v[56:59], a[44:47], a[188:191], v[56:59]
    buffer_store_dwordx4 a[248:251], v29, s[20:23], s43 offen offset:2048 sc1
    v_add_f32 v112, v112, v33
    v_cvt_pk_bf16_f32 v64, v32, v33
    v_mfma_f32_16x16x32_bf16 v[224:227], a[64:67], v[76:79], v[224:227]
    v_exp_f32 v34, v34
    v_mul_f32 v35, s46, v35
    v_mfma_f32_16x16x32_bf16 v[228:231], a[68:71], v[76:79], v[228:231]
    ds_read_b64_tr_b16 a[126:127], v15 offset:28672
    v_add_f32 v112, v112, v34
    v_mfma_f32_16x16x32_bf16 v[232:235], a[72:75], v[76:79], v[232:235]
    v_exp_f32 v35, v35
    v_mul_f32 v36, s46, v36
    v_mfma_f32_16x16x32_bf16 v[236:239], a[76:79], v[76:79], v[236:239]
    ds_read_b128 a[16:19], v17 offset:36864
    v_cvt_pk_bf16_f32 v65, v34, v35
    v_mfma_f32_16x16x32_bf16 v[240:243], a[80:83], v[76:79], v[240:243]
    v_exp_f32 v36, v36
    v_mul_f32 v37, s46, v37
    v_mfma_f32_16x16x32_bf16 v[244:247], a[84:87], v[76:79], v[244:247]
    ds_read_b128 a[20:23], v18 offset:36864
    v_add_f32 v112, v112, v35
    v_mfma_f32_16x16x32_bf16 v[248:251], a[88:91], v[76:79], v[248:251]
    v_exp_f32 v37, v37
    v_mul_f32 v38, s46, v38
    v_mfma_f32_16x16x32_bf16 v[252:255], a[92:95], v[76:79], v[252:255]
    buffer_store_dwordx4 a[252:255], v29, s[20:23], s43 offen offset:3072 sc1
    v_add_f32 v112, v112, v36
    v_cvt_pk_bf16_f32 v66, v36, v37
    v_mfma_f32_16x16x32_bf16 v[100:103], v[104:107], v[76:79], v[100:103]
    v_exp_f32 v38, v38
    v_mul_f32 v39, s46, v39
    v_mfma_f32_16x16x32_bf16 v[60:63], a[48:51], a[176:179], v[92:95]
    ds_read_b128 a[24:27], v19 offset:36864
    v_add_f32 v112, v112, v37
    v_mfma_f32_16x16x32_bf16 v[60:63], a[52:55], a[180:183], v[60:63]
    v_exp_f32 v39, v39
    v_mfma_f32_16x16x32_bf16 v[60:63], a[56:59], a[184:187], v[60:63]
    s_waitcnt vmcnt(18) lgkmcnt(15)
    ds_read_b128 a[28:31], v20 offset:36864
    v_cvt_pk_bf16_f32 v67, v38, v39
    v_mfma_f32_16x16x32_bf16 v[60:63], a[60:63], a[188:191], v[60:63]
    s_barrier
    v_mfma_f32_16x16x32_bf16 v[32:35], a[0:3], a[128:131], v[80:83]
    v_mul_f32 v40, s46, v40
    v_exp_f32 v40, v40
    v_mul_f32 v41, s46, v41
    v_mfma_f32_16x16x32_bf16 v[32:35], a[4:7], a[132:135], v[32:35]
    ds_read_b128 a[32:35], v17 offset:40960
    v_add_f32 v112, v112, v38
    v_mfma_f32_16x16x32_bf16 v[32:35], a[8:11], a[136:139], v[32:35]
    v_exp_f32 v41, v41
    v_mul_f32 v42, s46, v42
    v_mfma_f32_16x16x32_bf16 v[32:35], a[12:15], a[140:143], v[32:35]
    s_waitcnt lgkmcnt(5)
    ds_read_b128 a[36:39], v18 offset:40960
    v_cvt_pk_bf16_f32 v68, v40, v41
    v_mfma_f32_16x16x32_bf16 v[128:131], a[96:99], v[64:67], v[128:131]
    v_exp_f32 v42, v42
    v_mul_f32 v43, s46, v43
    v_mfma_f32_16x16x32_bf16 v[132:135], a[100:103], v[64:67], v[132:135]
    ds_read_b128 a[40:43], v19 offset:40960
    v_add_f32 v112, v112, v39
    v_mfma_f32_16x16x32_bf16 v[136:139], a[104:107], v[64:67], v[136:139]
    v_exp_f32 v43, v43
    v_mul_f32 v44, s46, v44
    v_mfma_f32_16x16x32_bf16 v[140:143], a[108:111], v[64:67], v[140:143]
    ds_read_b128 a[44:47], v20 offset:40960
    v_cvt_pk_bf16_f32 v69, v42, v43
    v_mfma_f32_16x16x32_bf16 v[144:147], a[112:115], v[64:67], v[144:147]
    v_exp_f32 v44, v44
    v_mul_f32 v45, s46, v45
    v_mfma_f32_16x16x32_bf16 v[148:151], a[116:119], v[64:67], v[148:151]
    v_mfma_f32_16x16x32_bf16 v[152:155], a[120:123], v[64:67], v[152:155]
    v_exp_f32 v45, v45
    v_mul_f32 v46, s46, v46
    v_mfma_f32_16x16x32_bf16 v[156:159], a[124:127], v[64:67], v[156:159]
    s_waitcnt lgkmcnt(4)
    ds_read_b64_tr_b16 a[64:65], v8 offset:32768
    v_cvt_pk_bf16_f32 v70, v44, v45
    v_mfma_f32_16x16x32_bf16 v[36:39], a[16:19], a[128:131], v[80:83]
    v_exp_f32 v46, v46
    v_mul_f32 v47, s46, v47
    v_mfma_f32_16x16x32_bf16 v[36:39], a[20:23], a[132:135], v[36:39]
    v_mfma_f32_16x16x32_bf16 v[36:39], a[24:27], a[136:139], v[36:39]
    v_exp_f32 v47, v47
    v_mfma_f32_16x16x32_bf16 v[36:39], a[28:31], a[140:143], v[36:39]
    ds_read_b64_tr_b16 a[66:67], v8 offset:36864
    v_cvt_pk_bf16_f32 v71, v46, v47
    v_mfma_f32_16x16x32_bf16 v[40:43], a[0:3], a[144:147], v[84:87]
    v_mul_f32 v48, s46, v48
    v_exp_f32 v48, v48
    v_mul_f32 v49, s46, v49
    v_mfma_f32_16x16x32_bf16 v[40:43], a[4:7], a[148:151], v[40:43]
    ds_read_b64_tr_b16 a[68:69], v9 offset:32768
    v_add_f32 v113, v113, v48
    v_mfma_f32_16x16x32_bf16 v[40:43], a[8:11], a[152:155], v[40:43]
    v_exp_f32 v49, v49
    v_mul_f32 v50, s46, v50
    v_mfma_f32_16x16x32_bf16 v[40:43], a[12:15], a[156:159], v[40:43]
    v_add_f32 v113, v113, v49
    v_cvt_pk_bf16_f32 v72, v48, v49
    v_mfma_f32_16x16x32_bf16 v[160:163], a[96:99], v[68:71], v[160:163]
    v_exp_f32 v50, v50
    v_mul_f32 v51, s46, v51
    v_mfma_f32_16x16x32_bf16 v[164:167], a[100:103], v[68:71], v[164:167]
    ds_read_b64_tr_b16 a[70:71], v9 offset:36864
    v_add_f32 v113, v113, v50
    v_mfma_f32_16x16x32_bf16 v[168:171], a[104:107], v[68:71], v[168:171]
    v_exp_f32 v51, v51
    v_mul_f32 v52, s46, v52
    v_mfma_f32_16x16x32_bf16 v[172:175], a[108:111], v[68:71], v[172:175]
    ds_read_b64_tr_b16 a[72:73], v10 offset:32768
    v_cvt_pk_bf16_f32 v73, v50, v51
    v_mfma_f32_16x16x32_bf16 v[176:179], a[112:115], v[68:71], v[176:179]
    v_exp_f32 v52, v52
    v_mul_f32 v53, s46, v53
    v_mfma_f32_16x16x32_bf16 v[180:183], a[116:119], v[68:71], v[180:183]
    ds_read_b64_tr_b16 a[74:75], v10 offset:36864
    v_add_f32 v113, v113, v51
    v_mfma_f32_16x16x32_bf16 v[184:187], a[120:123], v[68:71], v[184:187]
    v_exp_f32 v53, v53
    v_mul_f32 v54, s46, v54
    v_mfma_f32_16x16x32_bf16 v[188:191], a[124:127], v[68:71], v[188:191]
    v_add_f32 v113, v113, v52
    v_cvt_pk_bf16_f32 v74, v52, v53
    v_mfma_f32_16x16x32_bf16 v[96:99], v[104:107], v[68:71], v[96:99]
    v_exp_f32 v54, v54
    v_mul_f32 v55, s46, v55
    v_mfma_f32_16x16x32_bf16 v[44:47], a[16:19], a[144:147], v[84:87]
    ds_read_b64_tr_b16 a[76:77], v11 offset:32768
    v_add_f32 v113, v113, v53
    v_mfma_f32_16x16x32_bf16 v[44:47], a[20:23], a[148:151], v[44:47]
    v_exp_f32 v55, v55
    v_mfma_f32_16x16x32_bf16 v[44:47], a[24:27], a[152:155], v[44:47]
    ds_read_b64_tr_b16 a[78:79], v11 offset:36864
    v_cvt_pk_bf16_f32 v75, v54, v55
    v_mfma_f32_16x16x32_bf16 v[44:47], a[28:31], a[156:159], v[44:47]
    global_load_dword v31, v110, s[80:81]
    v_mfma_f32_16x16x32_bf16 v[48:51], a[0:3], a[160:163], v[88:91]
    v_mul_f32 v56, s46, v56
    v_exp_f32 v56, v56
    v_mul_f32 v57, s46, v57
    v_mfma_f32_16x16x32_bf16 v[48:51], a[4:7], a[164:167], v[48:51]
    ds_read_b64_tr_b16 a[80:81], v12 offset:32768
    v_add_f32 v113, v113, v54
    v_lshl_add_u32 v30, v0, 24, s35
    v_mfma_f32_16x16x32_bf16 v[48:51], a[8:11], a[168:171], v[48:51]
    v_exp_f32 v57, v57
    v_mul_f32 v58, s46, v58
    v_mfma_f32_16x16x32_bf16 v[48:51], a[12:15], a[172:175], v[48:51]
    ds_read_b64_tr_b16 a[82:83], v12 offset:36864
    v_cvt_pk_bf16_f32 v76, v56, v57
    v_mfma_f32_16x16x32_bf16 v[192:195], a[96:99], v[72:75], v[192:195]
    v_exp_f32 v58, v58
    v_mul_f32 v59, s46, v59
    v_mfma_f32_16x16x32_bf16 v[196:199], a[100:103], v[72:75], v[196:199]
    ds_read_b64_tr_b16 a[84:85], v13 offset:32768
    v_add_f32 v113, v113, v55
    v_lshlrev_b32 v1, 4, v0
    v_mfma_f32_16x16x32_bf16 v[200:203], a[104:107], v[72:75], v[200:203]
    v_exp_f32 v59, v59
    v_mul_f32 v60, s46, v60
    v_mfma_f32_16x16x32_bf16 v[204:207], a[108:111], v[72:75], v[204:207]
    ds_read_b64_tr_b16 a[86:87], v13 offset:36864
    v_cvt_pk_bf16_f32 v77, v58, v59
    v_mfma_f32_16x16x32_bf16 v[208:211], a[112:115], v[72:75], v[208:211]
    s_add_u32 m0, s29, 122880
    v_exp_f32 v60, v60
    v_mul_f32 v61, s46, v61
    v_mfma_f32_16x16x32_bf16 v[212:215], a[116:119], v[72:75], v[212:215]
    buffer_load_dwordx4 v27, s[8:11], s51 offen nt lds
    v_mfma_f32_16x16x32_bf16 v[216:219], a[120:123], v[72:75], v[216:219]
    v_exp_f32 v61, v61
    v_mul_f32 v62, s46, v62
    v_mfma_f32_16x16x32_bf16 v[220:223], a[124:127], v[72:75], v[220:223]
    ds_read_b64_tr_b16 a[88:89], v14 offset:32768
    v_cvt_pk_bf16_f32 v78, v60, v61
    v_mfma_f32_16x16x32_bf16 v[52:55], a[16:19], a[160:163], v[88:91]
    s_add_u32 s26, s26, 8192
    v_exp_f32 v62, v62
    v_mul_f32 v63, s46, v63
    v_mfma_f32_16x16x32_bf16 v[52:55], a[20:23], a[164:167], v[52:55]
    buffer_load_dwordx4 v28, s[8:11], s51 offen offset:1024 nt lds
    v_add_u32 v2, s101, v1
    v_mfma_f32_16x16x32_bf16 v[52:55], a[24:27], a[168:171], v[52:55]
    s_xor_b32 s51, s26, s49
    v_exp_f32 v63, v63
    v_mfma_f32_16x16x32_bf16 v[52:55], a[28:31], a[172:175], v[52:55]
    ds_read_b64_tr_b16 a[90:91], v14 offset:36864
    v_cvt_pk_bf16_f32 v79, v62, v63
    v_mfma_f32_16x16x32_bf16 v[56:59], a[0:3], a[176:179], v[92:95]
    v_mul_f32 v32, s46, v32
    v_exp_f32 v32, v32
    v_mul_f32 v33, s46, v33
    v_mfma_f32_16x16x32_bf16 v[56:59], a[4:7], a[180:183], v[56:59]
    ds_read_b64_tr_b16 a[92:93], v15 offset:32768
    v_add_f32 v112, v112, v32
    v_mfma_f32_16x16x32_bf16 v[56:59], a[8:11], a[184:187], v[56:59]
    s_and_b32 s40, s37, 1
    v_exp_f32 v33, v33
    v_mul_f32 v34, s46, v34
    v_mfma_f32_16x16x32_bf16 v[56:59], a[12:15], a[188:191], v[56:59]
    v_add_f32 v112, v112, v33
    v_cvt_pk_bf16_f32 v64, v32, v33
    v_mfma_f32_16x16x32_bf16 v[224:227], a[96:99], v[76:79], v[224:227]
    s_cselect_b32 s40, 1073741824, s100
    v_exp_f32 v34, v34
    v_mul_f32 v35, s46, v35
    v_mfma_f32_16x16x32_bf16 v[228:231], a[100:103], v[76:79], v[228:231]
    ds_read_b64_tr_b16 a[94:95], v15 offset:36864
    v_add_f32 v112, v112, v34
    v_mfma_f32_16x16x32_bf16 v[232:235], a[104:107], v[76:79], v[232:235]
    s_or_b32 s37, s37, 1
    v_exp_f32 v35, v35
    v_mul_f32 v36, s46, v36
    v_mfma_f32_16x16x32_bf16 v[236:239], a[108:111], v[76:79], v[236:239]
    ds_read_b128 a[48:51], v17 offset:45056
    v_cvt_pk_bf16_f32 v65, v34, v35
    v_mfma_f32_16x16x32_bf16 v[240:243], a[112:115], v[76:79], v[240:243]
    v_exp_f32 v36, v36
    v_mul_f32 v37, s46, v37
    v_lshl_add_u32 v118, v0, 24, s40
    v_mfma_f32_16x16x32_bf16 v[244:247], a[116:119], v[76:79], v[244:247]
    ds_read_b128 a[52:55], v18 offset:45056
    v_add_f32 v112, v112, v35
    v_mov_b32 v119, 1
    v_mfma_f32_16x16x32_bf16 v[248:251], a[120:123], v[76:79], v[248:251]
    v_exp_f32 v37, v37
    v_mul_f32 v38, s46, v38
    v_mfma_f32_16x16x32_bf16 v[252:255], a[124:127], v[76:79], v[252:255]
    v_add_f32 v112, v112, v36
    v_cvt_pk_bf16_f32 v66, v36, v37
    v_mfma_f32_16x16x32_bf16 v[100:103], v[104:107], v[76:79], v[100:103]
    v_exp_f32 v38, v38
    v_mul_f32 v39, s46, v39
    v_mfma_f32_16x16x32_bf16 v[60:63], a[16:19], a[176:179], v[92:95]
    ds_read_b128 a[56:59], v19 offset:45056
    v_add_f32 v112, v112, v37
    v_mfma_f32_16x16x32_bf16 v[60:63], a[20:23], a[180:183], v[60:63]
    v_exp_f32 v39, v39
    v_mfma_f32_16x16x32_bf16 v[60:63], a[24:27], a[184:187], v[60:63]
    s_waitcnt vmcnt(3) lgkmcnt(15)
    ds_read_b128 a[60:63], v20 offset:45056
    v_cvt_pk_bf16_f32 v67, v38, v39
    v_mfma_f32_16x16x32_bf16 v[60:63], a[28:31], a[188:191], v[60:63]
    s_barrier
    v_mfma_f32_16x16x32_bf16 v[32:35], a[32:35], a[128:131], v[80:83]
    buffer_atomic_add v119, v118, s[96:99], 0 offen offset:0
    v_mul_f32 v40, s46, v40
    v_exp_f32 v40, v40
    v_mul_f32 v41, s46, v41
    v_mfma_f32_16x16x32_bf16 v[32:35], a[36:39], a[132:135], v[32:35]
    s_bfe_u32 s3, s60, 0x30000
    ds_read_b128 a[0:3], v17 offset:49152
    v_add_f32 v112, v112, v38
    v_mfma_f32_16x16x32_bf16 v[32:35], a[40:43], a[136:139], v[32:35]
    s_mul_i32 s3, s3, 524288
    v_exp_f32 v41, v41
    v_mul_f32 v42, s46, v42
    v_mfma_f32_16x16x32_bf16 v[32:35], a[44:47], a[140:143], v[32:35]
    s_waitcnt lgkmcnt(5)
    ds_read_b128 a[4:7], v18 offset:49152
    v_cvt_pk_bf16_f32 v68, v40, v41
    v_mfma_f32_16x16x32_bf16 v[128:131], a[64:67], v[64:67], v[128:131]
    s_add_u32 s3, s3, 0
    v_exp_f32 v42, v42
    v_mul_f32 v43, s46, v43
    v_mfma_f32_16x16x32_bf16 v[132:135], a[68:71], v[64:67], v[132:135]
    s_add_u32 s59, s3, s53
    ds_read_b128 a[8:11], v19 offset:49152
    v_add_f32 v112, v112, v39
    v_mfma_f32_16x16x32_bf16 v[136:139], a[72:75], v[64:67], v[136:139]
    s_add_u32 s25, s59, 16384
    v_exp_f32 v43, v43
    v_mul_f32 v44, s46, v44
    v_mfma_f32_16x16x32_bf16 v[140:143], a[76:79], v[64:67], v[140:143]
    ds_read_b128 a[12:15], v20 offset:49152
    v_cvt_pk_bf16_f32 v69, v42, v43
    v_mfma_f32_16x16x32_bf16 v[144:147], a[80:83], v[64:67], v[144:147]
    s_add_u32 m0, s31, 0
    v_exp_f32 v44, v44
    v_mul_f32 v45, s46, v45
    v_mfma_f32_16x16x32_bf16 v[148:151], a[84:87], v[64:67], v[148:151]
    buffer_load_dwordx4 v21, s[92:95], s59 offen offset:0 lds
    v_mfma_f32_16x16x32_bf16 v[152:155], a[88:91], v[64:67], v[152:155]
    v_exp_f32 v45, v45
    v_mul_f32 v46, s46, v46
    v_mfma_f32_16x16x32_bf16 v[156:159], a[92:95], v[64:67], v[156:159]
    s_waitcnt lgkmcnt(4)
    ds_read_b64_tr_b16 a[96:97], v8 offset:40960
    v_cvt_pk_bf16_f32 v70, v44, v45
    v_mfma_f32_16x16x32_bf16 v[36:39], a[48:51], a[128:131], v[80:83]
    v_exp_f32 v46, v46
    v_mul_f32 v47, s46, v47
    v_mfma_f32_16x16x32_bf16 v[36:39], a[52:55], a[132:135], v[36:39]
    buffer_load_dwordx4 v22, s[92:95], s59 offen offset:1024 lds
    v_mfma_f32_16x16x32_bf16 v[36:39], a[56:59], a[136:139], v[36:39]
    v_exp_f32 v47, v47
    v_mfma_f32_16x16x32_bf16 v[36:39], a[60:63], a[140:143], v[36:39]
    ds_read_b64_tr_b16 a[98:99], v8 offset:45056
    v_cvt_pk_bf16_f32 v71, v46, v47
    v_mfma_f32_16x16x32_bf16 v[40:43], a[32:35], a[144:147], v[84:87]
    v_mul_f32 v48, s46, v48
    v_exp_f32 v48, v48
    v_mul_f32 v49, s46, v49
    v_mfma_f32_16x16x32_bf16 v[40:43], a[36:39], a[148:151], v[40:43]
    ds_read_b64_tr_b16 a[100:101], v9 offset:40960
    v_add_f32 v113, v113, v48
    v_mfma_f32_16x16x32_bf16 v[40:43], a[40:43], a[152:155], v[40:43]
    v_exp_f32 v49, v49
    v_mul_f32 v50, s46, v50
    v_mfma_f32_16x16x32_bf16 v[40:43], a[44:47], a[156:159], v[40:43]
    buffer_load_dwordx4 v23, s[92:95], s59 offen offset:2048 lds
    v_add_f32 v113, v113, v49
    v_cvt_pk_bf16_f32 v72, v48, v49
    v_mfma_f32_16x16x32_bf16 v[160:163], a[64:67], v[68:71], v[160:163]
    v_exp_f32 v50, v50
    v_mul_f32 v51, s46, v51
    v_mfma_f32_16x16x32_bf16 v[164:167], a[68:71], v[68:71], v[164:167]
    ds_read_b64_tr_b16 a[102:103], v9 offset:45056
    v_add_f32 v113, v113, v50
    v_mfma_f32_16x16x32_bf16 v[168:171], a[72:75], v[68:71], v[168:171]
    s_mov_b32 s22, 15728640
    v_exp_f32 v51, v51
    v_mul_f32 v52, s46, v52
    v_mfma_f32_16x16x32_bf16 v[172:175], a[76:79], v[68:71], v[172:175]
    ds_read_b64_tr_b16 a[104:105], v10 offset:40960
    v_cvt_pk_bf16_f32 v73, v50, v51
    v_mfma_f32_16x16x32_bf16 v[176:179], a[80:83], v[68:71], v[176:179]
    v_exp_f32 v52, v52
    v_mul_f32 v53, s46, v53
    v_mfma_f32_16x16x32_bf16 v[180:183], a[84:87], v[68:71], v[180:183]
    ds_read_b64_tr_b16 a[106:107], v10 offset:45056
    v_add_f32 v113, v113, v51
    v_mfma_f32_16x16x32_bf16 v[184:187], a[88:91], v[68:71], v[184:187]
    v_exp_f32 v53, v53
    v_mul_f32 v54, s46, v54
    v_mfma_f32_16x16x32_bf16 v[188:191], a[92:95], v[68:71], v[188:191]
    buffer_load_dwordx4 v24, s[92:95], s59 offen offset:3072 lds
    v_add_f32 v113, v113, v52
    v_cvt_pk_bf16_f32 v74, v52, v53
    v_mfma_f32_16x16x32_bf16 v[96:99], v[104:107], v[68:71], v[96:99]
    v_exp_f32 v54, v54
    v_mul_f32 v55, s46, v55
    v_mfma_f32_16x16x32_bf16 v[44:47], a[48:51], a[144:147], v[84:87]
    ds_read_b64_tr_b16 a[108:109], v11 offset:40960
    v_add_f32 v113, v113, v53
    v_mfma_f32_16x16x32_bf16 v[44:47], a[52:55], a[148:151], v[44:47]
    v_exp_f32 v55, v55
    v_mfma_f32_16x16x32_bf16 v[44:47], a[56:59], a[152:155], v[44:47]
    ds_read_b64_tr_b16 a[110:111], v11 offset:45056
    v_cvt_pk_bf16_f32 v75, v54, v55
    v_mfma_f32_16x16x32_bf16 v[44:47], a[60:63], a[156:159], v[44:47]
    v_add_f32 v113, v113, v54
    v_add_f32 v113, v113, v55
    v_mfma_f32_16x16x32_bf16 v[48:51], a[32:35], a[160:163], v[88:91]
    v_mul_f32 v56, s46, v56
    v_exp_f32 v56, v56
    v_mul_f32 v57, s46, v57
    v_mfma_f32_16x16x32_bf16 v[48:51], a[36:39], a[164:167], v[48:51]
    ds_read_b64_tr_b16 a[112:113], v12 offset:40960
    v_mfma_f32_16x16x32_bf16 v[48:51], a[40:43], a[168:171], v[48:51]
    v_exp_f32 v57, v57
    v_mul_f32 v58, s46, v58
    v_mfma_f32_16x16x32_bf16 v[48:51], a[44:47], a[172:175], v[48:51]
    ds_read_b64_tr_b16 a[114:115], v12 offset:45056
    v_cvt_pk_bf16_f32 v76, v56, v57
    v_mfma_f32_16x16x32_bf16 v[192:195], a[64:67], v[72:75], v[192:195]
    v_exp_f32 v58, v58
    v_mul_f32 v59, s46, v59
    v_mfma_f32_16x16x32_bf16 v[196:199], a[68:71], v[72:75], v[196:199]
    ds_read_b64_tr_b16 a[116:117], v13 offset:40960
    v_mfma_f32_16x16x32_bf16 v[200:203], a[72:75], v[72:75], v[200:203]
    v_exp_f32 v59, v59
    v_mul_f32 v60, s46, v60
    v_mfma_f32_16x16x32_bf16 v[204:207], a[76:79], v[72:75], v[204:207]
    ds_read_b64_tr_b16 a[118:119], v13 offset:45056
    v_cvt_pk_bf16_f32 v77, v58, v59
    v_mfma_f32_16x16x32_bf16 v[208:211], a[80:83], v[72:75], v[208:211]
    s_add_u32 m0, s31, 4096
    v_exp_f32 v60, v60
    v_mul_f32 v61, s46, v61
    v_mfma_f32_16x16x32_bf16 v[212:215], a[84:87], v[72:75], v[212:215]
    buffer_load_dwordx4 v21, s[92:95], s25 offen offset:0 lds
    v_mfma_f32_16x16x32_bf16 v[216:219], a[88:91], v[72:75], v[216:219]
    v_exp_f32 v61, v61
    v_mul_f32 v62, s46, v62
    v_mfma_f32_16x16x32_bf16 v[220:223], a[92:95], v[72:75], v[220:223]
    ds_read_b64_tr_b16 a[120:121], v14 offset:40960
    v_cvt_pk_bf16_f32 v78, v60, v61
    v_mfma_f32_16x16x32_bf16 v[52:55], a[48:51], a[160:163], v[88:91]
    v_exp_f32 v62, v62
    v_mul_f32 v63, s46, v63
    v_mfma_f32_16x16x32_bf16 v[52:55], a[52:55], a[164:167], v[52:55]
    buffer_load_dwordx4 v22, s[92:95], s25 offen offset:1024 lds
    v_mfma_f32_16x16x32_bf16 v[52:55], a[56:59], a[168:171], v[52:55]
    v_exp_f32 v63, v63
    v_mfma_f32_16x16x32_bf16 v[52:55], a[60:63], a[172:175], v[52:55]
    ds_read_b64_tr_b16 a[122:123], v14 offset:45056
    v_cvt_pk_bf16_f32 v79, v62, v63
    v_mfma_f32_16x16x32_bf16 v[56:59], a[32:35], a[176:179], v[92:95]
    v_mul_f32 v32, s46, v32
    v_exp_f32 v32, v32
    v_mul_f32 v33, s46, v33
    v_mfma_f32_16x16x32_bf16 v[56:59], a[36:39], a[180:183], v[56:59]
    ds_read_b64_tr_b16 a[124:125], v15 offset:40960
    v_add_f32 v112, v112, v32
    v_mfma_f32_16x16x32_bf16 v[56:59], a[40:43], a[184:187], v[56:59]
    v_exp_f32 v33, v33
    v_mul_f32 v34, s46, v34
    v_mfma_f32_16x16x32_bf16 v[56:59], a[44:47], a[188:191], v[56:59]
    buffer_load_dwordx4 v23, s[92:95], s25 offen offset:2048 lds
    v_add_f32 v112, v112, v33
    v_cvt_pk_bf16_f32 v64, v32, v33
    v_mfma_f32_16x16x32_bf16 v[224:227], a[64:67], v[76:79], v[224:227]
    v_exp_f32 v34, v34
    v_mul_f32 v35, s46, v35
    v_mfma_f32_16x16x32_bf16 v[228:231], a[68:71], v[76:79], v[228:231]
    ds_read_b64_tr_b16 a[126:127], v15 offset:45056
    v_add_f32 v112, v112, v34
    v_mfma_f32_16x16x32_bf16 v[232:235], a[72:75], v[76:79], v[232:235]
    v_exp_f32 v35, v35
    v_mul_f32 v36, s46, v36
    v_mfma_f32_16x16x32_bf16 v[236:239], a[76:79], v[76:79], v[236:239]
    ds_read_b128 a[16:19], v17 offset:53248
    v_cvt_pk_bf16_f32 v65, v34, v35
    v_mfma_f32_16x16x32_bf16 v[240:243], a[80:83], v[76:79], v[240:243]
    v_exp_f32 v36, v36
    v_mul_f32 v37, s46, v37
    v_mfma_f32_16x16x32_bf16 v[244:247], a[84:87], v[76:79], v[244:247]
    ds_read_b128 a[20:23], v18 offset:53248
    v_add_f32 v112, v112, v35
    v_mfma_f32_16x16x32_bf16 v[248:251], a[88:91], v[76:79], v[248:251]
    v_exp_f32 v37, v37
    v_mul_f32 v38, s46, v38
    v_mfma_f32_16x16x32_bf16 v[252:255], a[92:95], v[76:79], v[252:255]
    buffer_load_dwordx4 v24, s[92:95], s25 offen offset:3072 lds
    v_add_f32 v112, v112, v36
    v_cvt_pk_bf16_f32 v66, v36, v37
    v_mfma_f32_16x16x32_bf16 v[100:103], v[104:107], v[76:79], v[100:103]
    v_exp_f32 v38, v38
    v_mul_f32 v39, s46, v39
    v_mfma_f32_16x16x32_bf16 v[60:63], a[48:51], a[176:179], v[92:95]
    ds_read_b128 a[24:27], v19 offset:53248
    v_add_f32 v112, v112, v37
    v_mfma_f32_16x16x32_bf16 v[60:63], a[52:55], a[180:183], v[60:63]
    v_exp_f32 v39, v39
    v_mfma_f32_16x16x32_bf16 v[60:63], a[56:59], a[184:187], v[60:63]
    s_waitcnt vmcnt(13) lgkmcnt(15)
    ds_read_b128 a[28:31], v20 offset:53248
    v_cvt_pk_bf16_f32 v67, v38, v39
    v_mfma_f32_16x16x32_bf16 v[60:63], a[60:63], a[188:191], v[60:63]
    s_barrier
    v_mfma_f32_16x16x32_bf16 v[32:35], a[0:3], a[128:131], v[80:83]
    v_mul_f32 v40, s46, v40
    v_exp_f32 v40, v40
    v_mul_f32 v41, s46, v41
    v_mfma_f32_16x16x32_bf16 v[32:35], a[4:7], a[132:135], v[32:35]
    s_bfe_u32 s3, s60, 0x30003
    ds_read_b128 a[32:35], v17 offset:57344
    v_add_f32 v112, v112, v38
    v_mfma_f32_16x16x32_bf16 v[32:35], a[8:11], a[136:139], v[32:35]
    s_mul_i32 s3, s3, 524288
    buffer_load_dword v16, v30, s[96:99], 0 offen offset:0 sc1
    v_exp_f32 v41, v41
    v_mul_f32 v42, s46, v42
    v_mfma_f32_16x16x32_bf16 v[32:35], a[12:15], a[140:143], v[32:35]
    s_waitcnt lgkmcnt(5)
    ds_read_b128 a[36:39], v18 offset:57344
    v_cvt_pk_bf16_f32 v68, v40, v41
    v_mfma_f32_16x16x32_bf16 v[128:131], a[96:99], v[64:67], v[128:131]
    s_add_u32 s3, s3, 0
    v_exp_f32 v42, v42
    v_mul_f32 v43, s46, v43
    v_mfma_f32_16x16x32_bf16 v[132:135], a[100:103], v[64:67], v[132:135]
    s_add_u32 s59, s3, s53
    ds_read_b128 a[40:43], v19 offset:57344
    v_add_f32 v112, v112, v39
    v_mfma_f32_16x16x32_bf16 v[136:139], a[104:107], v[64:67], v[136:139]
    s_add_u32 s25, s59, 16384
    v_exp_f32 v43, v43
    v_mul_f32 v44, s46, v44
    v_mfma_f32_16x16x32_bf16 v[140:143], a[108:111], v[64:67], v[140:143]
    ds_read_b128 a[44:47], v20 offset:57344
    v_cvt_pk_bf16_f32 v69, v42, v43
    v_mfma_f32_16x16x32_bf16 v[144:147], a[112:115], v[64:67], v[144:147]
    s_add_u32 m0, s31, 65536
    v_exp_f32 v44, v44
    v_mul_f32 v45, s46, v45
    v_mfma_f32_16x16x32_bf16 v[148:151], a[116:119], v[64:67], v[148:151]
    buffer_load_dwordx4 v21, s[92:95], s59 offen offset:0 lds
    v_mfma_f32_16x16x32_bf16 v[152:155], a[120:123], v[64:67], v[152:155]
    v_exp_f32 v45, v45
    v_mul_f32 v46, s46, v46
    v_mfma_f32_16x16x32_bf16 v[156:159], a[124:127], v[64:67], v[156:159]
    s_waitcnt lgkmcnt(4)
    ds_read_b64_tr_b16 a[64:65], v8 offset:49152
    v_cvt_pk_bf16_f32 v70, v44, v45
    v_mfma_f32_16x16x32_bf16 v[36:39], a[16:19], a[128:131], v[80:83]
    v_exp_f32 v46, v46
    v_mul_f32 v47, s46, v47
    v_mfma_f32_16x16x32_bf16 v[36:39], a[20:23], a[132:135], v[36:39]
    buffer_load_dwordx4 v22, s[92:95], s59 offen offset:1024 lds
    v_mfma_f32_16x16x32_bf16 v[36:39], a[24:27], a[136:139], v[36:39]
    v_exp_f32 v47, v47
    v_mfma_f32_16x16x32_bf16 v[36:39], a[28:31], a[140:143], v[36:39]
    ds_read_b64_tr_b16 a[66:67], v8 offset:53248
    v_cvt_pk_bf16_f32 v71, v46, v47
    v_mfma_f32_16x16x32_bf16 v[40:43], a[0:3], a[144:147], v[84:87]
    v_mul_f32 v48, s46, v48
    v_exp_f32 v48, v48
    v_mul_f32 v49, s46, v49
    v_mfma_f32_16x16x32_bf16 v[40:43], a[4:7], a[148:151], v[40:43]
    ds_read_b64_tr_b16 a[68:69], v9 offset:49152
    v_add_f32 v113, v113, v48
    v_mfma_f32_16x16x32_bf16 v[40:43], a[8:11], a[152:155], v[40:43]
    v_exp_f32 v49, v49
    v_mul_f32 v50, s46, v50
    v_mfma_f32_16x16x32_bf16 v[40:43], a[12:15], a[156:159], v[40:43]
    buffer_load_dwordx4 v23, s[92:95], s59 offen offset:2048 lds
    v_add_f32 v113, v113, v49
    v_cvt_pk_bf16_f32 v72, v48, v49
    v_mfma_f32_16x16x32_bf16 v[160:163], a[96:99], v[68:71], v[160:163]
    v_exp_f32 v50, v50
    v_mul_f32 v51, s46, v51
    v_mfma_f32_16x16x32_bf16 v[164:167], a[100:103], v[68:71], v[164:167]
    ds_read_b64_tr_b16 a[70:71], v9 offset:53248
    v_add_f32 v113, v113, v50
    v_mfma_f32_16x16x32_bf16 v[168:171], a[104:107], v[68:71], v[168:171]
    v_exp_f32 v51, v51
    v_mul_f32 v52, s46, v52
    v_mfma_f32_16x16x32_bf16 v[172:175], a[108:111], v[68:71], v[172:175]
    ds_read_b64_tr_b16 a[72:73], v10 offset:49152
    v_cvt_pk_bf16_f32 v73, v50, v51
    v_mfma_f32_16x16x32_bf16 v[176:179], a[112:115], v[68:71], v[176:179]
    v_exp_f32 v52, v52
    v_mul_f32 v53, s46, v53
    v_mfma_f32_16x16x32_bf16 v[180:183], a[116:119], v[68:71], v[180:183]
    ds_read_b64_tr_b16 a[74:75], v10 offset:53248
    v_add_f32 v113, v113, v51
    v_mfma_f32_16x16x32_bf16 v[184:187], a[120:123], v[68:71], v[184:187]
    v_exp_f32 v53, v53
    v_mul_f32 v54, s46, v54
    v_mfma_f32_16x16x32_bf16 v[188:191], a[124:127], v[68:71], v[188:191]
    buffer_load_dwordx4 v24, s[92:95], s59 offen offset:3072 lds
    v_add_f32 v113, v113, v52
    v_cvt_pk_bf16_f32 v74, v52, v53
    v_mfma_f32_16x16x32_bf16 v[96:99], v[104:107], v[68:71], v[96:99]
    v_exp_f32 v54, v54
    v_mul_f32 v55, s46, v55
    v_mfma_f32_16x16x32_bf16 v[44:47], a[16:19], a[144:147], v[84:87]
    ds_read_b64_tr_b16 a[76:77], v11 offset:49152
    v_add_f32 v113, v113, v53
    v_mfma_f32_16x16x32_bf16 v[44:47], a[20:23], a[148:151], v[44:47]
    v_exp_f32 v55, v55
    v_mfma_f32_16x16x32_bf16 v[44:47], a[24:27], a[152:155], v[44:47]
    ds_read_b64_tr_b16 a[78:79], v11 offset:53248
    v_cvt_pk_bf16_f32 v75, v54, v55
    v_mfma_f32_16x16x32_bf16 v[44:47], a[28:31], a[156:159], v[44:47]
    v_add_f32 v113, v113, v54
    v_add_f32 v113, v113, v55
    v_mfma_f32_16x16x32_bf16 v[48:51], a[0:3], a[160:163], v[88:91]
    s_bfe_u32 s3, s60, 0x30000
    v_mul_f32 v56, s46, v56
    v_exp_f32 v56, v56
    v_mul_f32 v57, s46, v57
    v_mfma_f32_16x16x32_bf16 v[48:51], a[4:7], a[164:167], v[48:51]
    s_mul_i32 s3, s3, 1966080
    ds_read_b64_tr_b16 a[80:81], v12 offset:49152
    v_mfma_f32_16x16x32_bf16 v[48:51], a[8:11], a[168:171], v[48:51]
    s_add_u32 s3, s3, 0
    v_exp_f32 v57, v57
    v_mul_f32 v58, s46, v58
    v_mfma_f32_16x16x32_bf16 v[48:51], a[12:15], a[172:175], v[48:51]
    s_add_u32 s58, s3, s52
    ds_read_b64_tr_b16 a[82:83], v12 offset:53248
    v_cvt_pk_bf16_f32 v76, v56, v57
    v_mfma_f32_16x16x32_bf16 v[192:195], a[96:99], v[72:75], v[192:195]
    v_exp_f32 v58, v58
    v_mul_f32 v59, s46, v59
    v_mfma_f32_16x16x32_bf16 v[196:199], a[100:103], v[72:75], v[196:199]
    ds_read_b64_tr_b16 a[84:85], v13 offset:49152
    v_mfma_f32_16x16x32_bf16 v[200:203], a[104:107], v[72:75], v[200:203]
    v_exp_f32 v59, v59
    v_mul_f32 v60, s46, v60
    v_mfma_f32_16x16x32_bf16 v[204:207], a[108:111], v[72:75], v[204:207]
    ds_read_b64_tr_b16 a[86:87], v13 offset:53248
    v_cvt_pk_bf16_f32 v77, v58, v59
    v_mfma_f32_16x16x32_bf16 v[208:211], a[112:115], v[72:75], v[208:211]
    s_add_u32 m0, s31, 69632
    v_exp_f32 v60, v60
    v_mul_f32 v61, s46, v61
    v_mfma_f32_16x16x32_bf16 v[212:215], a[116:119], v[72:75], v[212:215]
    buffer_load_dwordx4 v21, s[92:95], s25 offen offset:0 lds
    v_mfma_f32_16x16x32_bf16 v[216:219], a[120:123], v[72:75], v[216:219]
    v_exp_f32 v61, v61
    v_mul_f32 v62, s46, v62
    v_mfma_f32_16x16x32_bf16 v[220:223], a[124:127], v[72:75], v[220:223]
    ds_read_b64_tr_b16 a[88:89], v14 offset:49152
    v_cvt_pk_bf16_f32 v78, v60, v61
    v_mfma_f32_16x16x32_bf16 v[52:55], a[16:19], a[160:163], v[88:91]
    v_exp_f32 v62, v62
    v_mul_f32 v63, s46, v63
    v_mfma_f32_16x16x32_bf16 v[52:55], a[20:23], a[164:167], v[52:55]
    buffer_load_dwordx4 v22, s[92:95], s25 offen offset:1024 lds
    v_mfma_f32_16x16x32_bf16 v[52:55], a[24:27], a[168:171], v[52:55]
    v_exp_f32 v63, v63
    v_mfma_f32_16x16x32_bf16 v[52:55], a[28:31], a[172:175], v[52:55]
    ds_read_b64_tr_b16 a[90:91], v14 offset:53248
    v_cvt_pk_bf16_f32 v79, v62, v63
    v_mfma_f32_16x16x32_bf16 v[56:59], a[0:3], a[176:179], v[92:95]
    v_mul_f32 v32, s46, v32
    v_exp_f32 v32, v32
    v_mul_f32 v33, s46, v33
    v_mfma_f32_16x16x32_bf16 v[56:59], a[4:7], a[180:183], v[56:59]
    ds_read_b64_tr_b16 a[92:93], v15 offset:49152
    v_add_f32 v112, v112, v32
    v_mfma_f32_16x16x32_bf16 v[56:59], a[8:11], a[184:187], v[56:59]
    v_exp_f32 v33, v33
    v_mul_f32 v34, s46, v34
    v_mfma_f32_16x16x32_bf16 v[56:59], a[12:15], a[188:191], v[56:59]
    buffer_load_dwordx4 v23, s[92:95], s25 offen offset:2048 lds
    v_add_f32 v112, v112, v33
    v_cvt_pk_bf16_f32 v64, v32, v33
    v_mfma_f32_16x16x32_bf16 v[224:227], a[96:99], v[76:79], v[224:227]
    v_exp_f32 v34, v34
    v_mul_f32 v35, s46, v35
    v_mfma_f32_16x16x32_bf16 v[228:231], a[100:103], v[76:79], v[228:231]
    ds_read_b64_tr_b16 a[94:95], v15 offset:53248
    v_add_f32 v112, v112, v34
    v_mfma_f32_16x16x32_bf16 v[232:235], a[104:107], v[76:79], v[232:235]
    v_exp_f32 v35, v35
    v_mul_f32 v36, s46, v36
    v_mfma_f32_16x16x32_bf16 v[236:239], a[108:111], v[76:79], v[236:239]
    ds_read_b128 a[48:51], v17 offset:61440
    v_cvt_pk_bf16_f32 v65, v34, v35
    v_mfma_f32_16x16x32_bf16 v[240:243], a[112:115], v[76:79], v[240:243]
    v_exp_f32 v36, v36
    v_mul_f32 v37, s46, v37
    v_mfma_f32_16x16x32_bf16 v[244:247], a[116:119], v[76:79], v[244:247]
    ds_read_b128 a[52:55], v18 offset:61440
    v_add_f32 v112, v112, v35
    v_mfma_f32_16x16x32_bf16 v[248:251], a[120:123], v[76:79], v[248:251]
    v_exp_f32 v37, v37
    v_mul_f32 v38, s46, v38
    v_mfma_f32_16x16x32_bf16 v[252:255], a[124:127], v[76:79], v[252:255]
    buffer_load_dwordx4 v24, s[92:95], s25 offen offset:3072 lds
    v_add_f32 v112, v112, v36
    v_cvt_pk_bf16_f32 v66, v36, v37
    v_mfma_f32_16x16x32_bf16 v[100:103], v[104:107], v[76:79], v[100:103]
    s_waitcnt vmcnt(8)
    v_exp_f32 v38, v38
    v_mul_f32 v39, s46, v39
    v_readfirstlane_b32 s40, v16
    v_mfma_f32_16x16x32_bf16 v[60:63], a[16:19], a[176:179], v[92:95]
    ds_read_b128 a[56:59], v19 offset:61440
    v_add_f32 v112, v112, v37
    v_mfma_f32_16x16x32_bf16 v[60:63], a[20:23], a[180:183], v[60:63]
    s_cmp_ge_u32 s40, s91
    v_exp_f32 v39, v39
    v_mfma_f32_16x16x32_bf16 v[60:63], a[24:27], a[184:187], v[60:63]
    s_waitcnt vmcnt(17) lgkmcnt(15)
    ds_read_b128 a[60:63], v20 offset:61440
    v_cvt_pk_bf16_f32 v67, v38, v39
    s_cbranch_scc0 L_spin0
L_spin0b:
    v_mfma_f32_16x16x32_bf16 v[60:63], a[28:31], a[188:191], v[60:63]
    s_barrier
    v_mfma_f32_16x16x32_bf16 v[32:35], a[32:35], a[128:131], v[80:83]
    v_mul_f32 v40, s46, v40
    v_exp_f32 v40, v40
    v_mul_f32 v41, s46, v41
    v_mfma_f32_16x16x32_bf16 v[32:35], a[36:39], a[132:135], v[32:35]
    buffer_load_dwordx4 a[192:195], v1, s[20:23], s58 offen offset:0 sc1
    v_add_f32 v112, v112, v38
    v_mfma_f32_16x16x32_bf16 v[32:35], a[40:43], a[136:139], v[32:35]
    v_exp_f32 v41, v41
    v_mul_f32 v42, s46, v42
    v_mfma_f32_16x16x32_bf16 v[32:35], a[44:47], a[140:143], v[32:35]
    s_waitcnt lgkmcnt(4)
    v_cvt_pk_bf16_f32 v68, v40, v41
    v_mfma_f32_16x16x32_bf16 v[128:131], a[64:67], v[64:67], v[128:131]
    v_exp_f32 v42, v42
    v_mul_f32 v43, s46, v43
    v_mfma_f32_16x16x32_bf16 v[132:135], a[68:71], v[64:67], v[132:135]
    buffer_load_dwordx4 a[196:199], v2, s[20:23], s58 offen offset:0 sc1
    v_add_f32 v112, v112, v39
    v_mfma_f32_16x16x32_bf16 v[136:139], a[72:75], v[64:67], v[136:139]
    v_exp_f32 v43, v43
    v_mul_f32 v44, s46, v44
    v_mfma_f32_16x16x32_bf16 v[140:143], a[76:79], v[64:67], v[140:143]
    v_cvt_pk_bf16_f32 v69, v42, v43
    v_mfma_f32_16x16x32_bf16 v[144:147], a[80:83], v[64:67], v[144:147]
    v_exp_f32 v44, v44
    v_mul_f32 v45, s46, v45
    v_mfma_f32_16x16x32_bf16 v[148:151], a[84:87], v[64:67], v[148:151]
    buffer_load_dwordx4 a[200:203], v1, s[20:23], s58 offen offset:1024 sc1
    v_mfma_f32_16x16x32_bf16 v[152:155], a[88:91], v[64:67], v[152:155]
    v_exp_f32 v45, v45
    v_mul_f32 v46, s46, v46
    v_mfma_f32_16x16x32_bf16 v[156:159], a[92:95], v[64:67], v[156:159]
    s_waitcnt lgkmcnt(0)
    ds_read_b64_tr_b16 a[96:97], v8 offset:57344
    v_cvt_pk_bf16_f32 v70, v44, v45
    v_mfma_f32_16x16x32_bf16 v[36:39], a[48:51], a[128:131], v[80:83]
    v_exp_f32 v46, v46
    v_mul_f32 v47, s46, v47
    v_mfma_f32_16x16x32_bf16 v[36:39], a[52:55], a[132:135], v[36:39]
    buffer_load_dwordx4 a[204:207], v2, s[20:23], s58 offen offset:1024 sc1
    v_mfma_f32_16x16x32_bf16 v[36:39], a[56:59], a[136:139], v[36:39]
    v_exp_f32 v47, v47
    v_mfma_f32_16x16x32_bf16 v[36:39], a[60:63], a[140:143], v[36:39]
    ds_read_b64_tr_b16 a[98:99], v8 offset:61440
    v_cvt_pk_bf16_f32 v71, v46, v47
    v_mfma_f32_16x16x32_bf16 v[40:43], a[32:35], a[144:147], v[84:87]
    v_mul_f32 v48, s46, v48
    v_exp_f32 v48, v48
    v_mul_f32 v49, s46, v49
    v_mfma_f32_16x16x32_bf16 v[40:43], a[36:39], a[148:151], v[40:43]
    ds_read_b64_tr_b16 a[100:101], v9 offset:57344
    v_add_f32 v113, v113, v48
    v_mfma_f32_16x16x32_bf16 v[40:43], a[40:43], a[152:155], v[40:43]
    buffer_load_dwordx4 a[208:211], v1, s[20:23], s58 offen offset:2048 sc1
    v_exp_f32 v49, v49
    v_mul_f32 v50, s46, v50
    v_mfma_f32_16x16x32_bf16 v[40:43], a[44:47], a[156:159], v[40:43]
    v_add_f32 v113, v113, v49
    v_cvt_pk_bf16_f32 v72, v48, v49
    v_mfma_f32_16x16x32_bf16 v[160:163], a[64:67], v[68:71], v[160:163]
    v_exp_f32 v50, v50
    v_mul_f32 v51, s46, v51
    v_mfma_f32_16x16x32_bf16 v[164:167], a[68:71], v[68:71], v[164:167]
    ds_read_b64_tr_b16 a[102:103], v9 offset:61440
    v_add_f32 v113, v113, v50
    v_mfma_f32_16x16x32_bf16 v[168:171], a[72:75], v[68:71], v[168:171]
    buffer_load_dwordx4 a[212:215], v2, s[20:23], s58 offen offset:2048 sc1
    v_exp_f32 v51, v51
    v_mul_f32 v52, s46, v52
    v_mfma_f32_16x16x32_bf16 v[172:175], a[76:79], v[68:71], v[172:175]
    s_bfe_u32 s3, s60, 0x30003
    ds_read_b64_tr_b16 a[104:105], v10 offset:57344
    v_cvt_pk_bf16_f32 v73, v50, v51
    v_mfma_f32_16x16x32_bf16 v[176:179], a[80:83], v[68:71], v[176:179]
    s_mul_i32 s3, s3, 1966080
    v_exp_f32 v52, v52
    v_mul_f32 v53, s46, v53
    v_mfma_f32_16x16x32_bf16 v[180:183], a[84:87], v[68:71], v[180:183]
    s_add_u32 s3, s3, 0
    ds_read_b64_tr_b16 a[106:107], v10 offset:61440
    v_add_f32 v113, v113, v51
    v_mfma_f32_16x16x32_bf16 v[184:187], a[88:91], v[68:71], v[184:187]
    buffer_load_dwordx4 a[216:219], v1, s[20:23], s58 offen offset:3072 sc1
    v_exp_f32 v53, v53
    v_mul_f32 v54, s46, v54
    v_mfma_f32_16x16x32_bf16 v[188:191], a[92:95], v[68:71], v[188:191]
    v_add_f32 v113, v113, v52
    v_cvt_pk_bf16_f32 v74, v52, v53
    v_mfma_f32_16x16x32_bf16 v[96:99], v[104:107], v[68:71], v[96:99]
    buffer_load_dwordx4 a[220:223], v2, s[20:23], s58 offen offset:3072 sc1
    v_exp_f32 v54, v54
    v_mul_f32 v55, s46, v55
    v_mfma_f32_16x16x32_bf16 v[44:47], a[48:51], a[144:147], v[84:87]
    ds_read_b64_tr_b16 a[108:109], v11 offset:57344
    v_add_f32 v113, v113, v53
    v_mfma_f32_16x16x32_bf16 v[44:47], a[52:55], a[148:151], v[44:47]
    s_add_u32 s58, s3, s52
    v_exp_f32 v55, v55
    v_mfma_f32_16x16x32_bf16 v[44:47], a[56:59], a[152:155], v[44:47]
    ds_read_b64_tr_b16 a[110:111], v11 offset:61440
    v_cvt_pk_bf16_f32 v75, v54, v55
    v_mfma_f32_16x16x32_bf16 v[44:47], a[60:63], a[156:159], v[44:47]
    v_add_f32 v113, v113, v54
    v_add_f32 v113, v113, v55
    v_mfma_f32_16x16x32_bf16 v[48:51], a[32:35], a[160:163], v[88:91]
    v_mul_f32 v56, s46, v56
    v_exp_f32 v56, v56
    v_mul_f32 v57, s46, v57
    v_mfma_f32_16x16x32_bf16 v[48:51], a[36:39], a[164:167], v[48:51]
    ds_read_b64_tr_b16 a[112:113], v12 offset:57344
    v_mfma_f32_16x16x32_bf16 v[48:51], a[40:43], a[168:171], v[48:51]
    buffer_load_dwordx4 a[224:227], v1, s[20:23], s58 offen offset:0 sc1
    v_exp_f32 v57, v57
    v_mul_f32 v58, s46, v58
    v_mfma_f32_16x16x32_bf16 v[48:51], a[44:47], a[172:175], v[48:51]
    ds_read_b64_tr_b16 a[114:115], v12 offset:61440
    v_cvt_pk_bf16_f32 v76, v56, v57
    v_mfma_f32_16x16x32_bf16 v[192:195], a[64:67], v[72:75], v[192:195]
    v_exp_f32 v58, v58
    v_mul_f32 v59, s46, v59
    v_mfma_f32_16x16x32_bf16 v[196:199], a[68:71], v[72:75], v[196:199]
    ds_read_b64_tr_b16 a[116:117], v13 offset:57344
    v_mfma_f32_16x16x32_bf16 v[200:203], a[72:75], v[72:75], v[200:203]
    buffer_load_dwordx4 a[228:231], v2, s[20:23], s58 offen offset:0 sc1
    v_exp_f32 v59, v59
    v_mul_f32 v60, s46, v60
    v_mfma_f32_16x16x32_bf16 v[204:207], a[76:79], v[72:75], v[204:207]
    ds_read_b64_tr_b16 a[118:119], v13 offset:61440
    v_cvt_pk_bf16_f32 v77, v58, v59
    v_mfma_f32_16x16x32_bf16 v[208:211], a[80:83], v[72:75], v[208:211]
    v_exp_f32 v60, v60
    v_mul_f32 v61, s46, v61
    v_mfma_f32_16x16x32_bf16 v[212:215], a[84:87], v[72:75], v[212:215]
    buffer_load_dwordx4 a[232:235], v1, s[20:23], s58 offen offset:1024 sc1
    v_mfma_f32_16x16x32_bf16 v[216:219], a[88:91], v[72:75], v[216:219]
    v_exp_f32 v61, v61
    v_mul_f32 v62, s46, v62
    v_mfma_f32_16x16x32_bf16 v[220:223], a[92:95], v[72:75], v[220:223]
    ds_read_b64_tr_b16 a[120:121], v14 offset:57344
    v_cvt_pk_bf16_f32 v78, v60, v61
    v_mfma_f32_16x16x32_bf16 v[52:55], a[48:51], a[160:163], v[88:91]
    v_exp_f32 v62, v62
    v_mul_f32 v63, s46, v63
    v_mfma_f32_16x16x32_bf16 v[52:55], a[52:55], a[164:167], v[52:55]
    buffer_load_dwordx4 a[236:239], v2, s[20:23], s58 offen offset:1024 sc1
    v_mfma_f32_16x16x32_bf16 v[52:55], a[56:59], a[168:171], v[52:55]
    v_exp_f32 v63, v63
    v_mfma_f32_16x16x32_bf16 v[52:55], a[60:63], a[172:175], v[52:55]
    ds_read_b64_tr_b16 a[122:123], v14 offset:61440
    v_cvt_pk_bf16_f32 v79, v62, v63
    v_mfma_f32_16x16x32_bf16 v[56:59], a[32:35], a[176:179], v[92:95]
    v_mul_f32 v32, s46, v32
    v_exp_f32 v32, v32
    v_mul_f32 v33, s46, v33
    v_mfma_f32_16x16x32_bf16 v[56:59], a[36:39], a[180:183], v[56:59]
    ds_read_b64_tr_b16 a[124:125], v15 offset:57344
    v_add_f32 v112, v112, v32
    v_mfma_f32_16x16x32_bf16 v[56:59], a[40:43], a[184:187], v[56:59]
    v_exp_f32 v33, v33
    v_mul_f32 v34, s46, v34
    v_mfma_f32_16x16x32_bf16 v[56:59], a[44:47], a[188:191], v[56:59]
    buffer_load_dwordx4 a[240:243], v1, s[20:23], s58 offen offset:2048 sc1
    v_add_f32 v112, v112, v33
    v_cvt_pk_bf16_f32 v64, v32, v33
    v_mfma_f32_16x16x32_bf16 v[224:227], a[64:67], v[76:79], v[224:227]
    v_exp_f32 v34, v34
    v_mul_f32 v35, s46, v35
    v_mfma_f32_16x16x32_bf16 v[228:231], a[68:71], v[76:79], v[228:231]
    ds_read_b64_tr_b16 a[126:127], v15 offset:61440
    v_add_f32 v112, v112, v34
    v_mfma_f32_16x16x32_bf16 v[232:235], a[72:75], v[76:79], v[232:235]
    v_exp_f32 v35, v35
    v_mul_f32 v36, s46, v36
    v_mfma_f32_16x16x32_bf16 v[236:239], a[76:79], v[76:79], v[236:239]
    buffer_load_dwordx4 a[244:247], v2, s[20:23], s58 offen offset:2048 sc1
    v_cvt_pk_bf16_f32 v65, v34, v35
    v_mfma_f32_16x16x32_bf16 v[240:243], a[80:83], v[76:79], v[240:243]
    v_exp_f32 v36, v36
    v_mul_f32 v37, s46, v37
    v_mfma_f32_16x16x32_bf16 v[244:247], a[84:87], v[76:79], v[244:247]
    v_add_f32 v112, v112, v35
    v_mfma_f32_16x16x32_bf16 v[248:251], a[88:91], v[76:79], v[248:251]
    v_exp_f32 v37, v37
    v_mul_f32 v38, s46, v38
    v_mfma_f32_16x16x32_bf16 v[252:255], a[92:95], v[76:79], v[252:255]
    buffer_load_dwordx4 a[248:251], v1, s[20:23], s58 offen offset:3072 sc1
    v_add_f32 v112, v112, v36
    v_cvt_pk_bf16_f32 v66, v36, v37
    v_mfma_f32_16x16x32_bf16 v[100:103], v[104:107], v[76:79], v[100:103]
    v_exp_f32 v38, v38
    v_mul_f32 v39, s46, v39
    v_mfma_f32_16x16x32_bf16 v[60:63], a[48:51], a[176:179], v[92:95]
    v_add_f32 v112, v112, v37
    v_mfma_f32_16x16x32_bf16 v[60:63], a[52:55], a[180:183], v[60:63]
    buffer_load_dwordx4 a[252:255], v2, s[20:23], s58 offen offset:3072 sc1
    v_exp_f32 v39, v39
    v_mfma_f32_16x16x32_bf16 v[60:63], a[56:59], a[184:187], v[60:63]
    s_waitcnt lgkmcnt(15)
    v_cvt_pk_bf16_f32 v67, v38, v39
    v_mfma_f32_16x16x32_bf16 v[60:63], a[60:63], a[188:191], v[60:63]
    s_barrier
    s_bfe_u32 s3, s60, 0x30006
    s_mul_i32 s3, s3, 524288
    s_add_u32 s3, s3, 0
    s_add_u32 s59, s3, s53
    s_add_u32 s25, s59, 16384
    s_waitcnt lgkmcnt(0)
    v_mfma_f32_16x16x32_bf16 v[128:131], a[96:99], v[64:67], v[128:131]
    s_add_u32 m0, s31, 32768
    v_add_f32 v112, v112, v38
    v_add_f32 v112, v112, v39
    v_mul_f32 v40, s46, v40
    v_mfma_f32_16x16x32_bf16 v[132:135], a[100:103], v[64:67], v[132:135]
    buffer_load_dwordx4 v21, s[92:95], s59 offen offset:0 lds
    v_exp_f32 v40, v40
    v_mul_f32 v41, s46, v41
    v_mfma_f32_16x16x32_bf16 v[136:139], a[104:107], v[64:67], v[136:139]
    v_exp_f32 v41, v41
    v_mul_f32 v42, s46, v42
    v_exp_f32 v42, v42
    v_mul_f32 v43, s46, v43
    v_mfma_f32_16x16x32_bf16 v[140:143], a[108:111], v[64:67], v[140:143]
    buffer_load_dwordx4 v22, s[92:95], s59 offen offset:1024 lds
    v_cvt_pk_bf16_f32 v68, v40, v41
    v_exp_f32 v43, v43
    v_mfma_f32_16x16x32_bf16 v[144:147], a[112:115], v[64:67], v[144:147]
    v_mul_f32 v44, s46, v44
    v_exp_f32 v44, v44
    v_mul_f32 v45, s46, v45
    v_cvt_pk_bf16_f32 v69, v42, v43
    v_mfma_f32_16x16x32_bf16 v[148:151], a[116:119], v[64:67], v[148:151]
    buffer_load_dwordx4 v23, s[92:95], s59 offen offset:2048 lds
    v_exp_f32 v45, v45
    v_mul_f32 v46, s46, v46
    v_mfma_f32_16x16x32_bf16 v[152:155], a[120:123], v[64:67], v[152:155]
    v_exp_f32 v46, v46
    v_mul_f32 v47, s46, v47
    v_cvt_pk_bf16_f32 v70, v44, v45
    v_mfma_f32_16x16x32_bf16 v[156:159], a[124:127], v[64:67], v[156:159]
    buffer_load_dwordx4 v24, s[92:95], s59 offen offset:3072 lds
    v_exp_f32 v47, v47
    s_nop 0
    v_cvt_pk_bf16_f32 v71, v46, v47
    s_nop 1
    v_mfma_f32_16x16x32_bf16 v[160:163], a[96:99], v[68:71], v[160:163]
    s_add_u32 m0, s31, 36864
    v_mul_f32 v48, s46, v48
    v_exp_f32 v48, v48
    v_mul_f32 v49, s46, v49
    v_mfma_f32_16x16x32_bf16 v[164:167], a[100:103], v[68:71], v[164:167]
    buffer_load_dwordx4 v21, s[92:95], s25 offen offset:0 lds
    v_exp_f32 v49, v49
    v_mul_f32 v50, s46, v50
    v_add_f32 v113, v113, v48
    v_mfma_f32_16x16x32_bf16 v[168:171], a[104:107], v[68:71], v[168:171]
    v_exp_f32 v50, v50
    v_mul_f32 v51, s46, v51
    v_add_f32 v113, v113, v49
    v_cvt_pk_bf16_f32 v72, v48, v49
    v_mfma_f32_16x16x32_bf16 v[172:175], a[108:111], v[68:71], v[172:175]
    buffer_load_dwordx4 v22, s[92:95], s25 offen offset:1024 lds
    v_exp_f32 v51, v51
    v_mul_f32 v52, s46, v52
    v_mfma_f32_16x16x32_bf16 v[176:179], a[112:115], v[68:71], v[176:179]
    v_add_f32 v113, v113, v50
    v_exp_f32 v52, v52
    v_mul_f32 v53, s46, v53
    v_add_f32 v113, v113, v51
    v_mfma_f32_16x16x32_bf16 v[180:183], a[116:119], v[68:71], v[180:183]
    buffer_load_dwordx4 v23, s[92:95], s25 offen offset:2048 lds
    v_cvt_pk_bf16_f32 v73, v50, v51
    v_exp_f32 v53, v53
    v_mfma_f32_16x16x32_bf16 v[184:187], a[120:123], v[68:71], v[184:187]
    v_mul_f32 v54, s46, v54
    v_add_f32 v113, v113, v52
    v_exp_f32 v54, v54
    v_mul_f32 v55, s46, v55
    v_mfma_f32_16x16x32_bf16 v[188:191], a[124:127], v[68:71], v[188:191]
    buffer_load_dwordx4 v24, s[92:95], s25 offen offset:3072 lds
    v_add_f32 v113, v113, v53
    v_cvt_pk_bf16_f32 v74, v52, v53
    v_mfma_f32_16x16x32_bf16 v[96:99], v[104:107], v[68:71], v[96:99]
    s_bfe_u32 s3, s60, 0x30006
    s_mul_i32 s3, s3, 1966080
    s_add_u32 s3, s3, 0
    s_add_u32 s58, s3, s52
    v_exp_f32 v55, v55
    v_add_f32 v113, v113, v54
    v_add_f32 v113, v113, v55
    v_cvt_pk_bf16_f32 v75, v54, v55
    s_nop 1
    v_mfma_f32_16x16x32_bf16 v[192:195], a[96:99], v[72:75], v[192:195]
    buffer_load_dwordx4 a[64:67], v1, s[20:23], s58 offen offset:0 sc1
    v_mul_f32 v56, s46, v56
    v_mfma_f32_16x16x32_bf16 v[196:199], a[100:103], v[72:75], v[196:199]
    v_exp_f32 v56, v56
    v_mul_f32 v57, s46, v57
    v_exp_f32 v57, v57
    v_mfma_f32_16x16x32_bf16 v[200:203], a[104:107], v[72:75], v[200:203]
    buffer_load_dwordx4 a[68:71], v2, s[20:23], s58 offen offset:0 sc1
    v_mul_f32 v58, s46, v58
    v_exp_f32 v58, v58
    v_mfma_f32_16x16x32_bf16 v[204:207], a[108:111], v[72:75], v[204:207]
    v_mul_f32 v59, s46, v59
    v_cvt_pk_bf16_f32 v76, v56, v57
    v_exp_f32 v59, v59
    v_mul_f32 v60, s46, v60
    v_mfma_f32_16x16x32_bf16 v[208:211], a[112:115], v[72:75], v[208:211]
    buffer_load_dwordx4 a[72:75], v1, s[20:23], s58 offen offset:1024 sc1
    v_exp_f32 v60, v60
    v_mul_f32 v61, s46, v61
    v_mfma_f32_16x16x32_bf16 v[212:215], a[116:119], v[72:75], v[212:215]
    v_cvt_pk_bf16_f32 v77, v58, v59
    v_exp_f32 v61, v61
    v_mul_f32 v62, s46, v62
    v_mfma_f32_16x16x32_bf16 v[216:219], a[120:123], v[72:75], v[216:219]
    buffer_load_dwordx4 a[76:79], v2, s[20:23], s58 offen offset:1024 sc1
    v_exp_f32 v62, v62
    v_mul_f32 v63, s46, v63
    v_mfma_f32_16x16x32_bf16 v[220:223], a[124:127], v[72:75], v[220:223]
    v_cvt_pk_bf16_f32 v78, v60, v61
    v_exp_f32 v63, v63
    s_nop 0
    v_cvt_pk_bf16_f32 v79, v62, v63
    s_nop 1
    v_mfma_f32_16x16x32_bf16 v[224:227], a[96:99], v[76:79], v[224:227]
    buffer_load_dwordx4 a[80:83], v1, s[20:23], s58 offen offset:2048 sc1
    v_mov_b32 v114, v112
    v_mfma_f32_16x16x32_bf16 v[228:231], a[100:103], v[76:79], v[228:231]
    s_nop 0
    v_permlane16_swap_b32 v112, v114
    v_add_f32 v112, v112, v114
    v_mov_b32 v114, v112
    v_mfma_f32_16x16x32_bf16 v[232:235], a[104:107], v[76:79], v[232:235]
    buffer_load_dwordx4 a[84:87], v2, s[20:23], s58 offen offset:2048 sc1
    v_permlane32_swap_b32 v112, v114
    v_mfma_f32_16x16x32_bf16 v[236:239], a[108:111], v[76:79], v[236:239]
    v_add_f32 v112, v112, v114
    v_cmp_nge_f32 vcc, s48, v112
    v_rcp_f32 v114, v112
    s_nop 0
    s_or_b32 s47, s47, vcc_lo
    s_or_b32 s47, s47, vcc_hi
    v_mfma_f32_16x16x32_bf16 v[240:243], a[112:115], v[76:79], v[240:243]
    buffer_load_dwordx4 a[88:91], v1, s[20:23], s58 offen offset:3072 sc1
    v_cmp_nge_f32 vcc, s48, v96
    v_mfma_f32_16x16x32_bf16 v[244:247], a[116:119], v[76:79], v[244:247]
    v_rcp_f32 v115, v96
    s_or_b32 s47, s47, vcc_lo
    s_or_b32 s47, s47, vcc_hi
    v_mov_b32 v116, v113
    v_mfma_f32_16x16x32_bf16 v[248:251], a[120:123], v[76:79], v[248:251]
    s_nop 0
    v_permlane16_swap_b32 v113, v116
    v_add_f32 v113, v113, v116
    v_mov_b32 v116, v113
    v_mfma_f32_16x16x32_bf16 v[252:255], a[124:127], v[76:79], v[252:255]
    buffer_load_dwordx4 a[92:95], v2, s[20:23], s58 offen offset:3072 sc1
    v_permlane32_swap_b32 v113, v116
    v_add_f32 v113, v113, v116
    v_mfma_f32_16x16x32_bf16 v[100:103], v[104:107], v[76:79], v[100:103]
    v_cmp_nge_f32 vcc, s48, v113
    v_rcp_f32 v116, v113
    s_nop 0
    s_or_b32 s47, s47, vcc_lo
    s_or_b32 s47, s47, vcc_hi
    s_add_u32 s39, s39, 491520
    s_add_u32 s41, s39, 4096
    s_add_u32 s42, s39, 8192
    s_add_u32 s43, s39, 12288
    s_cmp_eq_u32 s24, 3
    s_cselect_b32 s43, 15728640, s43
    s_bfe_u32 s3, s2, 65536
    s_lshl_b32 s3, s3, 7
    v_xor_b32 v8, s3, v8
    v_xor_b32 v9, s3, v9
    v_xor_b32 v10, s3, v10
    v_xor_b32 v11, s3, v11
    v_xor_b32 v12, s3, v12
    v_xor_b32 v13, s3, v13
    v_xor_b32 v14, s3, v14
    v_xor_b32 v15, s3, v15
    v_cmp_nge_f32 vcc, s48, v100
    v_rcp_f32 v117, v100
    s_nop 0
    s_or_b32 vcc_lo, vcc_lo, vcc_hi
    s_and_b32 vcc_lo, vcc_lo, s28
    s_or_b32 s47, s47, vcc_lo
    s_lshl_b32 s40, s24, 2
    s_add_u32 s40, s40, 131072
    v_mov_b32 v104, s47
    v_mov_b32 v105, s40
    v_mov_b32 v106, 131072
    ds_write_b32 v105, v104
    s_bfe_u32 s3, s60, 0x30009
    s_mul_i32 s3, s3, 1966080
    s_add_u32 s3, s3, 0
    s_add_u32 s58, s3, s52
    v_pk_mul_f32 v[128:129], v[128:129], v[114:115] op_sel_hi:[1,0]
    v_pk_mul_f32 v[130:131], v[130:131], v[114:115] op_sel_hi:[1,0]
    v_pk_mul_f32 v[132:133], v[132:133], v[114:115] op_sel_hi:[1,0]
    v_pk_mul_f32 v[134:135], v[134:135], v[114:115] op_sel_hi:[1,0]
    v_cvt_pk_bf16_f32 v128, v128, v129
    v_cvt_pk_bf16_f32 v129, v130, v131
    v_cvt_pk_bf16_f32 v130, v132, v133
    v_cvt_pk_bf16_f32 v131, v134, v135
    v_pk_mul_f32 v[136:137], v[136:137], v[114:115] op_sel_hi:[1,0]
    v_pk_mul_f32 v[138:139], v[138:139], v[114:115] op_sel_hi:[1,0]
    v_pk_mul_f32 v[140:141], v[140:141], v[114:115] op_sel_hi:[1,0]
    v_pk_mul_f32 v[142:143], v[142:143], v[114:115] op_sel_hi:[1,0]
    v_cvt_pk_bf16_f32 v136, v136, v137
    v_cvt_pk_bf16_f32 v137, v138, v139
    v_cvt_pk_bf16_f32 v138, v140, v141
    v_cvt_pk_bf16_f32 v139, v142, v143
    s_waitcnt lgkmcnt(0)
    s_barrier
    ds_read_b128 v[4:7], v106
    v_pk_mul_f32 v[144:145], v[144:145], v[114:115] op_sel_hi:[1,0]
    v_pk_mul_f32 v[146:147], v[146:147], v[114:115] op_sel_hi:[1,0]
    v_pk_mul_f32 v[148:149], v[148:149], v[114:115] op_sel_hi:[1,0]
    v_pk_mul_f32 v[150:151], v[150:151], v[114:115] op_sel_hi:[1,0]
    v_cvt_pk_bf16_f32 v144, v144, v145
    v_cvt_pk_bf16_f32 v145, v146, v147
    v_cvt_pk_bf16_f32 v146, v148, v149
    v_cvt_pk_bf16_f32 v147, v150, v151
    v_pk_mul_f32 v[152:153], v[152:153], v[114:115] op_sel_hi:[1,0]
    v_pk_mul_f32 v[154:155], v[154:155], v[114:115] op_sel_hi:[1,0]
    v_pk_mul_f32 v[156:157], v[156:157], v[114:115] op_sel_hi:[1,0]
    v_pk_mul_f32 v[158:159], v[158:159], v[114:115] op_sel_hi:[1,0]
    v_cvt_pk_bf16_f32 v152, v152, v153
    v_cvt_pk_bf16_f32 v153, v154, v155
    v_cvt_pk_bf16_f32 v154, v156, v157
    v_cvt_pk_bf16_f32 v155, v158, v159
    v_add_u32 v96, 0xffff0000, v8
    v_add_u32 v97, 0xffff0000, v9
    v_add_u32 v98, 0xffff0000, v10
    v_add_u32 v99, 0xffff0000, v11
    v_add_u32 v100, 0xffff0000, v12
    v_add_u32 v101, 0xffff0000, v13
    v_add_u32 v102, 0xffff0000, v14
    v_add_u32 v103, 0xffff0000, v15
    s_mov_b32 s12, s82
    s_mov_b32 s13, s83
    s_mov_b32 s14, 3932160
    s_mov_b32 s15, 0x20000
    s_lshr_b32 s62, s91, 4
    s_waitcnt lgkmcnt(0)
    v_or3_b32 v4, v4, v5, v6
    v_or_b32 v4, v4, v7
    s_nop 0
    v_readfirstlane_b32 s40, v4
    s_nop 1
    s_cmp_eq_u32 s40, 0
    s_cbranch_scc1 L_oproj
    s_cmp_eq_u32 s38, 0
    s_cbranch_scc0 L_oproj
    s_branch L_restart
L_oproj:
    s_waitcnt vmcnt(24)
    s_barrier
    ds_read_b64_tr_b16 a[128:129], v96 offset:0
    ds_read_b64_tr_b16 a[130:131], v96 offset:4096
    ds_read_b64_tr_b16 a[132:133], v97 offset:0
    ds_read_b64_tr_b16 a[134:135], v97 offset:4096
    ds_read_b64_tr_b16 a[136:137], v98 offset:0
    ds_read_b64_tr_b16 a[138:139], v98 offset:4096
    ds_read_b64_tr_b16 a[140:141], v99 offset:0
    ds_read_b64_tr_b16 a[142:143], v99 offset:4096
    s_waitcnt lgkmcnt(4)
    v_mfma_f32_16x16x32_bf16 v[32:35], a[128:131], a[192:195], 0
    ds_read_b64_tr_b16 a[144:145], v100 offset:0
    ds_read_b64_tr_b16 a[146:147], v100 offset:4096
    v_mul_f32 v160, v115, v160
    v_mul_f32 v161, v115, v161
    v_mfma_f32_16x16x32_bf16 v[48:51], a[128:131], a[196:199], 0
    buffer_store_dwordx4 v[128:131], v29, s[20:23], s39 offen offset:0 sc1
    v_mfma_f32_16x16x32_bf16 v[36:39], a[132:135], a[192:195], 0
    ds_read_b64_tr_b16 a[148:149], v101 offset:0
    v_mul_f32 v162, v115, v162
    v_mul_f32 v163, v115, v163
    v_mfma_f32_16x16x32_bf16 v[52:55], a[132:135], a[196:199], 0
    s_waitcnt lgkmcnt(3)
    ds_read_b64_tr_b16 a[150:151], v101 offset:4096
    v_mul_f32 v164, v115, v164
    v_mul_f32 v165, v115, v165
    v_mul_f32 v166, v115, v166
    v_mfma_f32_16x16x32_bf16 v[40:43], a[136:139], a[192:195], 0
    ds_read_b64_tr_b16 a[152:153], v102 offset:0
    v_mul_f32 v167, v115, v167
    v_cvt_pk_bf16_f32 v160, v160, v161
    v_mfma_f32_16x16x32_bf16 v[56:59], a[136:139], a[196:199], 0
    ds_read_b64_tr_b16 a[154:155], v102 offset:4096
    v_cvt_pk_bf16_f32 v161, v162, v163
    v_cvt_pk_bf16_f32 v162, v164, v165
    v_mfma_f32_16x16x32_bf16 v[44:47], a[140:143], a[192:195], 0
    ds_read_b64_tr_b16 a[156:157], v103 offset:0
    ds_read_b64_tr_b16 a[158:159], v103 offset:4096
    v_cvt_pk_bf16_f32 v163, v166, v167
    buffer_store_dwordx4 v[160:163], v29, s[20:23], s41 offen offset:0 sc1
    v_mfma_f32_16x16x32_bf16 v[60:63], a[140:143], a[196:199], 0
    s_waitcnt lgkmcnt(4)
    buffer_store_dwordx4 v[136:139], v29, s[20:23], s39 offen offset:1024 sc1
    v_mfma_f32_16x16x32_bf16 v[64:67], a[144:147], a[192:195], 0
    ds_read_b64_tr_b16 a[128:129], v96 offset:8192
    v_mul_f32 v168, v115, v168
    v_mul_f32 v169, v115, v169
    v_mfma_f32_16x16x32_bf16 v[80:83], a[144:147], a[196:199], 0
    ds_read_b64_tr_b16 a[130:131], v96 offset:12288
    v_mul_f32 v170, v115, v170
    v_mul_f32 v171, v115, v171
    v_mfma_f32_16x16x32_bf16 v[68:71], a[148:151], a[192:195], 0
    ds_read_b64_tr_b16 a[132:133], v97 offset:8192
    v_mul_f32 v172, v115, v172
    v_mul_f32 v173, v115, v173
    v_mfma_f32_16x16x32_bf16 v[84:87], a[148:151], a[196:199], 0
    s_waitcnt lgkmcnt(3)
    ds_read_b64_tr_b16 a[134:135], v97 offset:12288
    v_mul_f32 v174, v115, v174
    v_mul_f32 v175, v115, v175
    v_mfma_f32_16x16x32_bf16 v[72:75], a[152:155], a[192:195], 0
    ds_read_b64_tr_b16 a[136:137], v98 offset:8192
    ds_read_b64_tr_b16 a[138:139], v98 offset:12288
    v_cvt_pk_bf16_f32 v168, v168, v169
    v_cvt_pk_bf16_f32 v169, v170, v171
    v_mfma_f32_16x16x32_bf16 v[88:91], a[152:155], a[196:199], 0
    buffer_store_dwordx4 v[144:147], v29, s[20:23], s39 offen offset:2048 sc1
    v_mfma_f32_16x16x32_bf16 v[76:79], a[156:159], a[192:195], 0
    ds_read_b64_tr_b16 a[140:141], v99 offset:8192
    v_cvt_pk_bf16_f32 v170, v172, v173
    v_cvt_pk_bf16_f32 v171, v174, v175
    v_mfma_f32_16x16x32_bf16 v[92:95], a[156:159], a[196:199], 0
    s_waitcnt lgkmcnt(3)
    ds_read_b64_tr_b16 a[142:143], v99 offset:12288
    buffer_store_dwordx4 v[168:171], v29, s[20:23], s41 offen offset:1024 sc1
    v_mfma_f32_16x16x32_bf16 v[32:35], a[128:131], a[200:203], v[32:35]
    ds_read_b64_tr_b16 a[144:145], v100 offset:8192
    v_mul_f32 v176, v115, v176
    v_mul_f32 v177, v115, v177
    v_mfma_f32_16x16x32_bf16 v[48:51], a[128:131], a[204:207], v[48:51]
    ds_read_b64_tr_b16 a[146:147], v100 offset:12288
    v_mul_f32 v178, v115, v178
    v_mul_f32 v179, v115, v179
    v_mfma_f32_16x16x32_bf16 v[36:39], a[132:135], a[200:203], v[36:39]
    ds_read_b64_tr_b16 a[148:149], v101 offset:8192
    ds_read_b64_tr_b16 a[150:151], v101 offset:12288
    v_mul_f32 v180, v115, v180
    v_mul_f32 v181, v115, v181
    v_mfma_f32_16x16x32_bf16 v[52:55], a[132:135], a[204:207], v[52:55]
    s_waitcnt lgkmcnt(4)
    buffer_store_dwordx4 v[152:155], v29, s[20:23], s39 offen offset:3072 sc1
    v_mfma_f32_16x16x32_bf16 v[40:43], a[136:139], a[200:203], v[40:43]
    ds_read_b64_tr_b16 a[152:153], v102 offset:8192
    v_mul_f32 v182, v115, v182
    v_mul_f32 v183, v115, v183
    v_mfma_f32_16x16x32_bf16 v[56:59], a[136:139], a[204:207], v[56:59]
    ds_read_b64_tr_b16 a[154:155], v102 offset:12288
    v_cvt_pk_bf16_f32 v176, v176, v177
    v_cvt_pk_bf16_f32 v177, v178, v179
    v_mfma_f32_16x16x32_bf16 v[44:47], a[140:143], a[200:203], v[44:47]
    ds_read_b64_tr_b16 a[156:157], v103 offset:8192
    v_cvt_pk_bf16_f32 v178, v180, v181
    v_cvt_pk_bf16_f32 v179, v182, v183
    v_mfma_f32_16x16x32_bf16 v[60:63], a[140:143], a[204:207], v[60:63]
    s_waitcnt lgkmcnt(3)
    ds_read_b64_tr_b16 a[158:159], v103 offset:12288
    buffer_store_dwordx4 v[176:179], v29, s[20:23], s41 offen offset:2048 sc1
    v_mfma_f32_16x16x32_bf16 v[64:67], a[144:147], a[200:203], v[64:67]
    ds_read_b64_tr_b16 a[128:129], v96 offset:16384
    v_mul_f32 v184, v115, v184
    v_mfma_f32_16x16x32_bf16 v[80:83], a[144:147], a[204:207], v[80:83]
    ds_read_b64_tr_b16 a[130:131], v96 offset:20480
    v_mul_f32 v185, v115, v185
    v_mul_f32 v186, v115, v186
    v_mfma_f32_16x16x32_bf16 v[68:71], a[148:151], a[200:203], v[68:71]
    ds_read_b64_tr_b16 a[132:133], v97 offset:16384
    v_mul_f32 v187, v115, v187
    v_mul_f32 v188, v115, v188
    v_mfma_f32_16x16x32_bf16 v[84:87], a[148:151], a[204:207], v[84:87]
    s_waitcnt lgkmcnt(3)
    ds_read_b64_tr_b16 a[134:135], v97 offset:20480
    v_mul_f32 v189, v115, v189
    v_mul_f32 v190, v115, v190
    v_mfma_f32_16x16x32_bf16 v[72:75], a[152:155], a[200:203], v[72:75]
    ds_read_b64_tr_b16 a[136:137], v98 offset:16384
    v_mul_f32 v191, v115, v191
    v_mfma_f32_16x16x32_bf16 v[88:91], a[152:155], a[204:207], v[88:91]
    ds_read_b64_tr_b16 a[138:139], v98 offset:20480
    v_cvt_pk_bf16_f32 v184, v184, v185
    v_cvt_pk_bf16_f32 v185, v186, v187
    v_mfma_f32_16x16x32_bf16 v[76:79], a[156:159], a[200:203], v[76:79]
    ds_read_b64_tr_b16 a[140:141], v99 offset:16384
    v_cvt_pk_bf16_f32 v186, v188, v189
    v_cvt_pk_bf16_f32 v187, v190, v191
    v_mfma_f32_16x16x32_bf16 v[92:95], a[156:159], a[204:207], v[92:95]
    s_waitcnt lgkmcnt(3)
    ds_read_b64_tr_b16 a[142:143], v99 offset:20480
    buffer_store_dwordx4 v[184:187], v29, s[20:23], s41 offen offset:3072 sc1
    v_mfma_f32_16x16x32_bf16 v[32:35], a[128:131], a[208:211], v[32:35]
    ds_read_b64_tr_b16 a[144:145], v100 offset:16384
    v_mul_f32 v192, v116, v192
    v_mfma_f32_16x16x32_bf16 v[48:51], a[128:131], a[212:215], v[48:51]
    ds_read_b64_tr_b16 a[146:147], v100 offset:20480
    v_mul_f32 v193, v116, v193
    v_mul_f32 v194, v116, v194
    v_mfma_f32_16x16x32_bf16 v[36:39], a[132:135], a[208:211], v[36:39]
    ds_read_b64_tr_b16 a[148:149], v101 offset:16384
    v_mul_f32 v195, v116, v195
    v_mul_f32 v196, v116, v196
    v_mfma_f32_16x16x32_bf16 v[52:55], a[132:135], a[212:215], v[52:55]
    s_waitcnt lgkmcnt(3)
    ds_read_b64_tr_b16 a[150:151], v101 offset:20480
    v_mul_f32 v197, v116, v197
    v_mul_f32 v198, v116, v198
    v_mfma_f32_16x16x32_bf16 v[40:43], a[136:139], a[208:211], v[40:43]
    ds_read_b64_tr_b16 a[152:153], v102 offset:16384
    v_mul_f32 v199, v116, v199
    v_mfma_f32_16x16x32_bf16 v[56:59], a[136:139], a[212:215], v[56:59]
    ds_read_b64_tr_b16 a[154:155], v102 offset:20480
    v_cvt_pk_bf16_f32 v192, v192, v193
    v_cvt_pk_bf16_f32 v193, v194, v195
    v_mfma_f32_16x16x32_bf16 v[44:47], a[140:143], a[208:211], v[44:47]
    ds_read_b64_tr_b16 a[156:157], v103 offset:16384
    v_cvt_pk_bf16_f32 v194, v196, v197
    v_cvt_pk_bf16_f32 v195, v198, v199
    v_mfma_f32_16x16x32_bf16 v[60:63], a[140:143], a[212:215], v[60:63]
    s_waitcnt lgkmcnt(3)
    ds_read_b64_tr_b16 a[158:159], v103 offset:20480
    buffer_store_dwordx4 v[192:195], v29, s[20:23], s42 offen offset:0 sc1
    v_mfma_f32_16x16x32_bf16 v[64:67], a[144:147], a[208:211], v[64:67]
    ds_read_b64_tr_b16 a[128:129], v96 offset:24576
    v_mul_f32 v200, v116, v200
    v_mfma_f32_16x16x32_bf16 v[80:83], a[144:147], a[212:215], v[80:83]
    ds_read_b64_tr_b16 a[130:131], v96 offset:28672
    v_mul_f32 v201, v116, v201
    v_mul_f32 v202, v116, v202
    v_mfma_f32_16x16x32_bf16 v[68:71], a[148:151], a[208:211], v[68:71]
    ds_read_b64_tr_b16 a[132:133], v97 offset:24576
    v_mul_f32 v203, v116, v203
    v_mul_f32 v204, v116, v204
    v_mfma_f32_16x16x32_bf16 v[84:87], a[148:151], a[212:215], v[84:87]
    s_waitcnt lgkmcnt(3)
    ds_read_b64_tr_b16 a[134:135], v97 offset:28672
    v_mul_f32 v205, v116, v205
    v_mul_f32 v206, v116, v206
    v_mfma_f32_16x16x32_bf16 v[72:75], a[152:155], a[208:211], v[72:75]
    ds_read_b64_tr_b16 a[136:137], v98 offset:24576
    v_mul_f32 v207, v116, v207
    v_mfma_f32_16x16x32_bf16 v[88:91], a[152:155], a[212:215], v[88:91]
    ds_read_b64_tr_b16 a[138:139], v98 offset:28672
    v_cvt_pk_bf16_f32 v200, v200, v201
    v_cvt_pk_bf16_f32 v201, v202, v203
    v_mfma_f32_16x16x32_bf16 v[76:79], a[156:159], a[208:211], v[76:79]
    ds_read_b64_tr_b16 a[140:141], v99 offset:24576
    v_cvt_pk_bf16_f32 v202, v204, v205
    v_cvt_pk_bf16_f32 v203, v206, v207
    v_mfma_f32_16x16x32_bf16 v[92:95], a[156:159], a[212:215], v[92:95]
    s_waitcnt lgkmcnt(3)
    ds_read_b64_tr_b16 a[142:143], v99 offset:28672
    buffer_store_dwordx4 v[200:203], v29, s[20:23], s42 offen offset:1024 sc1
    v_mfma_f32_16x16x32_bf16 v[32:35], a[128:131], a[216:219], v[32:35]
    ds_read_b64_tr_b16 a[144:145], v100 offset:24576
    v_mfma_f32_16x16x32_bf16 v[48:51], a[128:131], a[220:223], v[48:51]
    ds_read_b64_tr_b16 a[146:147], v100 offset:28672
    v_mfma_f32_16x16x32_bf16 v[36:39], a[132:135], a[216:219], v[36:39]
    ds_read_b64_tr_b16 a[148:149], v101 offset:24576
    v_mfma_f32_16x16x32_bf16 v[52:55], a[132:135], a[220:223], v[52:55]
    s_waitcnt lgkmcnt(3)
    ds_read_b64_tr_b16 a[150:151], v101 offset:28672
    v_mfma_f32_16x16x32_bf16 v[40:43], a[136:139], a[216:219], v[40:43]
    s_waitcnt vmcnt(26)
    ds_read_b64_tr_b16 a[152:153], v102 offset:24576
    v_mfma_f32_16x16x32_bf16 v[56:59], a[136:139], a[220:223], v[56:59]
    ds_read_b64_tr_b16 a[154:155], v102 offset:28672
    v_mfma_f32_16x16x32_bf16 v[44:47], a[140:143], a[216:219], v[44:47]
    ds_read_b64_tr_b16 a[156:157], v103 offset:24576
    v_mfma_f32_16x16x32_bf16 v[60:63], a[140:143], a[220:223], v[60:63]
    s_waitcnt lgkmcnt(3)
    ds_read_b64_tr_b16 a[158:159], v103 offset:28672
    s_barrier
    v_mfma_f32_16x16x32_bf16 v[64:67], a[144:147], a[216:219], v[64:67]
    ds_read_b64_tr_b16 a[128:129], v8 offset:0
    v_mfma_f32_16x16x32_bf16 v[80:83], a[144:147], a[220:223], v[80:83]
    ds_read_b64_tr_b16 a[130:131], v8 offset:4096
    v_mfma_f32_16x16x32_bf16 v[68:71], a[148:151], a[216:219], v[68:71]
    ds_read_b64_tr_b16 a[132:133], v9 offset:0
    v_mfma_f32_16x16x32_bf16 v[84:87], a[148:151], a[220:223], v[84:87]
    s_waitcnt lgkmcnt(3)
    ds_read_b64_tr_b16 a[134:135], v9 offset:4096
    v_mfma_f32_16x16x32_bf16 v[72:75], a[152:155], a[216:219], v[72:75]
    ds_read_b64_tr_b16 a[136:137], v10 offset:0
    v_mfma_f32_16x16x32_bf16 v[88:91], a[152:155], a[220:223], v[88:91]
    ds_read_b64_tr_b16 a[138:139], v10 offset:4096
    v_mfma_f32_16x16x32_bf16 v[76:79], a[156:159], a[216:219], v[76:79]
    ds_read_b64_tr_b16 a[140:141], v11 offset:0
    v_mfma_f32_16x16x32_bf16 v[92:95], a[156:159], a[220:223], v[92:95]
    s_waitcnt lgkmcnt(3)
    ds_read_b64_tr_b16 a[142:143], v11 offset:4096
    v_mfma_f32_16x16x32_bf16 v[32:35], a[128:131], a[224:227], v[32:35]
    ds_read_b64_tr_b16 a[144:145], v12 offset:0
    ds_read_b64_tr_b16 a[146:147], v12 offset:4096
    s_bfe_u32 s3, s60, 0x30009
    s_mul_i32 s3, s3, 524288
    s_add_u32 s3, s3, 0
    s_add_u32 s59, s3, s53
    s_add_u32 s25, s59, 16384
    s_add_u32 m0, s31, 98304
    v_mfma_f32_16x16x32_bf16 v[48:51], a[128:131], a[228:231], v[48:51]
    buffer_load_dwordx4 v21, s[92:95], s59 offen offset:0 lds
    v_mfma_f32_16x16x32_bf16 v[36:39], a[132:135], a[224:227], v[36:39]
    ds_read_b64_tr_b16 a[148:149], v13 offset:0
    v_mul_f32 v208, v116, v208
    v_mfma_f32_16x16x32_bf16 v[52:55], a[132:135], a[228:231], v[52:55]
    s_waitcnt lgkmcnt(3)
    ds_read_b64_tr_b16 a[150:151], v13 offset:4096
    v_mul_f32 v209, v116, v209
    v_mul_f32 v210, v116, v210
    v_mul_f32 v211, v116, v211
    v_mfma_f32_16x16x32_bf16 v[40:43], a[136:139], a[224:227], v[40:43]
    ds_read_b64_tr_b16 a[152:153], v14 offset:0
    ds_read_b64_tr_b16 a[154:155], v14 offset:4096
    v_mul_f32 v212, v116, v212
    v_mul_f32 v213, v116, v213
    v_mul_f32 v214, v116, v214
    v_mfma_f32_16x16x32_bf16 v[56:59], a[136:139], a[228:231], v[56:59]
    buffer_load_dwordx4 v22, s[92:95], s59 offen offset:1024 lds
    v_mul_f32 v215, v116, v215
    v_mfma_f32_16x16x32_bf16 v[44:47], a[140:143], a[224:227], v[44:47]
    ds_read_b64_tr_b16 a[156:157], v15 offset:0
    v_cvt_pk_bf16_f32 v208, v208, v209
    v_cvt_pk_bf16_f32 v209, v210, v211
    v_cvt_pk_bf16_f32 v210, v212, v213
    v_mfma_f32_16x16x32_bf16 v[60:63], a[140:143], a[228:231], v[60:63]
    s_waitcnt lgkmcnt(3)
    ds_read_b64_tr_b16 a[158:159], v15 offset:4096
    v_cvt_pk_bf16_f32 v211, v214, v215
    buffer_store_dwordx4 v[208:211], v29, s[20:23], s42 offen offset:2048 sc1
    v_mfma_f32_16x16x32_bf16 v[64:67], a[144:147], a[224:227], v[64:67]
    ds_read_b64_tr_b16 a[128:129], v8 offset:8192
    ds_read_b64_tr_b16 a[130:131], v8 offset:12288
    v_mul_f32 v216, v116, v216
    v_mul_f32 v217, v116, v217
    v_mfma_f32_16x16x32_bf16 v[80:83], a[144:147], a[228:231], v[80:83]
    buffer_load_dwordx4 v23, s[92:95], s59 offen offset:2048 lds
    v_mfma_f32_16x16x32_bf16 v[68:71], a[148:151], a[224:227], v[68:71]
    ds_read_b64_tr_b16 a[132:133], v9 offset:8192
    v_mul_f32 v218, v116, v218
    v_mul_f32 v219, v116, v219
    v_mfma_f32_16x16x32_bf16 v[84:87], a[148:151], a[228:231], v[84:87]
    s_waitcnt lgkmcnt(3)
    ds_read_b64_tr_b16 a[134:135], v9 offset:12288
    v_mul_f32 v220, v116, v220
    v_mul_f32 v221, v116, v221
    v_mul_f32 v222, v116, v222
    v_mfma_f32_16x16x32_bf16 v[72:75], a[152:155], a[224:227], v[72:75]
    ds_read_b64_tr_b16 a[136:137], v10 offset:8192
    ds_read_b64_tr_b16 a[138:139], v10 offset:12288
    v_mul_f32 v223, v116, v223
    v_cvt_pk_bf16_f32 v216, v216, v217
    v_mfma_f32_16x16x32_bf16 v[88:91], a[152:155], a[228:231], v[88:91]
    buffer_load_dwordx4 v24, s[92:95], s59 offen offset:3072 lds
    v_mfma_f32_16x16x32_bf16 v[76:79], a[156:159], a[224:227], v[76:79]
    ds_read_b64_tr_b16 a[140:141], v11 offset:8192
    v_cvt_pk_bf16_f32 v217, v218, v219
    v_cvt_pk_bf16_f32 v218, v220, v221
    v_mfma_f32_16x16x32_bf16 v[92:95], a[156:159], a[228:231], v[92:95]
    s_waitcnt lgkmcnt(3)
    ds_read_b64_tr_b16 a[142:143], v11 offset:12288
    v_cvt_pk_bf16_f32 v219, v222, v223
    buffer_store_dwordx4 v[216:219], v29, s[20:23], s42 offen offset:3072 sc1
    v_mfma_f32_16x16x32_bf16 v[32:35], a[128:131], a[232:235], v[32:35]
    s_add_u32 m0, s31, 102400
    ds_read_b64_tr_b16 a[144:145], v12 offset:8192
    ds_read_b64_tr_b16 a[146:147], v12 offset:12288
    v_mul_f32 v224, v117, v224
    v_mul_f32 v225, v117, v225
    v_mfma_f32_16x16x32_bf16 v[48:51], a[128:131], a[236:239], v[48:51]
    buffer_load_dwordx4 v21, s[92:95], s25 offen offset:0 lds
    v_mfma_f32_16x16x32_bf16 v[36:39], a[132:135], a[232:235], v[36:39]
    ds_read_b64_tr_b16 a[148:149], v13 offset:8192
    v_mul_f32 v226, v117, v226
    v_mul_f32 v227, v117, v227
    v_mfma_f32_16x16x32_bf16 v[52:55], a[132:135], a[236:239], v[52:55]
    s_waitcnt lgkmcnt(3)
    ds_read_b64_tr_b16 a[150:151], v13 offset:12288
    v_mul_f32 v228, v117, v228
    v_mul_f32 v229, v117, v229
    v_mul_f32 v230, v117, v230
    v_mfma_f32_16x16x32_bf16 v[40:43], a[136:139], a[232:235], v[40:43]
    ds_read_b64_tr_b16 a[152:153], v14 offset:8192
    ds_read_b64_tr_b16 a[154:155], v14 offset:12288
    v_mul_f32 v231, v117, v231
    v_cvt_pk_bf16_f32 v224, v224, v225
    v_mfma_f32_16x16x32_bf16 v[56:59], a[136:139], a[236:239], v[56:59]
    buffer_load_dwordx4 v22, s[92:95], s25 offen offset:1024 lds
    v_mfma_f32_16x16x32_bf16 v[44:47], a[140:143], a[232:235], v[44:47]
    ds_read_b64_tr_b16 a[156:157], v15 offset:8192
    v_cvt_pk_bf16_f32 v225, v226, v227
    v_cvt_pk_bf16_f32 v226, v228, v229
    v_mfma_f32_16x16x32_bf16 v[60:63], a[140:143], a[236:239], v[60:63]
    s_waitcnt lgkmcnt(3)
    ds_read_b64_tr_b16 a[158:159], v15 offset:12288
    v_cvt_pk_bf16_f32 v227, v230, v231
    buffer_store_dwordx4 v[224:227], v29, s[20:23], s43 offen offset:0 sc1
    v_mfma_f32_16x16x32_bf16 v[64:67], a[144:147], a[232:235], v[64:67]
    ds_read_b64_tr_b16 a[128:129], v8 offset:16384
    ds_read_b64_tr_b16 a[130:131], v8 offset:20480
    v_mul_f32 v232, v117, v232
    v_mul_f32 v233, v117, v233
    v_mfma_f32_16x16x32_bf16 v[80:83], a[144:147], a[236:239], v[80:83]
    buffer_load_dwordx4 v23, s[92:95], s25 offen offset:2048 lds
    v_mfma_f32_16x16x32_bf16 v[68:71], a[148:151], a[232:235], v[68:71]
    ds_read_b64_tr_b16 a[132:133], v9 offset:16384
    v_mul_f32 v234, v117, v234
    v_mul_f32 v235, v117, v235
    v_mfma_f32_16x16x32_bf16 v[84:87], a[148:151], a[236:239], v[84:87]
    s_waitcnt lgkmcnt(3)
    ds_read_b64_tr_b16 a[134:135], v9 offset:20480
    v_mul_f32 v236, v117, v236
    v_mul_f32 v237, v117, v237
    v_mul_f32 v238, v117, v238
    v_mfma_f32_16x16x32_bf16 v[72:75], a[152:155], a[232:235], v[72:75]
    ds_read_b64_tr_b16 a[136:137], v10 offset:16384
    ds_read_b64_tr_b16 a[138:139], v10 offset:20480
    v_mul_f32 v239, v117, v239
    v_cvt_pk_bf16_f32 v232, v232, v233
    v_mfma_f32_16x16x32_bf16 v[88:91], a[152:155], a[236:239], v[88:91]
    buffer_load_dwordx4 v24, s[92:95], s25 offen offset:3072 lds
    v_mfma_f32_16x16x32_bf16 v[76:79], a[156:159], a[232:235], v[76:79]
    s_bfe_u32 s3, s60, 0x30009
    s_mul_i32 s3, s3, 1966080
    ds_read_b64_tr_b16 a[140:141], v11 offset:16384
    v_cvt_pk_bf16_f32 v233, v234, v235
    v_cvt_pk_bf16_f32 v234, v236, v237
    v_mfma_f32_16x16x32_bf16 v[92:95], a[156:159], a[236:239], v[92:95]
    s_waitcnt lgkmcnt(3)
    s_add_u32 s3, s3, 0
    ds_read_b64_tr_b16 a[142:143], v11 offset:20480
    v_cvt_pk_bf16_f32 v235, v238, v239
    buffer_store_dwordx4 v[232:235], v29, s[20:23], s43 offen offset:1024 sc1
    v_mfma_f32_16x16x32_bf16 v[32:35], a[128:131], a[240:243], v[32:35]
    s_add_u32 s58, s3, s52
    ds_read_b64_tr_b16 a[144:145], v12 offset:16384
    ds_read_b64_tr_b16 a[146:147], v12 offset:20480
    v_mul_f32 v240, v117, v240
    v_mul_f32 v241, v117, v241
    v_mfma_f32_16x16x32_bf16 v[48:51], a[128:131], a[244:247], v[48:51]
    buffer_load_dwordx4 a[96:99], v1, s[20:23], s58 offen offset:0 sc1
    v_mfma_f32_16x16x32_bf16 v[36:39], a[132:135], a[240:243], v[36:39]
    ds_read_b64_tr_b16 a[148:149], v13 offset:16384
    v_mul_f32 v242, v117, v242
    v_mul_f32 v243, v117, v243
    v_mfma_f32_16x16x32_bf16 v[52:55], a[132:135], a[244:247], v[52:55]
    s_waitcnt lgkmcnt(3)
    ds_read_b64_tr_b16 a[150:151], v13 offset:20480
    v_mul_f32 v244, v117, v244
    v_mul_f32 v245, v117, v245
    v_mul_f32 v246, v117, v246
    v_mfma_f32_16x16x32_bf16 v[40:43], a[136:139], a[240:243], v[40:43]
    ds_read_b64_tr_b16 a[152:153], v14 offset:16384
    ds_read_b64_tr_b16 a[154:155], v14 offset:20480
    v_mul_f32 v247, v117, v247
    v_cvt_pk_bf16_f32 v240, v240, v241
    v_mfma_f32_16x16x32_bf16 v[56:59], a[136:139], a[244:247], v[56:59]
    buffer_load_dwordx4 a[100:103], v2, s[20:23], s58 offen offset:0 sc1
    v_mfma_f32_16x16x32_bf16 v[44:47], a[140:143], a[240:243], v[44:47]
    ds_read_b64_tr_b16 a[156:157], v15 offset:16384
    v_cvt_pk_bf16_f32 v241, v242, v243
    v_cvt_pk_bf16_f32 v242, v244, v245
    v_mfma_f32_16x16x32_bf16 v[60:63], a[140:143], a[244:247], v[60:63]
    s_waitcnt lgkmcnt(3)
    ds_read_b64_tr_b16 a[158:159], v15 offset:20480
    v_cvt_pk_bf16_f32 v243, v246, v247
    buffer_store_dwordx4 v[240:243], v29, s[20:23], s43 offen offset:2048 sc1
    v_mfma_f32_16x16x32_bf16 v[64:67], a[144:147], a[240:243], v[64:67]
    ds_read_b64_tr_b16 a[128:129], v8 offset:24576
    ds_read_b64_tr_b16 a[130:131], v8 offset:28672
    v_mul_f32 v248, v117, v248
    v_mul_f32 v249, v117, v249
    v_mfma_f32_16x16x32_bf16 v[80:83], a[144:147], a[244:247], v[80:83]
    buffer_load_dwordx4 a[104:107], v1, s[20:23], s58 offen offset:1024 sc1
    v_mfma_f32_16x16x32_bf16 v[68:71], a[148:151], a[240:243], v[68:71]
    ds_read_b64_tr_b16 a[132:133], v9 offset:24576
    v_mul_f32 v250, v117, v250
    v_mul_f32 v251, v117, v251
    v_mfma_f32_16x16x32_bf16 v[84:87], a[148:151], a[244:247], v[84:87]
    s_waitcnt lgkmcnt(3)
    ds_read_b64_tr_b16 a[134:135], v9 offset:28672
    v_mul_f32 v252, v117, v252
    v_mul_f32 v253, v117, v253
    v_mul_f32 v254, v117, v254
    v_mfma_f32_16x16x32_bf16 v[72:75], a[152:155], a[240:243], v[72:75]
    ds_read_b64_tr_b16 a[136:137], v10 offset:24576
    ds_read_b64_tr_b16 a[138:139], v10 offset:28672
    v_mul_f32 v255, v117, v255
    v_cvt_pk_bf16_f32 v248, v248, v249
    v_mfma_f32_16x16x32_bf16 v[88:91], a[152:155], a[244:247], v[88:91]
    buffer_load_dwordx4 a[108:111], v2, s[20:23], s58 offen offset:1024 sc1
    v_mfma_f32_16x16x32_bf16 v[76:79], a[156:159], a[240:243], v[76:79]
    ds_read_b64_tr_b16 a[140:141], v11 offset:24576
    v_cvt_pk_bf16_f32 v249, v250, v251
    v_cvt_pk_bf16_f32 v250, v252, v253
    v_mfma_f32_16x16x32_bf16 v[92:95], a[156:159], a[244:247], v[92:95]
    s_waitcnt lgkmcnt(3)
    ds_read_b64_tr_b16 a[142:143], v11 offset:28672
    v_cvt_pk_bf16_f32 v251, v254, v255
    buffer_store_dwordx4 v[248:251], v29, s[20:23], s43 offen offset:3072 sc1
    v_mfma_f32_16x16x32_bf16 v[32:35], a[128:131], a[248:251], v[32:35]
    ds_read_b64_tr_b16 a[144:145], v12 offset:24576
    ds_read_b64_tr_b16 a[146:147], v12 offset:28672
    v_mfma_f32_16x16x32_bf16 v[48:51], a[128:131], a[252:255], v[48:51]
    buffer_load_dwordx4 a[112:115], v1, s[20:23], s58 offen offset:2048 sc1
    v_mfma_f32_16x16x32_bf16 v[36:39], a[132:135], a[248:251], v[36:39]
    ds_read_b64_tr_b16 a[148:149], v13 offset:24576
    v_mfma_f32_16x16x32_bf16 v[52:55], a[132:135], a[252:255], v[52:55]
    s_waitcnt lgkmcnt(3)
    ds_read_b64_tr_b16 a[150:151], v13 offset:28672
    v_mfma_f32_16x16x32_bf16 v[40:43], a[136:139], a[248:251], v[40:43]
    s_waitcnt vmcnt(29)
    ds_read_b64_tr_b16 a[152:153], v14 offset:24576
    ds_read_b64_tr_b16 a[154:155], v14 offset:28672
    v_mfma_f32_16x16x32_bf16 v[56:59], a[136:139], a[252:255], v[56:59]
    buffer_load_dwordx4 a[116:119], v2, s[20:23], s58 offen offset:2048 sc1
    v_mfma_f32_16x16x32_bf16 v[44:47], a[140:143], a[248:251], v[44:47]
    ds_read_b64_tr_b16 a[156:157], v15 offset:24576
    v_mfma_f32_16x16x32_bf16 v[60:63], a[140:143], a[252:255], v[60:63]
    s_waitcnt lgkmcnt(3)
    ds_read_b64_tr_b16 a[158:159], v15 offset:28672
    s_barrier
    v_mfma_f32_16x16x32_bf16 v[64:67], a[144:147], a[248:251], v[64:67]
    ds_read_b64_tr_b16 a[128:129], v96 offset:32768
    ds_read_b64_tr_b16 a[130:131], v96 offset:36864
    v_mfma_f32_16x16x32_bf16 v[80:83], a[144:147], a[252:255], v[80:83]
    buffer_load_dwordx4 a[120:123], v1, s[20:23], s58 offen offset:3072 sc1
    v_mfma_f32_16x16x32_bf16 v[68:71], a[148:151], a[248:251], v[68:71]
    ds_read_b64_tr_b16 a[132:133], v97 offset:32768
    v_mfma_f32_16x16x32_bf16 v[84:87], a[148:151], a[252:255], v[84:87]
    s_waitcnt lgkmcnt(3)
    ds_read_b64_tr_b16 a[134:135], v97 offset:36864
    v_mfma_f32_16x16x32_bf16 v[72:75], a[152:155], a[248:251], v[72:75]
    ds_read_b64_tr_b16 a[136:137], v98 offset:32768
    v_mfma_f32_16x16x32_bf16 v[88:91], a[152:155], a[252:255], v[88:91]
    ds_read_b64_tr_b16 a[138:139], v98 offset:36864
    ds_read_b64_tr_b16 a[140:141], v99 offset:32768
    v_mfma_f32_16x16x32_bf16 v[76:79], a[156:159], a[248:251], v[76:79]
    buffer_load_dwordx4 a[124:127], v2, s[20:23], s58 offen offset:3072 sc1
    v_mfma_f32_16x16x32_bf16 v[92:95], a[156:159], a[252:255], v[92:95]
    s_waitcnt lgkmcnt(3)
    ds_read_b64_tr_b16 a[142:143], v99 offset:36864
    v_mfma_f32_16x16x32_bf16 v[32:35], a[128:131], a[64:67], v[32:35]
    ds_read_b64_tr_b16 a[144:145], v100 offset:32768
    ds_read_b64_tr_b16 a[146:147], v100 offset:36864
    s_bfe_u32 s3, s60, 0x3000c
    s_mul_i32 s3, s3, 524288
    s_add_u32 s3, s3, 0
    s_add_u32 s59, s3, s53
    s_add_u32 s25, s59, 16384
    s_add_u32 m0, s31, 0
    v_mfma_f32_16x16x32_bf16 v[48:51], a[128:131], a[68:71], v[48:51]
    buffer_load_dwordx4 v21, s[92:95], s59 offen offset:0 lds
    v_mfma_f32_16x16x32_bf16 v[36:39], a[132:135], a[64:67], v[36:39]
    ds_read_b64_tr_b16 a[148:149], v101 offset:32768
    v_mfma_f32_16x16x32_bf16 v[52:55], a[132:135], a[68:71], v[52:55]
    s_waitcnt lgkmcnt(3)
    ds_read_b64_tr_b16 a[150:151], v101 offset:36864
    ds_read_b64_tr_b16 a[152:153], v102 offset:32768
    v_mfma_f32_16x16x32_bf16 v[40:43], a[136:139], a[64:67], v[40:43]
    buffer_load_dwordx4 v22, s[92:95], s59 offen offset:1024 lds
    v_mfma_f32_16x16x32_bf16 v[56:59], a[136:139], a[68:71], v[56:59]
    ds_read_b64_tr_b16 a[154:155], v102 offset:36864
    v_mfma_f32_16x16x32_bf16 v[44:47], a[140:143], a[64:67], v[44:47]
    ds_read_b64_tr_b16 a[156:157], v103 offset:32768
    ds_read_b64_tr_b16 a[158:159], v103 offset:36864
    v_mfma_f32_16x16x32_bf16 v[60:63], a[140:143], a[68:71], v[60:63]
    s_waitcnt lgkmcnt(4)
    buffer_load_dwordx4 v23, s[92:95], s59 offen offset:2048 lds
    v_mfma_f32_16x16x32_bf16 v[64:67], a[144:147], a[64:67], v[64:67]
    ds_read_b64_tr_b16 a[128:129], v96 offset:40960
    v_mfma_f32_16x16x32_bf16 v[80:83], a[144:147], a[68:71], v[80:83]
    ds_read_b64_tr_b16 a[130:131], v96 offset:45056
    ds_read_b64_tr_b16 a[132:133], v97 offset:40960
    v_mfma_f32_16x16x32_bf16 v[68:71], a[148:151], a[64:67], v[68:71]
    buffer_load_dwordx4 v24, s[92:95], s59 offen offset:3072 lds
    v_mfma_f32_16x16x32_bf16 v[84:87], a[148:151], a[68:71], v[84:87]
    s_waitcnt lgkmcnt(3)
    ds_read_b64_tr_b16 a[134:135], v97 offset:45056
    v_mfma_f32_16x16x32_bf16 v[72:75], a[152:155], a[64:67], v[72:75]
    s_add_u32 m0, s31, 4096
    ds_read_b64_tr_b16 a[136:137], v98 offset:40960
    ds_read_b64_tr_b16 a[138:139], v98 offset:45056
    v_mfma_f32_16x16x32_bf16 v[88:91], a[152:155], a[68:71], v[88:91]
    buffer_load_dwordx4 v21, s[92:95], s25 offen offset:0 lds
    v_mfma_f32_16x16x32_bf16 v[76:79], a[156:159], a[64:67], v[76:79]
    ds_read_b64_tr_b16 a[140:141], v99 offset:40960
    v_mfma_f32_16x16x32_bf16 v[92:95], a[156:159], a[68:71], v[92:95]
    s_waitcnt lgkmcnt(3)
    ds_read_b64_tr_b16 a[142:143], v99 offset:45056
    v_mfma_f32_16x16x32_bf16 v[32:35], a[128:131], a[72:75], v[32:35]
    ds_read_b64_tr_b16 a[144:145], v100 offset:40960
    buffer_load_dwordx4 v22, s[92:95], s25 offen offset:1024 lds
    v_mfma_f32_16x16x32_bf16 v[48:51], a[128:131], a[76:79], v[48:51]
    ds_read_b64_tr_b16 a[146:147], v100 offset:45056
    v_mfma_f32_16x16x32_bf16 v[36:39], a[132:135], a[72:75], v[36:39]
    ds_read_b64_tr_b16 a[148:149], v101 offset:40960
    ds_read_b64_tr_b16 a[150:151], v101 offset:45056
    v_mfma_f32_16x16x32_bf16 v[52:55], a[132:135], a[76:79], v[52:55]
    s_waitcnt lgkmcnt(4)
    buffer_load_dwordx4 v23, s[92:95], s25 offen offset:2048 lds
    v_mfma_f32_16x16x32_bf16 v[40:43], a[136:139], a[72:75], v[40:43]
    ds_read_b64_tr_b16 a[152:153], v102 offset:40960
    v_mfma_f32_16x16x32_bf16 v[56:59], a[136:139], a[76:79], v[56:59]
    ds_read_b64_tr_b16 a[154:155], v102 offset:45056
    ds_read_b64_tr_b16 a[156:157], v103 offset:40960
    v_mfma_f32_16x16x32_bf16 v[44:47], a[140:143], a[72:75], v[44:47]
    buffer_load_dwordx4 v24, s[92:95], s25 offen offset:3072 lds
    v_mfma_f32_16x16x32_bf16 v[60:63], a[140:143], a[76:79], v[60:63]
    s_waitcnt lgkmcnt(3)
    s_bfe_u32 s3, s60, 0x3000c
    s_mul_i32 s3, s3, 1966080
    s_add_u32 s3, s3, 0
    ds_read_b64_tr_b16 a[158:159], v103 offset:45056
    v_mfma_f32_16x16x32_bf16 v[64:67], a[144:147], a[72:75], v[64:67]
    s_add_u32 s58, s3, s52
    ds_read_b64_tr_b16 a[128:129], v96 offset:49152
    ds_read_b64_tr_b16 a[130:131], v96 offset:53248
    v_mfma_f32_16x16x32_bf16 v[80:83], a[144:147], a[76:79], v[80:83]
    buffer_load_dwordx4 a[0:3], v1, s[20:23], s58 offen offset:0 sc1
    v_mfma_f32_16x16x32_bf16 v[68:71], a[148:151], a[72:75], v[68:71]
    ds_read_b64_tr_b16 a[132:133], v97 offset:49152
    v_mfma_f32_16x16x32_bf16 v[84:87], a[148:151], a[76:79], v[84:87]
    s_waitcnt lgkmcnt(3)
    ds_read_b64_tr_b16 a[134:135], v97 offset:53248
    ds_read_b64_tr_b16 a[136:137], v98 offset:49152
    v_mfma_f32_16x16x32_bf16 v[72:75], a[152:155], a[72:75], v[72:75]
    buffer_load_dwordx4 a[4:7], v2, s[20:23], s58 offen offset:0 sc1
    v_mfma_f32_16x16x32_bf16 v[88:91], a[152:155], a[76:79], v[88:91]
    ds_read_b64_tr_b16 a[138:139], v98 offset:53248
    v_mfma_f32_16x16x32_bf16 v[76:79], a[156:159], a[72:75], v[76:79]
    ds_read_b64_tr_b16 a[140:141], v99 offset:49152
    ds_read_b64_tr_b16 a[142:143], v99 offset:53248
    v_mfma_f32_16x16x32_bf16 v[92:95], a[156:159], a[76:79], v[92:95]
    s_waitcnt lgkmcnt(4)
    buffer_load_dwordx4 a[8:11], v1, s[20:23], s58 offen offset:1024 sc1
    v_mfma_f32_16x16x32_bf16 v[32:35], a[128:131], a[80:83], v[32:35]
    ds_read_b64_tr_b16 a[144:145], v100 offset:49152
    v_mfma_f32_16x16x32_bf16 v[48:51], a[128:131], a[84:87], v[48:51]
    ds_read_b64_tr_b16 a[146:147], v100 offset:53248
    ds_read_b64_tr_b16 a[148:149], v101 offset:49152
    v_mfma_f32_16x16x32_bf16 v[36:39], a[132:135], a[80:83], v[36:39]
    buffer_load_dwordx4 a[12:15], v2, s[20:23], s58 offen offset:1024 sc1
    v_mfma_f32_16x16x32_bf16 v[52:55], a[132:135], a[84:87], v[52:55]
    s_waitcnt lgkmcnt(3)
    ds_read_b64_tr_b16 a[150:151], v101 offset:53248
    v_mfma_f32_16x16x32_bf16 v[40:43], a[136:139], a[80:83], v[40:43]
    ds_read_b64_tr_b16 a[152:153], v102 offset:49152
    ds_read_b64_tr_b16 a[154:155], v102 offset:53248
    v_mfma_f32_16x16x32_bf16 v[56:59], a[136:139], a[84:87], v[56:59]
    buffer_load_dwordx4 a[16:19], v1, s[20:23], s58 offen offset:2048 sc1
    v_mfma_f32_16x16x32_bf16 v[44:47], a[140:143], a[80:83], v[44:47]
    ds_read_b64_tr_b16 a[156:157], v103 offset:49152
    v_mfma_f32_16x16x32_bf16 v[60:63], a[140:143], a[84:87], v[60:63]
    s_waitcnt lgkmcnt(3)
    ds_read_b64_tr_b16 a[158:159], v103 offset:53248
    v_mfma_f32_16x16x32_bf16 v[64:67], a[144:147], a[80:83], v[64:67]
    ds_read_b64_tr_b16 a[128:129], v96 offset:57344
    buffer_load_dwordx4 a[20:23], v2, s[20:23], s58 offen offset:2048 sc1
    v_mfma_f32_16x16x32_bf16 v[80:83], a[144:147], a[84:87], v[80:83]
    ds_read_b64_tr_b16 a[130:131], v96 offset:61440
    v_mfma_f32_16x16x32_bf16 v[68:71], a[148:151], a[80:83], v[68:71]
    ds_read_b64_tr_b16 a[132:133], v97 offset:57344
    ds_read_b64_tr_b16 a[134:135], v97 offset:61440
    v_mfma_f32_16x16x32_bf16 v[84:87], a[148:151], a[84:87], v[84:87]
    s_waitcnt lgkmcnt(4)
    buffer_load_dwordx4 a[24:27], v1, s[20:23], s58 offen offset:3072 sc1
    v_mfma_f32_16x16x32_bf16 v[72:75], a[152:155], a[80:83], v[72:75]
    ds_read_b64_tr_b16 a[136:137], v98 offset:57344
    v_mfma_f32_16x16x32_bf16 v[88:91], a[152:155], a[84:87], v[88:91]
    ds_read_b64_tr_b16 a[138:139], v98 offset:61440
    ds_read_b64_tr_b16 a[140:141], v99 offset:57344
    v_mfma_f32_16x16x32_bf16 v[76:79], a[156:159], a[80:83], v[76:79]
    buffer_load_dwordx4 a[28:31], v2, s[20:23], s58 offen offset:3072 sc1
    v_mfma_f32_16x16x32_bf16 v[92:95], a[156:159], a[84:87], v[92:95]
    s_waitcnt lgkmcnt(3)
    ds_read_b64_tr_b16 a[142:143], v99 offset:61440
    v_mfma_f32_16x16x32_bf16 v[32:35], a[128:131], a[88:91], v[32:35]
    ds_read_b64_tr_b16 a[144:145], v100 offset:57344
    v_mfma_f32_16x16x32_bf16 v[48:51], a[128:131], a[92:95], v[48:51]
    ds_read_b64_tr_b16 a[146:147], v100 offset:61440
    ds_read_b64_tr_b16 a[148:149], v101 offset:57344
    v_mfma_f32_16x16x32_bf16 v[36:39], a[132:135], a[88:91], v[36:39]
    global_load_dword v31, v110, s[80:81]
    v_mfma_f32_16x16x32_bf16 v[52:55], a[132:135], a[92:95], v[52:55]
    s_waitcnt lgkmcnt(3)
    ds_read_b64_tr_b16 a[150:151], v101 offset:61440
    v_mfma_f32_16x16x32_bf16 v[40:43], a[136:139], a[88:91], v[40:43]
    s_waitcnt vmcnt(17)
    ds_read_b64_tr_b16 a[152:153], v102 offset:57344
    v_mfma_f32_16x16x32_bf16 v[56:59], a[136:139], a[92:95], v[56:59]
    ds_read_b64_tr_b16 a[154:155], v102 offset:61440
    v_mfma_f32_16x16x32_bf16 v[44:47], a[140:143], a[88:91], v[44:47]
    ds_read_b64_tr_b16 a[156:157], v103 offset:57344
    v_mfma_f32_16x16x32_bf16 v[60:63], a[140:143], a[92:95], v[60:63]
    s_waitcnt lgkmcnt(3)
    ds_read_b64_tr_b16 a[158:159], v103 offset:61440
    s_barrier
    v_mfma_f32_16x16x32_bf16 v[64:67], a[144:147], a[88:91], v[64:67]
    ds_read_b64_tr_b16 a[128:129], v8 offset:32768
    v_mfma_f32_16x16x32_bf16 v[80:83], a[144:147], a[92:95], v[80:83]
    ds_read_b64_tr_b16 a[130:131], v8 offset:36864
    s_and_b32 s40, s37, 2
    s_cselect_b32 s40, 1073741824, s100
    s_or_b32 s37, s37, 2
    v_lshl_add_u32 v118, v0, 24, s40
    v_mov_b32 v119, 1
    v_mfma_f32_16x16x32_bf16 v[68:71], a[148:151], a[88:91], v[68:71]
    ds_read_b64_tr_b16 a[132:133], v9 offset:32768
    ds_read_b64_tr_b16 a[134:135], v9 offset:36864
    v_mfma_f32_16x16x32_bf16 v[84:87], a[148:151], a[92:95], v[84:87]
    s_waitcnt lgkmcnt(4)
    buffer_atomic_add v119, v118, s[96:99], 0 offen offset:256
    v_mfma_f32_16x16x32_bf16 v[72:75], a[152:155], a[88:91], v[72:75]
    ds_read_b64_tr_b16 a[136:137], v10 offset:32768
    v_mfma_f32_16x16x32_bf16 v[88:91], a[152:155], a[92:95], v[88:91]
    ds_read_b64_tr_b16 a[138:139], v10 offset:36864
    v_mfma_f32_16x16x32_bf16 v[76:79], a[156:159], a[88:91], v[76:79]
    ds_read_b64_tr_b16 a[140:141], v11 offset:32768
    v_mfma_f32_16x16x32_bf16 v[92:95], a[156:159], a[92:95], v[92:95]
    s_waitcnt lgkmcnt(3)
    ds_read_b64_tr_b16 a[142:143], v11 offset:36864
    v_mfma_f32_16x16x32_bf16 v[32:35], a[128:131], a[96:99], v[32:35]
    ds_read_b64_tr_b16 a[144:145], v12 offset:32768
    ds_read_b64_tr_b16 a[146:147], v12 offset:36864
    s_bfe_u32 s3, s60, 0x3000f
    s_mul_i32 s3, s3, 524288
    s_add_u32 s3, s3, 0
    s_add_u32 s59, s3, s53
    s_add_u32 s25, s59, 16384
    s_add_u32 m0, s31, 65536
    v_mfma_f32_16x16x32_bf16 v[48:51], a[128:131], a[100:103], v[48:51]
    buffer_load_dwordx4 v21, s[92:95], s59 offen offset:0 lds
    v_mfma_f32_16x16x32_bf16 v[36:39], a[132:135], a[96:99], v[36:39]
    ds_read_b64_tr_b16 a[148:149], v13 offset:32768
    v_mfma_f32_16x16x32_bf16 v[52:55], a[132:135], a[100:103], v[52:55]
    s_waitcnt lgkmcnt(3)
    ds_read_b64_tr_b16 a[150:151], v13 offset:36864
    v_mfma_f32_16x16x32_bf16 v[40:43], a[136:139], a[96:99], v[40:43]
    ds_read_b64_tr_b16 a[152:153], v14 offset:32768
    ds_read_b64_tr_b16 a[154:155], v14 offset:36864
    v_mfma_f32_16x16x32_bf16 v[56:59], a[136:139], a[100:103], v[56:59]
    buffer_load_dwordx4 v22, s[92:95], s59 offen offset:1024 lds
    v_mfma_f32_16x16x32_bf16 v[44:47], a[140:143], a[96:99], v[44:47]
    ds_read_b64_tr_b16 a[156:157], v15 offset:32768
    v_mfma_f32_16x16x32_bf16 v[60:63], a[140:143], a[100:103], v[60:63]
    s_waitcnt lgkmcnt(3)
    ds_read_b64_tr_b16 a[158:159], v15 offset:36864
    v_mfma_f32_16x16x32_bf16 v[64:67], a[144:147], a[96:99], v[64:67]
    ds_read_b64_tr_b16 a[128:129], v8 offset:40960
    ds_read_b64_tr_b16 a[130:131], v8 offset:45056
    v_mfma_f32_16x16x32_bf16 v[80:83], a[144:147], a[100:103], v[80:83]
    buffer_load_dwordx4 v23, s[92:95], s59 offen offset:2048 lds
    v_mfma_f32_16x16x32_bf16 v[68:71], a[148:151], a[96:99], v[68:71]
    ds_read_b64_tr_b16 a[132:133], v9 offset:40960
    v_mfma_f32_16x16x32_bf16 v[84:87], a[148:151], a[100:103], v[84:87]
    s_waitcnt lgkmcnt(3)
    ds_read_b64_tr_b16 a[134:135], v9 offset:45056
    v_mfma_f32_16x16x32_bf16 v[72:75], a[152:155], a[96:99], v[72:75]
    ds_read_b64_tr_b16 a[136:137], v10 offset:40960
    ds_read_b64_tr_b16 a[138:139], v10 offset:45056
    v_mfma_f32_16x16x32_bf16 v[88:91], a[152:155], a[100:103], v[88:91]
    buffer_load_dwordx4 v24, s[92:95], s59 offen offset:3072 lds
    v_mfma_f32_16x16x32_bf16 v[76:79], a[156:159], a[96:99], v[76:79]
    ds_read_b64_tr_b16 a[140:141], v11 offset:40960
    v_mfma_f32_16x16x32_bf16 v[92:95], a[156:159], a[100:103], v[92:95]
    s_waitcnt lgkmcnt(3)
    ds_read_b64_tr_b16 a[142:143], v11 offset:45056
    v_mfma_f32_16x16x32_bf16 v[32:35], a[128:131], a[104:107], v[32:35]
    s_add_u32 m0, s31, 69632
    ds_read_b64_tr_b16 a[144:145], v12 offset:40960
    ds_read_b64_tr_b16 a[146:147], v12 offset:45056
    v_mfma_f32_16x16x32_bf16 v[48:51], a[128:131], a[108:111], v[48:51]
    buffer_load_dwordx4 v21, s[92:95], s25 offen offset:0 lds
    v_mfma_f32_16x16x32_bf16 v[36:39], a[132:135], a[104:107], v[36:39]
    ds_read_b64_tr_b16 a[148:149], v13 offset:40960
    v_mfma_f32_16x16x32_bf16 v[52:55], a[132:135], a[108:111], v[52:55]
    s_waitcnt lgkmcnt(3)
    ds_read_b64_tr_b16 a[150:151], v13 offset:45056
    v_mfma_f32_16x16x32_bf16 v[40:43], a[136:139], a[104:107], v[40:43]
    ds_read_b64_tr_b16 a[152:153], v14 offset:40960
    ds_read_b64_tr_b16 a[154:155], v14 offset:45056
    v_mfma_f32_16x16x32_bf16 v[56:59], a[136:139], a[108:111], v[56:59]
    buffer_load_dwordx4 v22, s[92:95], s25 offen offset:1024 lds
    v_mfma_f32_16x16x32_bf16 v[44:47], a[140:143], a[104:107], v[44:47]
    ds_read_b64_tr_b16 a[156:157], v15 offset:40960
    v_mfma_f32_16x16x32_bf16 v[60:63], a[140:143], a[108:111], v[60:63]
    s_waitcnt lgkmcnt(3)
    ds_read_b64_tr_b16 a[158:159], v15 offset:45056
    v_mfma_f32_16x16x32_bf16 v[64:67], a[144:147], a[104:107], v[64:67]
    ds_read_b64_tr_b16 a[128:129], v8 offset:49152
    ds_read_b64_tr_b16 a[130:131], v8 offset:53248
    v_mfma_f32_16x16x32_bf16 v[80:83], a[144:147], a[108:111], v[80:83]
    buffer_load_dwordx4 v23, s[92:95], s25 offen offset:2048 lds
    v_mfma_f32_16x16x32_bf16 v[68:71], a[148:151], a[104:107], v[68:71]
    ds_read_b64_tr_b16 a[132:133], v9 offset:49152
    v_mfma_f32_16x16x32_bf16 v[84:87], a[148:151], a[108:111], v[84:87]
    s_waitcnt lgkmcnt(3)
    ds_read_b64_tr_b16 a[134:135], v9 offset:53248
    v_mfma_f32_16x16x32_bf16 v[72:75], a[152:155], a[104:107], v[72:75]
    ds_read_b64_tr_b16 a[136:137], v10 offset:49152
    ds_read_b64_tr_b16 a[138:139], v10 offset:53248
    v_mfma_f32_16x16x32_bf16 v[88:91], a[152:155], a[108:111], v[88:91]
    buffer_load_dwordx4 v24, s[92:95], s25 offen offset:3072 lds
    v_mfma_f32_16x16x32_bf16 v[76:79], a[156:159], a[104:107], v[76:79]
    s_bfe_u32 s3, s60, 0x3000f
    s_mul_i32 s3, s3, 1966080
    ds_read_b64_tr_b16 a[140:141], v11 offset:49152
    v_mfma_f32_16x16x32_bf16 v[92:95], a[156:159], a[108:111], v[92:95]
    s_waitcnt lgkmcnt(3)
    s_add_u32 s3, s3, 0
    ds_read_b64_tr_b16 a[142:143], v11 offset:53248
    v_mfma_f32_16x16x32_bf16 v[32:35], a[128:131], a[112:115], v[32:35]
    s_add_u32 s58, s3, s52
    ds_read_b64_tr_b16 a[144:145], v12 offset:49152
    ds_read_b64_tr_b16 a[146:147], v12 offset:53248
    v_mfma_f32_16x16x32_bf16 v[48:51], a[128:131], a[116:119], v[48:51]
    buffer_load_dwordx4 a[32:35], v1, s[20:23], s58 offen offset:0 sc1
    v_mfma_f32_16x16x32_bf16 v[36:39], a[132:135], a[112:115], v[36:39]
    ds_read_b64_tr_b16 a[148:149], v13 offset:49152
    v_mfma_f32_16x16x32_bf16 v[52:55], a[132:135], a[116:119], v[52:55]
    s_waitcnt lgkmcnt(3)
    ds_read_b64_tr_b16 a[150:151], v13 offset:53248
    v_mfma_f32_16x16x32_bf16 v[40:43], a[136:139], a[112:115], v[40:43]
    ds_read_b64_tr_b16 a[152:153], v14 offset:49152
    ds_read_b64_tr_b16 a[154:155], v14 offset:53248
    v_mfma_f32_16x16x32_bf16 v[56:59], a[136:139], a[116:119], v[56:59]
    buffer_load_dwordx4 a[36:39], v2, s[20:23], s58 offen offset:0 sc1
    v_mfma_f32_16x16x32_bf16 v[44:47], a[140:143], a[112:115], v[44:47]
    ds_read_b64_tr_b16 a[156:157], v15 offset:49152
    v_mfma_f32_16x16x32_bf16 v[60:63], a[140:143], a[116:119], v[60:63]
    s_waitcnt lgkmcnt(3)
    ds_read_b64_tr_b16 a[158:159], v15 offset:53248
    v_mfma_f32_16x16x32_bf16 v[64:67], a[144:147], a[112:115], v[64:67]
    ds_read_b64_tr_b16 a[128:129], v8 offset:57344
    ds_read_b64_tr_b16 a[130:131], v8 offset:61440
    v_mfma_f32_16x16x32_bf16 v[80:83], a[144:147], a[116:119], v[80:83]
    buffer_load_dwordx4 a[40:43], v1, s[20:23], s58 offen offset:1024 sc1
    v_mfma_f32_16x16x32_bf16 v[68:71], a[148:151], a[112:115], v[68:71]
    ds_read_b64_tr_b16 a[132:133], v9 offset:57344
    v_mfma_f32_16x16x32_bf16 v[84:87], a[148:151], a[116:119], v[84:87]
    s_waitcnt lgkmcnt(3)
    ds_read_b64_tr_b16 a[134:135], v9 offset:61440
    v_mfma_f32_16x16x32_bf16 v[72:75], a[152:155], a[112:115], v[72:75]
    ds_read_b64_tr_b16 a[136:137], v10 offset:57344
    ds_read_b64_tr_b16 a[138:139], v10 offset:61440
    v_mfma_f32_16x16x32_bf16 v[88:91], a[152:155], a[116:119], v[88:91]
    buffer_load_dwordx4 a[44:47], v2, s[20:23], s58 offen offset:1024 sc1
    v_mfma_f32_16x16x32_bf16 v[76:79], a[156:159], a[112:115], v[76:79]
    ds_read_b64_tr_b16 a[140:141], v11 offset:57344
    v_mfma_f32_16x16x32_bf16 v[92:95], a[156:159], a[116:119], v[92:95]
    s_waitcnt lgkmcnt(3)
    ds_read_b64_tr_b16 a[142:143], v11 offset:61440
    v_mfma_f32_16x16x32_bf16 v[32:35], a[128:131], a[120:123], v[32:35]
    ds_read_b64_tr_b16 a[144:145], v12 offset:57344
    ds_read_b64_tr_b16 a[146:147], v12 offset:61440
    v_mfma_f32_16x16x32_bf16 v[48:51], a[128:131], a[124:127], v[48:51]
    buffer_load_dwordx4 a[48:51], v1, s[20:23], s58 offen offset:2048 sc1
    v_mfma_f32_16x16x32_bf16 v[36:39], a[132:135], a[120:123], v[36:39]
    ds_read_b64_tr_b16 a[148:149], v13 offset:57344
    v_mfma_f32_16x16x32_bf16 v[52:55], a[132:135], a[124:127], v[52:55]
    s_waitcnt lgkmcnt(3)
    ds_read_b64_tr_b16 a[150:151], v13 offset:61440
    v_mfma_f32_16x16x32_bf16 v[40:43], a[136:139], a[120:123], v[40:43]
    s_waitcnt vmcnt(14)
    ds_read_b64_tr_b16 a[152:153], v14 offset:57344
    ds_read_b64_tr_b16 a[154:155], v14 offset:61440
    v_mfma_f32_16x16x32_bf16 v[56:59], a[136:139], a[124:127], v[56:59]
    buffer_load_dwordx4 a[52:55], v2, s[20:23], s58 offen offset:2048 sc1
    v_mfma_f32_16x16x32_bf16 v[44:47], a[140:143], a[120:123], v[44:47]
    ds_read_b64_tr_b16 a[156:157], v15 offset:57344
    v_mfma_f32_16x16x32_bf16 v[60:63], a[140:143], a[124:127], v[60:63]
    s_waitcnt lgkmcnt(3)
    ds_read_b64_tr_b16 a[158:159], v15 offset:61440
    s_barrier
    v_mfma_f32_16x16x32_bf16 v[64:67], a[144:147], a[120:123], v[64:67]
    ds_read_b64_tr_b16 a[128:129], v96 offset:0
    ds_read_b64_tr_b16 a[130:131], v96 offset:4096
    v_mfma_f32_16x16x32_bf16 v[80:83], a[144:147], a[124:127], v[80:83]
    buffer_load_dwordx4 a[56:59], v1, s[20:23], s58 offen offset:3072 sc1
    v_mfma_f32_16x16x32_bf16 v[68:71], a[148:151], a[120:123], v[68:71]
    ds_read_b64_tr_b16 a[132:133], v97 offset:0
    v_mfma_f32_16x16x32_bf16 v[84:87], a[148:151], a[124:127], v[84:87]
    s_waitcnt lgkmcnt(3)
    ds_read_b64_tr_b16 a[134:135], v97 offset:4096
    v_mfma_f32_16x16x32_bf16 v[72:75], a[152:155], a[120:123], v[72:75]
    ds_read_b64_tr_b16 a[136:137], v98 offset:0
    v_mfma_f32_16x16x32_bf16 v[88:91], a[152:155], a[124:127], v[88:91]
    ds_read_b64_tr_b16 a[138:139], v98 offset:4096
    ds_read_b64_tr_b16 a[140:141], v99 offset:0
    v_mfma_f32_16x16x32_bf16 v[76:79], a[156:159], a[120:123], v[76:79]
    buffer_load_dwordx4 a[60:63], v2, s[20:23], s58 offen offset:3072 sc1
    v_mfma_f32_16x16x32_bf16 v[92:95], a[156:159], a[124:127], v[92:95]
    s_waitcnt lgkmcnt(3)
    ds_read_b64_tr_b16 a[142:143], v99 offset:4096
    v_mfma_f32_16x16x32_bf16 v[32:35], a[128:131], a[0:3], v[32:35]
    ds_read_b64_tr_b16 a[144:145], v100 offset:0
    ds_read_b64_tr_b16 a[146:147], v100 offset:4096
    s_bfe_u32 s3, s60, 0x30012
    s_mul_i32 s3, s3, 524288
    s_add_u32 s3, s3, 0
    s_add_u32 s59, s3, s53
    s_add_u32 s25, s59, 16384
    s_add_u32 m0, s31, 32768
    v_mfma_f32_16x16x32_bf16 v[48:51], a[128:131], a[4:7], v[48:51]
    buffer_load_dwordx4 v21, s[92:95], s59 offen offset:0 lds
    v_mfma_f32_16x16x32_bf16 v[36:39], a[132:135], a[0:3], v[36:39]
    ds_read_b64_tr_b16 a[148:149], v101 offset:0
    v_mfma_f32_16x16x32_bf16 v[52:55], a[132:135], a[4:7], v[52:55]
    s_waitcnt lgkmcnt(3)
    ds_read_b64_tr_b16 a[150:151], v101 offset:4096
    ds_read_b64_tr_b16 a[152:153], v102 offset:0
    v_mfma_f32_16x16x32_bf16 v[40:43], a[136:139], a[0:3], v[40:43]
    buffer_load_dwordx4 v22, s[92:95], s59 offen offset:1024 lds
    v_mfma_f32_16x16x32_bf16 v[56:59], a[136:139], a[4:7], v[56:59]
    ds_read_b64_tr_b16 a[154:155], v102 offset:4096
    v_mfma_f32_16x16x32_bf16 v[44:47], a[140:143], a[0:3], v[44:47]
    ds_read_b64_tr_b16 a[156:157], v103 offset:0
    v_mfma_f32_16x16x32_bf16 v[60:63], a[140:143], a[4:7], v[60:63]
    s_waitcnt lgkmcnt(3)
    ds_read_b64_tr_b16 a[158:159], v103 offset:4096
    v_mfma_f32_16x16x32_bf16 v[64:67], a[144:147], a[0:3], v[64:67]
    ds_read_b64_tr_b16 a[128:129], v96 offset:8192
    buffer_load_dwordx4 v23, s[92:95], s59 offen offset:2048 lds
    v_mfma_f32_16x16x32_bf16 v[80:83], a[144:147], a[4:7], v[80:83]
    ds_read_b64_tr_b16 a[130:131], v96 offset:12288
    v_mfma_f32_16x16x32_bf16 v[68:71], a[148:151], a[0:3], v[68:71]
    ds_read_b64_tr_b16 a[132:133], v97 offset:8192
    v_mfma_f32_16x16x32_bf16 v[84:87], a[148:151], a[4:7], v[84:87]
    s_waitcnt lgkmcnt(3)
    ds_read_b64_tr_b16 a[134:135], v97 offset:12288
    ds_read_b64_tr_b16 a[136:137], v98 offset:8192
    v_mfma_f32_16x16x32_bf16 v[72:75], a[152:155], a[0:3], v[72:75]
    buffer_load_dwordx4 v24, s[92:95], s59 offen offset:3072 lds
    v_mfma_f32_16x16x32_bf16 v[88:91], a[152:155], a[4:7], v[88:91]
    ds_read_b64_tr_b16 a[138:139], v98 offset:12288
    v_mfma_f32_16x16x32_bf16 v[76:79], a[156:159], a[0:3], v[76:79]
    ds_read_b64_tr_b16 a[140:141], v99 offset:8192
    v_mfma_f32_16x16x32_bf16 v[92:95], a[156:159], a[4:7], v[92:95]
    s_waitcnt lgkmcnt(3)
    s_add_u32 m0, s31, 36864
    ds_read_b64_tr_b16 a[142:143], v99 offset:12288
    v_mfma_f32_16x16x32_bf16 v[32:35], a[128:131], a[8:11], v[32:35]
    ds_read_b64_tr_b16 a[144:145], v100 offset:8192
    buffer_load_dwordx4 v21, s[92:95], s25 offen offset:0 lds
    v_mfma_f32_16x16x32_bf16 v[48:51], a[128:131], a[12:15], v[48:51]
    ds_read_b64_tr_b16 a[146:147], v100 offset:12288
    v_mfma_f32_16x16x32_bf16 v[36:39], a[132:135], a[8:11], v[36:39]
    ds_read_b64_tr_b16 a[148:149], v101 offset:8192
    v_mfma_f32_16x16x32_bf16 v[52:55], a[132:135], a[12:15], v[52:55]
    s_waitcnt lgkmcnt(3)
    ds_read_b64_tr_b16 a[150:151], v101 offset:12288
    ds_read_b64_tr_b16 a[152:153], v102 offset:8192
    v_mfma_f32_16x16x32_bf16 v[40:43], a[136:139], a[8:11], v[40:43]
    buffer_load_dwordx4 v22, s[92:95], s25 offen offset:1024 lds
    v_mfma_f32_16x16x32_bf16 v[56:59], a[136:139], a[12:15], v[56:59]
    ds_read_b64_tr_b16 a[154:155], v102 offset:12288
    v_mfma_f32_16x16x32_bf16 v[44:47], a[140:143], a[8:11], v[44:47]
    ds_read_b64_tr_b16 a[156:157], v103 offset:8192
    ds_read_b64_tr_b16 a[158:159], v103 offset:12288
    v_mfma_f32_16x16x32_bf16 v[60:63], a[140:143], a[12:15], v[60:63]
    s_waitcnt lgkmcnt(4)
    buffer_load_dwordx4 v23, s[92:95], s25 offen offset:2048 lds
    v_mfma_f32_16x16x32_bf16 v[64:67], a[144:147], a[8:11], v[64:67]
    ds_read_b64_tr_b16 a[128:129], v96 offset:16384
    v_mfma_f32_16x16x32_bf16 v[80:83], a[144:147], a[12:15], v[80:83]
    ds_read_b64_tr_b16 a[130:131], v96 offset:20480
    v_mfma_f32_16x16x32_bf16 v[68:71], a[148:151], a[8:11], v[68:71]
    ds_read_b64_tr_b16 a[132:133], v97 offset:16384
    ds_read_b64_tr_b16 a[134:135], v97 offset:20480
    v_mfma_f32_16x16x32_bf16 v[84:87], a[148:151], a[12:15], v[84:87]
    s_waitcnt lgkmcnt(4)
    buffer_load_dwordx4 v24, s[92:95], s25 offen offset:3072 lds
    v_mfma_f32_16x16x32_bf16 v[72:75], a[152:155], a[8:11], v[72:75]
    s_bfe_u32 s3, s60, 0x30012
    s_mul_i32 s3, s3, 1966080
    ds_read_b64_tr_b16 a[136:137], v98 offset:16384
    v_mfma_f32_16x16x32_bf16 v[88:91], a[152:155], a[12:15], v[88:91]
    s_add_u32 s3, s3, 0
    ds_read_b64_tr_b16 a[138:139], v98 offset:20480
    v_mfma_f32_16x16x32_bf16 v[76:79], a[156:159], a[8:11], v[76:79]
    s_add_u32 s58, s3, s52
    ds_read_b64_tr_b16 a[140:141], v99 offset:16384
    ds_read_b64_tr_b16 a[142:143], v99 offset:20480
    v_mfma_f32_16x16x32_bf16 v[92:95], a[156:159], a[12:15], v[92:95]
    s_waitcnt lgkmcnt(4)
    buffer_load_dwordx4 a[64:67], v1, s[20:23], s58 offen offset:0 sc1
    v_mfma_f32_16x16x32_bf16 v[32:35], a[128:131], a[16:19], v[32:35]
    ds_read_b64_tr_b16 a[144:145], v100 offset:16384
    v_mfma_f32_16x16x32_bf16 v[48:51], a[128:131], a[20:23], v[48:51]
    ds_read_b64_tr_b16 a[146:147], v100 offset:20480
    v_mfma_f32_16x16x32_bf16 v[36:39], a[132:135], a[16:19], v[36:39]
    ds_read_b64_tr_b16 a[148:149], v101 offset:16384
    ds_read_b64_tr_b16 a[150:151], v101 offset:20480
    v_mfma_f32_16x16x32_bf16 v[52:55], a[132:135], a[20:23], v[52:55]
    s_waitcnt lgkmcnt(4)
    buffer_load_dwordx4 a[68:71], v2, s[20:23], s58 offen offset:0 sc1
    v_mfma_f32_16x16x32_bf16 v[40:43], a[136:139], a[16:19], v[40:43]
    ds_read_b64_tr_b16 a[152:153], v102 offset:16384
    v_mfma_f32_16x16x32_bf16 v[56:59], a[136:139], a[20:23], v[56:59]
    ds_read_b64_tr_b16 a[154:155], v102 offset:20480
    v_mfma_f32_16x16x32_bf16 v[44:47], a[140:143], a[16:19], v[44:47]
    ds_read_b64_tr_b16 a[156:157], v103 offset:16384
    ds_read_b64_tr_b16 a[158:159], v103 offset:20480
    v_mfma_f32_16x16x32_bf16 v[60:63], a[140:143], a[20:23], v[60:63]
    s_waitcnt lgkmcnt(4)
    buffer_load_dwordx4 a[72:75], v1, s[20:23], s58 offen offset:1024 sc1
    v_mfma_f32_16x16x32_bf16 v[64:67], a[144:147], a[16:19], v[64:67]
    ds_read_b64_tr_b16 a[128:129], v96 offset:24576
    v_mfma_f32_16x16x32_bf16 v[80:83], a[144:147], a[20:23], v[80:83]
    ds_read_b64_tr_b16 a[130:131], v96 offset:28672
    ds_read_b64_tr_b16 a[132:133], v97 offset:24576
    v_mfma_f32_16x16x32_bf16 v[68:71], a[148:151], a[16:19], v[68:71]
    buffer_load_dwordx4 a[76:79], v2, s[20:23], s58 offen offset:1024 sc1
    v_mfma_f32_16x16x32_bf16 v[84:87], a[148:151], a[20:23], v[84:87]
    s_waitcnt lgkmcnt(3)
    ds_read_b64_tr_b16 a[134:135], v97 offset:28672
    v_mfma_f32_16x16x32_bf16 v[72:75], a[152:155], a[16:19], v[72:75]
    ds_read_b64_tr_b16 a[136:137], v98 offset:24576
    v_mfma_f32_16x16x32_bf16 v[88:91], a[152:155], a[20:23], v[88:91]
    ds_read_b64_tr_b16 a[138:139], v98 offset:28672
    ds_read_b64_tr_b16 a[140:141], v99 offset:24576
    v_mfma_f32_16x16x32_bf16 v[76:79], a[156:159], a[16:19], v[76:79]
    buffer_load_dwordx4 a[80:83], v1, s[20:23], s58 offen offset:2048 sc1
    v_mfma_f32_16x16x32_bf16 v[92:95], a[156:159], a[20:23], v[92:95]
    s_waitcnt lgkmcnt(3)
    ds_read_b64_tr_b16 a[142:143], v99 offset:28672
    v_mfma_f32_16x16x32_bf16 v[32:35], a[128:131], a[24:27], v[32:35]
    ds_read_b64_tr_b16 a[144:145], v100 offset:24576
    v_mfma_f32_16x16x32_bf16 v[48:51], a[128:131], a[28:31], v[48:51]
    ds_read_b64_tr_b16 a[146:147], v100 offset:28672
    ds_read_b64_tr_b16 a[148:149], v101 offset:24576
    v_mfma_f32_16x16x32_bf16 v[36:39], a[132:135], a[24:27], v[36:39]
    buffer_load_dwordx4 a[84:87], v2, s[20:23], s58 offen offset:2048 sc1
    v_mfma_f32_16x16x32_bf16 v[52:55], a[132:135], a[28:31], v[52:55]
    s_waitcnt lgkmcnt(3)
    ds_read_b64_tr_b16 a[150:151], v101 offset:28672
    v_mfma_f32_16x16x32_bf16 v[40:43], a[136:139], a[24:27], v[40:43]
    s_waitcnt vmcnt(14)
    ds_read_b64_tr_b16 a[152:153], v102 offset:24576
    v_mfma_f32_16x16x32_bf16 v[56:59], a[136:139], a[28:31], v[56:59]
    ds_read_b64_tr_b16 a[154:155], v102 offset:28672
    ds_read_b64_tr_b16 a[156:157], v103 offset:24576
    v_mfma_f32_16x16x32_bf16 v[44:47], a[140:143], a[24:27], v[44:47]
    buffer_load_dwordx4 a[88:91], v1, s[20:23], s58 offen offset:3072 sc1
    v_mfma_f32_16x16x32_bf16 v[60:63], a[140:143], a[28:31], v[60:63]
    s_waitcnt lgkmcnt(3)
    ds_read_b64_tr_b16 a[158:159], v103 offset:28672
    s_barrier
    v_mfma_f32_16x16x32_bf16 v[64:67], a[144:147], a[24:27], v[64:67]
    ds_read_b64_tr_b16 a[128:129], v8 offset:0
    v_mfma_f32_16x16x32_bf16 v[80:83], a[144:147], a[28:31], v[80:83]
    ds_read_b64_tr_b16 a[130:131], v8 offset:4096
    ds_read_b64_tr_b16 a[132:133], v9 offset:0
    v_mfma_f32_16x16x32_bf16 v[68:71], a[148:151], a[24:27], v[68:71]
    buffer_load_dwordx4 a[92:95], v2, s[20:23], s58 offen offset:3072 sc1
    v_mfma_f32_16x16x32_bf16 v[84:87], a[148:151], a[28:31], v[84:87]
    s_waitcnt lgkmcnt(3)
    ds_read_b64_tr_b16 a[134:135], v9 offset:4096
    v_mfma_f32_16x16x32_bf16 v[72:75], a[152:155], a[24:27], v[72:75]
    ds_read_b64_tr_b16 a[136:137], v10 offset:0
    v_mfma_f32_16x16x32_bf16 v[88:91], a[152:155], a[28:31], v[88:91]
    ds_read_b64_tr_b16 a[138:139], v10 offset:4096
    ds_read_b64_tr_b16 a[140:141], v11 offset:0
    v_mfma_f32_16x16x32_bf16 v[76:79], a[156:159], a[24:27], v[76:79]
    buffer_load_dword v16, v30, s[96:99], 0 offen offset:256 sc1
    v_mfma_f32_16x16x32_bf16 v[92:95], a[156:159], a[28:31], v[92:95]
    s_waitcnt lgkmcnt(3)
    ds_read_b64_tr_b16 a[142:143], v11 offset:4096
    v_mfma_f32_16x16x32_bf16 v[32:35], a[128:131], a[32:35], v[32:35]
    ds_read_b64_tr_b16 a[144:145], v12 offset:0
    ds_read_b64_tr_b16 a[146:147], v12 offset:4096
    s_bfe_u32 s3, s60, 0x30015
    s_mul_i32 s3, s3, 524288
    s_add_u32 s3, s3, 0
    s_add_u32 s59, s3, s53
    s_add_u32 s25, s59, 16384
    s_add_u32 m0, s31, 98304
    v_mfma_f32_16x16x32_bf16 v[48:51], a[128:131], a[36:39], v[48:51]
    buffer_load_dwordx4 v21, s[92:95], s59 offen offset:0 lds
    v_mfma_f32_16x16x32_bf16 v[36:39], a[132:135], a[32:35], v[36:39]
    ds_read_b64_tr_b16 a[148:149], v13 offset:0
    v_mfma_f32_16x16x32_bf16 v[52:55], a[132:135], a[36:39], v[52:55]
    s_waitcnt lgkmcnt(3)
    ds_read_b64_tr_b16 a[150:151], v13 offset:4096
    ds_read_b64_tr_b16 a[152:153], v14 offset:0
    v_mfma_f32_16x16x32_bf16 v[40:43], a[136:139], a[32:35], v[40:43]
    buffer_load_dwordx4 v22, s[92:95], s59 offen offset:1024 lds
    v_mfma_f32_16x16x32_bf16 v[56:59], a[136:139], a[36:39], v[56:59]
    ds_read_b64_tr_b16 a[154:155], v14 offset:4096
    v_mfma_f32_16x16x32_bf16 v[44:47], a[140:143], a[32:35], v[44:47]
    ds_read_b64_tr_b16 a[156:157], v15 offset:0
    ds_read_b64_tr_b16 a[158:159], v15 offset:4096
    v_mfma_f32_16x16x32_bf16 v[60:63], a[140:143], a[36:39], v[60:63]
    s_waitcnt lgkmcnt(4)
    buffer_load_dwordx4 v23, s[92:95], s59 offen offset:2048 lds
    v_mfma_f32_16x16x32_bf16 v[64:67], a[144:147], a[32:35], v[64:67]
    ds_read_b64_tr_b16 a[128:129], v8 offset:8192
    v_mfma_f32_16x16x32_bf16 v[80:83], a[144:147], a[36:39], v[80:83]
    ds_read_b64_tr_b16 a[130:131], v8 offset:12288
    ds_read_b64_tr_b16 a[132:133], v9 offset:8192
    v_mfma_f32_16x16x32_bf16 v[68:71], a[148:151], a[32:35], v[68:71]
    buffer_load_dwordx4 v24, s[92:95], s59 offen offset:3072 lds
    v_mfma_f32_16x16x32_bf16 v[84:87], a[148:151], a[36:39], v[84:87]
    s_waitcnt lgkmcnt(3)
    ds_read_b64_tr_b16 a[134:135], v9 offset:12288
    v_mfma_f32_16x16x32_bf16 v[72:75], a[152:155], a[32:35], v[72:75]
    s_add_u32 m0, s31, 102400
    ds_read_b64_tr_b16 a[136:137], v10 offset:8192
    ds_read_b64_tr_b16 a[138:139], v10 offset:12288
    v_mfma_f32_16x16x32_bf16 v[88:91], a[152:155], a[36:39], v[88:91]
    buffer_load_dwordx4 v21, s[92:95], s25 offen offset:0 lds
    v_mfma_f32_16x16x32_bf16 v[76:79], a[156:159], a[32:35], v[76:79]
    ds_read_b64_tr_b16 a[140:141], v11 offset:8192
    v_mfma_f32_16x16x32_bf16 v[92:95], a[156:159], a[36:39], v[92:95]
    s_waitcnt lgkmcnt(3)
    ds_read_b64_tr_b16 a[142:143], v11 offset:12288
    v_mfma_f32_16x16x32_bf16 v[32:35], a[128:131], a[40:43], v[32:35]
    ds_read_b64_tr_b16 a[144:145], v12 offset:8192
    buffer_load_dwordx4 v22, s[92:95], s25 offen offset:1024 lds
    v_mfma_f32_16x16x32_bf16 v[48:51], a[128:131], a[44:47], v[48:51]
    ds_read_b64_tr_b16 a[146:147], v12 offset:12288
    v_mfma_f32_16x16x32_bf16 v[36:39], a[132:135], a[40:43], v[36:39]
    ds_read_b64_tr_b16 a[148:149], v13 offset:8192
    ds_read_b64_tr_b16 a[150:151], v13 offset:12288
    v_mfma_f32_16x16x32_bf16 v[52:55], a[132:135], a[44:47], v[52:55]
    s_waitcnt lgkmcnt(4)
    buffer_load_dwordx4 v23, s[92:95], s25 offen offset:2048 lds
    v_mfma_f32_16x16x32_bf16 v[40:43], a[136:139], a[40:43], v[40:43]
    ds_read_b64_tr_b16 a[152:153], v14 offset:8192
    v_mfma_f32_16x16x32_bf16 v[56:59], a[136:139], a[44:47], v[56:59]
    ds_read_b64_tr_b16 a[154:155], v14 offset:12288
    ds_read_b64_tr_b16 a[156:157], v15 offset:8192
    v_mfma_f32_16x16x32_bf16 v[44:47], a[140:143], a[40:43], v[44:47]
    buffer_load_dwordx4 v24, s[92:95], s25 offen offset:3072 lds
    v_mfma_f32_16x16x32_bf16 v[60:63], a[140:143], a[44:47], v[60:63]
    s_waitcnt lgkmcnt(3)
    s_bfe_u32 s3, s60, 0x30015
    s_mul_i32 s3, s3, 1966080
    s_add_u32 s3, s3, 0
    ds_read_b64_tr_b16 a[158:159], v15 offset:12288
    v_mfma_f32_16x16x32_bf16 v[64:67], a[144:147], a[40:43], v[64:67]
    s_add_u32 s58, s3, s52
    ds_read_b64_tr_b16 a[128:129], v8 offset:16384
    ds_read_b64_tr_b16 a[130:131], v8 offset:20480
    v_mfma_f32_16x16x32_bf16 v[80:83], a[144:147], a[44:47], v[80:83]
    buffer_load_dwordx4 a[96:99], v1, s[20:23], s58 offen offset:0 sc1
    v_mfma_f32_16x16x32_bf16 v[68:71], a[148:151], a[40:43], v[68:71]
    ds_read_b64_tr_b16 a[132:133], v9 offset:16384
    v_mfma_f32_16x16x32_bf16 v[84:87], a[148:151], a[44:47], v[84:87]
    s_waitcnt lgkmcnt(3)
    ds_read_b64_tr_b16 a[134:135], v9 offset:20480
    ds_read_b64_tr_b16 a[136:137], v10 offset:16384
    v_mfma_f32_16x16x32_bf16 v[72:75], a[152:155], a[40:43], v[72:75]
    buffer_load_dwordx4 a[100:103], v2, s[20:23], s58 offen offset:0 sc1
    v_mfma_f32_16x16x32_bf16 v[88:91], a[152:155], a[44:47], v[88:91]
    ds_read_b64_tr_b16 a[138:139], v10 offset:20480
    v_mfma_f32_16x16x32_bf16 v[76:79], a[156:159], a[40:43], v[76:79]
    ds_read_b64_tr_b16 a[140:141], v11 offset:16384
    ds_read_b64_tr_b16 a[142:143], v11 offset:20480
    v_mfma_f32_16x16x32_bf16 v[92:95], a[156:159], a[44:47], v[92:95]
    s_waitcnt lgkmcnt(4)
    buffer_load_dwordx4 a[104:107], v1, s[20:23], s58 offen offset:1024 sc1
    v_mfma_f32_16x16x32_bf16 v[32:35], a[128:131], a[48:51], v[32:35]
    ds_read_b64_tr_b16 a[144:145], v12 offset:16384
    v_mfma_f32_16x16x32_bf16 v[48:51], a[128:131], a[52:55], v[48:51]
    ds_read_b64_tr_b16 a[146:147], v12 offset:20480
    ds_read_b64_tr_b16 a[148:149], v13 offset:16384
    v_mfma_f32_16x16x32_bf16 v[36:39], a[132:135], a[48:51], v[36:39]
    buffer_load_dwordx4 a[108:111], v2, s[20:23], s58 offen offset:1024 sc1
    v_mfma_f32_16x16x32_bf16 v[52:55], a[132:135], a[52:55], v[52:55]
    s_waitcnt lgkmcnt(3)
    ds_read_b64_tr_b16 a[150:151], v13 offset:20480
    v_mfma_f32_16x16x32_bf16 v[40:43], a[136:139], a[48:51], v[40:43]
    ds_read_b64_tr_b16 a[152:153], v14 offset:16384
    ds_read_b64_tr_b16 a[154:155], v14 offset:20480
    v_mfma_f32_16x16x32_bf16 v[56:59], a[136:139], a[52:55], v[56:59]
    buffer_load_dwordx4 a[112:115], v1, s[20:23], s58 offen offset:2048 sc1
    v_mfma_f32_16x16x32_bf16 v[44:47], a[140:143], a[48:51], v[44:47]
    ds_read_b64_tr_b16 a[156:157], v15 offset:16384
    v_mfma_f32_16x16x32_bf16 v[60:63], a[140:143], a[52:55], v[60:63]
    s_waitcnt lgkmcnt(3)
    ds_read_b64_tr_b16 a[158:159], v15 offset:20480
    v_mfma_f32_16x16x32_bf16 v[64:67], a[144:147], a[48:51], v[64:67]
    ds_read_b64_tr_b16 a[128:129], v8 offset:24576
    buffer_load_dwordx4 a[116:119], v2, s[20:23], s58 offen offset:2048 sc1
    v_mfma_f32_16x16x32_bf16 v[80:83], a[144:147], a[52:55], v[80:83]
    ds_read_b64_tr_b16 a[130:131], v8 offset:28672
    v_mfma_f32_16x16x32_bf16 v[68:71], a[148:151], a[48:51], v[68:71]
    ds_read_b64_tr_b16 a[132:133], v9 offset:24576
    ds_read_b64_tr_b16 a[134:135], v9 offset:28672
    v_mfma_f32_16x16x32_bf16 v[84:87], a[148:151], a[52:55], v[84:87]
    s_waitcnt lgkmcnt(4)
    buffer_load_dwordx4 a[120:123], v1, s[20:23], s58 offen offset:3072 sc1
    v_mfma_f32_16x16x32_bf16 v[72:75], a[152:155], a[48:51], v[72:75]
    ds_read_b64_tr_b16 a[136:137], v10 offset:24576
    v_mfma_f32_16x16x32_bf16 v[88:91], a[152:155], a[52:55], v[88:91]
    ds_read_b64_tr_b16 a[138:139], v10 offset:28672
    ds_read_b64_tr_b16 a[140:141], v11 offset:24576
    v_mfma_f32_16x16x32_bf16 v[76:79], a[156:159], a[48:51], v[76:79]
    buffer_load_dwordx4 a[124:127], v2, s[20:23], s58 offen offset:3072 sc1
    v_mfma_f32_16x16x32_bf16 v[92:95], a[156:159], a[52:55], v[92:95]
    s_waitcnt lgkmcnt(3)
    ds_read_b64_tr_b16 a[142:143], v11 offset:28672
    v_mfma_f32_16x16x32_bf16 v[32:35], a[128:131], a[56:59], v[32:35]
    ds_read_b64_tr_b16 a[144:145], v12 offset:24576
    v_mfma_f32_16x16x32_bf16 v[48:51], a[128:131], a[60:63], v[48:51]
    ds_read_b64_tr_b16 a[146:147], v12 offset:28672
    ds_read_b64_tr_b16 a[148:149], v13 offset:24576
    v_mfma_f32_16x16x32_bf16 v[36:39], a[132:135], a[56:59], v[36:39]
    global_load_dword v31, v110, s[80:81]
    v_mfma_f32_16x16x32_bf16 v[52:55], a[132:135], a[60:63], v[52:55]
    s_waitcnt lgkmcnt(3)
    ds_read_b64_tr_b16 a[150:151], v13 offset:28672
    v_mfma_f32_16x16x32_bf16 v[40:43], a[136:139], a[56:59], v[40:43]
    s_waitcnt vmcnt(17)
    ds_read_b64_tr_b16 a[152:153], v14 offset:24576
    v_readfirstlane_b32 s40, v16
    v_mfma_f32_16x16x32_bf16 v[56:59], a[136:139], a[60:63], v[56:59]
    ds_read_b64_tr_b16 a[154:155], v14 offset:28672
    v_mfma_f32_16x16x32_bf16 v[44:47], a[140:143], a[56:59], v[44:47]
    ds_read_b64_tr_b16 a[156:157], v15 offset:24576
    v_mfma_f32_16x16x32_bf16 v[60:63], a[140:143], a[60:63], v[60:63]
    s_waitcnt lgkmcnt(3)
    ds_read_b64_tr_b16 a[158:159], v15 offset:28672
    s_cmp_ge_u32 s40, s91
    s_cbranch_scc0 L_spin1
L_spin1b:
    s_barrier
    v_mfma_f32_16x16x32_bf16 v[64:67], a[144:147], a[56:59], v[64:67]
    ds_read_b64_tr_b16 a[128:129], v96 offset:32768
    v_mfma_f32_16x16x32_bf16 v[80:83], a[144:147], a[60:63], v[80:83]
    ds_read_b64_tr_b16 a[130:131], v96 offset:36864
    v_mfma_f32_16x16x32_bf16 v[68:71], a[148:151], a[56:59], v[68:71]
    ds_read_b64_tr_b16 a[132:133], v97 offset:32768
    v_mfma_f32_16x16x32_bf16 v[84:87], a[148:151], a[60:63], v[84:87]
    s_waitcnt lgkmcnt(3)
    ds_read_b64_tr_b16 a[134:135], v97 offset:36864
    v_mfma_f32_16x16x32_bf16 v[72:75], a[152:155], a[56:59], v[72:75]
    ds_read_b64_tr_b16 a[136:137], v98 offset:32768
    v_mfma_f32_16x16x32_bf16 v[88:91], a[152:155], a[60:63], v[88:91]
    ds_read_b64_tr_b16 a[138:139], v98 offset:36864
    v_mfma_f32_16x16x32_bf16 v[76:79], a[156:159], a[56:59], v[76:79]
    ds_read_b64_tr_b16 a[140:141], v99 offset:32768
    v_mfma_f32_16x16x32_bf16 v[92:95], a[156:159], a[60:63], v[92:95]
    s_waitcnt lgkmcnt(3)
    ds_read_b64_tr_b16 a[142:143], v99 offset:36864
    v_mfma_f32_16x16x32_bf16 v[32:35], a[128:131], a[64:67], v[32:35]
    ds_read_b64_tr_b16 a[144:145], v100 offset:32768
    ds_read_b64_tr_b16 a[146:147], v100 offset:36864
    s_xor_b32 s3, s54, 0
    s_mul_i32 s3, s3, 524288
    s_add_u32 s3, s3, 131072
    s_add_u32 s59, s3, s53
    s_add_u32 s25, s59, 16384
    s_add_u32 m0, s31, 0
    v_mfma_f32_16x16x32_bf16 v[48:51], a[128:131], a[68:71], v[48:51]
    buffer_load_dwordx4 v21, s[92:95], s59 offen offset:0 lds
    v_mfma_f32_16x16x32_bf16 v[36:39], a[132:135], a[64:67], v[36:39]
    ds_read_b64_tr_b16 a[148:149], v101 offset:32768
    v_mfma_f32_16x16x32_bf16 v[52:55], a[132:135], a[68:71], v[52:55]
    s_waitcnt lgkmcnt(3)
    ds_read_b64_tr_b16 a[150:151], v101 offset:36864
    v_mfma_f32_16x16x32_bf16 v[40:43], a[136:139], a[64:67], v[40:43]
    ds_read_b64_tr_b16 a[152:153], v102 offset:32768
    ds_read_b64_tr_b16 a[154:155], v102 offset:36864
    v_mfma_f32_16x16x32_bf16 v[56:59], a[136:139], a[68:71], v[56:59]
    buffer_load_dwordx4 v22, s[92:95], s59 offen offset:1024 lds
    v_mfma_f32_16x16x32_bf16 v[44:47], a[140:143], a[64:67], v[44:47]
    ds_read_b64_tr_b16 a[156:157], v103 offset:32768
    v_mfma_f32_16x16x32_bf16 v[60:63], a[140:143], a[68:71], v[60:63]
    s_waitcnt lgkmcnt(3)
    ds_read_b64_tr_b16 a[158:159], v103 offset:36864
    v_mfma_f32_16x16x32_bf16 v[64:67], a[144:147], a[64:67], v[64:67]
    ds_read_b64_tr_b16 a[128:129], v96 offset:40960
    ds_read_b64_tr_b16 a[130:131], v96 offset:45056
    v_mfma_f32_16x16x32_bf16 v[80:83], a[144:147], a[68:71], v[80:83]
    buffer_load_dwordx4 v23, s[92:95], s59 offen offset:2048 lds
    v_mfma_f32_16x16x32_bf16 v[68:71], a[148:151], a[64:67], v[68:71]
    ds_read_b64_tr_b16 a[132:133], v97 offset:40960
    v_mfma_f32_16x16x32_bf16 v[84:87], a[148:151], a[68:71], v[84:87]
    s_waitcnt lgkmcnt(3)
    ds_read_b64_tr_b16 a[134:135], v97 offset:45056
    v_mfma_f32_16x16x32_bf16 v[72:75], a[152:155], a[64:67], v[72:75]
    ds_read_b64_tr_b16 a[136:137], v98 offset:40960
    ds_read_b64_tr_b16 a[138:139], v98 offset:45056
    v_mfma_f32_16x16x32_bf16 v[88:91], a[152:155], a[68:71], v[88:91]
    buffer_load_dwordx4 v24, s[92:95], s59 offen offset:3072 lds
    v_mfma_f32_16x16x32_bf16 v[76:79], a[156:159], a[64:67], v[76:79]
    ds_read_b64_tr_b16 a[140:141], v99 offset:40960
    v_mfma_f32_16x16x32_bf16 v[92:95], a[156:159], a[68:71], v[92:95]
    s_waitcnt lgkmcnt(3)
    ds_read_b64_tr_b16 a[142:143], v99 offset:45056
    v_mfma_f32_16x16x32_bf16 v[32:35], a[128:131], a[72:75], v[32:35]
    s_add_u32 m0, s31, 4096
    ds_read_b64_tr_b16 a[144:145], v100 offset:40960
    ds_read_b64_tr_b16 a[146:147], v100 offset:45056
    v_mfma_f32_16x16x32_bf16 v[48:51], a[128:131], a[76:79], v[48:51]
    buffer_load_dwordx4 v21, s[92:95], s25 offen offset:0 lds
    v_mfma_f32_16x16x32_bf16 v[36:39], a[132:135], a[72:75], v[36:39]
    ds_read_b64_tr_b16 a[148:149], v101 offset:40960
    v_mfma_f32_16x16x32_bf16 v[52:55], a[132:135], a[76:79], v[52:55]
    s_waitcnt lgkmcnt(3)
    ds_read_b64_tr_b16 a[150:151], v101 offset:45056
    v_mfma_f32_16x16x32_bf16 v[40:43], a[136:139], a[72:75], v[40:43]
    ds_read_b64_tr_b16 a[152:153], v102 offset:40960
    ds_read_b64_tr_b16 a[154:155], v102 offset:45056
    v_mfma_f32_16x16x32_bf16 v[56:59], a[136:139], a[76:79], v[56:59]
    buffer_load_dwordx4 v22, s[92:95], s25 offen offset:1024 lds
    v_mfma_f32_16x16x32_bf16 v[44:47], a[140:143], a[72:75], v[44:47]
    ds_read_b64_tr_b16 a[156:157], v103 offset:40960
    v_mfma_f32_16x16x32_bf16 v[60:63], a[140:143], a[76:79], v[60:63]
    s_waitcnt lgkmcnt(3)
    ds_read_b64_tr_b16 a[158:159], v103 offset:45056
    v_mfma_f32_16x16x32_bf16 v[64:67], a[144:147], a[72:75], v[64:67]
    ds_read_b64_tr_b16 a[128:129], v96 offset:49152
    ds_read_b64_tr_b16 a[130:131], v96 offset:53248
    v_mfma_f32_16x16x32_bf16 v[80:83], a[144:147], a[76:79], v[80:83]
    buffer_load_dwordx4 v23, s[92:95], s25 offen offset:2048 lds
    v_mfma_f32_16x16x32_bf16 v[68:71], a[148:151], a[72:75], v[68:71]
    ds_read_b64_tr_b16 a[132:133], v97 offset:49152
    v_mfma_f32_16x16x32_bf16 v[84:87], a[148:151], a[76:79], v[84:87]
    s_waitcnt lgkmcnt(3)
    ds_read_b64_tr_b16 a[134:135], v97 offset:53248
    v_mfma_f32_16x16x32_bf16 v[72:75], a[152:155], a[72:75], v[72:75]
    ds_read_b64_tr_b16 a[136:137], v98 offset:49152
    ds_read_b64_tr_b16 a[138:139], v98 offset:53248
    v_mfma_f32_16x16x32_bf16 v[88:91], a[152:155], a[76:79], v[88:91]
    buffer_load_dwordx4 v24, s[92:95], s25 offen offset:3072 lds
    v_mfma_f32_16x16x32_bf16 v[76:79], a[156:159], a[72:75], v[76:79]
    s_xor_b32 s3, s54, 0
    s_mul_i32 s3, s3, 1966080
    ds_read_b64_tr_b16 a[140:141], v99 offset:49152
    v_mfma_f32_16x16x32_bf16 v[92:95], a[156:159], a[76:79], v[92:95]
    s_waitcnt lgkmcnt(3)
    s_add_u32 s3, s3, 491520
    ds_read_b64_tr_b16 a[142:143], v99 offset:53248
    v_mfma_f32_16x16x32_bf16 v[32:35], a[128:131], a[80:83], v[32:35]
    s_add_u32 s58, s3, s52
    ds_read_b64_tr_b16 a[144:145], v100 offset:49152
    ds_read_b64_tr_b16 a[146:147], v100 offset:53248
    v_mfma_f32_16x16x32_bf16 v[48:51], a[128:131], a[84:87], v[48:51]
    buffer_load_dwordx4 a[0:3], v1, s[20:23], s58 offen offset:0 sc1
    v_mfma_f32_16x16x32_bf16 v[36:39], a[132:135], a[80:83], v[36:39]
    ds_read_b64_tr_b16 a[148:149], v101 offset:49152
    v_mfma_f32_16x16x32_bf16 v[52:55], a[132:135], a[84:87], v[52:55]
    s_waitcnt lgkmcnt(3)
    ds_read_b64_tr_b16 a[150:151], v101 offset:53248
    v_mfma_f32_16x16x32_bf16 v[40:43], a[136:139], a[80:83], v[40:43]
    ds_read_b64_tr_b16 a[152:153], v102 offset:49152
    ds_read_b64_tr_b16 a[154:155], v102 offset:53248
    v_mfma_f32_16x16x32_bf16 v[56:59], a[136:139], a[84:87], v[56:59]
    buffer_load_dwordx4 a[4:7], v2, s[20:23], s58 offen offset:0 sc1
    v_mfma_f32_16x16x32_bf16 v[44:47], a[140:143], a[80:83], v[44:47]
    ds_read_b64_tr_b16 a[156:157], v103 offset:49152
    v_mfma_f32_16x16x32_bf16 v[60:63], a[140:143], a[84:87], v[60:63]
    s_waitcnt lgkmcnt(3)
    ds_read_b64_tr_b16 a[158:159], v103 offset:53248
    v_mfma_f32_16x16x32_bf16 v[64:67], a[144:147], a[80:83], v[64:67]
    ds_read_b64_tr_b16 a[128:129], v96 offset:57344
    ds_read_b64_tr_b16 a[130:131], v96 offset:61440
    v_mfma_f32_16x16x32_bf16 v[80:83], a[144:147], a[84:87], v[80:83]
    buffer_load_dwordx4 a[8:11], v1, s[20:23], s58 offen offset:1024 sc1
    v_mfma_f32_16x16x32_bf16 v[68:71], a[148:151], a[80:83], v[68:71]
    ds_read_b64_tr_b16 a[132:133], v97 offset:57344
    v_mfma_f32_16x16x32_bf16 v[84:87], a[148:151], a[84:87], v[84:87]
    s_waitcnt lgkmcnt(3)
    ds_read_b64_tr_b16 a[134:135], v97 offset:61440
    v_mfma_f32_16x16x32_bf16 v[72:75], a[152:155], a[80:83], v[72:75]
    ds_read_b64_tr_b16 a[136:137], v98 offset:57344
    ds_read_b64_tr_b16 a[138:139], v98 offset:61440
    v_mfma_f32_16x16x32_bf16 v[88:91], a[152:155], a[84:87], v[88:91]
    buffer_load_dwordx4 a[12:15], v2, s[20:23], s58 offen offset:1024 sc1
    v_mfma_f32_16x16x32_bf16 v[76:79], a[156:159], a[80:83], v[76:79]
    ds_read_b64_tr_b16 a[140:141], v99 offset:57344
    v_mfma_f32_16x16x32_bf16 v[92:95], a[156:159], a[84:87], v[92:95]
    s_waitcnt lgkmcnt(3)
    ds_read_b64_tr_b16 a[142:143], v99 offset:61440
    v_mfma_f32_16x16x32_bf16 v[32:35], a[128:131], a[88:91], v[32:35]
    ds_read_b64_tr_b16 a[144:145], v100 offset:57344
    ds_read_b64_tr_b16 a[146:147], v100 offset:61440
    v_mfma_f32_16x16x32_bf16 v[48:51], a[128:131], a[92:95], v[48:51]
    buffer_load_dwordx4 a[16:19], v1, s[20:23], s58 offen offset:2048 sc1
    v_mfma_f32_16x16x32_bf16 v[36:39], a[132:135], a[88:91], v[36:39]
    ds_read_b64_tr_b16 a[148:149], v101 offset:57344
    v_mfma_f32_16x16x32_bf16 v[52:55], a[132:135], a[92:95], v[52:55]
    s_waitcnt lgkmcnt(3)
    ds_read_b64_tr_b16 a[150:151], v101 offset:61440
    v_mfma_f32_16x16x32_bf16 v[40:43], a[136:139], a[88:91], v[40:43]
    s_waitcnt vmcnt(14)
    ds_read_b64_tr_b16 a[152:153], v102 offset:57344
    ds_read_b64_tr_b16 a[154:155], v102 offset:61440
    v_mfma_f32_16x16x32_bf16 v[56:59], a[136:139], a[92:95], v[56:59]
    buffer_load_dwordx4 a[20:23], v2, s[20:23], s58 offen offset:2048 sc1
    v_mfma_f32_16x16x32_bf16 v[44:47], a[140:143], a[88:91], v[44:47]
    ds_read_b64_tr_b16 a[156:157], v103 offset:57344
    v_mfma_f32_16x16x32_bf16 v[60:63], a[140:143], a[92:95], v[60:63]
    s_waitcnt lgkmcnt(3)
    ds_read_b64_tr_b16 a[158:159], v103 offset:61440
    s_barrier
    v_mfma_f32_16x16x32_bf16 v[64:67], a[144:147], a[88:91], v[64:67]
    ds_read_b64_tr_b16 a[128:129], v8 offset:32768
    ds_read_b64_tr_b16 a[130:131], v8 offset:36864
    v_mfma_f32_16x16x32_bf16 v[80:83], a[144:147], a[92:95], v[80:83]
    buffer_load_dwordx4 a[24:27], v1, s[20:23], s58 offen offset:3072 sc1
    v_mfma_f32_16x16x32_bf16 v[68:71], a[148:151], a[88:91], v[68:71]
    ds_read_b64_tr_b16 a[132:133], v9 offset:32768
    v_mfma_f32_16x16x32_bf16 v[84:87], a[148:151], a[92:95], v[84:87]
    s_waitcnt lgkmcnt(3)
    ds_read_b64_tr_b16 a[134:135], v9 offset:36864
    v_mfma_f32_16x16x32_bf16 v[72:75], a[152:155], a[88:91], v[72:75]
    ds_read_b64_tr_b16 a[136:137], v10 offset:32768
    v_mfma_f32_16x16x32_bf16 v[88:91], a[152:155], a[92:95], v[88:91]
    ds_read_b64_tr_b16 a[138:139], v10 offset:36864
    ds_read_b64_tr_b16 a[140:141], v11 offset:32768
    v_mfma_f32_16x16x32_bf16 v[76:79], a[156:159], a[88:91], v[76:79]
    buffer_load_dwordx4 a[28:31], v2, s[20:23], s58 offen offset:3072 sc1
    v_mfma_f32_16x16x32_bf16 v[92:95], a[156:159], a[92:95], v[92:95]
    s_waitcnt lgkmcnt(3)
    ds_read_b64_tr_b16 a[142:143], v11 offset:36864
    v_mfma_f32_16x16x32_bf16 v[32:35], a[128:131], a[96:99], v[32:35]
    ds_read_b64_tr_b16 a[144:145], v12 offset:32768
    ds_read_b64_tr_b16 a[146:147], v12 offset:36864
    s_xor_b32 s3, s54, 1
    s_mul_i32 s3, s3, 524288
    s_add_u32 s3, s3, 131072
    s_add_u32 s59, s3, s53
    s_add_u32 s25, s59, 16384
    s_add_u32 m0, s31, 65536
    v_mfma_f32_16x16x32_bf16 v[48:51], a[128:131], a[100:103], v[48:51]
    buffer_load_dwordx4 v21, s[92:95], s59 offen offset:0 lds
    v_mfma_f32_16x16x32_bf16 v[36:39], a[132:135], a[96:99], v[36:39]
    ds_read_b64_tr_b16 a[148:149], v13 offset:32768
    v_mfma_f32_16x16x32_bf16 v[52:55], a[132:135], a[100:103], v[52:55]
    s_waitcnt lgkmcnt(3)
    ds_read_b64_tr_b16 a[150:151], v13 offset:36864
    v_mfma_f32_16x16x32_bf16 v[40:43], a[136:139], a[96:99], v[40:43]
    ds_read_b64_tr_b16 a[152:153], v14 offset:32768
    ds_read_b64_tr_b16 a[154:155], v14 offset:36864
    v_mfma_f32_16x16x32_bf16 v[56:59], a[136:139], a[100:103], v[56:59]
    buffer_load_dwordx4 v22, s[92:95], s59 offen offset:1024 lds
    v_mfma_f32_16x16x32_bf16 v[44:47], a[140:143], a[96:99], v[44:47]
    ds_read_b64_tr_b16 a[156:157], v15 offset:32768
    v_mfma_f32_16x16x32_bf16 v[60:63], a[140:143], a[100:103], v[60:63]
    s_waitcnt lgkmcnt(3)
    ds_read_b64_tr_b16 a[158:159], v15 offset:36864
    v_mfma_f32_16x16x32_bf16 v[64:67], a[144:147], a[96:99], v[64:67]
    ds_read_b64_tr_b16 a[128:129], v8 offset:40960
    ds_read_b64_tr_b16 a[130:131], v8 offset:45056
    v_lshrrev_b32 v118, 3, v0
    v_mfma_f32_16x16x32_bf16 v[80:83], a[144:147], a[100:103], v[80:83]
    buffer_load_dwordx4 v23, s[92:95], s59 offen offset:2048 lds
    v_mfma_f32_16x16x32_bf16 v[68:71], a[148:151], a[96:99], v[68:71]
    ds_read_b64_tr_b16 a[132:133], v9 offset:40960
    v_mfma_f32_16x16x32_bf16 v[84:87], a[148:151], a[100:103], v[84:87]
    s_waitcnt lgkmcnt(3)
    ds_read_b64_tr_b16 a[134:135], v9 offset:45056
    v_and_b32 v119, 6, v118
    v_xor_b32 v119, v119, v0
    v_mfma_f32_16x16x32_bf16 v[72:75], a[152:155], a[96:99], v[72:75]
    ds_read_b64_tr_b16 a[136:137], v10 offset:40960
    ds_read_b64_tr_b16 a[138:139], v10 offset:45056
    v_and_b32 v119, 7, v119
    v_mfma_f32_16x16x32_bf16 v[88:91], a[152:155], a[100:103], v[88:91]
    buffer_load_dwordx4 v24, s[92:95], s59 offen offset:3072 lds
    v_mfma_f32_16x16x32_bf16 v[76:79], a[156:159], a[96:99], v[76:79]
    ds_read_b64_tr_b16 a[140:141], v11 offset:40960
    v_mfma_f32_16x16x32_bf16 v[92:95], a[156:159], a[100:103], v[92:95]
    s_waitcnt lgkmcnt(3)
    ds_read_b64_tr_b16 a[142:143], v11 offset:45056
    v_lshlrev_b32 v119, 4, v119
    v_lshl_add_u32 v25, v118, 10, v119
    v_mfma_f32_16x16x32_bf16 v[32:35], a[128:131], a[104:107], v[32:35]
    s_add_u32 m0, s31, 69632
    ds_read_b64_tr_b16 a[144:145], v12 offset:40960
    ds_read_b64_tr_b16 a[146:147], v12 offset:45056
    v_add_u32 v26, 7168, v25
    v_mfma_f32_16x16x32_bf16 v[48:51], a[128:131], a[108:111], v[48:51]
    buffer_load_dwordx4 v21, s[92:95], s25 offen offset:0 lds
    v_mfma_f32_16x16x32_bf16 v[36:39], a[132:135], a[104:107], v[36:39]
    ds_read_b64_tr_b16 a[148:149], v13 offset:40960
    v_mfma_f32_16x16x32_bf16 v[52:55], a[132:135], a[108:111], v[52:55]
    s_waitcnt lgkmcnt(3)
    ds_read_b64_tr_b16 a[150:151], v13 offset:45056
    v_add_u32 v27, 14336, v25
    v_add_u32 v28, 21504, v25
    v_mfma_f32_16x16x32_bf16 v[40:43], a[136:139], a[104:107], v[40:43]
    ds_read_b64_tr_b16 a[152:153], v14 offset:40960
    ds_read_b64_tr_b16 a[154:155], v14 offset:45056
    v_lshrrev_b32 v4, 2, v0
    v_mfma_f32_16x16x32_bf16 v[56:59], a[136:139], a[108:111], v[56:59]
    buffer_load_dwordx4 v22, s[92:95], s25 offen offset:1024 lds
    v_mfma_f32_16x16x32_bf16 v[44:47], a[140:143], a[104:107], v[44:47]
    ds_read_b64_tr_b16 a[156:157], v15 offset:40960
    v_mfma_f32_16x16x32_bf16 v[60:63], a[140:143], a[108:111], v[60:63]
    s_waitcnt lgkmcnt(3)
    ds_read_b64_tr_b16 a[158:159], v15 offset:45056
    v_and_b32 v5, 3, v0
    v_bfe_u32 v6, v0, 3, 2
    v_mfma_f32_16x16x32_bf16 v[64:67], a[144:147], a[104:107], v[64:67]
    ds_read_b64_tr_b16 a[128:129], v8 offset:49152
    ds_read_b64_tr_b16 a[130:131], v8 offset:53248
    v_lshlrev_b32 v4, 7, v4
    v_mfma_f32_16x16x32_bf16 v[80:83], a[144:147], a[108:111], v[80:83]
    buffer_load_dwordx4 v23, s[92:95], s25 offen offset:2048 lds
    v_mfma_f32_16x16x32_bf16 v[68:71], a[148:151], a[104:107], v[68:71]
    ds_read_b64_tr_b16 a[132:133], v9 offset:49152
    v_mfma_f32_16x16x32_bf16 v[84:87], a[148:151], a[108:111], v[84:87]
    s_waitcnt lgkmcnt(3)
    ds_read_b64_tr_b16 a[134:135], v9 offset:53248
    v_lshl_add_u32 v4, v6, 5, v4
    v_lshl_add_u32 v17, v5, 3, v4
    v_mfma_f32_16x16x32_bf16 v[72:75], a[152:155], a[104:107], v[72:75]
    ds_read_b64_tr_b16 a[136:137], v10 offset:49152
    ds_read_b64_tr_b16 a[138:139], v10 offset:53248
    v_xor_b32 v18, 32, v17
    v_mfma_f32_16x16x32_bf16 v[88:91], a[152:155], a[108:111], v[88:91]
    buffer_load_dwordx4 v24, s[92:95], s25 offen offset:3072 lds
    v_mfma_f32_16x16x32_bf16 v[76:79], a[156:159], a[104:107], v[76:79]
    s_xor_b32 s3, s54, 1
    s_mul_i32 s3, s3, 1966080
    ds_read_b64_tr_b16 a[140:141], v11 offset:49152
    v_mfma_f32_16x16x32_bf16 v[92:95], a[156:159], a[108:111], v[92:95]
    s_waitcnt lgkmcnt(3)
    s_add_u32 s3, s3, 491520
    ds_read_b64_tr_b16 a[142:143], v11 offset:53248
    v_xor_b32 v19, 64, v17
    v_xor_b32 v20, 0x60, v17
    v_mfma_f32_16x16x32_bf16 v[32:35], a[128:131], a[112:115], v[32:35]
    s_add_u32 s58, s3, s52
    ds_read_b64_tr_b16 a[144:145], v12 offset:49152
    ds_read_b64_tr_b16 a[146:147], v12 offset:53248
    v_add_u32 v104, 0x10000, v17
    v_mfma_f32_16x16x32_bf16 v[48:51], a[128:131], a[116:119], v[48:51]
    buffer_load_dwordx4 a[32:35], v1, s[20:23], s58 offen offset:0 sc1
    v_mfma_f32_16x16x32_bf16 v[36:39], a[132:135], a[112:115], v[36:39]
    ds_read_b64_tr_b16 a[148:149], v13 offset:49152
    v_mfma_f32_16x16x32_bf16 v[52:55], a[132:135], a[116:119], v[52:55]
    s_waitcnt lgkmcnt(3)
    ds_read_b64_tr_b16 a[150:151], v13 offset:53248
    v_add_u32 v105, 0x10000, v18
    v_add_u32 v106, 0x10000, v19
    v_mfma_f32_16x16x32_bf16 v[40:43], a[136:139], a[112:115], v[40:43]
    ds_read_b64_tr_b16 a[152:153], v14 offset:49152
    ds_read_b64_tr_b16 a[154:155], v14 offset:53248
    v_add_u32 v107, 0x10000, v20
    v_mfma_f32_16x16x32_bf16 v[56:59], a[136:139], a[116:119], v[56:59]
    buffer_load_dwordx4 a[36:39], v2, s[20:23], s58 offen offset:0 sc1
    v_mfma_f32_16x16x32_bf16 v[44:47], a[140:143], a[112:115], v[44:47]
    ds_read_b64_tr_b16 a[156:157], v15 offset:49152
    v_mfma_f32_16x16x32_bf16 v[60:63], a[140:143], a[116:119], v[60:63]
    s_waitcnt lgkmcnt(3)
    ds_read_b64_tr_b16 a[158:159], v15 offset:53248
    v_and_b32 v4, 15, v0
    v_bfe_u32 v5, v0, 5, 1
    v_mfma_f32_16x16x32_bf16 v[64:67], a[144:147], a[112:115], v[64:67]
    ds_read_b64_tr_b16 a[128:129], v8 offset:57344
    ds_read_b64_tr_b16 a[130:131], v8 offset:61440
    v_bfe_u32 v6, v0, 4, 1
    v_mfma_f32_16x16x32_bf16 v[80:83], a[144:147], a[116:119], v[80:83]
    buffer_load_dwordx4 a[40:43], v1, s[20:23], s58 offen offset:1024 sc1
    v_mfma_f32_16x16x32_bf16 v[68:71], a[148:151], a[112:115], v[68:71]
    ds_read_b64_tr_b16 a[132:133], v9 offset:57344
    v_mfma_f32_16x16x32_bf16 v[84:87], a[148:151], a[116:119], v[84:87]
    s_waitcnt lgkmcnt(3)
    ds_read_b64_tr_b16 a[134:135], v9 offset:61440
    v_lshl_or_b32 v5, v6, 1, v5
    v_lshlrev_b32 v5, 4, v5
    v_mfma_f32_16x16x32_bf16 v[72:75], a[152:155], a[112:115], v[72:75]
    ds_read_b64_tr_b16 a[136:137], v10 offset:57344
    ds_read_b64_tr_b16 a[138:139], v10 offset:61440
    v_lshl_add_u32 v3, v4, 11, v5
    v_mfma_f32_16x16x32_bf16 v[88:91], a[152:155], a[116:119], v[88:91]
    buffer_load_dwordx4 a[44:47], v2, s[20:23], s58 offen offset:1024 sc1
    v_mfma_f32_16x16x32_bf16 v[76:79], a[156:159], a[112:115], v[76:79]
    ds_read_b64_tr_b16 a[140:141], v11 offset:57344
    v_mfma_f32_16x16x32_bf16 v[92:95], a[156:159], a[116:119], v[92:95]
    s_waitcnt lgkmcnt(3)
    ds_read_b64_tr_b16 a[142:143], v11 offset:61440
    v_mfma_f32_16x16x32_bf16 v[32:35], a[128:131], a[120:123], v[32:35]
    ds_read_b64_tr_b16 a[144:145], v12 offset:57344
    ds_read_b64_tr_b16 a[146:147], v12 offset:61440
    v_mfma_f32_16x16x32_bf16 v[48:51], a[128:131], a[124:127], v[48:51]
    buffer_load_dwordx4 a[48:51], v1, s[20:23], s58 offen offset:2048 sc1
    v_mfma_f32_16x16x32_bf16 v[36:39], a[132:135], a[120:123], v[36:39]
    ds_read_b64_tr_b16 a[148:149], v13 offset:57344
    v_mfma_f32_16x16x32_bf16 v[52:55], a[132:135], a[124:127], v[52:55]
    s_waitcnt lgkmcnt(3)
    ds_read_b64_tr_b16 a[150:151], v13 offset:61440
    v_mfma_f32_16x16x32_bf16 v[40:43], a[136:139], a[120:123], v[40:43]
    s_waitcnt vmcnt(13)
    ds_read_b64_tr_b16 a[152:153], v14 offset:57344
    ds_read_b64_tr_b16 a[154:155], v14 offset:61440
    v_mfma_f32_16x16x32_bf16 v[56:59], a[136:139], a[124:127], v[56:59]
    buffer_load_dwordx4 a[52:55], v2, s[20:23], s58 offen offset:2048 sc1
    v_mfma_f32_16x16x32_bf16 v[44:47], a[140:143], a[120:123], v[44:47]
    ds_read_b64_tr_b16 a[156:157], v15 offset:57344
    v_mfma_f32_16x16x32_bf16 v[60:63], a[140:143], a[124:127], v[60:63]
    s_waitcnt lgkmcnt(3)
    ds_read_b64_tr_b16 a[158:159], v15 offset:61440
    s_barrier
    v_mfma_f32_16x16x32_bf16 v[64:67], a[144:147], a[120:123], v[64:67]
    ds_read_b64_tr_b16 a[128:129], v96 offset:0
    ds_read_b64_tr_b16 a[130:131], v96 offset:4096
    v_mfma_f32_16x16x32_bf16 v[80:83], a[144:147], a[124:127], v[80:83]
    buffer_load_dwordx4 a[56:59], v1, s[20:23], s58 offen offset:3072 sc1
    v_mfma_f32_16x16x32_bf16 v[68:71], a[148:151], a[120:123], v[68:71]
    ds_read_b64_tr_b16 a[132:133], v97 offset:0
    v_mfma_f32_16x16x32_bf16 v[84:87], a[148:151], a[124:127], v[84:87]
    s_waitcnt lgkmcnt(3)
    ds_read_b64_tr_b16 a[134:135], v97 offset:4096
    v_mfma_f32_16x16x32_bf16 v[72:75], a[152:155], a[120:123], v[72:75]
    ds_read_b64_tr_b16 a[136:137], v98 offset:0
    v_mfma_f32_16x16x32_bf16 v[88:91], a[152:155], a[124:127], v[88:91]
    ds_read_b64_tr_b16 a[138:139], v98 offset:4096
    ds_read_b64_tr_b16 a[140:141], v99 offset:0
    v_mfma_f32_16x16x32_bf16 v[76:79], a[156:159], a[120:123], v[76:79]
    buffer_load_dwordx4 a[60:63], v2, s[20:23], s58 offen offset:3072 sc1
    v_mfma_f32_16x16x32_bf16 v[92:95], a[156:159], a[124:127], v[92:95]
    s_waitcnt lgkmcnt(3)
    ds_read_b64_tr_b16 a[142:143], v99 offset:4096
    v_mfma_f32_16x16x32_bf16 v[32:35], a[128:131], a[0:3], v[32:35]
    ds_read_b64_tr_b16 a[144:145], v100 offset:0
    ds_read_b64_tr_b16 a[146:147], v100 offset:4096
    s_xor_b32 s3, s54, 2
    s_mul_i32 s3, s3, 524288
    s_add_u32 s3, s3, 131072
    s_add_u32 s59, s3, s53
    s_add_u32 s25, s59, 16384
    s_add_u32 m0, s31, 32768
    v_mfma_f32_16x16x32_bf16 v[48:51], a[128:131], a[4:7], v[48:51]
    buffer_load_dwordx4 v21, s[92:95], s59 offen offset:0 lds
    v_mfma_f32_16x16x32_bf16 v[36:39], a[132:135], a[0:3], v[36:39]
    ds_read_b64_tr_b16 a[148:149], v101 offset:0
    v_mfma_f32_16x16x32_bf16 v[52:55], a[132:135], a[4:7], v[52:55]
    s_waitcnt lgkmcnt(3)
    ds_read_b64_tr_b16 a[150:151], v101 offset:4096
    ds_read_b64_tr_b16 a[152:153], v102 offset:0
    v_mfma_f32_16x16x32_bf16 v[40:43], a[136:139], a[0:3], v[40:43]
    buffer_load_dwordx4 v22, s[92:95], s59 offen offset:1024 lds
    v_mfma_f32_16x16x32_bf16 v[56:59], a[136:139], a[4:7], v[56:59]
    ds_read_b64_tr_b16 a[154:155], v102 offset:4096
    v_mfma_f32_16x16x32_bf16 v[44:47], a[140:143], a[0:3], v[44:47]
    ds_read_b64_tr_b16 a[156:157], v103 offset:0
    v_mfma_f32_16x16x32_bf16 v[60:63], a[140:143], a[4:7], v[60:63]
    s_waitcnt lgkmcnt(3)
    ds_read_b64_tr_b16 a[158:159], v103 offset:4096
    v_mfma_f32_16x16x32_bf16 v[64:67], a[144:147], a[0:3], v[64:67]
    ds_read_b64_tr_b16 a[128:129], v96 offset:8192
    buffer_load_dwordx4 v23, s[92:95], s59 offen offset:2048 lds
    v_mfma_f32_16x16x32_bf16 v[80:83], a[144:147], a[4:7], v[80:83]
    ds_read_b64_tr_b16 a[130:131], v96 offset:12288
    v_mfma_f32_16x16x32_bf16 v[68:71], a[148:151], a[0:3], v[68:71]
    ds_read_b64_tr_b16 a[132:133], v97 offset:8192
    v_mfma_f32_16x16x32_bf16 v[84:87], a[148:151], a[4:7], v[84:87]
    s_waitcnt lgkmcnt(3)
    ds_read_b64_tr_b16 a[134:135], v97 offset:12288
    ds_read_b64_tr_b16 a[136:137], v98 offset:8192
    v_mfma_f32_16x16x32_bf16 v[72:75], a[152:155], a[0:3], v[72:75]
    buffer_load_dwordx4 v24, s[92:95], s59 offen offset:3072 lds
    v_mfma_f32_16x16x32_bf16 v[88:91], a[152:155], a[4:7], v[88:91]
    ds_read_b64_tr_b16 a[138:139], v98 offset:12288
    v_mfma_f32_16x16x32_bf16 v[76:79], a[156:159], a[0:3], v[76:79]
    ds_read_b64_tr_b16 a[140:141], v99 offset:8192
    v_mfma_f32_16x16x32_bf16 v[92:95], a[156:159], a[4:7], v[92:95]
    s_waitcnt lgkmcnt(3)
    s_add_u32 m0, s31, 36864
    ds_read_b64_tr_b16 a[142:143], v99 offset:12288
    v_mfma_f32_16x16x32_bf16 v[32:35], a[128:131], a[8:11], v[32:35]
    ds_read_b64_tr_b16 a[144:145], v100 offset:8192
    buffer_load_dwordx4 v21, s[92:95], s25 offen offset:0 lds
    v_mfma_f32_16x16x32_bf16 v[48:51], a[128:131], a[12:15], v[48:51]
    ds_read_b64_tr_b16 a[146:147], v100 offset:12288
    v_mfma_f32_16x16x32_bf16 v[36:39], a[132:135], a[8:11], v[36:39]
    ds_read_b64_tr_b16 a[148:149], v101 offset:8192
    v_mfma_f32_16x16x32_bf16 v[52:55], a[132:135], a[12:15], v[52:55]
    s_waitcnt lgkmcnt(3)
    ds_read_b64_tr_b16 a[150:151], v101 offset:12288
    ds_read_b64_tr_b16 a[152:153], v102 offset:8192
    v_mfma_f32_16x16x32_bf16 v[40:43], a[136:139], a[8:11], v[40:43]
    buffer_load_dwordx4 v22, s[92:95], s25 offen offset:1024 lds
    v_mfma_f32_16x16x32_bf16 v[56:59], a[136:139], a[12:15], v[56:59]
    ds_read_b64_tr_b16 a[154:155], v102 offset:12288
    v_mfma_f32_16x16x32_bf16 v[44:47], a[140:143], a[8:11], v[44:47]
    ds_read_b64_tr_b16 a[156:157], v103 offset:8192
    ds_read_b64_tr_b16 a[158:159], v103 offset:12288
    v_mfma_f32_16x16x32_bf16 v[60:63], a[140:143], a[12:15], v[60:63]
    s_waitcnt lgkmcnt(4)
    buffer_load_dwordx4 v23, s[92:95], s25 offen offset:2048 lds
    v_mfma_f32_16x16x32_bf16 v[64:67], a[144:147], a[8:11], v[64:67]
    ds_read_b64_tr_b16 a[128:129], v96 offset:16384
    v_mfma_f32_16x16x32_bf16 v[80:83], a[144:147], a[12:15], v[80:83]
    ds_read_b64_tr_b16 a[130:131], v96 offset:20480
    v_mfma_f32_16x16x32_bf16 v[68:71], a[148:151], a[8:11], v[68:71]
    ds_read_b64_tr_b16 a[132:133], v97 offset:16384
    ds_read_b64_tr_b16 a[134:135], v97 offset:20480
    v_mfma_f32_16x16x32_bf16 v[84:87], a[148:151], a[12:15], v[84:87]
    s_waitcnt lgkmcnt(4)
    buffer_load_dwordx4 v24, s[92:95], s25 offen offset:3072 lds
    v_mfma_f32_16x16x32_bf16 v[72:75], a[152:155], a[8:11], v[72:75]
    s_xor_b32 s3, s54, 2
    s_mul_i32 s3, s3, 1966080
    ds_read_b64_tr_b16 a[136:137], v98 offset:16384
    v_mfma_f32_16x16x32_bf16 v[88:91], a[152:155], a[12:15], v[88:91]
    s_add_u32 s3, s3, 491520
    ds_read_b64_tr_b16 a[138:139], v98 offset:20480
    v_mfma_f32_16x16x32_bf16 v[76:79], a[156:159], a[8:11], v[76:79]
    s_add_u32 s58, s3, s52
    ds_read_b64_tr_b16 a[140:141], v99 offset:16384
    ds_read_b64_tr_b16 a[142:143], v99 offset:20480
    v_mfma_f32_16x16x32_bf16 v[92:95], a[156:159], a[12:15], v[92:95]
    s_waitcnt lgkmcnt(4)
    buffer_load_dwordx4 a[64:67], v1, s[20:23], s58 offen offset:0 sc1
    v_mfma_f32_16x16x32_bf16 v[32:35], a[128:131], a[16:19], v[32:35]
    ds_read_b64_tr_b16 a[144:145], v100 offset:16384
    v_mfma_f32_16x16x32_bf16 v[48:51], a[128:131], a[20:23], v[48:51]
    ds_read_b64_tr_b16 a[146:147], v100 offset:20480
    v_mfma_f32_16x16x32_bf16 v[36:39], a[132:135], a[16:19], v[36:39]
    ds_read_b64_tr_b16 a[148:149], v101 offset:16384
    ds_read_b64_tr_b16 a[150:151], v101 offset:20480
    v_mfma_f32_16x16x32_bf16 v[52:55], a[132:135], a[20:23], v[52:55]
    s_waitcnt lgkmcnt(4)
    buffer_load_dwordx4 a[68:71], v2, s[20:23], s58 offen offset:0 sc1
    v_mfma_f32_16x16x32_bf16 v[40:43], a[136:139], a[16:19], v[40:43]
    ds_read_b64_tr_b16 a[152:153], v102 offset:16384
    v_mfma_f32_16x16x32_bf16 v[56:59], a[136:139], a[20:23], v[56:59]
    ds_read_b64_tr_b16 a[154:155], v102 offset:20480
    v_mfma_f32_16x16x32_bf16 v[44:47], a[140:143], a[16:19], v[44:47]
    ds_read_b64_tr_b16 a[156:157], v103 offset:16384
    ds_read_b64_tr_b16 a[158:159], v103 offset:20480
    v_mfma_f32_16x16x32_bf16 v[60:63], a[140:143], a[20:23], v[60:63]
    s_waitcnt lgkmcnt(4)
    buffer_load_dwordx4 a[72:75], v1, s[20:23], s58 offen offset:1024 sc1
    v_mfma_f32_16x16x32_bf16 v[64:67], a[144:147], a[16:19], v[64:67]
    ds_read_b64_tr_b16 a[128:129], v96 offset:24576
    v_mfma_f32_16x16x32_bf16 v[80:83], a[144:147], a[20:23], v[80:83]
    ds_read_b64_tr_b16 a[130:131], v96 offset:28672
    ds_read_b64_tr_b16 a[132:133], v97 offset:24576
    v_mfma_f32_16x16x32_bf16 v[68:71], a[148:151], a[16:19], v[68:71]
    buffer_load_dwordx4 a[76:79], v2, s[20:23], s58 offen offset:1024 sc1
    v_mfma_f32_16x16x32_bf16 v[84:87], a[148:151], a[20:23], v[84:87]
    s_waitcnt lgkmcnt(3)
    ds_read_b64_tr_b16 a[134:135], v97 offset:28672
    v_mfma_f32_16x16x32_bf16 v[72:75], a[152:155], a[16:19], v[72:75]
    ds_read_b64_tr_b16 a[136:137], v98 offset:24576
    v_mfma_f32_16x16x32_bf16 v[88:91], a[152:155], a[20:23], v[88:91]
    ds_read_b64_tr_b16 a[138:139], v98 offset:28672
    ds_read_b64_tr_b16 a[140:141], v99 offset:24576
    v_mfma_f32_16x16x32_bf16 v[76:79], a[156:159], a[16:19], v[76:79]
    buffer_load_dwordx4 a[80:83], v1, s[20:23], s58 offen offset:2048 sc1
    v_mfma_f32_16x16x32_bf16 v[92:95], a[156:159], a[20:23], v[92:95]
    s_waitcnt lgkmcnt(3)
    ds_read_b64_tr_b16 a[142:143], v99 offset:28672
    v_mfma_f32_16x16x32_bf16 v[32:35], a[128:131], a[24:27], v[32:35]
    ds_read_b64_tr_b16 a[144:145], v100 offset:24576
    v_mfma_f32_16x16x32_bf16 v[48:51], a[128:131], a[28:31], v[48:51]
    ds_read_b64_tr_b16 a[146:147], v100 offset:28672
    ds_read_b64_tr_b16 a[148:149], v101 offset:24576
    v_mfma_f32_16x16x32_bf16 v[36:39], a[132:135], a[24:27], v[36:39]
    buffer_load_dwordx4 a[84:87], v2, s[20:23], s58 offen offset:2048 sc1
    v_mfma_f32_16x16x32_bf16 v[52:55], a[132:135], a[28:31], v[52:55]
    s_waitcnt lgkmcnt(3)
    ds_read_b64_tr_b16 a[150:151], v101 offset:28672
    v_mfma_f32_16x16x32_bf16 v[40:43], a[136:139], a[24:27], v[40:43]
    s_waitcnt vmcnt(14)
    ds_read_b64_tr_b16 a[152:153], v102 offset:24576
    v_mfma_f32_16x16x32_bf16 v[56:59], a[136:139], a[28:31], v[56:59]
    ds_read_b64_tr_b16 a[154:155], v102 offset:28672
    ds_read_b64_tr_b16 a[156:157], v103 offset:24576
    v_mfma_f32_16x16x32_bf16 v[44:47], a[140:143], a[24:27], v[44:47]
    buffer_load_dwordx4 a[88:91], v1, s[20:23], s58 offen offset:3072 sc1
    v_mfma_f32_16x16x32_bf16 v[60:63], a[140:143], a[28:31], v[60:63]
    s_waitcnt lgkmcnt(3)
    ds_read_b64_tr_b16 a[158:159], v103 offset:28672
    s_barrier
    v_mfma_f32_16x16x32_bf16 v[64:67], a[144:147], a[24:27], v[64:67]
    ds_read_b64_tr_b16 a[128:129], v8 offset:0
    v_mfma_f32_16x16x32_bf16 v[80:83], a[144:147], a[28:31], v[80:83]
    ds_read_b64_tr_b16 a[130:131], v8 offset:4096
    ds_read_b64_tr_b16 a[132:133], v9 offset:0
    v_mfma_f32_16x16x32_bf16 v[68:71], a[148:151], a[24:27], v[68:71]
    buffer_load_dwordx4 a[92:95], v2, s[20:23], s58 offen offset:3072 sc1
    v_mfma_f32_16x16x32_bf16 v[84:87], a[148:151], a[28:31], v[84:87]
    s_waitcnt lgkmcnt(3)
    ds_read_b64_tr_b16 a[134:135], v9 offset:4096
    v_mfma_f32_16x16x32_bf16 v[72:75], a[152:155], a[24:27], v[72:75]
    ds_read_b64_tr_b16 a[136:137], v10 offset:0
    v_mfma_f32_16x16x32_bf16 v[88:91], a[152:155], a[28:31], v[88:91]
    ds_read_b64_tr_b16 a[138:139], v10 offset:4096
    ds_read_b64_tr_b16 a[140:141], v11 offset:0
    v_mfma_f32_16x16x32_bf16 v[76:79], a[156:159], a[24:27], v[76:79]
    global_load_dword v31, v110, s[80:81]
    v_mfma_f32_16x16x32_bf16 v[92:95], a[156:159], a[28:31], v[92:95]
    s_waitcnt lgkmcnt(3)
    ds_read_b64_tr_b16 a[142:143], v11 offset:4096
    v_mfma_f32_16x16x32_bf16 v[32:35], a[128:131], a[32:35], v[32:35]
    ds_read_b64_tr_b16 a[144:145], v12 offset:0
    ds_read_b64_tr_b16 a[146:147], v12 offset:4096
    s_xor_b32 s3, s54, 3
    s_mul_i32 s3, s3, 524288
    s_add_u32 s3, s3, 131072
    s_add_u32 s59, s3, s53
    s_add_u32 s25, s59, 16384
    s_add_u32 m0, s31, 98304
    v_mfma_f32_16x16x32_bf16 v[48:51], a[128:131], a[36:39], v[48:51]
    buffer_load_dwordx4 v21, s[92:95], s59 offen offset:0 lds
    v_mfma_f32_16x16x32_bf16 v[36:39], a[132:135], a[32:35], v[36:39]
    ds_read_b64_tr_b16 a[148:149], v13 offset:0
    v_mfma_f32_16x16x32_bf16 v[52:55], a[132:135], a[36:39], v[52:55]
    s_waitcnt lgkmcnt(3)
    ds_read_b64_tr_b16 a[150:151], v13 offset:4096
    v_mfma_f32_16x16x32_bf16 v[40:43], a[136:139], a[32:35], v[40:43]
    ds_read_b64_tr_b16 a[152:153], v14 offset:0
    ds_read_b64_tr_b16 a[154:155], v14 offset:4096
    v_mfma_f32_16x16x32_bf16 v[56:59], a[136:139], a[36:39], v[56:59]
    buffer_load_dwordx4 v22, s[92:95], s59 offen offset:1024 lds
    v_mfma_f32_16x16x32_bf16 v[44:47], a[140:143], a[32:35], v[44:47]
    ds_read_b64_tr_b16 a[156:157], v15 offset:0
    v_mfma_f32_16x16x32_bf16 v[60:63], a[140:143], a[36:39], v[60:63]
    s_waitcnt lgkmcnt(3)
    ds_read_b64_tr_b16 a[158:159], v15 offset:4096
    v_mfma_f32_16x16x32_bf16 v[64:67], a[144:147], a[32:35], v[64:67]
    ds_read_b64_tr_b16 a[128:129], v8 offset:8192
    ds_read_b64_tr_b16 a[130:131], v8 offset:12288
    v_mfma_f32_16x16x32_bf16 v[80:83], a[144:147], a[36:39], v[80:83]
    buffer_load_dwordx4 v23, s[92:95], s59 offen offset:2048 lds
    v_mfma_f32_16x16x32_bf16 v[68:71], a[148:151], a[32:35], v[68:71]
    ds_read_b64_tr_b16 a[132:133], v9 offset:8192
    v_mfma_f32_16x16x32_bf16 v[84:87], a[148:151], a[36:39], v[84:87]
    s_waitcnt lgkmcnt(3)
    ds_read_b64_tr_b16 a[134:135], v9 offset:12288
    v_mfma_f32_16x16x32_bf16 v[72:75], a[152:155], a[32:35], v[72:75]
    ds_read_b64_tr_b16 a[136:137], v10 offset:8192
    ds_read_b64_tr_b16 a[138:139], v10 offset:12288
    v_mfma_f32_16x16x32_bf16 v[88:91], a[152:155], a[36:39], v[88:91]
    buffer_load_dwordx4 v24, s[92:95], s59 offen offset:3072 lds
    v_mfma_f32_16x16x32_bf16 v[76:79], a[156:159], a[32:35], v[76:79]
    ds_read_b64_tr_b16 a[140:141], v11 offset:8192
    v_mfma_f32_16x16x32_bf16 v[92:95], a[156:159], a[36:39], v[92:95]
    s_waitcnt lgkmcnt(3)
    ds_read_b64_tr_b16 a[142:143], v11 offset:12288
    v_mfma_f32_16x16x32_bf16 v[32:35], a[128:131], a[40:43], v[32:35]
    s_add_u32 m0, s31, 102400
    ds_read_b64_tr_b16 a[144:145], v12 offset:8192
    ds_read_b64_tr_b16 a[146:147], v12 offset:12288
    v_mfma_f32_16x16x32_bf16 v[48:51], a[128:131], a[44:47], v[48:51]
    buffer_load_dwordx4 v21, s[92:95], s25 offen offset:0 lds
    v_mfma_f32_16x16x32_bf16 v[36:39], a[132:135], a[40:43], v[36:39]
    ds_read_b64_tr_b16 a[148:149], v13 offset:8192
    v_mfma_f32_16x16x32_bf16 v[52:55], a[132:135], a[44:47], v[52:55]
    s_waitcnt lgkmcnt(3)
    ds_read_b64_tr_b16 a[150:151], v13 offset:12288
    v_mfma_f32_16x16x32_bf16 v[40:43], a[136:139], a[40:43], v[40:43]
    ds_read_b64_tr_b16 a[152:153], v14 offset:8192
    ds_read_b64_tr_b16 a[154:155], v14 offset:12288
    v_mfma_f32_16x16x32_bf16 v[56:59], a[136:139], a[44:47], v[56:59]
    buffer_load_dwordx4 v22, s[92:95], s25 offen offset:1024 lds
    v_mfma_f32_16x16x32_bf16 v[44:47], a[140:143], a[40:43], v[44:47]
    ds_read_b64_tr_b16 a[156:157], v15 offset:8192
    v_mfma_f32_16x16x32_bf16 v[60:63], a[140:143], a[44:47], v[60:63]
    s_waitcnt lgkmcnt(3)
    ds_read_b64_tr_b16 a[158:159], v15 offset:12288
    v_mfma_f32_16x16x32_bf16 v[64:67], a[144:147], a[40:43], v[64:67]
    ds_read_b64_tr_b16 a[128:129], v8 offset:16384
    ds_read_b64_tr_b16 a[130:131], v8 offset:20480
    v_mfma_f32_16x16x32_bf16 v[80:83], a[144:147], a[44:47], v[80:83]
    buffer_load_dwordx4 v23, s[92:95], s25 offen offset:2048 lds
    v_mfma_f32_16x16x32_bf16 v[68:71], a[148:151], a[40:43], v[68:71]
    ds_read_b64_tr_b16 a[132:133], v9 offset:16384
    v_mfma_f32_16x16x32_bf16 v[84:87], a[148:151], a[44:47], v[84:87]
    s_waitcnt lgkmcnt(3)
    ds_read_b64_tr_b16 a[134:135], v9 offset:20480
    v_mfma_f32_16x16x32_bf16 v[72:75], a[152:155], a[40:43], v[72:75]
    ds_read_b64_tr_b16 a[136:137], v10 offset:16384
    ds_read_b64_tr_b16 a[138:139], v10 offset:20480
    v_mfma_f32_16x16x32_bf16 v[88:91], a[152:155], a[44:47], v[88:91]
    buffer_load_dwordx4 v24, s[92:95], s25 offen offset:3072 lds
    v_mfma_f32_16x16x32_bf16 v[76:79], a[156:159], a[40:43], v[76:79]
    s_xor_b32 s3, s54, 3
    s_mul_i32 s3, s3, 1966080
    ds_read_b64_tr_b16 a[140:141], v11 offset:16384
    v_mfma_f32_16x16x32_bf16 v[92:95], a[156:159], a[44:47], v[92:95]
    s_waitcnt lgkmcnt(3)
    s_add_u32 s3, s3, 491520
    ds_read_b64_tr_b16 a[142:143], v11 offset:20480
    v_mfma_f32_16x16x32_bf16 v[32:35], a[128:131], a[48:51], v[32:35]
    s_add_u32 s58, s3, s52
    ds_read_b64_tr_b16 a[144:145], v12 offset:16384
    ds_read_b64_tr_b16 a[146:147], v12 offset:20480
    v_mfma_f32_16x16x32_bf16 v[48:51], a[128:131], a[52:55], v[48:51]
    buffer_load_dwordx4 a[96:99], v1, s[20:23], s58 offen offset:0 sc1
    v_mfma_f32_16x16x32_bf16 v[36:39], a[132:135], a[48:51], v[36:39]
    ds_read_b64_tr_b16 a[148:149], v13 offset:16384
    v_mfma_f32_16x16x32_bf16 v[52:55], a[132:135], a[52:55], v[52:55]
    s_waitcnt lgkmcnt(3)
    ds_read_b64_tr_b16 a[150:151], v13 offset:20480
    v_mfma_f32_16x16x32_bf16 v[40:43], a[136:139], a[48:51], v[40:43]
    ds_read_b64_tr_b16 a[152:153], v14 offset:16384
    ds_read_b64_tr_b16 a[154:155], v14 offset:20480
    v_mfma_f32_16x16x32_bf16 v[56:59], a[136:139], a[52:55], v[56:59]
    buffer_load_dwordx4 a[100:103], v2, s[20:23], s58 offen offset:0 sc1
    v_mfma_f32_16x16x32_bf16 v[44:47], a[140:143], a[48:51], v[44:47]
    ds_read_b64_tr_b16 a[156:157], v15 offset:16384
    v_mfma_f32_16x16x32_bf16 v[60:63], a[140:143], a[52:55], v[60:63]
    s_waitcnt lgkmcnt(3)
    ds_read_b64_tr_b16 a[158:159], v15 offset:20480
    v_mfma_f32_16x16x32_bf16 v[64:67], a[144:147], a[48:51], v[64:67]
    ds_read_b64_tr_b16 a[128:129], v8 offset:24576
    ds_read_b64_tr_b16 a[130:131], v8 offset:28672
    v_mfma_f32_16x16x32_bf16 v[80:83], a[144:147], a[52:55], v[80:83]
    buffer_load_dwordx4 a[104:107], v1, s[20:23], s58 offen offset:1024 sc1
    v_mfma_f32_16x16x32_bf16 v[68:71], a[148:151], a[48:51], v[68:71]
    ds_read_b64_tr_b16 a[132:133], v9 offset:24576
    v_mfma_f32_16x16x32_bf16 v[84:87], a[148:151], a[52:55], v[84:87]
    s_waitcnt lgkmcnt(3)
    ds_read_b64_tr_b16 a[134:135], v9 offset:28672
    v_mfma_f32_16x16x32_bf16 v[72:75], a[152:155], a[48:51], v[72:75]
    ds_read_b64_tr_b16 a[136:137], v10 offset:24576
    ds_read_b64_tr_b16 a[138:139], v10 offset:28672
    v_mfma_f32_16x16x32_bf16 v[88:91], a[152:155], a[52:55], v[88:91]
    buffer_load_dwordx4 a[108:111], v2, s[20:23], s58 offen offset:1024 sc1
    v_mfma_f32_16x16x32_bf16 v[76:79], a[156:159], a[48:51], v[76:79]
    ds_read_b64_tr_b16 a[140:141], v11 offset:24576
    v_mfma_f32_16x16x32_bf16 v[92:95], a[156:159], a[52:55], v[92:95]
    s_waitcnt lgkmcnt(3)
    ds_read_b64_tr_b16 a[142:143], v11 offset:28672
    v_mfma_f32_16x16x32_bf16 v[32:35], a[128:131], a[56:59], v[32:35]
    ds_read_b64_tr_b16 a[144:145], v12 offset:24576
    ds_read_b64_tr_b16 a[146:147], v12 offset:28672
    v_mfma_f32_16x16x32_bf16 v[48:51], a[128:131], a[60:63], v[48:51]
    buffer_load_dwordx4 a[112:115], v1, s[20:23], s58 offen offset:2048 sc1
    v_mfma_f32_16x16x32_bf16 v[36:39], a[132:135], a[56:59], v[36:39]
    ds_read_b64_tr_b16 a[148:149], v13 offset:24576
    v_mfma_f32_16x16x32_bf16 v[52:55], a[132:135], a[60:63], v[52:55]
    s_waitcnt lgkmcnt(3)
    ds_read_b64_tr_b16 a[150:151], v13 offset:28672
    v_mfma_f32_16x16x32_bf16 v[40:43], a[136:139], a[56:59], v[40:43]
    s_waitcnt vmcnt(14)
    ds_read_b64_tr_b16 a[152:153], v14 offset:24576
    ds_read_b64_tr_b16 a[154:155], v14 offset:28672
    v_mfma_f32_16x16x32_bf16 v[56:59], a[136:139], a[60:63], v[56:59]
    buffer_load_dwordx4 a[116:119], v2, s[20:23], s58 offen offset:2048 sc1
    v_mfma_f32_16x16x32_bf16 v[44:47], a[140:143], a[56:59], v[44:47]
    ds_read_b64_tr_b16 a[156:157], v15 offset:24576
    v_mfma_f32_16x16x32_bf16 v[60:63], a[140:143], a[60:63], v[60:63]
    s_waitcnt lgkmcnt(3)
    ds_read_b64_tr_b16 a[158:159], v15 offset:28672
    s_barrier
    v_mfma_f32_16x16x32_bf16 v[64:67], a[144:147], a[56:59], v[64:67]
    ds_read_b64_tr_b16 a[128:129], v96 offset:32768
    ds_read_b64_tr_b16 a[130:131], v96 offset:36864
    v_mfma_f32_16x16x32_bf16 v[80:83], a[144:147], a[60:63], v[80:83]
    buffer_load_dwordx4 a[120:123], v1, s[20:23], s58 offen offset:3072 sc1
    v_mfma_f32_16x16x32_bf16 v[68:71], a[148:151], a[56:59], v[68:71]
    ds_read_b64_tr_b16 a[132:133], v97 offset:32768
    v_mfma_f32_16x16x32_bf16 v[84:87], a[148:151], a[60:63], v[84:87]
    s_waitcnt lgkmcnt(3)
    ds_read_b64_tr_b16 a[134:135], v97 offset:36864
    v_mfma_f32_16x16x32_bf16 v[72:75], a[152:155], a[56:59], v[72:75]
    ds_read_b64_tr_b16 a[136:137], v98 offset:32768
    v_mfma_f32_16x16x32_bf16 v[88:91], a[152:155], a[60:63], v[88:91]
    ds_read_b64_tr_b16 a[138:139], v98 offset:36864
    ds_read_b64_tr_b16 a[140:141], v99 offset:32768
    v_mfma_f32_16x16x32_bf16 v[76:79], a[156:159], a[56:59], v[76:79]
    buffer_load_dwordx4 a[124:127], v2, s[20:23], s58 offen offset:3072 sc1
    v_mfma_f32_16x16x32_bf16 v[92:95], a[156:159], a[60:63], v[92:95]
    s_waitcnt lgkmcnt(3)
    ds_read_b64_tr_b16 a[142:143], v99 offset:36864
    v_mfma_f32_16x16x32_bf16 v[32:35], a[128:131], a[64:67], v[32:35]
    ds_read_b64_tr_b16 a[144:145], v100 offset:32768
    ds_read_b64_tr_b16 a[146:147], v100 offset:36864
    s_bfe_u32 s3, s60, 0x30000
    s_mul_i32 s3, s3, 262144
    s_add_u32 s3, s3, 2228224
    s_add_u32 s59, s3, s57
    s_add_u32 m0, s30, 0
    v_mfma_f32_16x16x32_bf16 v[48:51], a[128:131], a[68:71], v[48:51]
    buffer_load_dwordx4 v25, s[92:95], s59 offen offset:0 lds
    v_mfma_f32_16x16x32_bf16 v[36:39], a[132:135], a[64:67], v[36:39]
    ds_read_b64_tr_b16 a[148:149], v101 offset:32768
    ds_read_b64_tr_b16 a[150:151], v101 offset:36864
    v_mfma_f32_16x16x32_bf16 v[52:55], a[132:135], a[68:71], v[52:55]
    s_waitcnt lgkmcnt(4)
    buffer_load_dwordx4 v26, s[92:95], s59 offen offset:1024 lds
    v_mfma_f32_16x16x32_bf16 v[40:43], a[136:139], a[64:67], v[40:43]
    ds_read_b64_tr_b16 a[152:153], v102 offset:32768
    v_mfma_f32_16x16x32_bf16 v[56:59], a[136:139], a[68:71], v[56:59]
    ds_read_b64_tr_b16 a[154:155], v102 offset:36864
    ds_read_b64_tr_b16 a[156:157], v103 offset:32768
    v_mfma_f32_16x16x32_bf16 v[44:47], a[140:143], a[64:67], v[44:47]
    buffer_load_dwordx4 v27, s[92:95], s59 offen offset:2048 lds
    v_mfma_f32_16x16x32_bf16 v[60:63], a[140:143], a[68:71], v[60:63]
    s_waitcnt lgkmcnt(3)
    ds_read_b64_tr_b16 a[158:159], v103 offset:36864
    v_mfma_f32_16x16x32_bf16 v[64:67], a[144:147], a[64:67], v[64:67]
    ds_read_b64_tr_b16 a[128:129], v96 offset:40960
    buffer_load_dwordx4 v28, s[92:95], s59 offen offset:3072 lds
    v_mfma_f32_16x16x32_bf16 v[80:83], a[144:147], a[68:71], v[80:83]
    s_bfe_u32 s3, s60, 0x30000
    s_mul_i32 s3, s3, 983040
    s_add_u32 s3, s3, 8355840
    ds_read_b64_tr_b16 a[130:131], v96 offset:45056
    v_mfma_f32_16x16x32_bf16 v[68:71], a[148:151], a[64:67], v[68:71]
    s_add_u32 s58, s3, s56
    ds_read_b64_tr_b16 a[132:133], v97 offset:40960
    ds_read_b64_tr_b16 a[134:135], v97 offset:45056
    v_mfma_f32_16x16x32_bf16 v[84:87], a[148:151], a[68:71], v[84:87]
    s_waitcnt lgkmcnt(4)
    buffer_load_dwordx4 a[192:195], v1, s[20:23], s58 offen offset:0 sc1
    v_mfma_f32_16x16x32_bf16 v[72:75], a[152:155], a[64:67], v[72:75]
    ds_read_b64_tr_b16 a[136:137], v98 offset:40960
    v_mfma_f32_16x16x32_bf16 v[88:91], a[152:155], a[68:71], v[88:91]
    ds_read_b64_tr_b16 a[138:139], v98 offset:45056
    ds_read_b64_tr_b16 a[140:141], v99 offset:40960
    v_mfma_f32_16x16x32_bf16 v[76:79], a[156:159], a[64:67], v[76:79]
    buffer_load_dwordx4 a[196:199], v2, s[20:23], s58 offen offset:0 sc1
    v_mfma_f32_16x16x32_bf16 v[92:95], a[156:159], a[68:71], v[92:95]
    s_waitcnt lgkmcnt(3)
    ds_read_b64_tr_b16 a[142:143], v99 offset:45056
    v_mfma_f32_16x16x32_bf16 v[32:35], a[128:131], a[72:75], v[32:35]
    ds_read_b64_tr_b16 a[144:145], v100 offset:40960
    buffer_load_dwordx4 a[200:203], v1, s[20:23], s58 offen offset:1024 sc1
    v_mfma_f32_16x16x32_bf16 v[48:51], a[128:131], a[76:79], v[48:51]
    ds_read_b64_tr_b16 a[146:147], v100 offset:45056
    v_mfma_f32_16x16x32_bf16 v[36:39], a[132:135], a[72:75], v[36:39]
    ds_read_b64_tr_b16 a[148:149], v101 offset:40960
    ds_read_b64_tr_b16 a[150:151], v101 offset:45056
    v_mfma_f32_16x16x32_bf16 v[52:55], a[132:135], a[76:79], v[52:55]
    s_waitcnt lgkmcnt(4)
    buffer_load_dwordx4 a[204:207], v2, s[20:23], s58 offen offset:1024 sc1
    v_mfma_f32_16x16x32_bf16 v[40:43], a[136:139], a[72:75], v[40:43]
    ds_read_b64_tr_b16 a[152:153], v102 offset:40960
    v_mfma_f32_16x16x32_bf16 v[56:59], a[136:139], a[76:79], v[56:59]
    ds_read_b64_tr_b16 a[154:155], v102 offset:45056
    ds_read_b64_tr_b16 a[156:157], v103 offset:40960
    v_mfma_f32_16x16x32_bf16 v[44:47], a[140:143], a[72:75], v[44:47]
    buffer_load_dwordx4 a[208:211], v1, s[20:23], s58 offen offset:2048 sc1
    v_mfma_f32_16x16x32_bf16 v[60:63], a[140:143], a[76:79], v[60:63]
    s_waitcnt lgkmcnt(3)
    ds_read_b64_tr_b16 a[158:159], v103 offset:45056
    v_mfma_f32_16x16x32_bf16 v[64:67], a[144:147], a[72:75], v[64:67]
    ds_read_b64_tr_b16 a[128:129], v96 offset:49152
    buffer_load_dwordx4 a[212:215], v2, s[20:23], s58 offen offset:2048 sc1
    v_mfma_f32_16x16x32_bf16 v[80:83], a[144:147], a[76:79], v[80:83]
    ds_read_b64_tr_b16 a[130:131], v96 offset:53248
    v_mfma_f32_16x16x32_bf16 v[68:71], a[148:151], a[72:75], v[68:71]
    ds_read_b64_tr_b16 a[132:133], v97 offset:49152
    ds_read_b64_tr_b16 a[134:135], v97 offset:53248
    v_mfma_f32_16x16x32_bf16 v[84:87], a[148:151], a[76:79], v[84:87]
    s_waitcnt lgkmcnt(4)
    buffer_load_dwordx4 a[216:219], v1, s[20:23], s58 offen offset:3072 sc1
    v_mfma_f32_16x16x32_bf16 v[72:75], a[152:155], a[72:75], v[72:75]
    ds_read_b64_tr_b16 a[136:137], v98 offset:49152
    v_mfma_f32_16x16x32_bf16 v[88:91], a[152:155], a[76:79], v[88:91]
    ds_read_b64_tr_b16 a[138:139], v98 offset:53248
    ds_read_b64_tr_b16 a[140:141], v99 offset:49152
    v_mfma_f32_16x16x32_bf16 v[76:79], a[156:159], a[72:75], v[76:79]
    buffer_load_dwordx4 a[220:223], v2, s[20:23], s58 offen offset:3072 sc1
    v_mfma_f32_16x16x32_bf16 v[92:95], a[156:159], a[76:79], v[92:95]
    s_waitcnt lgkmcnt(3)
    s_bfe_u32 s3, s60, 0x30003
    s_mul_i32 s3, s3, 262144
    s_add_u32 s3, s3, 2228224
    s_add_u32 s59, s3, s57
    s_add_u32 m0, s30, 16384
    ds_read_b64_tr_b16 a[142:143], v99 offset:53248
    v_mfma_f32_16x16x32_bf16 v[32:35], a[128:131], a[80:83], v[32:35]
    ds_read_b64_tr_b16 a[144:145], v100 offset:49152
    buffer_load_dwordx4 v25, s[92:95], s59 offen offset:0 lds
    v_mfma_f32_16x16x32_bf16 v[48:51], a[128:131], a[84:87], v[48:51]
    ds_read_b64_tr_b16 a[146:147], v100 offset:53248
    v_mfma_f32_16x16x32_bf16 v[36:39], a[132:135], a[80:83], v[36:39]
    ds_read_b64_tr_b16 a[148:149], v101 offset:49152
    ds_read_b64_tr_b16 a[150:151], v101 offset:53248
    v_mfma_f32_16x16x32_bf16 v[52:55], a[132:135], a[84:87], v[52:55]
    s_waitcnt lgkmcnt(4)
    buffer_load_dwordx4 v26, s[92:95], s59 offen offset:1024 lds
    v_mfma_f32_16x16x32_bf16 v[40:43], a[136:139], a[80:83], v[40:43]
    ds_read_b64_tr_b16 a[152:153], v102 offset:49152
    v_mfma_f32_16x16x32_bf16 v[56:59], a[136:139], a[84:87], v[56:59]
    ds_read_b64_tr_b16 a[154:155], v102 offset:53248
    ds_read_b64_tr_b16 a[156:157], v103 offset:49152
    v_mfma_f32_16x16x32_bf16 v[44:47], a[140:143], a[80:83], v[44:47]
    buffer_load_dwordx4 v27, s[92:95], s59 offen offset:2048 lds
    v_mfma_f32_16x16x32_bf16 v[60:63], a[140:143], a[84:87], v[60:63]
    s_waitcnt lgkmcnt(3)
    ds_read_b64_tr_b16 a[158:159], v103 offset:53248
    v_mfma_f32_16x16x32_bf16 v[64:67], a[144:147], a[80:83], v[64:67]
    ds_read_b64_tr_b16 a[128:129], v96 offset:57344
    buffer_load_dwordx4 v28, s[92:95], s59 offen offset:3072 lds
    v_mfma_f32_16x16x32_bf16 v[80:83], a[144:147], a[84:87], v[80:83]
    s_bfe_u32 s3, s60, 0x30003
    s_mul_i32 s3, s3, 983040
    s_add_u32 s3, s3, 8355840
    ds_read_b64_tr_b16 a[130:131], v96 offset:61440
    v_mfma_f32_16x16x32_bf16 v[68:71], a[148:151], a[80:83], v[68:71]
    s_add_u32 s58, s3, s56
    ds_read_b64_tr_b16 a[132:133], v97 offset:57344
    ds_read_b64_tr_b16 a[134:135], v97 offset:61440
    v_mfma_f32_16x16x32_bf16 v[84:87], a[148:151], a[84:87], v[84:87]
    s_waitcnt lgkmcnt(4)
    buffer_load_dwordx4 a[224:227], v1, s[20:23], s58 offen offset:0 sc1
    v_mfma_f32_16x16x32_bf16 v[72:75], a[152:155], a[80:83], v[72:75]
    ds_read_b64_tr_b16 a[136:137], v98 offset:57344
    v_mfma_f32_16x16x32_bf16 v[88:91], a[152:155], a[84:87], v[88:91]
    ds_read_b64_tr_b16 a[138:139], v98 offset:61440
    ds_read_b64_tr_b16 a[140:141], v99 offset:57344
    v_mfma_f32_16x16x32_bf16 v[76:79], a[156:159], a[80:83], v[76:79]
    buffer_load_dwordx4 a[228:231], v2, s[20:23], s58 offen offset:0 sc1
    v_mfma_f32_16x16x32_bf16 v[92:95], a[156:159], a[84:87], v[92:95]
    s_waitcnt lgkmcnt(3)
    ds_read_b64_tr_b16 a[142:143], v99 offset:61440
    v_mfma_f32_16x16x32_bf16 v[32:35], a[128:131], a[88:91], v[32:35]
    ds_read_b64_tr_b16 a[144:145], v100 offset:57344
    buffer_load_dwordx4 a[232:235], v1, s[20:23], s58 offen offset:1024 sc1
    v_mfma_f32_16x16x32_bf16 v[48:51], a[128:131], a[92:95], v[48:51]
    ds_read_b64_tr_b16 a[146:147], v100 offset:61440
    v_mfma_f32_16x16x32_bf16 v[36:39], a[132:135], a[88:91], v[36:39]
    ds_read_b64_tr_b16 a[148:149], v101 offset:57344
    ds_read_b64_tr_b16 a[150:151], v101 offset:61440
    v_mfma_f32_16x16x32_bf16 v[52:55], a[132:135], a[92:95], v[52:55]
    s_waitcnt lgkmcnt(4)
    buffer_load_dwordx4 a[236:239], v2, s[20:23], s58 offen offset:1024 sc1
    v_mfma_f32_16x16x32_bf16 v[40:43], a[136:139], a[88:91], v[40:43]
    s_waitcnt vmcnt(20)
    ds_read_b64_tr_b16 a[152:153], v102 offset:57344
    v_mfma_f32_16x16x32_bf16 v[56:59], a[136:139], a[92:95], v[56:59]
    ds_read_b64_tr_b16 a[154:155], v102 offset:61440
    ds_read_b64_tr_b16 a[156:157], v103 offset:57344
    v_mfma_f32_16x16x32_bf16 v[44:47], a[140:143], a[88:91], v[44:47]
    buffer_load_dwordx4 a[240:243], v1, s[20:23], s58 offen offset:2048 sc1
    v_mfma_f32_16x16x32_bf16 v[60:63], a[140:143], a[92:95], v[60:63]
    s_waitcnt lgkmcnt(3)
    ds_read_b64_tr_b16 a[158:159], v103 offset:61440
    s_barrier
    v_mfma_f32_16x16x32_bf16 v[64:67], a[144:147], a[88:91], v[64:67]
    ds_read_b64_tr_b16 a[128:129], v8 offset:32768
    buffer_load_dwordx4 a[244:247], v2, s[20:23], s58 offen offset:2048 sc1
    v_mfma_f32_16x16x32_bf16 v[80:83], a[144:147], a[92:95], v[80:83]
    ds_read_b64_tr_b16 a[130:131], v8 offset:36864
    v_mfma_f32_16x16x32_bf16 v[68:71], a[148:151], a[88:91], v[68:71]
    ds_read_b64_tr_b16 a[132:133], v9 offset:32768
    ds_read_b64_tr_b16 a[134:135], v9 offset:36864
    v_mfma_f32_16x16x32_bf16 v[84:87], a[148:151], a[92:95], v[84:87]
    s_waitcnt lgkmcnt(4)
    buffer_load_dwordx4 a[248:251], v1, s[20:23], s58 offen offset:3072 sc1
    v_mfma_f32_16x16x32_bf16 v[72:75], a[152:155], a[88:91], v[72:75]
    ds_read_b64_tr_b16 a[136:137], v10 offset:32768
    v_mfma_f32_16x16x32_bf16 v[88:91], a[152:155], a[92:95], v[88:91]
    ds_read_b64_tr_b16 a[138:139], v10 offset:36864
    ds_read_b64_tr_b16 a[140:141], v11 offset:32768
    v_mfma_f32_16x16x32_bf16 v[76:79], a[156:159], a[88:91], v[76:79]
    buffer_load_dwordx4 a[252:255], v2, s[20:23], s58 offen offset:3072 sc1
    v_mfma_f32_16x16x32_bf16 v[92:95], a[156:159], a[92:95], v[92:95]
    s_waitcnt lgkmcnt(3)
    ds_read_b64_tr_b16 a[142:143], v11 offset:36864
    v_mfma_f32_16x16x32_bf16 v[32:35], a[128:131], a[96:99], v[32:35]
    ds_read_b64_tr_b16 a[144:145], v12 offset:32768
    ds_read_b64_tr_b16 a[146:147], v12 offset:36864
    s_bfe_u32 s3, s60, 0x30006
    s_mul_i32 s3, s3, 262144
    s_add_u32 s3, s3, 2228224
    s_add_u32 s59, s3, s57
    s_add_u32 m0, s30, 65536
    v_mfma_f32_16x16x32_bf16 v[48:51], a[128:131], a[100:103], v[48:51]
    buffer_load_dwordx4 v25, s[92:95], s59 offen offset:0 lds
    v_mfma_f32_16x16x32_bf16 v[36:39], a[132:135], a[96:99], v[36:39]
    ds_read_b64_tr_b16 a[148:149], v13 offset:32768
    v_mfma_f32_16x16x32_bf16 v[52:55], a[132:135], a[100:103], v[52:55]
    s_waitcnt lgkmcnt(3)
    ds_read_b64_tr_b16 a[150:151], v13 offset:36864
    ds_read_b64_tr_b16 a[152:153], v14 offset:32768
    v_mfma_f32_16x16x32_bf16 v[40:43], a[136:139], a[96:99], v[40:43]
    buffer_load_dwordx4 v26, s[92:95], s59 offen offset:1024 lds
    v_mfma_f32_16x16x32_bf16 v[56:59], a[136:139], a[100:103], v[56:59]
    ds_read_b64_tr_b16 a[154:155], v14 offset:36864
    v_mfma_f32_16x16x32_bf16 v[44:47], a[140:143], a[96:99], v[44:47]
    ds_read_b64_tr_b16 a[156:157], v15 offset:32768
    v_mfma_f32_16x16x32_bf16 v[60:63], a[140:143], a[100:103], v[60:63]
    s_waitcnt lgkmcnt(3)
    ds_read_b64_tr_b16 a[158:159], v15 offset:36864
    v_mfma_f32_16x16x32_bf16 v[64:67], a[144:147], a[96:99], v[64:67]
    ds_read_b64_tr_b16 a[128:129], v8 offset:40960
    buffer_load_dwordx4 v27, s[92:95], s59 offen offset:2048 lds
    v_mfma_f32_16x16x32_bf16 v[80:83], a[144:147], a[100:103], v[80:83]
    ds_read_b64_tr_b16 a[130:131], v8 offset:45056
    v_mfma_f32_16x16x32_bf16 v[68:71], a[148:151], a[96:99], v[68:71]
    ds_read_b64_tr_b16 a[132:133], v9 offset:40960
    v_mfma_f32_16x16x32_bf16 v[84:87], a[148:151], a[100:103], v[84:87]
    s_waitcnt lgkmcnt(3)
    ds_read_b64_tr_b16 a[134:135], v9 offset:45056
    ds_read_b64_tr_b16 a[136:137], v10 offset:40960
    v_mfma_f32_16x16x32_bf16 v[72:75], a[152:155], a[96:99], v[72:75]
    buffer_load_dwordx4 v28, s[92:95], s59 offen offset:3072 lds
    v_mfma_f32_16x16x32_bf16 v[88:91], a[152:155], a[100:103], v[88:91]
    s_bfe_u32 s3, s60, 0x30006
    s_mul_i32 s3, s3, 983040
    ds_read_b64_tr_b16 a[138:139], v10 offset:45056
    v_mfma_f32_16x16x32_bf16 v[76:79], a[156:159], a[96:99], v[76:79]
    s_add_u32 s3, s3, 8355840
    ds_read_b64_tr_b16 a[140:141], v11 offset:40960
    v_mfma_f32_16x16x32_bf16 v[92:95], a[156:159], a[100:103], v[92:95]
    s_waitcnt lgkmcnt(3)
    s_add_u32 s58, s3, s56
    ds_read_b64_tr_b16 a[142:143], v11 offset:45056
    v_mfma_f32_16x16x32_bf16 v[32:35], a[128:131], a[104:107], v[32:35]
    ds_read_b64_tr_b16 a[144:145], v12 offset:40960
    buffer_load_dwordx4 a[0:3], v1, s[20:23], s58 offen offset:0 sc1
    v_mfma_f32_16x16x32_bf16 v[48:51], a[128:131], a[108:111], v[48:51]
    ds_read_b64_tr_b16 a[146:147], v12 offset:45056
    v_mfma_f32_16x16x32_bf16 v[36:39], a[132:135], a[104:107], v[36:39]
    ds_read_b64_tr_b16 a[148:149], v13 offset:40960
    v_mfma_f32_16x16x32_bf16 v[52:55], a[132:135], a[108:111], v[52:55]
    s_waitcnt lgkmcnt(3)
    ds_read_b64_tr_b16 a[150:151], v13 offset:45056
    ds_read_b64_tr_b16 a[152:153], v14 offset:40960
    v_mfma_f32_16x16x32_bf16 v[40:43], a[136:139], a[104:107], v[40:43]
    buffer_load_dwordx4 a[4:7], v2, s[20:23], s58 offen offset:0 sc1
    v_mfma_f32_16x16x32_bf16 v[56:59], a[136:139], a[108:111], v[56:59]
    ds_read_b64_tr_b16 a[154:155], v14 offset:45056
    v_mfma_f32_16x16x32_bf16 v[44:47], a[140:143], a[104:107], v[44:47]
    ds_read_b64_tr_b16 a[156:157], v15 offset:40960
    ds_read_b64_tr_b16 a[158:159], v15 offset:45056
    v_mfma_f32_16x16x32_bf16 v[60:63], a[140:143], a[108:111], v[60:63]
    s_waitcnt lgkmcnt(4)
    buffer_load_dwordx4 a[8:11], v1, s[20:23], s58 offen offset:1024 sc1
    v_mfma_f32_16x16x32_bf16 v[64:67], a[144:147], a[104:107], v[64:67]
    ds_read_b64_tr_b16 a[128:129], v8 offset:49152
    v_mfma_f32_16x16x32_bf16 v[80:83], a[144:147], a[108:111], v[80:83]
    ds_read_b64_tr_b16 a[130:131], v8 offset:53248
    v_mfma_f32_16x16x32_bf16 v[68:71], a[148:151], a[104:107], v[68:71]
    ds_read_b64_tr_b16 a[132:133], v9 offset:49152
    ds_read_b64_tr_b16 a[134:135], v9 offset:53248
    v_mfma_f32_16x16x32_bf16 v[84:87], a[148:151], a[108:111], v[84:87]
    s_waitcnt lgkmcnt(4)
    buffer_load_dwordx4 a[12:15], v2, s[20:23], s58 offen offset:1024 sc1
    v_mfma_f32_16x16x32_bf16 v[72:75], a[152:155], a[104:107], v[72:75]
    ds_read_b64_tr_b16 a[136:137], v10 offset:49152
    v_mfma_f32_16x16x32_bf16 v[88:91], a[152:155], a[108:111], v[88:91]
    ds_read_b64_tr_b16 a[138:139], v10 offset:53248
    v_mfma_f32_16x16x32_bf16 v[76:79], a[156:159], a[104:107], v[76:79]
    ds_read_b64_tr_b16 a[140:141], v11 offset:49152
    ds_read_b64_tr_b16 a[142:143], v11 offset:53248
    v_mfma_f32_16x16x32_bf16 v[92:95], a[156:159], a[108:111], v[92:95]
    s_waitcnt lgkmcnt(4)
    buffer_load_dwordx4 a[16:19], v1, s[20:23], s58 offen offset:2048 sc1
    v_mfma_f32_16x16x32_bf16 v[32:35], a[128:131], a[112:115], v[32:35]
    ds_read_b64_tr_b16 a[144:145], v12 offset:49152
    v_mfma_f32_16x16x32_bf16 v[48:51], a[128:131], a[116:119], v[48:51]
    ds_read_b64_tr_b16 a[146:147], v12 offset:53248
    v_mfma_f32_16x16x32_bf16 v[36:39], a[132:135], a[112:115], v[36:39]
    ds_read_b64_tr_b16 a[148:149], v13 offset:49152
    ds_read_b64_tr_b16 a[150:151], v13 offset:53248
    v_mfma_f32_16x16x32_bf16 v[52:55], a[132:135], a[116:119], v[52:55]
    s_waitcnt lgkmcnt(4)
    buffer_load_dwordx4 a[20:23], v2, s[20:23], s58 offen offset:2048 sc1
    v_mfma_f32_16x16x32_bf16 v[40:43], a[136:139], a[112:115], v[40:43]
    ds_read_b64_tr_b16 a[152:153], v14 offset:49152
    v_mfma_f32_16x16x32_bf16 v[56:59], a[136:139], a[116:119], v[56:59]
    ds_read_b64_tr_b16 a[154:155], v14 offset:53248
    v_mfma_f32_16x16x32_bf16 v[44:47], a[140:143], a[112:115], v[44:47]
    ds_read_b64_tr_b16 a[156:157], v15 offset:49152
    ds_read_b64_tr_b16 a[158:159], v15 offset:53248
    v_mfma_f32_16x16x32_bf16 v[60:63], a[140:143], a[116:119], v[60:63]
    s_waitcnt lgkmcnt(4)
    buffer_load_dwordx4 a[24:27], v1, s[20:23], s58 offen offset:3072 sc1
    v_mfma_f32_16x16x32_bf16 v[64:67], a[144:147], a[112:115], v[64:67]
    ds_read_b64_tr_b16 a[128:129], v8 offset:57344
    v_mfma_f32_16x16x32_bf16 v[80:83], a[144:147], a[116:119], v[80:83]
    ds_read_b64_tr_b16 a[130:131], v8 offset:61440
    ds_read_b64_tr_b16 a[132:133], v9 offset:57344
    v_mfma_f32_16x16x32_bf16 v[68:71], a[148:151], a[112:115], v[68:71]
    buffer_load_dwordx4 a[28:31], v2, s[20:23], s58 offen offset:3072 sc1
    v_mfma_f32_16x16x32_bf16 v[84:87], a[148:151], a[116:119], v[84:87]
    s_waitcnt lgkmcnt(3)
    s_bfe_u32 s3, s60, 0x30009
    s_mul_i32 s3, s3, 262144
    s_add_u32 s3, s3, 2228224
    ds_read_b64_tr_b16 a[134:135], v9 offset:61440
    v_mfma_f32_16x16x32_bf16 v[72:75], a[152:155], a[112:115], v[72:75]
    s_add_u32 s59, s3, s57
    ds_read_b64_tr_b16 a[136:137], v10 offset:57344
    v_mfma_f32_16x16x32_bf16 v[88:91], a[152:155], a[116:119], v[88:91]
    s_add_u32 m0, s30, 81920
    ds_read_b64_tr_b16 a[138:139], v10 offset:61440
    ds_read_b64_tr_b16 a[140:141], v11 offset:57344
    v_mfma_f32_16x16x32_bf16 v[76:79], a[156:159], a[112:115], v[76:79]
    buffer_load_dwordx4 v25, s[92:95], s59 offen offset:0 lds
    v_mfma_f32_16x16x32_bf16 v[92:95], a[156:159], a[116:119], v[92:95]
    s_waitcnt lgkmcnt(3)
    ds_read_b64_tr_b16 a[142:143], v11 offset:61440
    v_mfma_f32_16x16x32_bf16 v[32:35], a[128:131], a[120:123], v[32:35]
    ds_read_b64_tr_b16 a[144:145], v12 offset:57344
    v_mfma_f32_16x16x32_bf16 v[48:51], a[128:131], a[124:127], v[48:51]
    ds_read_b64_tr_b16 a[146:147], v12 offset:61440
    ds_read_b64_tr_b16 a[148:149], v13 offset:57344
    v_mfma_f32_16x16x32_bf16 v[36:39], a[132:135], a[120:123], v[36:39]
    buffer_load_dwordx4 v26, s[92:95], s59 offen offset:1024 lds
    v_mfma_f32_16x16x32_bf16 v[52:55], a[132:135], a[124:127], v[52:55]
    s_waitcnt lgkmcnt(3)
    ds_read_b64_tr_b16 a[150:151], v13 offset:61440
    v_mfma_f32_16x16x32_bf16 v[40:43], a[136:139], a[120:123], v[40:43]
    s_waitcnt vmcnt(26)
    ds_read_b64_tr_b16 a[152:153], v14 offset:57344
    v_mfma_f32_16x16x32_bf16 v[56:59], a[136:139], a[124:127], v[56:59]
    ds_read_b64_tr_b16 a[154:155], v14 offset:61440
    ds_read_b64_tr_b16 a[156:157], v15 offset:57344
    v_mfma_f32_16x16x32_bf16 v[44:47], a[140:143], a[120:123], v[44:47]
    buffer_load_dwordx4 v27, s[92:95], s59 offen offset:2048 lds
    v_mfma_f32_16x16x32_bf16 v[60:63], a[140:143], a[124:127], v[60:63]
    s_waitcnt lgkmcnt(3)
    ds_read_b64_tr_b16 a[158:159], v15 offset:61440
    s_barrier
    v_mfma_f32_16x16x32_bf16 v[64:67], a[144:147], a[120:123], v[64:67]
    ds_read_b64_tr_b16 a[128:129], v17 offset:0
    v_mfma_f32_16x16x32_bf16 v[80:83], a[144:147], a[124:127], v[80:83]
    ds_read_b64_tr_b16 a[130:131], v17 offset:2048
    ds_read_b64_tr_b16 a[132:133], v18 offset:0
    v_mfma_f32_16x16x32_bf16 v[68:71], a[148:151], a[120:123], v[68:71]
    buffer_load_dwordx4 v28, s[92:95], s59 offen offset:3072 lds
    v_mfma_f32_16x16x32_bf16 v[84:87], a[148:151], a[124:127], v[84:87]
    s_waitcnt lgkmcnt(3)
    ds_read_b64_tr_b16 a[134:135], v18 offset:2048
    v_mfma_f32_16x16x32_bf16 v[72:75], a[152:155], a[120:123], v[72:75]
    ds_read_b64_tr_b16 a[136:137], v19 offset:0
    v_mfma_f32_16x16x32_bf16 v[88:91], a[152:155], a[124:127], v[88:91]
    ds_read_b64_tr_b16 a[138:139], v19 offset:2048
    ds_read_b64_tr_b16 a[140:141], v20 offset:0
    v_mfma_f32_16x16x32_bf16 v[76:79], a[156:159], a[120:123], v[76:79]
    global_load_dword v31, v110, s[80:81]
    v_mfma_f32_16x16x32_bf16 v[92:95], a[156:159], a[124:127], v[92:95]
    s_waitcnt lgkmcnt(3)
    ds_read_b64_tr_b16 a[142:143], v20 offset:2048
    v_mfma_f32_16x16x32_bf16 v[32:35], a[128:131], a[192:195], v[32:35]
    ds_read_b64_tr_b16 a[144:145], v17 offset:4096
    v_mfma_f32_16x16x32_bf16 v[48:51], a[128:131], a[196:199], v[48:51]
    ds_read_b64_tr_b16 a[146:147], v17 offset:6144
    v_mfma_f32_16x16x32_bf16 v[36:39], a[132:135], a[192:195], v[36:39]
    ds_read_b64_tr_b16 a[148:149], v18 offset:4096
    v_mfma_f32_16x16x32_bf16 v[52:55], a[132:135], a[196:199], v[52:55]
    s_waitcnt lgkmcnt(3)
    ds_read_b64_tr_b16 a[150:151], v18 offset:6144
    v_mfma_f32_16x16x32_bf16 v[40:43], a[136:139], a[192:195], v[40:43]
    ds_read_b64_tr_b16 a[152:153], v19 offset:4096
    v_cvt_pk_bf16_f32 v64, v64, v65
    v_cvt_pk_bf16_f32 v65, v66, v67
    v_cvt_pk_bf16_f32 v66, v68, v69
    v_mfma_f32_16x16x32_bf16 v[56:59], a[136:139], a[196:199], v[56:59]
    ds_read_b64_tr_b16 a[154:155], v19 offset:6144
    v_cvt_pk_bf16_f32 v67, v70, v71
    v_cvt_pk_bf16_f32 v72, v72, v73
    v_cvt_pk_bf16_f32 v73, v74, v75
    v_mfma_f32_16x16x32_bf16 v[44:47], a[140:143], a[192:195], v[44:47]
    ds_read_b64_tr_b16 a[156:157], v20 offset:4096
    v_cvt_pk_bf16_f32 v74, v76, v77
    v_cvt_pk_bf16_f32 v75, v78, v79
    v_cvt_pk_bf16_f32 v80, v80, v81
    v_mfma_f32_16x16x32_bf16 v[60:63], a[140:143], a[196:199], v[60:63]
    s_waitcnt lgkmcnt(3)
    ds_read_b64_tr_b16 a[158:159], v20 offset:6144
    v_cvt_pk_bf16_f32 v81, v82, v83
    v_cvt_pk_bf16_f32 v82, v84, v85
    v_cvt_pk_bf16_f32 v83, v86, v87
    v_mfma_f32_16x16x32_bf16 v[32:35], a[144:147], a[200:203], v[32:35]
    ds_read_b64_tr_b16 a[128:129], v17 offset:8192
    v_cvt_pk_bf16_f32 v88, v88, v89
    v_cvt_pk_bf16_f32 v89, v90, v91
    v_cvt_pk_bf16_f32 v90, v92, v93
    v_mfma_f32_16x16x32_bf16 v[48:51], a[144:147], a[204:207], v[48:51]
    ds_read_b64_tr_b16 a[130:131], v17 offset:10240
    ds_read_b64_tr_b16 a[132:133], v18 offset:8192
    s_add_u32 s25, s32, 4096
    v_cvt_pk_bf16_f32 v91, v94, v95
    v_mfma_f32_16x16x32_bf16 v[36:39], a[148:151], a[200:203], v[36:39]
    buffer_store_dwordx4 v[64:67], v29, s[96:99], s32 offen offset:0 sc1
    v_mfma_f32_16x16x32_bf16 v[52:55], a[148:151], a[204:207], v[52:55]
    s_waitcnt lgkmcnt(3)
    ds_read_b64_tr_b16 a[134:135], v18 offset:10240
    buffer_store_dwordx4 v[72:75], v29, s[96:99], s32 offen offset:1024 sc1
    v_mfma_f32_16x16x32_bf16 v[40:43], a[152:155], a[200:203], v[40:43]
    ds_read_b64_tr_b16 a[136:137], v19 offset:8192
    ds_read_b64_tr_b16 a[138:139], v19 offset:10240
    v_mfma_f32_16x16x32_bf16 v[56:59], a[152:155], a[204:207], v[56:59]
    buffer_store_dwordx4 v[80:83], v29, s[96:99], s32 offen offset:2048 sc1
    v_mfma_f32_16x16x32_bf16 v[44:47], a[156:159], a[200:203], v[44:47]
    ds_read_b64_tr_b16 a[140:141], v20 offset:8192
    ds_read_b64_tr_b16 a[142:143], v20 offset:10240
    v_mfma_f32_16x16x32_bf16 v[60:63], a[156:159], a[204:207], v[60:63]
    s_waitcnt lgkmcnt(4)
    buffer_store_dwordx4 v[88:91], v29, s[96:99], s32 offen offset:3072 sc1
    v_mfma_f32_16x16x32_bf16 v[32:35], a[128:131], a[208:211], v[32:35]
    s_bfe_u32 s3, s60, 0x30009
    s_mul_i32 s3, s3, 983040
    s_add_u32 s3, s3, 8355840
    s_add_u32 s58, s3, s56
    ds_read_b64_tr_b16 a[144:145], v17 offset:12288
    ds_read_b64_tr_b16 a[146:147], v17 offset:14336
    v_mfma_f32_16x16x32_bf16 v[48:51], a[128:131], a[212:215], v[48:51]
    buffer_load_dwordx4 a[32:35], v1, s[20:23], s58 offen offset:0 sc1
    v_mfma_f32_16x16x32_bf16 v[36:39], a[132:135], a[208:211], v[36:39]
    ds_read_b64_tr_b16 a[148:149], v18 offset:12288
    ds_read_b64_tr_b16 a[150:151], v18 offset:14336
    v_mfma_f32_16x16x32_bf16 v[52:55], a[132:135], a[212:215], v[52:55]
    s_waitcnt lgkmcnt(4)
    buffer_load_dwordx4 a[36:39], v2, s[20:23], s58 offen offset:0 sc1
    v_mfma_f32_16x16x32_bf16 v[40:43], a[136:139], a[208:211], v[40:43]
    s_waitcnt vmcnt(23)
    ds_read_b64_tr_b16 a[152:153], v19 offset:12288
    buffer_load_dwordx4 a[40:43], v1, s[20:23], s58 offen offset:1024 sc1
    v_mfma_f32_16x16x32_bf16 v[56:59], a[136:139], a[212:215], v[56:59]
    ds_read_b64_tr_b16 a[154:155], v19 offset:14336
    ds_read_b64_tr_b16 a[156:157], v20 offset:12288
    v_mfma_f32_16x16x32_bf16 v[44:47], a[140:143], a[208:211], v[44:47]
    buffer_load_dwordx4 a[44:47], v2, s[20:23], s58 offen offset:1024 sc1
    v_mfma_f32_16x16x32_bf16 v[60:63], a[140:143], a[212:215], v[60:63]
    s_waitcnt lgkmcnt(3)
    ds_read_b64_tr_b16 a[158:159], v20 offset:14336
    s_barrier
    v_mfma_f32_16x16x32_bf16 v[32:35], a[144:147], a[216:219], v[32:35]
    ds_read_b64_tr_b16 a[128:129], v17 offset:16384
    buffer_load_dwordx4 a[48:51], v1, s[20:23], s58 offen offset:2048 sc1
    v_mfma_f32_16x16x32_bf16 v[48:51], a[144:147], a[220:223], v[48:51]
    ds_read_b64_tr_b16 a[130:131], v17 offset:18432
    ds_read_b64_tr_b16 a[132:133], v18 offset:16384
    v_mfma_f32_16x16x32_bf16 v[36:39], a[148:151], a[216:219], v[36:39]
    buffer_load_dwordx4 a[52:55], v2, s[20:23], s58 offen offset:2048 sc1
    v_mfma_f32_16x16x32_bf16 v[52:55], a[148:151], a[220:223], v[52:55]
    s_waitcnt lgkmcnt(3)
    ds_read_b64_tr_b16 a[134:135], v18 offset:18432
    ds_read_b64_tr_b16 a[136:137], v19 offset:16384
    v_mfma_f32_16x16x32_bf16 v[40:43], a[152:155], a[216:219], v[40:43]
    buffer_load_dwordx4 a[56:59], v1, s[20:23], s58 offen offset:3072 sc1
    v_mfma_f32_16x16x32_bf16 v[56:59], a[152:155], a[220:223], v[56:59]
    ds_read_b64_tr_b16 a[138:139], v19 offset:18432
    ds_read_b64_tr_b16 a[140:141], v20 offset:16384
    v_mfma_f32_16x16x32_bf16 v[44:47], a[156:159], a[216:219], v[44:47]
    buffer_load_dwordx4 a[60:63], v2, s[20:23], s58 offen offset:3072 sc1
    v_mfma_f32_16x16x32_bf16 v[60:63], a[156:159], a[220:223], v[60:63]
    s_waitcnt lgkmcnt(3)
    ds_read_b64_tr_b16 a[142:143], v20 offset:18432
    v_mfma_f32_16x16x32_bf16 v[32:35], a[128:131], a[224:227], v[32:35]
    ds_read_b64_tr_b16 a[144:145], v17 offset:20480
    ds_read_b64_tr_b16 a[146:147], v17 offset:22528
    s_bfe_u32 s3, s60, 0x3000c
    s_mul_i32 s3, s3, 262144
    s_add_u32 s3, s3, 2228224
    s_add_u32 s59, s3, s57
    s_add_u32 m0, s30, 32768
    v_mfma_f32_16x16x32_bf16 v[48:51], a[128:131], a[228:231], v[48:51]
    buffer_load_dwordx4 v25, s[92:95], s59 offen offset:0 lds
    v_mfma_f32_16x16x32_bf16 v[36:39], a[132:135], a[224:227], v[36:39]
    ds_read_b64_tr_b16 a[148:149], v18 offset:20480
    ds_read_b64_tr_b16 a[150:151], v18 offset:22528
    v_mfma_f32_16x16x32_bf16 v[52:55], a[132:135], a[228:231], v[52:55]
    s_waitcnt lgkmcnt(4)
    buffer_load_dwordx4 v26, s[92:95], s59 offen offset:1024 lds
    v_mfma_f32_16x16x32_bf16 v[40:43], a[136:139], a[224:227], v[40:43]
    ds_read_b64_tr_b16 a[152:153], v19 offset:20480
    v_mfma_f32_16x16x32_bf16 v[56:59], a[136:139], a[228:231], v[56:59]
    ds_read_b64_tr_b16 a[154:155], v19 offset:22528
    ds_read_b64_tr_b16 a[156:157], v20 offset:20480
    v_mfma_f32_16x16x32_bf16 v[44:47], a[140:143], a[224:227], v[44:47]
    buffer_load_dwordx4 v27, s[92:95], s59 offen offset:2048 lds
    v_mfma_f32_16x16x32_bf16 v[60:63], a[140:143], a[228:231], v[60:63]
    s_waitcnt lgkmcnt(3)
    ds_read_b64_tr_b16 a[158:159], v20 offset:22528
    v_mfma_f32_16x16x32_bf16 v[32:35], a[144:147], a[232:235], v[32:35]
    ds_read_b64_tr_b16 a[128:129], v17 offset:24576
    buffer_load_dwordx4 v28, s[92:95], s59 offen offset:3072 lds
    v_mfma_f32_16x16x32_bf16 v[48:51], a[144:147], a[236:239], v[48:51]
    s_bfe_u32 s3, s60, 0x3000c
    s_mul_i32 s3, s3, 983040
    s_add_u32 s3, s3, 8355840
    ds_read_b64_tr_b16 a[130:131], v17 offset:26624
    v_mfma_f32_16x16x32_bf16 v[36:39], a[148:151], a[232:235], v[36:39]
    s_add_u32 s58, s3, s56
    ds_read_b64_tr_b16 a[132:133], v18 offset:24576
    ds_read_b64_tr_b16 a[134:135], v18 offset:26624
    v_mfma_f32_16x16x32_bf16 v[52:55], a[148:151], a[236:239], v[52:55]
    s_waitcnt lgkmcnt(4)
    buffer_load_dwordx4 a[64:67], v1, s[20:23], s58 offen offset:0 sc1
    v_mfma_f32_16x16x32_bf16 v[40:43], a[152:155], a[232:235], v[40:43]
    ds_read_b64_tr_b16 a[136:137], v19 offset:24576
    v_mfma_f32_16x16x32_bf16 v[56:59], a[152:155], a[236:239], v[56:59]
    ds_read_b64_tr_b16 a[138:139], v19 offset:26624
    ds_read_b64_tr_b16 a[140:141], v20 offset:24576
    v_mfma_f32_16x16x32_bf16 v[44:47], a[156:159], a[232:235], v[44:47]
    buffer_load_dwordx4 a[68:71], v2, s[20:23], s58 offen offset:0 sc1
    v_mfma_f32_16x16x32_bf16 v[60:63], a[156:159], a[236:239], v[60:63]
    s_waitcnt lgkmcnt(3)
    ds_read_b64_tr_b16 a[142:143], v20 offset:26624
    v_mfma_f32_16x16x32_bf16 v[32:35], a[128:131], a[240:243], v[32:35]
    ds_read_b64_tr_b16 a[144:145], v17 offset:28672
    buffer_load_dwordx4 a[72:75], v1, s[20:23], s58 offen offset:1024 sc1
    v_mfma_f32_16x16x32_bf16 v[48:51], a[128:131], a[244:247], v[48:51]
    ds_read_b64_tr_b16 a[146:147], v17 offset:30720
    v_mfma_f32_16x16x32_bf16 v[36:39], a[132:135], a[240:243], v[36:39]
    ds_read_b64_tr_b16 a[148:149], v18 offset:28672
    ds_read_b64_tr_b16 a[150:151], v18 offset:30720
    v_mfma_f32_16x16x32_bf16 v[52:55], a[132:135], a[244:247], v[52:55]
    s_waitcnt lgkmcnt(4)
    buffer_load_dwordx4 a[76:79], v2, s[20:23], s58 offen offset:1024 sc1
    v_mfma_f32_16x16x32_bf16 v[40:43], a[136:139], a[240:243], v[40:43]
    s_waitcnt vmcnt(16)
    ds_read_b64_tr_b16 a[152:153], v19 offset:28672
    v_mfma_f32_16x16x32_bf16 v[56:59], a[136:139], a[244:247], v[56:59]
    ds_read_b64_tr_b16 a[154:155], v19 offset:30720
    ds_read_b64_tr_b16 a[156:157], v20 offset:28672
    v_mfma_f32_16x16x32_bf16 v[44:47], a[140:143], a[240:243], v[44:47]
    buffer_load_dwordx4 a[80:83], v1, s[20:23], s58 offen offset:2048 sc1
    v_mfma_f32_16x16x32_bf16 v[60:63], a[140:143], a[244:247], v[60:63]
    s_waitcnt lgkmcnt(3)
    ds_read_b64_tr_b16 a[158:159], v20 offset:30720
    s_barrier
    v_mfma_f32_16x16x32_bf16 v[32:35], a[144:147], a[248:251], v[32:35]
    ds_read_b64_tr_b16 a[128:129], v104 offset:0
    buffer_load_dwordx4 a[84:87], v2, s[20:23], s58 offen offset:2048 sc1
    v_mfma_f32_16x16x32_bf16 v[48:51], a[144:147], a[252:255], v[48:51]
    ds_read_b64_tr_b16 a[130:131], v104 offset:2048
    v_mov_b32 v119, 1
    v_mfma_f32_16x16x32_bf16 v[36:39], a[148:151], a[248:251], v[36:39]
    ds_read_b64_tr_b16 a[132:133], v105 offset:0
    ds_read_b64_tr_b16 a[134:135], v105 offset:2048
    v_mfma_f32_16x16x32_bf16 v[52:55], a[148:151], a[252:255], v[52:55]
    s_waitcnt lgkmcnt(4)
    buffer_atomic_add v119, v30, s[96:99], s55 offen
    buffer_load_dwordx4 a[88:91], v1, s[20:23], s58 offen offset:3072 sc1
    v_mfma_f32_16x16x32_bf16 v[40:43], a[152:155], a[248:251], v[40:43]
    s_xor_b32 s55, s55, 256
    ds_read_b64_tr_b16 a[136:137], v106 offset:0
    v_mfma_f32_16x16x32_bf16 v[56:59], a[152:155], a[252:255], v[56:59]
    ds_read_b64_tr_b16 a[138:139], v106 offset:2048
    ds_read_b64_tr_b16 a[140:141], v107 offset:0
    v_mfma_f32_16x16x32_bf16 v[44:47], a[156:159], a[248:251], v[44:47]
    buffer_load_dwordx4 a[92:95], v2, s[20:23], s58 offen offset:3072 sc1
    v_mfma_f32_16x16x32_bf16 v[60:63], a[156:159], a[252:255], v[60:63]
    s_waitcnt lgkmcnt(3)
    ds_read_b64_tr_b16 a[142:143], v107 offset:2048
    v_mfma_f32_16x16x32_bf16 v[32:35], a[128:131], a[0:3], v[32:35]
    ds_read_b64_tr_b16 a[144:145], v104 offset:4096
    ds_read_b64_tr_b16 a[146:147], v104 offset:6144
    s_bfe_u32 s3, s60, 0x3000f
    s_mul_i32 s3, s3, 262144
    s_add_u32 s3, s3, 2228224
    s_add_u32 s59, s3, s57
    s_add_u32 m0, s30, 49152
    v_mfma_f32_16x16x32_bf16 v[48:51], a[128:131], a[4:7], v[48:51]
    buffer_load_dwordx4 v25, s[92:95], s59 offen offset:0 lds
    v_mfma_f32_16x16x32_bf16 v[36:39], a[132:135], a[0:3], v[36:39]
    ds_read_b64_tr_b16 a[148:149], v105 offset:4096
    ds_read_b64_tr_b16 a[150:151], v105 offset:6144
    v_mfma_f32_16x16x32_bf16 v[52:55], a[132:135], a[4:7], v[52:55]
    s_waitcnt lgkmcnt(4)
    buffer_load_dwordx4 v26, s[92:95], s59 offen offset:1024 lds
    v_mfma_f32_16x16x32_bf16 v[40:43], a[136:139], a[0:3], v[40:43]
    ds_read_b64_tr_b16 a[152:153], v106 offset:4096
    v_mfma_f32_16x16x32_bf16 v[56:59], a[136:139], a[4:7], v[56:59]
    ds_read_b64_tr_b16 a[154:155], v106 offset:6144
    ds_read_b64_tr_b16 a[156:157], v107 offset:4096
    v_mfma_f32_16x16x32_bf16 v[44:47], a[140:143], a[0:3], v[44:47]
    buffer_load_dwordx4 v27, s[92:95], s59 offen offset:2048 lds
    v_mfma_f32_16x16x32_bf16 v[60:63], a[140:143], a[4:7], v[60:63]
    s_waitcnt lgkmcnt(3)
    ds_read_b64_tr_b16 a[158:159], v107 offset:6144
    v_mfma_f32_16x16x32_bf16 v[32:35], a[144:147], a[8:11], v[32:35]
    ds_read_b64_tr_b16 a[128:129], v104 offset:8192
    buffer_load_dwordx4 v28, s[92:95], s59 offen offset:3072 lds
    v_mfma_f32_16x16x32_bf16 v[48:51], a[144:147], a[12:15], v[48:51]
    s_bfe_u32 s3, s60, 0x3000f
    s_mul_i32 s3, s3, 983040
    s_add_u32 s3, s3, 8355840
    ds_read_b64_tr_b16 a[130:131], v104 offset:10240
    v_mfma_f32_16x16x32_bf16 v[36:39], a[148:151], a[8:11], v[36:39]
    s_add_u32 s58, s3, s56
    ds_read_b64_tr_b16 a[132:133], v105 offset:8192
    ds_read_b64_tr_b16 a[134:135], v105 offset:10240
    v_mfma_f32_16x16x32_bf16 v[52:55], a[148:151], a[12:15], v[52:55]
    s_waitcnt lgkmcnt(4)
    buffer_load_dwordx4 a[96:99], v1, s[20:23], s58 offen offset:0 sc1
    v_mfma_f32_16x16x32_bf16 v[40:43], a[152:155], a[8:11], v[40:43]
    ds_read_b64_tr_b16 a[136:137], v106 offset:8192
    v_mfma_f32_16x16x32_bf16 v[56:59], a[152:155], a[12:15], v[56:59]
    ds_read_b64_tr_b16 a[138:139], v106 offset:10240
    ds_read_b64_tr_b16 a[140:141], v107 offset:8192
    v_mfma_f32_16x16x32_bf16 v[44:47], a[156:159], a[8:11], v[44:47]
    buffer_load_dwordx4 a[100:103], v2, s[20:23], s58 offen offset:0 sc1
    v_mfma_f32_16x16x32_bf16 v[60:63], a[156:159], a[12:15], v[60:63]
    s_waitcnt lgkmcnt(3)
    ds_read_b64_tr_b16 a[142:143], v107 offset:10240
    v_mfma_f32_16x16x32_bf16 v[32:35], a[128:131], a[16:19], v[32:35]
    ds_read_b64_tr_b16 a[144:145], v104 offset:12288
    buffer_load_dwordx4 a[104:107], v1, s[20:23], s58 offen offset:1024 sc1
    v_mfma_f32_16x16x32_bf16 v[48:51], a[128:131], a[20:23], v[48:51]
    ds_read_b64_tr_b16 a[146:147], v104 offset:14336
    v_mfma_f32_16x16x32_bf16 v[36:39], a[132:135], a[16:19], v[36:39]
    ds_read_b64_tr_b16 a[148:149], v105 offset:12288
    ds_read_b64_tr_b16 a[150:151], v105 offset:14336
    v_mfma_f32_16x16x32_bf16 v[52:55], a[132:135], a[20:23], v[52:55]
    s_waitcnt lgkmcnt(4)
    buffer_load_dwordx4 a[108:111], v2, s[20:23], s58 offen offset:1024 sc1
    v_mfma_f32_16x16x32_bf16 v[40:43], a[136:139], a[16:19], v[40:43]
    s_waitcnt vmcnt(21)
    ds_read_b64_tr_b16 a[152:153], v106 offset:12288
    v_mfma_f32_16x16x32_bf16 v[56:59], a[136:139], a[20:23], v[56:59]
    ds_read_b64_tr_b16 a[154:155], v106 offset:14336
    ds_read_b64_tr_b16 a[156:157], v107 offset:12288
    v_mfma_f32_16x16x32_bf16 v[44:47], a[140:143], a[16:19], v[44:47]
    buffer_load_dwordx4 a[112:115], v1, s[20:23], s58 offen offset:2048 sc1
    v_mfma_f32_16x16x32_bf16 v[60:63], a[140:143], a[20:23], v[60:63]
    s_waitcnt lgkmcnt(3)
    ds_read_b64_tr_b16 a[158:159], v107 offset:14336
    s_barrier
    v_mfma_f32_16x16x32_bf16 v[32:35], a[144:147], a[24:27], v[32:35]
    ds_read_b64_tr_b16 a[128:129], v104 offset:16384
    buffer_load_dwordx4 a[116:119], v2, s[20:23], s58 offen offset:2048 sc1
    v_mfma_f32_16x16x32_bf16 v[48:51], a[144:147], a[28:31], v[48:51]
    ds_read_b64_tr_b16 a[130:131], v104 offset:18432
    v_mfma_f32_16x16x32_bf16 v[36:39], a[148:151], a[24:27], v[36:39]
    ds_read_b64_tr_b16 a[132:133], v105 offset:16384
    ds_read_b64_tr_b16 a[134:135], v105 offset:18432
    v_mfma_f32_16x16x32_bf16 v[52:55], a[148:151], a[28:31], v[52:55]
    s_waitcnt lgkmcnt(4)
    buffer_load_dwordx4 a[120:123], v1, s[20:23], s58 offen offset:3072 sc1
    v_mfma_f32_16x16x32_bf16 v[40:43], a[152:155], a[24:27], v[40:43]
    ds_read_b64_tr_b16 a[136:137], v106 offset:16384
    v_mfma_f32_16x16x32_bf16 v[56:59], a[152:155], a[28:31], v[56:59]
    ds_read_b64_tr_b16 a[138:139], v106 offset:18432
    ds_read_b64_tr_b16 a[140:141], v107 offset:16384
    v_mfma_f32_16x16x32_bf16 v[44:47], a[156:159], a[24:27], v[44:47]
    buffer_load_dwordx4 a[124:127], v2, s[20:23], s58 offen offset:3072 sc1
    v_mfma_f32_16x16x32_bf16 v[60:63], a[156:159], a[28:31], v[60:63]
    s_waitcnt lgkmcnt(3)
    ds_read_b64_tr_b16 a[142:143], v107 offset:18432
    v_mfma_f32_16x16x32_bf16 v[32:35], a[128:131], a[32:35], v[32:35]
    ds_read_b64_tr_b16 a[144:145], v104 offset:20480
    ds_read_b64_tr_b16 a[146:147], v104 offset:22528
    s_bfe_u32 s3, s60, 0x30012
    s_mul_i32 s3, s3, 262144
    s_add_u32 s3, s3, 2228224
    s_add_u32 s59, s3, s57
    s_add_u32 m0, s30, 98304
    v_mfma_f32_16x16x32_bf16 v[48:51], a[128:131], a[36:39], v[48:51]
    buffer_load_dwordx4 v25, s[92:95], s59 offen offset:0 lds
    v_mfma_f32_16x16x32_bf16 v[36:39], a[132:135], a[32:35], v[36:39]
    ds_read_b64_tr_b16 a[148:149], v105 offset:20480
    ds_read_b64_tr_b16 a[150:151], v105 offset:22528
    v_mfma_f32_16x16x32_bf16 v[52:55], a[132:135], a[36:39], v[52:55]
    s_waitcnt lgkmcnt(4)
    buffer_load_dwordx4 v26, s[92:95], s59 offen offset:1024 lds
    v_mfma_f32_16x16x32_bf16 v[40:43], a[136:139], a[32:35], v[40:43]
    ds_read_b64_tr_b16 a[152:153], v106 offset:20480
    v_mfma_f32_16x16x32_bf16 v[56:59], a[136:139], a[36:39], v[56:59]
    ds_read_b64_tr_b16 a[154:155], v106 offset:22528
    ds_read_b64_tr_b16 a[156:157], v107 offset:20480
    v_mfma_f32_16x16x32_bf16 v[44:47], a[140:143], a[32:35], v[44:47]
    buffer_load_dwordx4 v27, s[92:95], s59 offen offset:2048 lds
    v_mfma_f32_16x16x32_bf16 v[60:63], a[140:143], a[36:39], v[60:63]
    s_waitcnt lgkmcnt(3)
    ds_read_b64_tr_b16 a[158:159], v107 offset:22528
    v_mfma_f32_16x16x32_bf16 v[32:35], a[144:147], a[40:43], v[32:35]
    ds_read_b64_tr_b16 a[128:129], v104 offset:24576
    buffer_load_dwordx4 v28, s[92:95], s59 offen offset:3072 lds
    v_mfma_f32_16x16x32_bf16 v[48:51], a[144:147], a[44:47], v[48:51]
    s_bfe_u32 s3, s60, 0x30012
    s_mul_i32 s3, s3, 983040
    s_add_u32 s3, s3, 8355840
    ds_read_b64_tr_b16 a[130:131], v104 offset:26624
    v_mfma_f32_16x16x32_bf16 v[36:39], a[148:151], a[40:43], v[36:39]
    s_add_u32 s58, s3, s56
    ds_read_b64_tr_b16 a[132:133], v105 offset:24576
    ds_read_b64_tr_b16 a[134:135], v105 offset:26624
    v_mfma_f32_16x16x32_bf16 v[52:55], a[148:151], a[44:47], v[52:55]
    s_waitcnt lgkmcnt(4)
    buffer_load_dwordx4 a[192:195], v1, s[20:23], s58 offen offset:0 sc1
    v_mfma_f32_16x16x32_bf16 v[40:43], a[152:155], a[40:43], v[40:43]
    ds_read_b64_tr_b16 a[136:137], v106 offset:24576
    v_mfma_f32_16x16x32_bf16 v[56:59], a[152:155], a[44:47], v[56:59]
    ds_read_b64_tr_b16 a[138:139], v106 offset:26624
    ds_read_b64_tr_b16 a[140:141], v107 offset:24576
    v_mfma_f32_16x16x32_bf16 v[44:47], a[156:159], a[40:43], v[44:47]
    buffer_load_dwordx4 a[196:199], v2, s[20:23], s58 offen offset:0 sc1
    v_mfma_f32_16x16x32_bf16 v[60:63], a[156:159], a[44:47], v[60:63]
    s_waitcnt lgkmcnt(3)
    ds_read_b64_tr_b16 a[142:143], v107 offset:26624
    v_mfma_f32_16x16x32_bf16 v[32:35], a[128:131], a[48:51], v[32:35]
    ds_read_b64_tr_b16 a[144:145], v104 offset:28672
    buffer_load_dwordx4 a[200:203], v1, s[20:23], s58 offen offset:1024 sc1
    v_mfma_f32_16x16x32_bf16 v[48:51], a[128:131], a[52:55], v[48:51]
    ds_read_b64_tr_b16 a[146:147], v104 offset:30720
    v_mfma_f32_16x16x32_bf16 v[36:39], a[132:135], a[48:51], v[36:39]
    ds_read_b64_tr_b16 a[148:149], v105 offset:28672
    ds_read_b64_tr_b16 a[150:151], v105 offset:30720
    v_mfma_f32_16x16x32_bf16 v[52:55], a[132:135], a[52:55], v[52:55]
    s_waitcnt lgkmcnt(4)
    buffer_load_dwordx4 a[204:207], v2, s[20:23], s58 offen offset:1024 sc1
    v_mfma_f32_16x16x32_bf16 v[40:43], a[136:139], a[48:51], v[40:43]
    s_waitcnt vmcnt(20)
    ds_read_b64_tr_b16 a[152:153], v106 offset:28672
    v_mfma_f32_16x16x32_bf16 v[56:59], a[136:139], a[52:55], v[56:59]
    ds_read_b64_tr_b16 a[154:155], v106 offset:30720
    ds_read_b64_tr_b16 a[156:157], v107 offset:28672
    v_mfma_f32_16x16x32_bf16 v[44:47], a[140:143], a[48:51], v[44:47]
    buffer_load_dwordx4 a[208:211], v1, s[20:23], s58 offen offset:2048 sc1
    v_mfma_f32_16x16x32_bf16 v[60:63], a[140:143], a[52:55], v[60:63]
    s_waitcnt lgkmcnt(3)
    ds_read_b64_tr_b16 a[158:159], v107 offset:30720
    s_barrier
    v_mfma_f32_16x16x32_bf16 v[32:35], a[144:147], a[56:59], v[32:35]
    ds_read_b64_tr_b16 a[128:129], v17 offset:32768
    buffer_load_dwordx4 a[212:215], v2, s[20:23], s58 offen offset:2048 sc1
    v_mfma_f32_16x16x32_bf16 v[48:51], a[144:147], a[60:63], v[48:51]
    ds_read_b64_tr_b16 a[130:131], v17 offset:34816
    v_mfma_f32_16x16x32_bf16 v[36:39], a[148:151], a[56:59], v[36:39]
    ds_read_b64_tr_b16 a[132:133], v18 offset:32768
    ds_read_b64_tr_b16 a[134:135], v18 offset:34816
    v_mfma_f32_16x16x32_bf16 v[52:55], a[148:151], a[60:63], v[52:55]
    s_waitcnt lgkmcnt(4)
    buffer_load_dwordx4 a[216:219], v1, s[20:23], s58 offen offset:3072 sc1
    v_mfma_f32_16x16x32_bf16 v[40:43], a[152:155], a[56:59], v[40:43]
    ds_read_b64_tr_b16 a[136:137], v19 offset:32768
    v_mfma_f32_16x16x32_bf16 v[56:59], a[152:155], a[60:63], v[56:59]
    ds_read_b64_tr_b16 a[138:139], v19 offset:34816
    ds_read_b64_tr_b16 a[140:141], v20 offset:32768
    v_mfma_f32_16x16x32_bf16 v[44:47], a[156:159], a[56:59], v[44:47]
    buffer_load_dwordx4 a[220:223], v2, s[20:23], s58 offen offset:3072 sc1
    v_mfma_f32_16x16x32_bf16 v[60:63], a[156:159], a[60:63], v[60:63]
    s_waitcnt lgkmcnt(3)
    ds_read_b64_tr_b16 a[142:143], v20 offset:34816
    v_mfma_f32_16x16x32_bf16 v[32:35], a[128:131], a[64:67], v[32:35]
    ds_read_b64_tr_b16 a[144:145], v17 offset:36864
    ds_read_b64_tr_b16 a[146:147], v17 offset:38912
    s_bfe_u32 s3, s60, 0x30015
    s_mul_i32 s3, s3, 262144
    s_add_u32 s3, s3, 2228224
    s_add_u32 s59, s3, s57
    s_add_u32 m0, s30, 114688
    v_mfma_f32_16x16x32_bf16 v[48:51], a[128:131], a[68:71], v[48:51]
    buffer_load_dwordx4 v25, s[92:95], s59 offen offset:0 lds
    v_mfma_f32_16x16x32_bf16 v[36:39], a[132:135], a[64:67], v[36:39]
    ds_read_b64_tr_b16 a[148:149], v18 offset:36864
    ds_read_b64_tr_b16 a[150:151], v18 offset:38912
    v_mfma_f32_16x16x32_bf16 v[52:55], a[132:135], a[68:71], v[52:55]
    s_waitcnt lgkmcnt(4)
    buffer_load_dwordx4 v26, s[92:95], s59 offen offset:1024 lds
    v_mfma_f32_16x16x32_bf16 v[40:43], a[136:139], a[64:67], v[40:43]
    ds_read_b64_tr_b16 a[152:153], v19 offset:36864
    ds_read_b64_tr_b16 a[154:155], v19 offset:38912
    v_mfma_f32_16x16x32_bf16 v[56:59], a[136:139], a[68:71], v[56:59]
    buffer_load_dwordx4 v27, s[92:95], s59 offen offset:2048 lds
    v_mfma_f32_16x16x32_bf16 v[44:47], a[140:143], a[64:67], v[44:47]
    ds_read_b64_tr_b16 a[156:157], v20 offset:36864
    v_mfma_f32_16x16x32_bf16 v[60:63], a[140:143], a[68:71], v[60:63]
    s_waitcnt lgkmcnt(3)
    ds_read_b64_tr_b16 a[158:159], v20 offset:38912
    v_mfma_f32_16x16x32_bf16 v[32:35], a[144:147], a[72:75], v[32:35]
    ds_read_b64_tr_b16 a[128:129], v17 offset:40960
    buffer_load_dwordx4 v28, s[92:95], s59 offen offset:3072 lds
    v_mfma_f32_16x16x32_bf16 v[48:51], a[144:147], a[76:79], v[48:51]
    s_bfe_u32 s3, s60, 0x30015
    ds_read_b64_tr_b16 a[130:131], v17 offset:43008
    ds_read_b64_tr_b16 a[132:133], v18 offset:40960
    v_mfma_f32_16x16x32_bf16 v[36:39], a[148:151], a[72:75], v[36:39]
    buffer_load_dword v16, v30, s[96:99], s55 offen sc1
    v_mfma_f32_16x16x32_bf16 v[52:55], a[148:151], a[76:79], v[52:55]
    s_waitcnt lgkmcnt(3)
    s_mul_i32 s3, s3, 983040
    s_add_u32 s3, s3, 8355840
    ds_read_b64_tr_b16 a[134:135], v18 offset:43008
    v_mfma_f32_16x16x32_bf16 v[40:43], a[152:155], a[72:75], v[40:43]
    s_add_u32 s58, s3, s56
    ds_read_b64_tr_b16 a[136:137], v19 offset:40960
    ds_read_b64_tr_b16 a[138:139], v19 offset:43008
    v_mfma_f32_16x16x32_bf16 v[56:59], a[152:155], a[76:79], v[56:59]
    buffer_load_dwordx4 a[224:227], v1, s[20:23], s58 offen offset:0 sc1
    v_mfma_f32_16x16x32_bf16 v[44:47], a[156:159], a[72:75], v[44:47]
    ds_read_b64_tr_b16 a[140:141], v20 offset:40960
    ds_read_b64_tr_b16 a[142:143], v20 offset:43008
    v_mfma_f32_16x16x32_bf16 v[60:63], a[156:159], a[76:79], v[60:63]
    s_waitcnt lgkmcnt(4)
    buffer_load_dwordx4 a[228:231], v2, s[20:23], s58 offen offset:0 sc1
    v_mfma_f32_16x16x32_bf16 v[32:35], a[128:131], a[80:83], v[32:35]
    ds_read_b64_tr_b16 a[144:145], v17 offset:45056
    ds_read_b64_tr_b16 a[146:147], v17 offset:47104
    v_mfma_f32_16x16x32_bf16 v[48:51], a[128:131], a[84:87], v[48:51]
    buffer_load_dwordx4 a[232:235], v1, s[20:23], s58 offen offset:1024 sc1
    v_mfma_f32_16x16x32_bf16 v[36:39], a[132:135], a[80:83], v[36:39]
    ds_read_b64_tr_b16 a[148:149], v18 offset:45056
    v_mfma_f32_16x16x32_bf16 v[52:55], a[132:135], a[84:87], v[52:55]
    s_waitcnt lgkmcnt(3)
    ds_read_b64_tr_b16 a[150:151], v18 offset:47104
    ds_read_b64_tr_b16 a[152:153], v19 offset:45056
    v_mfma_f32_16x16x32_bf16 v[40:43], a[136:139], a[80:83], v[40:43]
    s_waitcnt vmcnt(20)
    buffer_load_dwordx4 a[236:239], v2, s[20:23], s58 offen offset:1024 sc1
    v_mfma_f32_16x16x32_bf16 v[56:59], a[136:139], a[84:87], v[56:59]
    ds_read_b64_tr_b16 a[154:155], v19 offset:47104
    ds_read_b64_tr_b16 a[156:157], v20 offset:45056
    v_mfma_f32_16x16x32_bf16 v[44:47], a[140:143], a[80:83], v[44:47]
    buffer_load_dwordx4 a[240:243], v1, s[20:23], s58 offen offset:2048 sc1
    v_mfma_f32_16x16x32_bf16 v[60:63], a[140:143], a[84:87], v[60:63]
    s_waitcnt lgkmcnt(3)
    ds_read_b64_tr_b16 a[158:159], v20 offset:47104
    s_barrier
    v_mfma_f32_16x16x32_bf16 v[32:35], a[144:147], a[88:91], v[32:35]
    ds_read_b64_tr_b16 a[128:129], v17 offset:49152
    ds_read_b64_tr_b16 a[130:131], v17 offset:51200
    v_mfma_f32_16x16x32_bf16 v[48:51], a[144:147], a[92:95], v[48:51]
    buffer_load_dwordx4 a[244:247], v2, s[20:23], s58 offen offset:2048 sc1
    v_mfma_f32_16x16x32_bf16 v[36:39], a[148:151], a[88:91], v[36:39]
    ds_read_b64_tr_b16 a[132:133], v18 offset:49152
    ds_read_b64_tr_b16 a[134:135], v18 offset:51200
    v_mfma_f32_16x16x32_bf16 v[52:55], a[148:151], a[92:95], v[52:55]
    s_waitcnt lgkmcnt(4)
    buffer_load_dwordx4 a[248:251], v1, s[20:23], s58 offen offset:3072 sc1
    v_mfma_f32_16x16x32_bf16 v[40:43], a[152:155], a[88:91], v[40:43]
    ds_read_b64_tr_b16 a[136:137], v19 offset:49152
    v_mfma_f32_16x16x32_bf16 v[56:59], a[152:155], a[92:95], v[56:59]
    ds_read_b64_tr_b16 a[138:139], v19 offset:51200
    ds_read_b64_tr_b16 a[140:141], v20 offset:49152
    v_mfma_f32_16x16x32_bf16 v[44:47], a[156:159], a[88:91], v[44:47]
    buffer_load_dwordx4 a[252:255], v2, s[20:23], s58 offen offset:3072 sc1
    v_mfma_f32_16x16x32_bf16 v[60:63], a[156:159], a[92:95], v[60:63]
    s_waitcnt lgkmcnt(3)
    ds_read_b64_tr_b16 a[142:143], v20 offset:51200
    v_mfma_f32_16x16x32_bf16 v[32:35], a[128:131], a[96:99], v[32:35]
    ds_read_b64_tr_b16 a[144:145], v17 offset:53248
    v_mfma_f32_16x16x32_bf16 v[48:51], a[128:131], a[100:103], v[48:51]
    ds_read_b64_tr_b16 a[146:147], v17 offset:55296
    v_mfma_f32_16x16x32_bf16 v[36:39], a[132:135], a[96:99], v[36:39]
    ds_read_b64_tr_b16 a[148:149], v18 offset:53248
    v_mfma_f32_16x16x32_bf16 v[52:55], a[132:135], a[100:103], v[52:55]
    s_waitcnt lgkmcnt(3)
    ds_read_b64_tr_b16 a[150:151], v18 offset:55296
    v_mfma_f32_16x16x32_bf16 v[40:43], a[136:139], a[96:99], v[40:43]
    ds_read_b64_tr_b16 a[152:153], v19 offset:53248
    v_mfma_f32_16x16x32_bf16 v[56:59], a[136:139], a[100:103], v[56:59]
    ds_read_b64_tr_b16 a[154:155], v19 offset:55296
    v_mfma_f32_16x16x32_bf16 v[44:47], a[140:143], a[96:99], v[44:47]
    ds_read_b64_tr_b16 a[156:157], v20 offset:53248
    v_mfma_f32_16x16x32_bf16 v[60:63], a[140:143], a[100:103], v[60:63]
    s_waitcnt lgkmcnt(3)
    ds_read_b64_tr_b16 a[158:159], v20 offset:55296
    v_mfma_f32_16x16x32_bf16 v[32:35], a[144:147], a[104:107], v[32:35]
    ds_read_b64_tr_b16 a[128:129], v17 offset:57344
    v_mfma_f32_16x16x32_bf16 v[48:51], a[144:147], a[108:111], v[48:51]
    ds_read_b64_tr_b16 a[130:131], v17 offset:59392
    v_mfma_f32_16x16x32_bf16 v[36:39], a[148:151], a[104:107], v[36:39]
    ds_read_b64_tr_b16 a[132:133], v18 offset:57344
    v_mfma_f32_16x16x32_bf16 v[52:55], a[148:151], a[108:111], v[52:55]
    s_waitcnt lgkmcnt(3)
    ds_read_b64_tr_b16 a[134:135], v18 offset:59392
    v_mfma_f32_16x16x32_bf16 v[40:43], a[152:155], a[104:107], v[40:43]
    ds_read_b64_tr_b16 a[136:137], v19 offset:57344
    v_mfma_f32_16x16x32_bf16 v[56:59], a[152:155], a[108:111], v[56:59]
    ds_read_b64_tr_b16 a[138:139], v19 offset:59392
    v_mfma_f32_16x16x32_bf16 v[44:47], a[156:159], a[104:107], v[44:47]
    ds_read_b64_tr_b16 a[140:141], v20 offset:57344
    v_mfma_f32_16x16x32_bf16 v[60:63], a[156:159], a[108:111], v[60:63]
    s_waitcnt lgkmcnt(3)
    ds_read_b64_tr_b16 a[142:143], v20 offset:59392
    v_mfma_f32_16x16x32_bf16 v[32:35], a[128:131], a[112:115], v[32:35]
    ds_read_b64_tr_b16 a[144:145], v17 offset:61440
    v_mfma_f32_16x16x32_bf16 v[48:51], a[128:131], a[116:119], v[48:51]
    ds_read_b64_tr_b16 a[146:147], v17 offset:63488
    v_mfma_f32_16x16x32_bf16 v[36:39], a[132:135], a[112:115], v[36:39]
    ds_read_b64_tr_b16 a[148:149], v18 offset:61440
    v_mfma_f32_16x16x32_bf16 v[52:55], a[132:135], a[116:119], v[52:55]
    s_waitcnt lgkmcnt(3)
    ds_read_b64_tr_b16 a[150:151], v18 offset:63488
    v_mfma_f32_16x16x32_bf16 v[40:43], a[136:139], a[112:115], v[40:43]
    s_waitcnt vmcnt(8)
    ds_read_b64_tr_b16 a[152:153], v19 offset:61440
    v_readfirstlane_b32 s40, v16
    v_mfma_f32_16x16x32_bf16 v[56:59], a[136:139], a[116:119], v[56:59]
    ds_read_b64_tr_b16 a[154:155], v19 offset:63488
    v_mfma_f32_16x16x32_bf16 v[44:47], a[140:143], a[112:115], v[44:47]
    ds_read_b64_tr_b16 a[156:157], v20 offset:61440
    v_mfma_f32_16x16x32_bf16 v[60:63], a[140:143], a[116:119], v[60:63]
    s_waitcnt lgkmcnt(3)
    ds_read_b64_tr_b16 a[158:159], v20 offset:63488
    s_cmp_ge_u32 s40, s62
    s_cbranch_scc0 L_spin3
L_spin3b:
    s_barrier
    v_mfma_f32_16x16x32_bf16 v[32:35], a[144:147], a[120:123], v[32:35]
    ds_read_b64_tr_b16 a[128:129], v104 offset:32768
    v_mfma_f32_16x16x32_bf16 v[48:51], a[144:147], a[124:127], v[48:51]
    ds_read_b64_tr_b16 a[130:131], v104 offset:34816
    v_mfma_f32_16x16x32_bf16 v[36:39], a[148:151], a[120:123], v[36:39]
    ds_read_b64_tr_b16 a[132:133], v105 offset:32768
    v_mfma_f32_16x16x32_bf16 v[52:55], a[148:151], a[124:127], v[52:55]
    s_waitcnt lgkmcnt(3)
    ds_read_b64_tr_b16 a[134:135], v105 offset:34816
    v_mfma_f32_16x16x32_bf16 v[40:43], a[152:155], a[120:123], v[40:43]
    ds_read_b64_tr_b16 a[136:137], v106 offset:32768
    v_mfma_f32_16x16x32_bf16 v[56:59], a[152:155], a[124:127], v[56:59]
    ds_read_b64_tr_b16 a[138:139], v106 offset:34816
    v_mfma_f32_16x16x32_bf16 v[44:47], a[156:159], a[120:123], v[44:47]
    ds_read_b64_tr_b16 a[140:141], v107 offset:32768
    v_mfma_f32_16x16x32_bf16 v[60:63], a[156:159], a[124:127], v[60:63]
    s_waitcnt lgkmcnt(3)
    ds_read_b64_tr_b16 a[142:143], v107 offset:34816
    v_mfma_f32_16x16x32_bf16 v[32:35], a[128:131], a[192:195], v[32:35]
    ds_read_b64_tr_b16 a[144:145], v104 offset:36864
    ds_read_b64_tr_b16 a[146:147], v104 offset:38912
    s_xor_b32 s32, s32, 32768
    s_add_u32 s25, s32, 4096
    v_mfma_f32_16x16x32_bf16 v[48:51], a[128:131], a[196:199], v[48:51]
    buffer_load_dwordx4 v[128:131], v29, s[96:99], s32 offen offset:0 sc1
    v_mfma_f32_16x16x32_bf16 v[36:39], a[132:135], a[192:195], v[36:39]
    ds_read_b64_tr_b16 a[148:149], v105 offset:36864
    v_mfma_f32_16x16x32_bf16 v[52:55], a[132:135], a[196:199], v[52:55]
    s_waitcnt lgkmcnt(3)
    ds_read_b64_tr_b16 a[150:151], v105 offset:38912
    v_mfma_f32_16x16x32_bf16 v[40:43], a[136:139], a[192:195], v[40:43]
    ds_read_b64_tr_b16 a[152:153], v106 offset:36864
    v_mfma_f32_16x16x32_bf16 v[56:59], a[136:139], a[196:199], v[56:59]
    ds_read_b64_tr_b16 a[154:155], v106 offset:38912
    ds_read_b64_tr_b16 a[156:157], v107 offset:36864
    v_mfma_f32_16x16x32_bf16 v[44:47], a[140:143], a[192:195], v[44:47]
    buffer_load_dwordx4 v[132:135], v29, s[96:99], s32 offen offset:1024 sc1
    v_mfma_f32_16x16x32_bf16 v[60:63], a[140:143], a[196:199], v[60:63]
    s_waitcnt lgkmcnt(3)
    ds_read_b64_tr_b16 a[158:159], v107 offset:38912
    v_mfma_f32_16x16x32_bf16 v[32:35], a[144:147], a[200:203], v[32:35]
    ds_read_b64_tr_b16 a[128:129], v104 offset:40960
    v_mfma_f32_16x16x32_bf16 v[48:51], a[144:147], a[204:207], v[48:51]
    ds_read_b64_tr_b16 a[130:131], v104 offset:43008
    v_mfma_f32_16x16x32_bf16 v[36:39], a[148:151], a[200:203], v[36:39]
    ds_read_b64_tr_b16 a[132:133], v105 offset:40960
    ds_read_b64_tr_b16 a[134:135], v105 offset:43008
    v_mfma_f32_16x16x32_bf16 v[52:55], a[148:151], a[204:207], v[52:55]
    s_waitcnt lgkmcnt(4)
    buffer_load_dwordx4 v[136:139], v29, s[96:99], s32 offen offset:2048 sc1
    v_mfma_f32_16x16x32_bf16 v[40:43], a[152:155], a[200:203], v[40:43]
    ds_read_b64_tr_b16 a[136:137], v106 offset:40960
    v_mfma_f32_16x16x32_bf16 v[56:59], a[152:155], a[204:207], v[56:59]
    ds_read_b64_tr_b16 a[138:139], v106 offset:43008
    v_mfma_f32_16x16x32_bf16 v[44:47], a[156:159], a[200:203], v[44:47]
    ds_read_b64_tr_b16 a[140:141], v107 offset:40960
    v_mfma_f32_16x16x32_bf16 v[60:63], a[156:159], a[204:207], v[60:63]
    s_waitcnt lgkmcnt(3)
    ds_read_b64_tr_b16 a[142:143], v107 offset:43008
    v_mfma_f32_16x16x32_bf16 v[32:35], a[128:131], a[208:211], v[32:35]
    ds_read_b64_tr_b16 a[144:145], v104 offset:45056
    buffer_load_dwordx4 v[140:143], v29, s[96:99], s32 offen offset:3072 sc1
    v_mfma_f32_16x16x32_bf16 v[48:51], a[128:131], a[212:215], v[48:51]
    ds_read_b64_tr_b16 a[146:147], v104 offset:47104
    v_mfma_f32_16x16x32_bf16 v[36:39], a[132:135], a[208:211], v[36:39]
    ds_read_b64_tr_b16 a[148:149], v105 offset:45056
    v_mfma_f32_16x16x32_bf16 v[52:55], a[132:135], a[212:215], v[52:55]
    s_waitcnt lgkmcnt(3)
    ds_read_b64_tr_b16 a[150:151], v105 offset:47104
    v_mfma_f32_16x16x32_bf16 v[40:43], a[136:139], a[208:211], v[40:43]
    s_waitcnt vmcnt(4)
    ds_read_b64_tr_b16 a[152:153], v106 offset:45056
    v_mfma_f32_16x16x32_bf16 v[56:59], a[136:139], a[212:215], v[56:59]
    ds_read_b64_tr_b16 a[154:155], v106 offset:47104
    v_mfma_f32_16x16x32_bf16 v[44:47], a[140:143], a[208:211], v[44:47]
    ds_read_b64_tr_b16 a[156:157], v107 offset:45056
    v_mfma_f32_16x16x32_bf16 v[60:63], a[140:143], a[212:215], v[60:63]
    s_waitcnt lgkmcnt(3)
    ds_read_b64_tr_b16 a[158:159], v107 offset:47104
    s_barrier
    v_mfma_f32_16x16x32_bf16 v[32:35], a[144:147], a[216:219], v[32:35]
    ds_read_b64_tr_b16 a[128:129], v104 offset:49152
    v_mfma_f32_16x16x32_bf16 v[48:51], a[144:147], a[220:223], v[48:51]
    ds_read_b64_tr_b16 a[130:131], v104 offset:51200
    v_mfma_f32_16x16x32_bf16 v[36:39], a[148:151], a[216:219], v[36:39]
    ds_read_b64_tr_b16 a[132:133], v105 offset:49152
    v_mfma_f32_16x16x32_bf16 v[52:55], a[148:151], a[220:223], v[52:55]
    s_waitcnt lgkmcnt(3)
    ds_read_b64_tr_b16 a[134:135], v105 offset:51200
    v_mfma_f32_16x16x32_bf16 v[40:43], a[152:155], a[216:219], v[40:43]
    ds_read_b64_tr_b16 a[136:137], v106 offset:49152
    v_mfma_f32_16x16x32_bf16 v[56:59], a[152:155], a[220:223], v[56:59]
    ds_read_b64_tr_b16 a[138:139], v106 offset:51200
    v_mfma_f32_16x16x32_bf16 v[44:47], a[156:159], a[216:219], v[44:47]
    ds_read_b64_tr_b16 a[140:141], v107 offset:49152
    v_mfma_f32_16x16x32_bf16 v[60:63], a[156:159], a[220:223], v[60:63]
    s_waitcnt lgkmcnt(3)
    ds_read_b64_tr_b16 a[142:143], v107 offset:51200
    v_mfma_f32_16x16x32_bf16 v[32:35], a[128:131], a[224:227], v[32:35]
    ds_read_b64_tr_b16 a[144:145], v104 offset:53248
    v_mfma_f32_16x16x32_bf16 v[48:51], a[128:131], a[228:231], v[48:51]
    ds_read_b64_tr_b16 a[146:147], v104 offset:55296
    v_mfma_f32_16x16x32_bf16 v[36:39], a[132:135], a[224:227], v[36:39]
    ds_read_b64_tr_b16 a[148:149], v105 offset:53248
    v_mfma_f32_16x16x32_bf16 v[52:55], a[132:135], a[228:231], v[52:55]
    s_waitcnt lgkmcnt(3)
    ds_read_b64_tr_b16 a[150:151], v105 offset:55296
    v_mfma_f32_16x16x32_bf16 v[40:43], a[136:139], a[224:227], v[40:43]
    ds_read_b64_tr_b16 a[152:153], v106 offset:53248
    v_mfma_f32_16x16x32_bf16 v[56:59], a[136:139], a[228:231], v[56:59]
    ds_read_b64_tr_b16 a[154:155], v106 offset:55296
    v_mfma_f32_16x16x32_bf16 v[44:47], a[140:143], a[224:227], v[44:47]
    ds_read_b64_tr_b16 a[156:157], v107 offset:53248
    v_mfma_f32_16x16x32_bf16 v[60:63], a[140:143], a[228:231], v[60:63]
    s_waitcnt lgkmcnt(3)
    ds_read_b64_tr_b16 a[158:159], v107 offset:55296
    v_mfma_f32_16x16x32_bf16 v[32:35], a[144:147], a[232:235], v[32:35]
    ds_read_b64_tr_b16 a[128:129], v104 offset:57344
    v_mfma_f32_16x16x32_bf16 v[48:51], a[144:147], a[236:239], v[48:51]
    ds_read_b64_tr_b16 a[130:131], v104 offset:59392
    v_mfma_f32_16x16x32_bf16 v[36:39], a[148:151], a[232:235], v[36:39]
    ds_read_b64_tr_b16 a[132:133], v105 offset:57344
    v_mfma_f32_16x16x32_bf16 v[52:55], a[148:151], a[236:239], v[52:55]
    s_waitcnt lgkmcnt(3)
    ds_read_b64_tr_b16 a[134:135], v105 offset:59392
    v_mfma_f32_16x16x32_bf16 v[40:43], a[152:155], a[232:235], v[40:43]
    ds_read_b64_tr_b16 a[136:137], v106 offset:57344
    v_mfma_f32_16x16x32_bf16 v[56:59], a[152:155], a[236:239], v[56:59]
    ds_read_b64_tr_b16 a[138:139], v106 offset:59392
    v_mfma_f32_16x16x32_bf16 v[44:47], a[156:159], a[232:235], v[44:47]
    ds_read_b64_tr_b16 a[140:141], v107 offset:57344
    v_mfma_f32_16x16x32_bf16 v[60:63], a[156:159], a[236:239], v[60:63]
    s_waitcnt lgkmcnt(3)
    ds_read_b64_tr_b16 a[142:143], v107 offset:59392
    v_mfma_f32_16x16x32_bf16 v[32:35], a[128:131], a[240:243], v[32:35]
    ds_read_b64_tr_b16 a[144:145], v104 offset:61440
    v_mfma_f32_16x16x32_bf16 v[48:51], a[128:131], a[244:247], v[48:51]
    ds_read_b64_tr_b16 a[146:147], v104 offset:63488
    v_mfma_f32_16x16x32_bf16 v[36:39], a[132:135], a[240:243], v[36:39]
    ds_read_b64_tr_b16 a[148:149], v105 offset:61440
    v_mfma_f32_16x16x32_bf16 v[52:55], a[132:135], a[244:247], v[52:55]
    s_waitcnt lgkmcnt(3)
    ds_read_b64_tr_b16 a[150:151], v105 offset:63488
    v_mfma_f32_16x16x32_bf16 v[40:43], a[136:139], a[240:243], v[40:43]
    ds_read_b64_tr_b16 a[152:153], v106 offset:61440
    v_mfma_f32_16x16x32_bf16 v[56:59], a[136:139], a[244:247], v[56:59]
    ds_read_b64_tr_b16 a[154:155], v106 offset:63488
    v_mfma_f32_16x16x32_bf16 v[44:47], a[140:143], a[240:243], v[44:47]
    ds_read_b64_tr_b16 a[156:157], v107 offset:61440
    v_mfma_f32_16x16x32_bf16 v[60:63], a[140:143], a[244:247], v[60:63]
    s_waitcnt lgkmcnt(3)
    ds_read_b64_tr_b16 a[158:159], v107 offset:63488
    v_mfma_f32_16x16x32_bf16 v[32:35], a[144:147], a[248:251], v[32:35]
    v_mfma_f32_16x16x32_bf16 v[48:51], a[144:147], a[252:255], v[48:51]
    v_mfma_f32_16x16x32_bf16 v[36:39], a[148:151], a[248:251], v[36:39]
    v_mfma_f32_16x16x32_bf16 v[52:55], a[148:151], a[252:255], v[52:55]
    s_waitcnt lgkmcnt(0)
    v_mfma_f32_16x16x32_bf16 v[40:43], a[152:155], a[248:251], v[40:43]
    v_mfma_f32_16x16x32_bf16 v[56:59], a[152:155], a[252:255], v[56:59]
    v_mfma_f32_16x16x32_bf16 v[44:47], a[156:159], a[248:251], v[44:47]
    v_mfma_f32_16x16x32_bf16 v[60:63], a[156:159], a[252:255], v[60:63]
    s_waitcnt vmcnt(0)
    v_lshlrev_b32 v160, 16, v128
    v_and_b32 v161, 0xffff0000, v128
    v_lshlrev_b32 v162, 16, v129
    v_and_b32 v163, 0xffff0000, v129
    v_lshlrev_b32 v164, 16, v130
    v_and_b32 v165, 0xffff0000, v130
    v_lshlrev_b32 v166, 16, v131
    v_and_b32 v167, 0xffff0000, v131
    v_lshlrev_b32 v168, 16, v132
    v_and_b32 v169, 0xffff0000, v132
    v_lshlrev_b32 v170, 16, v133
    v_and_b32 v171, 0xffff0000, v133
    v_lshlrev_b32 v172, 16, v134
    v_and_b32 v173, 0xffff0000, v134
    v_lshlrev_b32 v174, 16, v135
    v_and_b32 v175, 0xffff0000, v135
    v_lshlrev_b32 v176, 16, v136
    v_and_b32 v177, 0xffff0000, v136
    v_lshlrev_b32 v178, 16, v137
    v_and_b32 v179, 0xffff0000, v137
    v_lshlrev_b32 v180, 16, v138
    v_and_b32 v181, 0xffff0000, v138
    v_lshlrev_b32 v182, 16, v139
    v_and_b32 v183, 0xffff0000, v139
    v_lshlrev_b32 v184, 16, v140
    v_and_b32 v185, 0xffff0000, v140
    v_lshlrev_b32 v186, 16, v141
    v_and_b32 v187, 0xffff0000, v141
    v_lshlrev_b32 v188, 16, v142
    v_and_b32 v189, 0xffff0000, v142
    v_lshlrev_b32 v190, 16, v143
    v_and_b32 v191, 0xffff0000, v143
    v_add_f32 v32, v32, v160
    v_add_f32 v33, v33, v161
    v_add_f32 v34, v34, v162
    v_add_f32 v35, v35, v163
    v_add_f32 v36, v36, v164
    v_add_f32 v37, v37, v165
    v_add_f32 v38, v38, v166
    v_add_f32 v39, v39, v167
    v_add_f32 v40, v40, v168
    v_add_f32 v41, v41, v169
    v_add_f32 v42, v42, v170
    v_add_f32 v43, v43, v171
    v_add_f32 v44, v44, v172
    v_add_f32 v45, v45, v173
    v_add_f32 v46, v46, v174
    v_add_f32 v47, v47, v175
    v_add_f32 v48, v48, v176
    v_add_f32 v49, v49, v177
    v_add_f32 v50, v50, v178
    v_add_f32 v51, v51, v179
    v_add_f32 v52, v52, v180
    v_add_f32 v53, v53, v181
    v_add_f32 v54, v54, v182
    v_add_f32 v55, v55, v183
    v_add_f32 v56, v56, v184
    v_add_f32 v57, v57, v185
    v_add_f32 v58, v58, v186
    v_add_f32 v59, v59, v187
    v_add_f32 v60, v60, v188
    v_add_f32 v61, v61, v189
    v_add_f32 v62, v62, v190
    v_add_f32 v63, v63, v191
    v_cvt_pk_bf16_f32 v64, v32, v33
    v_cvt_pk_bf16_f32 v66, v36, v37
    v_cvt_pk_bf16_f32 v65, v34, v35
    v_cvt_pk_bf16_f32 v67, v38, v39
    v_permlane16_swap_b32 v64, v66
    s_nop 0
    v_permlane16_swap_b32 v65, v67
    buffer_store_dwordx4 v[64:67], v3, s[12:15], s63 offen offset:0
    v_cvt_pk_bf16_f32 v68, v40, v41
    v_cvt_pk_bf16_f32 v70, v44, v45
    v_cvt_pk_bf16_f32 v69, v42, v43
    v_cvt_pk_bf16_f32 v71, v46, v47
    v_permlane16_swap_b32 v68, v70
    s_nop 0
    v_permlane16_swap_b32 v69, v71
    buffer_store_dwordx4 v[68:71], v3, s[12:15], s63 offen offset:64
    v_cvt_pk_bf16_f32 v72, v48, v49
    v_cvt_pk_bf16_f32 v74, v52, v53
    v_cvt_pk_bf16_f32 v73, v50, v51
    v_cvt_pk_bf16_f32 v75, v54, v55
    v_permlane16_swap_b32 v72, v74
    s_nop 0
    v_permlane16_swap_b32 v73, v75
    buffer_store_dwordx4 v[72:75], v3, s[12:15], s34 offen offset:0
    v_cvt_pk_bf16_f32 v76, v56, v57
    v_cvt_pk_bf16_f32 v78, v60, v61
    v_cvt_pk_bf16_f32 v77, v58, v59
    v_cvt_pk_bf16_f32 v79, v62, v63
    v_permlane16_swap_b32 v76, v78
    s_nop 0
    v_permlane16_swap_b32 v77, v79
    buffer_store_dwordx4 v[76:79], v3, s[12:15], s34 offen offset:64
    s_branch L_done
L_restart:
    s_mov_b32 s38, 1
    s_waitcnt vmcnt(0) lgkmcnt(0)
    s_barrier
    s_branch L_start
L_maxpass:
    s_waitcnt vmcnt(0) lgkmcnt(0)
    s_barrier
    v_mov_b32 v110, 0xff800000
    s_mov_b32 s25, s29
    s_xor_b32 s50, s25, s49
    s_mov_b32 s36, 0
L_maxloop0:
    s_add_u32 m0, s29, 0
    s_nop 0
    buffer_load_dwordx4 v25, s[4:7], s50 offen nt lds
    buffer_load_dwordx4 v26, s[4:7], s50 offen offset:1024 nt lds
    s_add_u32 s25, s25, 8192
    s_xor_b32 s50, s25, s49
    s_waitcnt vmcnt(0)
    s_barrier
    ds_read_b128 a[0:3], v17 offset:0
    ds_read_b128 a[4:7], v18 offset:0
    ds_read_b128 a[8:11], v19 offset:0
    ds_read_b128 a[12:15], v20 offset:0
    ds_read_b128 a[16:19], v17 offset:4096
    ds_read_b128 a[20:23], v18 offset:4096
    ds_read_b128 a[24:27], v19 offset:4096
    ds_read_b128 a[28:31], v20 offset:4096
    s_waitcnt lgkmcnt(0)
    s_barrier
    v_mfma_f32_16x16x32_bf16 v[32:35], a[0:3], a[128:131], 0
    v_mfma_f32_16x16x32_bf16 v[32:35], a[4:7], a[132:135], v[32:35]
    v_mfma_f32_16x16x32_bf16 v[32:35], a[8:11], a[136:139], v[32:35]
    v_mfma_f32_16x16x32_bf16 v[32:35], a[12:15], a[140:143], v[32:35]
    v_mfma_f32_16x16x32_bf16 v[36:39], a[16:19], a[128:131], 0
    v_mfma_f32_16x16x32_bf16 v[36:39], a[20:23], a[132:135], v[36:39]
    v_mfma_f32_16x16x32_bf16 v[36:39], a[24:27], a[136:139], v[36:39]
    v_mfma_f32_16x16x32_bf16 v[36:39], a[28:31], a[140:143], v[36:39]
    v_mfma_f32_16x16x32_bf16 v[40:43], a[0:3], a[144:147], 0
    v_mfma_f32_16x16x32_bf16 v[40:43], a[4:7], a[148:151], v[40:43]
    v_mfma_f32_16x16x32_bf16 v[40:43], a[8:11], a[152:155], v[40:43]
    v_mfma_f32_16x16x32_bf16 v[40:43], a[12:15], a[156:159], v[40:43]
    v_mfma_f32_16x16x32_bf16 v[44:47], a[16:19], a[144:147], 0
    v_mfma_f32_16x16x32_bf16 v[44:47], a[20:23], a[148:151], v[44:47]
    v_mfma_f32_16x16x32_bf16 v[44:47], a[24:27], a[152:155], v[44:47]
    v_mfma_f32_16x16x32_bf16 v[44:47], a[28:31], a[156:159], v[44:47]
    v_mfma_f32_16x16x32_bf16 v[48:51], a[0:3], a[160:163], 0
    v_mfma_f32_16x16x32_bf16 v[48:51], a[4:7], a[164:167], v[48:51]
    v_mfma_f32_16x16x32_bf16 v[48:51], a[8:11], a[168:171], v[48:51]
    v_mfma_f32_16x16x32_bf16 v[48:51], a[12:15], a[172:175], v[48:51]
    v_mfma_f32_16x16x32_bf16 v[52:55], a[16:19], a[160:163], 0
    v_mfma_f32_16x16x32_bf16 v[52:55], a[20:23], a[164:167], v[52:55]
    v_mfma_f32_16x16x32_bf16 v[52:55], a[24:27], a[168:171], v[52:55]
    v_mfma_f32_16x16x32_bf16 v[52:55], a[28:31], a[172:175], v[52:55]
    v_mfma_f32_16x16x32_bf16 v[56:59], a[0:3], a[176:179], 0
    v_mfma_f32_16x16x32_bf16 v[56:59], a[4:7], a[180:183], v[56:59]
    v_mfma_f32_16x16x32_bf16 v[56:59], a[8:11], a[184:187], v[56:59]
    v_mfma_f32_16x16x32_bf16 v[56:59], a[12:15], a[188:191], v[56:59]
    v_mfma_f32_16x16x32_bf16 v[60:63], a[16:19], a[176:179], 0
    v_mfma_f32_16x16x32_bf16 v[60:63], a[20:23], a[180:183], v[60:63]
    v_mfma_f32_16x16x32_bf16 v[60:63], a[24:27], a[184:187], v[60:63]
    v_mfma_f32_16x16x32_bf16 v[60:63], a[28:31], a[188:191], v[60:63]
    s_nop 7
    v_max3_f32 v108, v108, v32, v33
    v_max3_f32 v108, v108, v34, v35
    v_max3_f32 v108, v108, v36, v37
    v_max3_f32 v108, v108, v38, v39
    v_max3_f32 v109, v109, v40, v41
    v_max3_f32 v109, v109, v42, v43
    v_max3_f32 v109, v109, v44, v45
    v_max3_f32 v109, v109, v46, v47
    v_max3_f32 v110, v110, v48, v49
    v_max3_f32 v110, v110, v50, v51
    v_max3_f32 v110, v110, v52, v53
    v_max3_f32 v110, v110, v54, v55
    v_max3_f32 v111, v111, v56, v57
    v_max3_f32 v111, v111, v58, v59
    v_max3_f32 v111, v111, v60, v61
    v_max3_f32 v111, v111, v62, v63
    s_add_u32 s36, s36, 1
    s_cmp_lt_u32 s36, 32
    s_cbranch_scc1 L_maxloop0
    s_mov_b32 s36, 0
L_maxloop1:
    s_add_u32 m0, s29, 0
    s_nop 0
    buffer_load_dwordx4 v25, s[4:7], s50 offen nt lds
    buffer_load_dwordx4 v26, s[4:7], s50 offen offset:1024 nt lds
    s_add_u32 s25, s25, 8192
    s_xor_b32 s50, s25, s49
    s_waitcnt vmcnt(0)
    s_barrier
    ds_read_b128 a[0:3], v17 offset:0
    ds_read_b128 a[4:7], v18 offset:0
    ds_read_b128 a[8:11], v19 offset:0
    ds_read_b128 a[12:15], v20 offset:0
    ds_read_b128 a[16:19], v17 offset:4096
    ds_read_b128 a[20:23], v18 offset:4096
    ds_read_b128 a[24:27], v19 offset:4096
    ds_read_b128 a[28:31], v20 offset:4096
    s_waitcnt lgkmcnt(0)
    s_barrier
    v_mfma_f32_16x16x32_bf16 v[32:35], a[0:3], a[192:195], 0
    v_mfma_f32_16x16x32_bf16 v[32:35], a[4:7], a[196:199], v[32:35]
    v_mfma_f32_16x16x32_bf16 v[32:35], a[8:11], a[200:203], v[32:35]
    v_mfma_f32_16x16x32_bf16 v[32:35], a[12:15], a[204:207], v[32:35]
    v_mfma_f32_16x16x32_bf16 v[36:39], a[16:19], a[192:195], 0
    v_mfma_f32_16x16x32_bf16 v[36:39], a[20:23], a[196:199], v[36:39]
    v_mfma_f32_16x16x32_bf16 v[36:39], a[24:27], a[200:203], v[36:39]
    v_mfma_f32_16x16x32_bf16 v[36:39], a[28:31], a[204:207], v[36:39]
    v_mfma_f32_16x16x32_bf16 v[40:43], a[0:3], a[208:211], 0
    v_mfma_f32_16x16x32_bf16 v[40:43], a[4:7], a[212:215], v[40:43]
    v_mfma_f32_16x16x32_bf16 v[40:43], a[8:11], a[216:219], v[40:43]
    v_mfma_f32_16x16x32_bf16 v[40:43], a[12:15], a[220:223], v[40:43]
    v_mfma_f32_16x16x32_bf16 v[44:47], a[16:19], a[208:211], 0
    v_mfma_f32_16x16x32_bf16 v[44:47], a[20:23], a[212:215], v[44:47]
    v_mfma_f32_16x16x32_bf16 v[44:47], a[24:27], a[216:219], v[44:47]
    v_mfma_f32_16x16x32_bf16 v[44:47], a[28:31], a[220:223], v[44:47]
    v_mfma_f32_16x16x32_bf16 v[48:51], a[0:3], a[224:227], 0
    v_mfma_f32_16x16x32_bf16 v[48:51], a[4:7], a[228:231], v[48:51]
    v_mfma_f32_16x16x32_bf16 v[48:51], a[8:11], a[232:235], v[48:51]
    v_mfma_f32_16x16x32_bf16 v[48:51], a[12:15], a[236:239], v[48:51]
    v_mfma_f32_16x16x32_bf16 v[52:55], a[16:19], a[224:227], 0
    v_mfma_f32_16x16x32_bf16 v[52:55], a[20:23], a[228:231], v[52:55]
    v_mfma_f32_16x16x32_bf16 v[52:55], a[24:27], a[232:235], v[52:55]
    v_mfma_f32_16x16x32_bf16 v[52:55], a[28:31], a[236:239], v[52:55]
    v_mfma_f32_16x16x32_bf16 v[56:59], a[0:3], a[240:243], 0
    v_mfma_f32_16x16x32_bf16 v[56:59], a[4:7], a[244:247], v[56:59]
    v_mfma_f32_16x16x32_bf16 v[56:59], a[8:11], a[248:251], v[56:59]
    v_mfma_f32_16x16x32_bf16 v[56:59], a[12:15], a[252:255], v[56:59]
    v_mfma_f32_16x16x32_bf16 v[60:63], a[16:19], a[240:243], 0
    v_mfma_f32_16x16x32_bf16 v[60:63], a[20:23], a[244:247], v[60:63]
    v_mfma_f32_16x16x32_bf16 v[60:63], a[24:27], a[248:251], v[60:63]
    v_mfma_f32_16x16x32_bf16 v[60:63], a[28:31], a[252:255], v[60:63]
    s_nop 7
    v_max3_f32 v21, v21, v32, v33
    v_max3_f32 v21, v21, v34, v35
    v_max3_f32 v21, v21, v36, v37
    v_max3_f32 v21, v21, v38, v39
    v_max3_f32 v22, v22, v40, v41
    v_max3_f32 v22, v22, v42, v43
    v_max3_f32 v22, v22, v44, v45
    v_max3_f32 v22, v22, v46, v47
    v_max3_f32 v23, v23, v48, v49
    v_max3_f32 v23, v23, v50, v51
    v_max3_f32 v23, v23, v52, v53
    v_max3_f32 v23, v23, v54, v55
    v_max3_f32 v24, v24, v56, v57
    v_max3_f32 v24, v24, v58, v59
    v_max3_f32 v24, v24, v60, v61
    v_max3_f32 v24, v24, v62, v63
    s_add_u32 s36, s36, 1
    s_cmp_lt_u32 s36, 32
    s_cbranch_scc1 L_maxloop1
    s_lshl_b32 s3, s2, 13
    s_add_u32 s3, s3, s29
    buffer_store_dword v108, v29, s[96:99], s3 offen offset:0 sc1
    buffer_store_dword v109, v29, s[96:99], s3 offen offset:4 sc1
    buffer_store_dword v110, v29, s[96:99], s3 offen offset:8 sc1
    buffer_store_dword v111, v29, s[96:99], s3 offen offset:12 sc1
    buffer_store_dword v21, v29, s[96:99], s3 offen offset:1024 sc1
    buffer_store_dword v22, v29, s[96:99], s3 offen offset:1028 sc1
    buffer_store_dword v23, v29, s[96:99], s3 offen offset:1032 sc1
    buffer_store_dword v24, v29, s[96:99], s3 offen offset:1036 sc1
    s_mov_b32 s38, 2
    s_waitcnt vmcnt(0) lgkmcnt(0)
    s_barrier
    s_branch L_start
L_mgload:
    s_lshl_b32 s3, s2, 13
    s_add_u32 s3, s3, s29
    v_lshlrev_b32 v6, 4, v0
    buffer_load_dword v108, v6, s[96:99], s3 offen offset:0 sc1
    buffer_load_dword v109, v6, s[96:99], s3 offen offset:4 sc1
    buffer_load_dword v110, v6, s[96:99], s3 offen offset:8 sc1
    buffer_load_dword v111, v6, s[96:99], s3 offen offset:12 sc1
    buffer_load_dword v21, v6, s[96:99], s3 offen offset:1024 sc1
    buffer_load_dword v22, v6, s[96:99], s3 offen offset:1028 sc1
    buffer_load_dword v23, v6, s[96:99], s3 offen offset:1032 sc1
    buffer_load_dword v24, v6, s[96:99], s3 offen offset:1036 sc1
    s_waitcnt vmcnt(0)
    s_branch L_mgback
L_alt1:
    v_mul_f32 v32, s46, v32
    v_exp_f32 v32, v32
    v_mul_f32 v33, s46, v33
    ds_read_b64_tr_b16 a[92:93], v15 offset:16384
    v_add_f32 v112, v112, v32
    v_exp_f32 v33, v33
    v_mul_f32 v34, s46, v34
    v_add_f32 v112, v112, v33
    v_cvt_pk_bf16_f32 v64, v32, v33
    v_exp_f32 v34, v34
    v_mul_f32 v35, s46, v35
    ds_read_b64_tr_b16 a[94:95], v15 offset:20480
    v_add_f32 v112, v112, v34
    v_exp_f32 v35, v35
    v_mul_f32 v36, s46, v36
    ds_read_b128 a[48:51], v17 offset:28672
    v_cvt_pk_bf16_f32 v65, v34, v35
    v_exp_f32 v36, v36
    v_mul_f32 v37, s46, v37
    ds_read_b128 a[52:55], v18 offset:28672
    v_add_f32 v112, v112, v35
    v_exp_f32 v37, v37
    v_mul_f32 v38, s46, v38
    v_add_f32 v112, v112, v36
    v_cvt_pk_bf16_f32 v66, v36, v37
    v_exp_f32 v38, v38
    v_mul_f32 v39, s46, v39
    ds_read_b128 a[56:59], v19 offset:28672
    v_add_f32 v112, v112, v37
    v_exp_f32 v39, v39
    s_waitcnt vmcnt(8) lgkmcnt(15)
    ds_read_b128 a[60:63], v20 offset:28672
    v_cvt_pk_bf16_f32 v67, v38, v39
    s_branch L_altb1
L_alt2:
    v_mul_f32 v32, s46, v32
    v_exp_f32 v32, v32
    v_mul_f32 v33, s46, v33
    ds_read_b64_tr_b16 a[124:125], v15 offset:24576
    v_add_f32 v112, v112, v32
    v_exp_f32 v33, v33
    v_mul_f32 v34, s46, v34
    v_add_f32 v112, v112, v33
    v_cvt_pk_bf16_f32 v64, v32, v33
    v_exp_f32 v34, v34
    v_mul_f32 v35, s46, v35
    ds_read_b64_tr_b16 a[126:127], v15 offset:28672
    v_add_f32 v112, v112, v34
    v_exp_f32 v35, v35
    v_mul_f32 v36, s46, v36
    ds_read_b128 a[16:19], v17 offset:36864
    v_cvt_pk_bf16_f32 v65, v34, v35
    v_exp_f32 v36, v36
    v_mul_f32 v37, s46, v37
    ds_read_b128 a[20:23], v18 offset:36864
    v_add_f32 v112, v112, v35
    v_exp_f32 v37, v37
    v_mul_f32 v38, s46, v38
    v_add_f32 v112, v112, v36
    v_cvt_pk_bf16_f32 v66, v36, v37
    v_exp_f32 v38, v38
    v_mul_f32 v39, s46, v39
    ds_read_b128 a[24:27], v19 offset:36864
    v_add_f32 v112, v112, v37
    v_exp_f32 v39, v39
    s_waitcnt vmcnt(8) lgkmcnt(15)
    ds_read_b128 a[28:31], v20 offset:36864
    v_cvt_pk_bf16_f32 v67, v38, v39
    s_branch L_altb2
L_alt3:
    v_mul_f32 v32, s46, v32
    v_exp_f32 v32, v32
    v_mul_f32 v33, s46, v33
    ds_read_b64_tr_b16 a[92:93], v15 offset:32768
    v_add_f32 v112, v112, v32
    v_exp_f32 v33, v33
    v_mul_f32 v34, s46, v34
    v_add_f32 v112, v112, v33
    v_cvt_pk_bf16_f32 v64, v32, v33
    v_exp_f32 v34, v34
    v_mul_f32 v35, s46, v35
    ds_read_b64_tr_b16 a[94:95], v15 offset:36864
    v_add_f32 v112, v112, v34
    v_exp_f32 v35, v35
    v_mul_f32 v36, s46, v36
    ds_read_b128 a[48:51], v17 offset:45056
    v_cvt_pk_bf16_f32 v65, v34, v35
    v_exp_f32 v36, v36
    v_mul_f32 v37, s46, v37
    ds_read_b128 a[52:55], v18 offset:45056
    v_add_f32 v112, v112, v35
    v_exp_f32 v37, v37
    v_mul_f32 v38, s46, v38
    v_add_f32 v112, v112, v36
    v_cvt_pk_bf16_f32 v66, v36, v37
    v_exp_f32 v38, v38
    v_mul_f32 v39, s46, v39
    ds_read_b128 a[56:59], v19 offset:45056
    v_add_f32 v112, v112, v37
    v_exp_f32 v39, v39
    s_waitcnt vmcnt(9) lgkmcnt(15)
    ds_read_b128 a[60:63], v20 offset:45056
    v_cvt_pk_bf16_f32 v67, v38, v39
    s_branch L_altb3
L_alt4:
    v_mul_f32 v32, s46, v32
    v_exp_f32 v32, v32
    v_mul_f32 v33, s46, v33
    ds_read_b64_tr_b16 a[124:125], v15 offset:40960
    v_add_f32 v112, v112, v32
    v_exp_f32 v33, v33
    v_mul_f32 v34, s46, v34
    v_add_f32 v112, v112, v33
    v_cvt_pk_bf16_f32 v64, v32, v33
    v_exp_f32 v34, v34
    v_mul_f32 v35, s46, v35
    ds_read_b64_tr_b16 a[126:127], v15 offset:45056
    v_add_f32 v112, v112, v34
    v_exp_f32 v35, v35
    v_mul_f32 v36, s46, v36
    ds_read_b128 a[16:19], v17 offset:53248
    v_cvt_pk_bf16_f32 v65, v34, v35
    v_exp_f32 v36, v36
    v_mul_f32 v37, s46, v37
    ds_read_b128 a[20:23], v18 offset:53248
    v_add_f32 v112, v112, v35
    v_exp_f32 v37, v37
    v_mul_f32 v38, s46, v38
    v_add_f32 v112, v112, v36
    v_cvt_pk_bf16_f32 v66, v36, v37
    v_exp_f32 v38, v38
    v_mul_f32 v39, s46, v39
    ds_read_b128 a[24:27], v19 offset:53248
    v_add_f32 v112, v112, v37
    v_exp_f32 v39, v39
    s_waitcnt vmcnt(9) lgkmcnt(15)
    ds_read_b128 a[28:31], v20 offset:53248
    v_cvt_pk_bf16_f32 v67, v38, v39
    s_branch L_altb4
L_alt5:
    v_mul_f32 v32, s46, v32
    v_exp_f32 v32, v32
    v_mul_f32 v33, s46, v33
    ds_read_b64_tr_b16 a[92:93], v15 offset:49152
    v_add_f32 v112, v112, v32
    v_exp_f32 v33, v33
    v_mul_f32 v34, s46, v34
    v_add_f32 v112, v112, v33
    v_cvt_pk_bf16_f32 v64, v32, v33
    v_exp_f32 v34, v34
    v_mul_f32 v35, s46, v35
    ds_read_b64_tr_b16 a[94:95], v15 offset:53248
    v_add_f32 v112, v112, v34
    v_exp_f32 v35, v35
    v_mul_f32 v36, s46, v36
    ds_read_b128 a[48:51], v17 offset:61440
    v_cvt_pk_bf16_f32 v65, v34, v35
    v_exp_f32 v36, v36
    v_mul_f32 v37, s46, v37
    ds_read_b128 a[52:55], v18 offset:61440
    v_add_f32 v112, v112, v35
    v_exp_f32 v37, v37
    v_mul_f32 v38, s46, v38
    v_add_f32 v112, v112, v36
    v_cvt_pk_bf16_f32 v66, v36, v37
    v_exp_f32 v38, v38
    v_mul_f32 v39, s46, v39
    ds_read_b128 a[56:59], v19 offset:61440
    v_add_f32 v112, v112, v37
    v_exp_f32 v39, v39
    s_waitcnt vmcnt(8) lgkmcnt(15)
    ds_read_b128 a[60:63], v20 offset:61440
    v_cvt_pk_bf16_f32 v67, v38, v39
    s_branch L_altb5
L_alt6:
    v_mul_f32 v32, s46, v32
    v_exp_f32 v32, v32
    v_mul_f32 v33, s46, v33
    ds_read_b64_tr_b16 a[124:125], v15 offset:57344
    v_add_f32 v112, v112, v32
    v_exp_f32 v33, v33
    v_mul_f32 v34, s46, v34
    v_add_f32 v112, v112, v33
    v_cvt_pk_bf16_f32 v64, v32, v33
    v_exp_f32 v34, v34
    v_mul_f32 v35, s46, v35
    ds_read_b64_tr_b16 a[126:127], v15 offset:61440
    v_add_f32 v112, v112, v34
    v_exp_f32 v35, v35
    v_mul_f32 v36, s46, v36
    ds_read_b128 a[16:19], v17 offset:4096
    v_cvt_pk_bf16_f32 v65, v34, v35
    v_exp_f32 v36, v36
    v_mul_f32 v37, s46, v37
    ds_read_b128 a[20:23], v18 offset:4096
    v_add_f32 v112, v112, v35
    v_exp_f32 v37, v37
    v_mul_f32 v38, s46, v38
    v_add_f32 v112, v112, v36
    v_cvt_pk_bf16_f32 v66, v36, v37
    s_add_u32 s36, s36, 1
    v_exp_f32 v38, v38
    v_mul_f32 v39, s46, v39
    ds_read_b128 a[24:27], v19 offset:4096
    v_add_f32 v112, v112, v37
    s_bitcmp0_b32 s33, s36
    v_exp_f32 v39, v39
    s_waitcnt vmcnt(8) lgkmcnt(15)
    ds_read_b128 a[28:31], v20 offset:4096
    v_cvt_pk_bf16_f32 v67, v38, v39
    s_branch L_altb6
L_alt7:
    v_mul_f32 v32, s46, v32
    v_exp_f32 v32, v32
    v_mul_f32 v33, s46, v33
    ds_read_b64_tr_b16 a[92:93], v15 offset:0
    v_add_f32 v112, v112, v32
    v_exp_f32 v33, v33
    v_mul_f32 v34, s46, v34
    v_add_f32 v112, v112, v33
    v_cvt_pk_bf16_f32 v64, v32, v33
    v_exp_f32 v34, v34
    v_mul_f32 v35, s46, v35
    ds_read_b64_tr_b16 a[94:95], v15 offset:4096
    v_add_f32 v112, v112, v34
    v_exp_f32 v35, v35
    v_mul_f32 v36, s46, v36
    ds_read_b128 a[48:51], v17 offset:12288
    v_cvt_pk_bf16_f32 v65, v34, v35
    v_exp_f32 v36, v36
    v_mul_f32 v37, s46, v37
    ds_read_b128 a[52:55], v18 offset:12288
    v_add_f32 v112, v112, v35
    v_exp_f32 v37, v37
    v_mul_f32 v38, s46, v38
    v_add_f32 v112, v112, v36
    v_cvt_pk_bf16_f32 v66, v36, v37
    v_exp_f32 v38, v38
    v_mul_f32 v39, s46, v39
    ds_read_b128 a[56:59], v19 offset:12288
    v_add_f32 v112, v112, v37
    v_exp_f32 v39, v39
    s_waitcnt vmcnt(8) lgkmcnt(15)
    ds_read_b128 a[60:63], v20 offset:12288
    v_cvt_pk_bf16_f32 v67, v38, v39
    s_branch L_altb7
L_alt0:
    v_mul_f32 v32, s46, v32
    v_exp_f32 v32, v32
    v_mul_f32 v33, s46, v33
    ds_read_b64_tr_b16 a[124:125], v15 offset:8192
    v_add_f32 v112, v112, v32
    v_exp_f32 v33, v33
    v_mul_f32 v34, s46, v34
    v_add_f32 v112, v112, v33
    v_cvt_pk_bf16_f32 v64, v32, v33
    v_exp_f32 v34, v34
    v_mul_f32 v35, s46, v35
    ds_read_b64_tr_b16 a[126:127], v15 offset:12288
    v_add_f32 v112, v112, v34
    v_exp_f32 v35, v35
    v_mul_f32 v36, s46, v36
    ds_read_b128 a[16:19], v17 offset:20480
    v_cvt_pk_bf16_f32 v65, v34, v35
    v_exp_f32 v36, v36
    v_mul_f32 v37, s46, v37
    ds_read_b128 a[20:23], v18 offset:20480
    v_add_f32 v112, v112, v35
    v_exp_f32 v37, v37
    v_mul_f32 v38, s46, v38
    v_add_f32 v112, v112, v36
    v_cvt_pk_bf16_f32 v66, v36, v37
    v_exp_f32 v38, v38
    v_mul_f32 v39, s46, v39
    ds_read_b128 a[24:27], v19 offset:20480
    v_add_f32 v112, v112, v37
    v_exp_f32 v39, v39
    s_waitcnt vmcnt(8) lgkmcnt(15)
    ds_read_b128 a[28:31], v20 offset:20480
    v_cvt_pk_bf16_f32 v67, v38, v39
    s_branch L_altb0
L_spin0:
    s_mov_b32 s3, 0
    v_mov_b32 v120, 0
L_spin0_l:
    s_sleep 4
    buffer_load_dword v16, v30, s[96:99], 0 offen offset:0 sc1
    s_waitcnt vmcnt(0)
    v_readfirstlane_b32 s40, v16
    s_add_u32 s3, s3, 1
    s_cmp_ge_u32 s3, 0x40000
    s_cbranch_scc1 L_spin0b
    s_cmp_ge_u32 s40, 16
    s_cbranch_scc0 L_spin0_l
    s_branch L_spin0b
L_spin1:
    s_mov_b32 s3, 0
    v_mov_b32 v120, 0
L_spin1_l:
    s_sleep 4
    buffer_load_dword v16, v30, s[96:99], 0 offen offset:256 sc1
    s_waitcnt vmcnt(0)
    v_readfirstlane_b32 s40, v16
    s_add_u32 s3, s3, 1
    s_cmp_ge_u32 s3, 0x40000
    s_cbranch_scc1 L_spin1b
    s_cmp_ge_u32 s40, 16
    s_cbranch_scc0 L_spin1_l
    s_branch L_spin1b
L_spin3:
    s_mov_b32 s3, 0
    v_mov_b32 v120, 0
L_spin3_l:
    s_sleep 4
    buffer_load_dword v16, v30, s[96:99], s55 offen sc1
    s_waitcnt vmcnt(0)
    v_readfirstlane_b32 s40, v16
    s_add_u32 s3, s3, 1
    s_cmp_ge_u32 s3, 0x40000
    s_cbranch_scc1 L_spin3b
    s_cmp_ge_u32 s40, 1
    s_cbranch_scc0 L_spin3_l
    s_branch L_spin3b
L_spin2:
    s_mov_b32 s3, 0
    v_mov_b32 v120, 0
L_spin2_l:
    s_sleep 4
    global_load_dword v16, v120, s[84:85] sc1
    s_waitcnt vmcnt(0)
    v_readfirstlane_b32 s40, v16
    s_add_u32 s3, s3, 1
    s_cmp_ge_u32 s3, 0x40000
    s_cbranch_scc1 L_spin2b
    s_cmp_ge_u32 s40, 16
    s_cbranch_scc0 L_spin2_l
    s_branch L_spin2b
L_announce:
    v_mov_b32 v6, 0
    v_mov_b32 v7, 1
    s_mov_b64 exec, 1
    global_atomic_add v6, v7, s[84:85]
    s_mov_b64 exec, -1
    s_branch L_annback
L_done:
L_end:
    s_endpgm
L_codeend:
.section .rodata,"a"
.p2align 6
.amdhsa_kernel concat_heads__mha_block_cached__gqa_block_cached__near_ridge_kernel
  .amdhsa_next_free_vgpr 512
  .amdhsa_next_free_sgpr 102
  .amdhsa_accum_offset 256
  .amdhsa_group_segment_fixed_size 0
  .amdhsa_kernarg_size 104
  .amdhsa_user_sgpr_count 2
  .amdhsa_user_sgpr_kernarg_segment_ptr 1
  .amdhsa_system_sgpr_workgroup_id_x 1
.end_amdhsa_kernel
```
